```python
import torch

def _softmax(x, axis=-1):
    return torch.softmax(x, dim=axis)
def _gelu(x):
    return torch.nn.functional.gelu(x, approximate="tanh")
def _silu(x):
    return torch.nn.functional.silu(x)
def _sigmoid(x):
    return torch.sigmoid(x)
def _layernorm(x, axis=-1, eps=1e-5):
    m = x.mean(dim=axis, keepdim=True)
    v = x.var(dim=axis, keepdim=True, unbiased=False)
    return (x - m) / torch.sqrt(v + eps)
def _scatter_add(tgt, idx, src, axis=0):
    return tgt.clone().index_add_(axis, idx, src)
def _segment_sum(src, seg, n):
    out = torch.zeros((n,) + src.shape[1:], dtype=src.dtype)
    return out.index_add_(0, seg, src)
def _pad(x, pw):
    flat = tuple(v for pair in reversed(pw) for v in pair)
    return torch.nn.functional.pad(x, flat)

kernel_name = 'gated_mix__sliding_local_dilated__dense_activation_squared_relu__prompt'

def setup_inputs():

    _w = (lambda a: (lambda t: t.to(torch.bfloat16) if t.is_floating_point() else t)(torch.as_tensor(a)))
    def _A_setup():
        B, S, D = 1, 2048, 576
        return {
            "x": _w((lambda *s: torch.randn(*s, dtype=torch.bfloat16) * 0.05)(B, S, D)),
            "wqkv": _w((lambda *s: torch.randn(*s, dtype=torch.bfloat16) * 0.8)(D, 3 * D)),
            "wo": _w((lambda *s: torch.randn(*s, dtype=torch.bfloat16) * 0.05)(D, D)),
        }
    _A_in = _A_setup()

    def _B_setup():
        B, S, D, F = 1, 2048, 576, 4608
        return {
            "x": _w((lambda *s: torch.randn(*s, dtype=torch.bfloat16) * 0.05)(B, S, D)),
            "w1": _w((lambda *s: torch.randn(*s, dtype=torch.bfloat16) * 0.1)(D, F)),
            "b1": _w((lambda *s: torch.randn(*s, dtype=torch.bfloat16) * 0.1)(F)),
            "w2": _w((lambda *s: torch.randn(*s, dtype=torch.bfloat16) * 0.1)(F, D)),
            "b2": _w((lambda *s: torch.randn(*s, dtype=torch.bfloat16) * 0.2)(D)),
        }
    _B_in = _B_setup()

    return {
        "A_x": _A_in["x"],
        "A_wqkv": _A_in["wqkv"],
        "A_wo": _A_in["wo"],
        "B_x": _B_in["x"],
        "B_w1": _B_in["w1"],
        "B_b1": _B_in["b1"],
        "B_w2": _B_in["w2"],
        "B_b2": _B_in["b2"],
        "gate_w": _w((lambda *s: torch.randn(*s, dtype=torch.bfloat16) * 0.05)(576) * 16.0),
    }

def reference(A_x, A_wqkv, A_wo, B_x, B_w1, B_b1, B_w2, B_b2, gate_w):
    def _A_ref(x, wqkv, wo):
        B, S, D = x.shape
        H = 32; Dh = D // H
        W, dil = 8, 2
        qkv = (lambda x, *d: x.permute(*d))((x @ wqkv).reshape(B, S, 3, H, Dh), 2, 0, 3, 1, 4)
        q, k, v = qkv[0], qkv[1], qkv[2]
        scale = Dh ** -0.5
        pos = torch.arange(S)
        off = torch.arange(W) * dil
        idx = pos[:, None] - off[None, :]
        mask = idx >= 0
        idx_c = torch.where(mask, idx, 0).reshape(-1)
        kg = k[:, :, idx_c, :].reshape(B, H, S, W, Dh)
        vg = v[:, :, idx_c, :].reshape(B, H, S, W, Dh)
        logits = torch.einsum("bhsd,bhswd->bhsw", q, kg) * scale
        logits = torch.where(mask[None, None, :, :], logits, -1e9)
        attn = _softmax(logits, axis=-1)
        o = torch.einsum("bhsw,bhswd->bhsd", attn, vg)
        return (lambda x, *d: x.permute(*d))(o, 0, 2, 1, 3).reshape(B, S, D) @ wo

    def _B_ref(x, w1, b1, w2, b2):
        h = torch.einsum("bsd,df->bsf", x, w1) + b1
        zero = torch.zeros_like(h)
        r = torch.where(h > zero, h, zero)
        h = r * r
        out = torch.einsum("bsf,fd->bsd", h, w2) + b2
        return out

    x = A_x
    g = _sigmoid((x * gate_w).sum(-1, keepdims=True))
    a = _A_ref(x, A_wqkv, A_wo)
    b = _B_ref(x, B_w1, B_b1, B_w2, B_b2)
    return g * a + (1 - g) * b
```

```asm
; @launch grid=(256,1,1) block=(256,1,1) lds=163840
.amdgcn_target "amdgcn-amd-amdhsa--gfx950"
.text
.globl gated_mix__sliding_local_dilated__dense_activation_squared_relu__prompt_kernel
.p2align 12
.type gated_mix__sliding_local_dilated__dense_activation_squared_relu__prompt_kernel,@function
gated_mix__sliding_local_dilated__dense_activation_squared_relu__prompt_kernel:
    s_cmp_ge_u32 s2, 256
    s_cbranch_scc1 L_exit
    s_load_dwordx2 s[4:5], s[0:1], 0
    s_mov_b32 s6, 2359296
    s_mov_b32 s7, 0x20000
    s_load_dwordx2 s[16:17], s[0:1], 88
    s_load_dwordx2 s[24:25], s[0:1], 56
    s_load_dwordx2 s[28:29], s[0:1], 80
    s_load_dwordx2 s[32:33], s[0:1], 72
    s_load_dwordx2 s[36:37], s[0:1], 64
    v_lshrrev_b32 v1, 6, v0
    v_and_b32 v0, 63, v0
    v_readfirstlane_b32 s48, v1
    s_and_b32 s49, s2, 3
    s_bfe_u32 s50, s2, 0x10002
    s_lshl_b32 s50, s50, 3
    s_lshr_b32 s55, s2, 5
    s_add_u32 s50, s50, s55
    s_bfe_u32 s51, s2, 0x20003
    s_lshl_b32 s52, s51, 2
    s_add_u32 s52, s52, s49
    s_bfe_u32 s67, s2, 0x10002
    s_add_u32 s3, s67, s55
    s_lshl_b32 s3, s3, 7
    s_and_b32 s53, s48, 1
    s_lshr_b32 s54, s48, 1
    s_bfe_u32 s82, s52, 0x20001
    s_cmp_eq_u32 s51, 3
    s_cselect_b32 s82, 0, s82
    s_lshr_b32 s56, s82, 1
    s_xor_b32 s56, s56, s48
    s_lshl2_add_u32 s56, s50, s56
    s_and_b32 s57, s82, 1
    s_lshl_b32 s56, s56, 5
    s_add_u32 s56, s56, s57
    s_mulk_i32 s57, -2304
    s_addk_i32 s57, 1152
    v_lshrrev_b32 v64, 3, v0
    v_lshl_add_u32 v66, v64, 1, s56
    v_mul_u32_u24 v66, 1152, v66
    v_and_b32 v65, 7, v0
    v_lshrrev_b32 v67, 4, v0
    v_xor_b32 v65, v65, v67
    v_lshl_add_u32 v8, v65, 4, v66
    v_xor_b32 v9, 64, v8
    v_add_u32 v9, 18432, v9
    v_add_u32 v10, s57, v8
    v_add_u32 v11, s57, v9
    s_cmp_lg_u32 s51, 3
    s_cbranch_scc1 L_roleF
L_roleA:
    s_load_dwordx2 s[8:9], s[0:1], 8
    s_mov_b32 s10, 1990656
    s_mov_b32 s11, 0x20000
    s_load_dwordx2 s[12:13], s[0:1], 16
    s_mov_b64 exec, 0
    s_cmp_eq_u32 s48, 2
    s_cbranch_scc1 L_stubA1
    s_cmp_eq_u32 s48, 3
    s_cbranch_scc1 L_stubA2
L_jrAs:
    s_mov_b64 exec, -1
    s_lshl_b32 s55, s50, 7
    s_sub_u32 s56, s55, 16
    s_max_i32 s56, s56, 0
    s_add_u32 s56, s56, 1
    s_sub_u32 s56, s56, s53
    v_lshl_add_u32 v34, v64, 1, s56
    v_mul_u32_u24 v34, 1152, v34
    s_lshl_b32 s56, s53, 2
    v_xor_b32 v35, s56, v65
    v_lshl_add_u32 v12, v35, 4, v34
    s_mul_i32 s58, s48, 6912
    s_lshl_b32 s60, s48, 12
    s_add_u32 s60, s60, 111616
    s_lshl_b32 s61, s53, 10
    s_add_u32 s61, s61, 128000
    s_and_b32 s55, s50, 7
    s_and_b32 s56, s49, 2
    s_add_u32 s55, s55, s56
    s_sub_u32 s56, s55, 6
    s_min_u32 s55, s55, s56
    s_and_b32 s66, s55, 1
    s_add_u32 s23, s55, 12
    s_and_b32 s55, s55, 6
    s_xor_b32 s56, s67, s49
    s_and_b32 s56, s56, 1
    s_add_u32 s55, s55, s56
    s_mul_i32 s46, s55, 128
    s_mul_i32 s47, s55, 221184
    s_mul_i32 s56, s66, 110592
    s_add_u32 s47, s47, s56
    s_lshl_b32 s56, s56, 1
    s_sub_u32 s68, 110592, s56
    s_add_u32 s69, 110592, s56
    s_lshl_b32 s55, s53, 4
    s_lshl_b32 s56, s54, 2
    s_add_u32 s55, s55, s56
    s_mul_i32 s55, s55, 3456
    s_mul_i32 s64, s49, 288
    s_add_u32 s55, s55, s64
    s_movk_i32 s20, 864
    s_mul_i32 s56, s53, -96768
    s_add_u32 s56, s56, 13824
    s_cmp_eq_u32 s48, 3
    s_cselect_b32 s56, 0x40000000, s56
    v_mul_u32_u24 v33, 3641, v0
    v_lshl_add_u32 v34, v0, 4, s55
    v_cmp_lt_u32 vcc, 23, v0
    v_lshrrev_b32 v32, 16, v33
    v_mad_u32_u24 v1, v32, s20, v34
    v_add_u32 v33, 233024, v33
    v_add_u32 v34, 1024, v34
    v_lshrrev_b32 v32, 16, v33
    v_mad_u32_u24 v2, v32, s20, v34
    v_add_u32 v33, 233024, v33
    v_add_u32 v34, 1024, v34
    v_lshrrev_b32 v32, 16, v33
    v_mad_u32_u24 v3, v32, s20, v34
    v_add_u32 v33, 233024, v33
    v_add_u32 v34, 1024, v34
    v_lshrrev_b32 v32, 16, v33
    v_mad_u32_u24 v4, v32, s20, v34
    v_add_u32 v32, 13824, v4
    v_cndmask_b32 v4, v4, v32, vcc
    v_add_u32 v33, 233024, v33
    v_add_u32 v34, 14848, v34
    v_lshrrev_b32 v32, 16, v33
    v_mad_u32_u24 v5, v32, s20, v34
    v_add_u32 v33, 233024, v33
    v_add_u32 v34, 1024, v34
    v_lshrrev_b32 v32, 16, v33
    v_mad_u32_u24 v6, v32, s20, v34
    v_add_u32 v33, 233024, v33
    v_add_u32 v34, 1024, v34
    v_lshrrev_b32 v32, 16, v33
    v_mad_u32_u24 v7, v32, s20, v34
    v_add_u32 v32, s56, v7
    v_cmp_lt_u32 vcc, 47, v0
    s_nop 1
    v_cndmask_b32 v7, v7, v32, vcc
    s_waitcnt lgkmcnt(0)
    s_add_u32 m0, s60, 0
    s_nop 0
    buffer_load_dwordx4 v8, s[4:7], s46 offen lds
    s_addk_i32 m0, 1024
    s_nop 0
    buffer_load_dwordx4 v9, s[4:7], s46 offen lds
    s_addk_i32 m0, 1024
    s_nop 0
    buffer_load_dwordx4 v10, s[4:7], s46 offen lds
    s_addk_i32 m0, 1024
    s_nop 0
    buffer_load_dwordx4 v11, s[4:7], s46 offen lds
    s_add_u32 m0, s61, 0
    s_nop 0
    buffer_load_dwordx4 v12, s[4:7], s46 offen lds
    s_add_u32 m0, s58, 0
    s_nop 0
    buffer_load_dwordx4 v1, s[8:11], s47 offen lds
    s_addk_i32 m0, 1024
    s_nop 0
    buffer_load_dwordx4 v2, s[8:11], s47 offen lds
    s_addk_i32 m0, 1024
    s_nop 0
    buffer_load_dwordx4 v3, s[8:11], s47 offen lds
    s_addk_i32 m0, 1024
    s_nop 0
    buffer_load_dwordx4 v4, s[8:11], s47 offen lds
    s_addk_i32 m0, 1024
    s_nop 0
    buffer_load_dwordx4 v5, s[8:11], s47 offen lds
    s_addk_i32 m0, 1024
    s_nop 0
    buffer_load_dwordx4 v6, s[8:11], s47 offen lds
    s_bfe_u32 s55, s50, 0x20001
    s_lshl_b32 s55, s55, 24
    s_and_b32 s56, s50, 1
    s_lshl_b32 s56, s56, 21
    s_add_u32 s55, s55, s56
    s_add_u32 s43, s55, 67108864
    s_mov_b32 s83, 0xffff0000
    s_mov_b64 exec, 0
    s_cmp_eq_u32 s48, 0
    s_cbranch_scc1 L_stubA3
    s_cmp_eq_u32 s48, 1
    s_cbranch_scc1 L_stubA4
L_jrA0:
    s_mov_b64 exec, -1
    s_branch L_splitA
L_roleF:
    s_load_dwordx2 s[8:9], s[0:1], 32
    s_load_dwordx2 s[20:21], s[0:1], 40
    s_mov_b32 s10, 5308416
    s_mov_b32 s11, 0x20000
    s_mov_b32 s22, 9216
    s_mov_b32 s23, 0x20000
    s_load_dwordx2 s[12:13], s[0:1], 48
    s_mov_b64 exec, 0
    s_cmp_eq_u32 s48, 2
    s_cbranch_scc1 L_stubF1
    s_cmp_eq_u32 s48, 3
    s_cbranch_scc1 L_stubF2
L_jrFs:
    s_mov_b64 exec, -1
    s_mul_i32 s64, s49, 3
    s_add_u32 s64, s64, s51
    s_mul_i32 s65, s64, 768
    s_and_b32 s56, s49, 2
    s_add_u32 s55, s55, s56
    s_sub_u32 s56, s55, 6
    s_min_u32 s55, s55, s56
    s_and_b32 s56, s55, 1
    s_mul_i32 s56, s56, 5
    s_add_u32 s56, s56, s55
    s_lshl_b32 s70, s56, 6
    s_and_b32 s55, s55, 6
    s_xor_b32 s56, s67, s49
    s_and_b32 s56, s56, 1
    s_add_u32 s55, s55, s56
    s_mul_i32 s46, s55, 128
    s_mul_i32 s47, s55, 589824
    s_add_u32 s55, s70, 128
    s_cmpk_eq_u32 s55, 768
    s_cselect_b32 s71, 0, s55
    s_add_u32 s55, s71, 128
    s_cmpk_eq_u32 s55, 768
    s_cselect_b32 s72, 0, s55
    s_add_u32 s55, s72, 128
    s_cmpk_eq_u32 s55, 768
    s_cselect_b32 s73, 0, s55
    s_add_u32 s55, s73, 128
    s_cmpk_eq_u32 s55, 768
    s_cselect_b32 s74, 0, s55
    s_add_u32 s55, s74, 128
    s_cmpk_eq_u32 s55, 768
    s_cselect_b32 s75, 0, s55
    v_lshl_add_u32 v31, v0, 4, s70
    v_subrev_u32 v40, 768, v31
    v_min_u32 v31, v31, v40
    v_bfe_u32 v40, v0, 1, 2
    v_bfe_u32 v41, v0, 4, 2
    v_xor_b32 v40, v40, v41
    v_and_b32 v41, 1, v0
    v_lshlrev_b32 v41, 4, v41
    v_lshl_add_u32 v42, v40, 5, v41
    v_lshrrev_b32 v40, 5, v0
    v_bfe_u32 v41, v0, 3, 2
    v_lshl_add_u32 v40, v40, 3, v41
    s_lshl_b32 s55, s53, 4
    s_lshl_b32 s56, s54, 2
    s_add_u32 s55, s55, s56
    v_add_u32 v40, s55, v40
    v_mul_u32_u24 v40, 9216, v40
    v_add3_u32 v1, v40, v42, s65
    v_add_u32 v34, 294912, v1
    s_lshl_b32 s58, s48, 10
    s_lshl_b32 s60, s48, 12
    s_add_u32 s60, s60, 98304
    s_lshl_b32 s62, s48, 11
    s_waitcnt lgkmcnt(0)
    s_add_u32 m0, s60, 49152
    s_nop 0
    buffer_load_dwordx4 v31, s[20:23], s65 offen lds
    s_add_u32 m0, s60, 0
    s_nop 0
    buffer_load_dwordx4 v8, s[4:7], s46 offen lds
    s_addk_i32 m0, 1024
    s_nop 0
    buffer_load_dwordx4 v9, s[4:7], s46 offen lds
    s_addk_i32 m0, 1024
    s_nop 0
    buffer_load_dwordx4 v10, s[4:7], s46 offen lds
    s_addk_i32 m0, 1024
    s_nop 0
    buffer_load_dwordx4 v11, s[4:7], s46 offen lds
    s_add_u32 m0, s58, 0
    s_add_u32 s59, s47, s70
    buffer_load_dwordx4 v1, s[8:11], s59 offen lds
    s_addk_i32 m0, 4096
    s_add_u32 s59, s47, s70
    buffer_load_dwordx4 v34, s[8:11], s59 offen lds
    s_addk_i32 m0, 4096
    s_add_u32 s59, s47, s71
    buffer_load_dwordx4 v1, s[8:11], s59 offen lds
    s_addk_i32 m0, 4096
    s_add_u32 s59, s47, s71
    buffer_load_dwordx4 v34, s[8:11], s59 offen lds
    s_addk_i32 m0, 4096
    s_add_u32 s59, s47, s72
    buffer_load_dwordx4 v1, s[8:11], s59 offen lds
    s_addk_i32 m0, 4096
    s_add_u32 s59, s47, s72
    buffer_load_dwordx4 v34, s[8:11], s59 offen lds
    s_addk_i32 m0, 4096
    s_add_u32 s59, s47, s73
    buffer_load_dwordx4 v1, s[8:11], s59 offen lds
L_splitF:
    s_bfe_u32 s55, s50, 0x20001
    s_lshl_b32 s55, s55, 24
    s_and_b32 s56, s50, 1
    s_lshl_b32 s56, s56, 21
    s_add_u32 s55, s55, s56
    s_add_u32 s43, s55, 67108864
    s_mov_b32 s83, 0xffff0000
    s_mov_b64 exec, 0
    s_cmp_eq_u32 s48, 0
    s_cbranch_scc1 L_stubF3
    s_cmp_eq_u32 s48, 1
    s_cbranch_scc1 L_stubF4
L_jrF0:
    s_mov_b64 exec, -1
    s_lshl_b32 s55, s54, 1
    v_bfe_u32 v40, v0, 3, 2
    v_xor_b32 v40, s55, v40
    v_lshlrev_b32 v40, 5, v40
    v_and_b32 v41, 3, v0
    v_lshl_add_u32 v40, v41, 3, v40
    v_lshrrev_b32 v41, 2, v0
    v_lshl_add_u32 v4, v41, 7, v40
    v_xor_b32 v5, 32, v4
    v_add_u32 v6, 49152, v4
    v_add_u32 v7, 49152, v5
    v_and_b32 v40, 15, v0
    v_bfe_u32 v41, v0, 1, 3
    v_lshrrev_b32 v43, 4, v0
    v_xor_b32 v41, v41, v43
    v_lshlrev_b32 v41, 4, v41
    v_lshl_add_u32 v40, v40, 7, v41
    s_lshl_b32 s55, s53, 13
    s_add_u32 s55, s55, 98304
    v_add_u32 v2, s55, v40
    v_xor_b32 v3, 64, v2
    s_lshl_b32 s55, s54, 6
    s_add_u32 s55, s55, s60
    s_add_u32 s55, s55, 49152
    v_lshl_add_u32 v52, v43, 3, s55
    s_mov_b32 s14, 5308416
    s_mov_b32 s15, 0x20000
    s_mov_b32 s18, 134217728
    s_mov_b32 s19, 0x20000
    s_mov_b32 s26, 1152
    s_mov_b32 s27, 0x20000
    s_mov_b32 s30, 256
    s_mov_b32 s31, 0x20000
    s_mov_b32 s34, 2359296
    s_mov_b32 s35, 0x20000
    s_mov_b32 s38, 1152
    s_mov_b32 s39, 0x20000
    s_waitcnt vmcnt(11)
    ds_read_b64 v[68:69], v52 offset:0
    ds_read_b64 v[84:85], v52 offset:32
    ds_read_b64 v[100:101], v52 offset:128
    ds_read_b64 v[116:117], v52 offset:160
    ds_read_b64 v[132:133], v52 offset:256
    ds_read_b64 v[148:149], v52 offset:288
    ds_read_b64 v[164:165], v52 offset:384
    ds_read_b64 v[180:181], v52 offset:416
    ds_read_b64 v[196:197], v52 offset:512
    ds_read_b64 v[212:213], v52 offset:544
    ds_read_b64 v[228:229], v52 offset:640
    ds_read_b64 v[244:245], v52 offset:672
    s_addk_i32 m0, 4096
    s_add_u32 s59, s47, s73
    buffer_load_dwordx4 v34, s[8:11], s59 offen lds
    s_waitcnt lgkmcnt(0)
    v_lshlrev_b32 v76, 16, v68
    v_and_b32 v77, s83, v68
    v_lshlrev_b32 v78, 16, v69
    v_and_b32 v79, s83, v69
    v_lshlrev_b32 v92, 16, v84
    s_addk_i32 m0, 4096
    s_add_u32 s59, s47, s74
    buffer_load_dwordx4 v1, s[8:11], s59 offen lds
    v_and_b32 v93, s83, v84
    v_lshlrev_b32 v94, 16, v85
    v_and_b32 v95, s83, v85
    v_lshlrev_b32 v108, 16, v100
    v_and_b32 v109, s83, v100
    v_lshlrev_b32 v110, 16, v101
    s_addk_i32 m0, 4096
    s_add_u32 s59, s47, s74
    buffer_load_dwordx4 v34, s[8:11], s59 offen lds
    v_and_b32 v111, s83, v101
    v_lshlrev_b32 v124, 16, v116
    v_and_b32 v125, s83, v116
    v_lshlrev_b32 v126, 16, v117
    v_and_b32 v127, s83, v117
    v_lshlrev_b32 v140, 16, v132
    s_addk_i32 m0, 4096
    s_add_u32 s59, s47, s75
    buffer_load_dwordx4 v1, s[8:11], s59 offen lds
    v_and_b32 v141, s83, v132
    v_lshlrev_b32 v142, 16, v133
    v_and_b32 v143, s83, v133
    v_lshlrev_b32 v156, 16, v148
    v_and_b32 v157, s83, v148
    v_lshlrev_b32 v158, 16, v149
    s_addk_i32 m0, 4096
    s_add_u32 s59, s47, s75
    buffer_load_dwordx4 v34, s[8:11], s59 offen lds
    v_and_b32 v159, s83, v149
    v_lshlrev_b32 v172, 16, v164
    v_and_b32 v173, s83, v164
    v_lshlrev_b32 v174, 16, v165
    v_and_b32 v175, s83, v165
    v_lshlrev_b32 v188, 16, v180
    s_add_u32 s46, s46, 128
    s_sub_u32 s67, s46, 768
    s_min_u32 s46, s46, s67
    s_add_u32 m0, s60, 16384
    s_nop 0
    buffer_load_dwordx4 v8, s[4:7], s46 offen lds
    v_and_b32 v189, s83, v180
    v_lshlrev_b32 v190, 16, v181
    v_and_b32 v191, s83, v181
    v_lshlrev_b32 v204, 16, v196
    v_and_b32 v205, s83, v196
    v_lshlrev_b32 v206, 16, v197
    s_addk_i32 m0, 1024
    s_nop 0
    buffer_load_dwordx4 v9, s[4:7], s46 offen lds
    v_and_b32 v207, s83, v197
    v_lshlrev_b32 v220, 16, v212
    v_and_b32 v221, s83, v212
    v_lshlrev_b32 v222, 16, v213
    v_and_b32 v223, s83, v213
    v_lshlrev_b32 v236, 16, v228
    s_addk_i32 m0, 1024
    s_nop 0
    buffer_load_dwordx4 v10, s[4:7], s46 offen lds
    v_and_b32 v237, s83, v228
    v_lshlrev_b32 v238, 16, v229
    v_and_b32 v239, s83, v229
    v_lshlrev_b32 v252, 16, v244
    v_and_b32 v253, s83, v244
    v_lshlrev_b32 v254, 16, v245
    s_addk_i32 m0, 1024
    s_nop 0
    buffer_load_dwordx4 v11, s[4:7], s46 offen lds
    v_and_b32 v255, s83, v245
    s_waitcnt vmcnt(10)
    s_barrier
    ds_read_b128 a[96:99], v2 offset:0
    ds_read_b128 a[112:115], v3 offset:0
    ds_read_b128 a[100:103], v2 offset:2048
    ds_read_b128 a[116:119], v3 offset:2048
    ds_read_b64_tr_b16 a[0:1], v4 offset:0
    ds_read_b64_tr_b16 a[2:3], v4 offset:2048
    ds_read_b64_tr_b16 a[4:5], v5 offset:0
    ds_read_b64_tr_b16 a[6:7], v5 offset:2048
    ds_read_b64_tr_b16 a[8:9], v4 offset:4096
    ds_read_b64_tr_b16 a[10:11], v4 offset:6144
    ds_read_b64_tr_b16 a[12:13], v5 offset:4096
    ds_read_b64_tr_b16 a[14:15], v5 offset:6144
    ds_read_b64_tr_b16 a[16:17], v4 offset:8192
    ds_read_b64_tr_b16 a[18:19], v4 offset:10240
    ds_read_b64_tr_b16 a[20:21], v5 offset:8192
    ds_read_b64_tr_b16 a[22:23], v5 offset:10240
    ds_read_b64_tr_b16 a[24:25], v4 offset:12288
    ds_read_b64_tr_b16 a[26:27], v4 offset:14336
    ds_read_b64_tr_b16 a[28:29], v5 offset:12288
    ds_read_b64_tr_b16 a[30:31], v5 offset:14336
    ds_read_b64_tr_b16 a[32:33], v4 offset:16384
    ds_read_b64_tr_b16 a[34:35], v4 offset:18432
    ds_read_b64_tr_b16 a[36:37], v5 offset:16384
    ds_read_b64_tr_b16 a[38:39], v5 offset:18432
    ds_read_b64_tr_b16 a[40:41], v4 offset:20480
    ds_read_b64_tr_b16 a[42:43], v4 offset:22528
    ds_read_b64_tr_b16 a[44:45], v5 offset:20480
    ds_read_b64_tr_b16 a[46:47], v5 offset:22528
    s_waitcnt lgkmcnt(0)
L_mainF:
    v_mfma_f32_16x16x32_bf16 v[64:67], a[0:3], a[96:99], v[76:79]
    s_add_u32 s47, s47, 589824
    s_sub_u32 s67, s47, 3538944
    s_min_u32 s47, s47, s67
    v_mfma_f32_16x16x32_bf16 v[64:67], a[8:11], a[112:115], v[64:67]
    s_add_u32 m0, s58, 49152
    ds_read_b128 a[104:107], v2 offset:4096
    s_add_u32 s59, s47, s70
    v_mfma_f32_16x16x32_bf16 v[80:83], a[12:15], a[112:115], v[92:95]
    buffer_load_dwordx4 v1, s[8:11], s59 offen lds
    v_mfma_f32_16x16x32_bf16 v[80:83], a[4:7], a[96:99], v[80:83]
    s_addk_i32 m0, 4096
    ds_read_b128 a[120:123], v3 offset:4096
    s_add_u32 s59, s47, s70
    v_mfma_f32_16x16x32_bf16 v[96:99], a[16:19], a[96:99], v[108:111]
    buffer_load_dwordx4 v34, s[8:11], s59 offen lds
    v_mfma_f32_16x16x32_bf16 v[96:99], a[24:27], a[112:115], v[96:99]
    s_addk_i32 m0, 4096
    ds_read_b128 a[108:111], v2 offset:6144
    s_add_u32 s59, s47, s71
    v_mfma_f32_16x16x32_bf16 v[112:115], a[28:31], a[112:115], v[124:127]
    buffer_load_dwordx4 v1, s[8:11], s59 offen lds
    v_mfma_f32_16x16x32_bf16 v[112:115], a[20:23], a[96:99], v[112:115]
    ds_read_b128 a[124:127], v3 offset:6144
    v_mfma_f32_16x16x32_bf16 v[128:131], a[32:35], a[96:99], v[140:143]
    s_waitcnt vmcnt(7)
    v_mfma_f32_16x16x32_bf16 v[128:131], a[40:43], a[112:115], v[128:131]
    s_barrier
    ds_read_b64_tr_b16 a[48:49], v4 offset:24576
    s_lshr_b32 s55, s50, 3
    s_lshl_b32 s56, s55, 16
    s_add_u32 s56, s56, s43
    s_add_u32 s42, s56, 8929280
    s_and_b32 s56, s50, 6
    s_add_u32 s55, s55, s56
    s_and_b32 s56, s50, 1
    s_lshl1_add_u32 s55, s55, s56
    s_lshl_b32 s44, s55, 2
    s_add_u32 s56, s56, 1
    s_xor_b32 s66, s52, s56
    v_mfma_f32_16x16x32_bf16 v[144:147], a[44:47], a[112:115], v[156:159]
    ds_read_b64_tr_b16 a[50:51], v4 offset:26624
    v_mfma_f32_16x16x32_bf16 v[144:147], a[36:39], a[96:99], v[144:147]
    ds_read_b64_tr_b16 a[52:53], v5 offset:24576
    v_mfma_f32_16x16x32_bf16 v[148:151], a[36:39], a[100:103], v[156:159]
    s_addk_i32 m0, 4096
    ds_read_b64_tr_b16 a[54:55], v5 offset:26624
    s_add_u32 s59, s47, s71
    v_mfma_f32_16x16x32_bf16 v[148:151], a[44:47], a[116:119], v[148:151]
    buffer_load_dwordx4 v34, s[8:11], s59 offen lds
    v_mfma_f32_16x16x32_bf16 v[132:135], a[40:43], a[116:119], v[140:143]
    ds_read_b64_tr_b16 a[56:57], v4 offset:28672
    v_mfma_f32_16x16x32_bf16 v[132:135], a[32:35], a[100:103], v[132:135]
    s_addk_i32 m0, 4096
    ds_read_b64_tr_b16 a[58:59], v4 offset:30720
    v_mfma_f32_16x16x32_bf16 v[116:119], a[20:23], a[100:103], v[124:127]
    s_add_u32 s59, s47, s72
    ds_read_b64_tr_b16 a[60:61], v5 offset:28672
    s_lshl_b32 s56, s53, 13
    s_or_b32 s55, s66, s54
    s_cselect_b32 s55, 0x40000000, s56
    v_lshl_add_u32 v20, v0, 4, s55
    s_lshl_b32 s56, s48, 12
    s_cmp_eq_u32 s66, 0
    s_cselect_b32 s55, s56, 0x40000000
    v_lshl_add_u32 v39, v0, 4, s55
    v_lshl_add_u32 v31, v0, 8, s55
    v_mov_b32 v14, 0
    v_mov_b32 v15, 0
    v_mov_b32 v16, 0
    v_mov_b32 v17, 0
    v_mfma_f32_16x16x32_bf16 v[116:119], a[28:31], a[116:119], v[116:119]
    buffer_load_dwordx4 v1, s[8:11], s59 offen lds
    v_mfma_f32_16x16x32_bf16 v[100:103], a[24:27], a[116:119], v[108:111]
    ds_read_b64_tr_b16 a[62:63], v5 offset:30720
    v_mfma_f32_16x16x32_bf16 v[100:103], a[16:19], a[100:103], v[100:103]
    ds_read_b64_tr_b16 a[64:65], v4 offset:32768
    v_mfma_f32_16x16x32_bf16 v[84:87], a[4:7], a[100:103], v[92:95]
    s_addk_i32 m0, 4096
    ds_read_b64_tr_b16 a[66:67], v4 offset:34816
    v_mfma_f32_16x16x32_bf16 v[84:87], a[12:15], a[116:119], v[84:87]
    s_add_u32 s59, s47, s72
    ds_read_b64_tr_b16 a[68:69], v5 offset:32768
    v_mfma_f32_16x16x32_bf16 v[68:71], a[8:11], a[116:119], v[76:79]
    buffer_load_dwordx4 v34, s[8:11], s59 offen lds
    v_mfma_f32_16x16x32_bf16 v[68:71], a[0:3], a[100:103], v[68:71]
    s_branch L_pageF
.p2align 12
L_pageF:
L_stubF1:
    s_cbranch_execz L_jrFs
    s_nop 0
    s_waitcnt lgkmcnt(8)
    ds_read_b64_tr_b16 a[70:71], v5 offset:34816
    v_and_b32 v40, 15, v0
    v_lshlrev_b32 v48, 7, v40
    s_getpc_b64 s[56:57]
L_pc18:
    s_sub_u32 s56, s56, L_pc18-gated_mix__sliding_local_dilated__dense_activation_squared_relu__prompt_kernel
    s_subb_u32 s57, s57, 0
    s_lshr_b32 s55, s2, 5
    s_mul_i32 s55, s55, 3
    s_add_u32 s55, s55, s51
    s_lshl2_add_u32 s55, s55, s48
    s_mul_i32 s55, s55, 896
    v_min_u32 v40, 6, v0
    v_lshl_add_u32 v40, v40, 7, s55
    v_min_u32 v40, L_code_end-gated_mix__sliding_local_dilated__dense_activation_squared_relu__prompt_kernel-4, v40
    v_mfma_f32_16x16x32_bf16 v[72:75], a[0:3], a[104:107], v[76:79]
    ds_read_b64_tr_b16 a[72:73], v4 offset:36864
    v_mfma_f32_16x16x32_bf16 v[72:75], a[8:11], a[120:123], v[72:75]
    s_addk_i32 m0, 4096
    ds_read_b64_tr_b16 a[74:75], v4 offset:38912
    v_mfma_f32_16x16x32_bf16 v[88:91], a[12:15], a[120:123], v[92:95]
    s_add_u32 s59, s47, s73
    ds_read_b64_tr_b16 a[76:77], v5 offset:36864
    v_mfma_f32_16x16x32_bf16 v[88:91], a[4:7], a[104:107], v[88:91]
    buffer_load_dwordx4 v1, s[8:11], s59 offen lds
    v_mfma_f32_16x16x32_bf16 v[104:107], a[16:19], a[104:107], v[108:111]
    ds_read_b64_tr_b16 a[78:79], v5 offset:38912
    v_mfma_f32_16x16x32_bf16 v[104:107], a[24:27], a[120:123], v[104:107]
    s_addk_i32 m0, 4096
    ds_read_b64_tr_b16 a[80:81], v4 offset:40960
    v_mfma_f32_16x16x32_bf16 v[120:123], a[28:31], a[120:123], v[124:127]
    s_add_u32 s59, s47, s73
    ds_read_b64_tr_b16 a[82:83], v4 offset:43008
    v_mov_b32 v19, s57
    v_add_co_u32 v18, vcc, s56, v40
    s_nop 1
    v_addc_co_u32 v19, vcc, 0, v19, vcc
    s_lshl2_add_u32 s55, s50, s51
    s_and_b32 s56, s49, 1
    s_lshl1_add_u32 s55, s55, s56
    s_lshr_b32 s56, s49, 1
    s_lshl4_add_u32 s55, s55, s56
    s_lshl2_add_u32 s55, s48, s55
    v_lshrrev_b32 v40, 5, v0
    v_lshl_add_u32 v40, v40, 1, s55
    v_mfma_f32_16x16x32_bf16 v[120:123], a[20:23], a[104:107], v[120:123]
    buffer_load_dwordx4 v34, s[8:11], s59 offen lds
    v_mfma_f32_16x16x32_bf16 v[136:139], a[32:35], a[104:107], v[140:143]
    ds_read_b64_tr_b16 a[84:85], v5 offset:40960
    v_mfma_f32_16x16x32_bf16 v[136:139], a[40:43], a[120:123], v[136:139]
    ds_read_b64_tr_b16 a[86:87], v5 offset:43008
    v_mfma_f32_16x16x32_bf16 v[152:155], a[44:47], a[120:123], v[156:159]
    s_addk_i32 m0, 4096
    ds_read_b64_tr_b16 a[88:89], v4 offset:45056
    v_mfma_f32_16x16x32_bf16 v[152:155], a[36:39], a[104:107], v[152:155]
    s_add_u32 s59, s47, s74
    ds_read_b64_tr_b16 a[90:91], v4 offset:47104
    v_mfma_f32_16x16x32_bf16 v[156:159], a[36:39], a[108:111], v[156:159]
    buffer_load_dwordx4 v1, s[8:11], s59 offen lds
    v_mfma_f32_16x16x32_bf16 v[156:159], a[44:47], a[124:127], v[156:159]
    ds_read_b64_tr_b16 a[92:93], v5 offset:45056
    v_mul_u32_u24 v40, 1152, v40
    v_and_b32 v41, 31, v0
    v_mul_u32_u24 v54, 12, v41
    v_add_u32 v53, v40, v54
    s_mul_i32 s55, s64, 384
    s_lshl_b32 s56, s48, 4
    s_add_u32 s55, s55, s56
    v_lshrrev_b32 v40, 3, v0
    v_add_u32 v40, s55, v40
    v_mul_u32_u24 v40, 1152, v40
    v_add_u32 v12, v40, v42
    v_mfma_f32_16x16x32_bf16 v[140:143], a[40:43], a[124:127], v[140:143]
    ds_read_b64_tr_b16 a[94:95], v5 offset:47104
    v_mfma_f32_16x16x32_bf16 v[140:143], a[32:35], a[108:111], v[140:143]
    s_addk_i32 m0, 4096
    v_mfma_f32_16x16x32_bf16 v[124:127], a[20:23], a[108:111], v[124:127]
    s_add_u32 s59, s47, s74
    v_mfma_f32_16x16x32_bf16 v[124:127], a[28:31], a[124:127], v[124:127]
    buffer_load_dwordx4 v34, s[8:11], s59 offen lds
    v_mfma_f32_16x16x32_bf16 v[108:111], a[24:27], a[124:127], v[108:111]
    v_mfma_f32_16x16x32_bf16 v[108:111], a[16:19], a[108:111], v[108:111]
    v_mfma_f32_16x16x32_bf16 v[92:95], a[4:7], a[108:111], v[92:95]
    v_mfma_f32_16x16x32_bf16 v[92:95], a[12:15], a[124:127], v[92:95]
    v_mfma_f32_16x16x32_bf16 v[76:79], a[8:11], a[124:127], v[76:79]
    v_mfma_f32_16x16x32_bf16 v[76:79], a[0:3], a[108:111], v[76:79]
    s_waitcnt lgkmcnt(0)
    v_mfma_f32_16x16x32_bf16 v[160:163], a[48:51], a[96:99], v[172:175]
    s_addk_i32 m0, 4096
    s_add_u32 s59, s47, s75
    v_mfma_f32_16x16x32_bf16 v[160:163], a[56:59], a[112:115], v[160:163]
    buffer_load_dwordx4 v1, s[8:11], s59 offen lds
    v_mfma_f32_16x16x32_bf16 v[176:179], a[60:63], a[112:115], v[188:191]
    s_addk_i32 m0, 4096
    v_add_u32 v33, 9216, v12
    s_mul_i32 s76, s70, 576
    s_mul_i32 s77, s71, 576
    s_mul_i32 s78, s72, 576
    s_mul_i32 s79, s73, 576
    s_mul_i32 s80, s74, 576
    s_mul_i32 s81, s75, 576
    s_sub_u32 s55, s42, 16384
    s_add_u32 s59, s47, s75
    v_mfma_f32_16x16x32_bf16 v[176:179], a[52:55], a[96:99], v[176:179]
    buffer_load_dwordx4 v34, s[8:11], s59 offen lds
    v_mfma_f32_16x16x32_bf16 v[192:195], a[64:67], a[96:99], v[204:207]
    s_add_u32 s47, s47, 589824
    s_sub_u32 s67, s47, 3538944
    s_min_u32 s47, s47, s67
    v_mfma_f32_16x16x32_bf16 v[192:195], a[72:75], a[112:115], v[192:195]
    s_add_u32 m0, s58, 0
    s_add_u32 s59, s47, s70
    v_mfma_f32_16x16x32_bf16 v[208:211], a[76:79], a[112:115], v[220:223]
    buffer_load_dwordx4 v1, s[8:11], s59 offen lds
    v_mfma_f32_16x16x32_bf16 v[208:211], a[68:71], a[96:99], v[208:211]
    v_mfma_f32_16x16x32_bf16 v[224:227], a[80:83], a[96:99], v[236:239]
    s_waitcnt vmcnt(7)
    v_mfma_f32_16x16x32_bf16 v[224:227], a[88:91], a[112:115], v[224:227]
    s_barrier
    ds_read_b64_tr_b16 a[0:1], v6 offset:0
    s_add_u32 s20, s16, s55
    s_addc_u32 s21, s17, 0
    s_or_b32 s55, s66, s48
    s_cselect_b64 s[20:21], s[4:5], s[20:21]
    s_mov_b32 s61, 0
    v_bfe_u32 v40, v0, 3, 1
    v_mul_u32_u24 v40, 32768, v40
    v_lshrrev_b32 v41, 5, v0
    v_lshl_add_u32 v40, v41, 14, v40
    v_bfe_u32 v41, v0, 4, 1
    v_lshl_add_u32 v40, v41, 12, v40
    v_mfma_f32_16x16x32_bf16 v[240:243], a[92:95], a[112:115], v[252:255]
    ds_read_b64_tr_b16 a[2:3], v6 offset:2048
    v_mfma_f32_16x16x32_bf16 v[240:243], a[84:87], a[96:99], v[240:243]
    ds_read_b64_tr_b16 a[4:5], v7 offset:0
    v_mfma_f32_16x16x32_bf16 v[244:247], a[84:87], a[100:103], v[252:255]
    s_addk_i32 m0, 4096
    ds_read_b64_tr_b16 a[6:7], v7 offset:2048
    s_add_u32 s59, s47, s70
    v_mfma_f32_16x16x32_bf16 v[244:247], a[92:95], a[116:119], v[244:247]
    buffer_load_dwordx4 v34, s[8:11], s59 offen lds
    v_mfma_f32_16x16x32_bf16 v[228:231], a[88:91], a[116:119], v[236:239]
    ds_read_b64_tr_b16 a[8:9], v6 offset:4096
    v_mfma_f32_16x16x32_bf16 v[228:231], a[80:83], a[100:103], v[228:231]
    s_addk_i32 m0, 4096
    ds_read_b64_tr_b16 a[10:11], v6 offset:6144
    v_mfma_f32_16x16x32_bf16 v[212:215], a[68:71], a[100:103], v[220:223]
    s_add_u32 s59, s47, s71
    ds_read_b64_tr_b16 a[12:13], v7 offset:4096
    v_lshrrev_b32 v41, 4, v0
    v_xor_b32 v41, s52, v41
    v_lshl_add_u32 v40, v41, 8, v40
    v_and_b32 v41, 7, v0
    v_lshl_add_u32 v40, v41, 4, v40
    s_mul_i32 s55, s53, 262144
    s_lshl_b32 s56, s54, 7
    s_add_u32 s55, s55, s56
    v_add_u32 v25, s55, v40
    v_mfma_f32_16x16x32_bf16 v[212:215], a[76:79], a[116:119], v[212:215]
    buffer_load_dwordx4 v1, s[8:11], s59 offen lds
    v_mfma_f32_16x16x32_bf16 v[196:199], a[72:75], a[116:119], v[204:207]
    ds_read_b64_tr_b16 a[14:15], v7 offset:6144
    v_mfma_f32_16x16x32_bf16 v[196:199], a[64:67], a[100:103], v[196:199]
    ds_read_b64_tr_b16 a[16:17], v6 offset:8192
    v_mfma_f32_16x16x32_bf16 v[180:183], a[52:55], a[100:103], v[188:191]
    s_addk_i32 m0, 4096
    ds_read_b64_tr_b16 a[18:19], v6 offset:10240
    v_mfma_f32_16x16x32_bf16 v[180:183], a[60:63], a[116:119], v[180:183]
    s_add_u32 s59, s47, s71
    ds_read_b64_tr_b16 a[20:21], v7 offset:8192
    v_mfma_f32_16x16x32_bf16 v[164:167], a[56:59], a[116:119], v[172:175]
    buffer_load_dwordx4 v34, s[8:11], s59 offen lds
    v_mfma_f32_16x16x32_bf16 v[164:167], a[48:51], a[100:103], v[164:167]
    ds_read_b64_tr_b16 a[22:23], v7 offset:10240
    s_lshl_b32 s55, s82, 16
    v_add_u32 v25, s55, v25
    v_xor_b32 v26, 65536, v25
    v_xor_b32 v27, 131072, v25
    v_xor_b32 v28, 196608, v25
    v_lshrrev_b32 v40, 15, v25
    v_mov_b32 v41, 0x40000000
    v_cmp_eq_u32 vcc, s52, v40
    s_nop 1
    v_cndmask_b32 v25, v25, v41, vcc
    v_mfma_f32_16x16x32_bf16 v[168:171], a[48:51], a[104:107], v[172:175]
    ds_read_b128 a[96:99], v2 offset:16384
    v_mfma_f32_16x16x32_bf16 v[168:171], a[56:59], a[120:123], v[168:171]
    s_addk_i32 m0, 4096
    ds_read_b128 a[112:115], v3 offset:16384
    v_mfma_f32_16x16x32_bf16 v[184:187], a[60:63], a[120:123], v[188:191]
    s_add_u32 s59, s47, s72
    ds_read_b128 a[100:103], v2 offset:18432
    v_mfma_f32_16x16x32_bf16 v[184:187], a[52:55], a[104:107], v[184:187]
    buffer_load_dwordx4 v1, s[8:11], s59 offen lds
    v_mfma_f32_16x16x32_bf16 v[200:203], a[64:67], a[104:107], v[204:207]
    ds_read_b128 a[116:119], v3 offset:18432
    v_mfma_f32_16x16x32_bf16 v[200:203], a[72:75], a[120:123], v[200:203]
    s_addk_i32 m0, 4096
    ds_read_b64_tr_b16 a[24:25], v6 offset:12288
    v_mfma_f32_16x16x32_bf16 v[216:219], a[76:79], a[120:123], v[220:223]
    s_add_u32 s59, s47, s72
    ds_read_b64_tr_b16 a[26:27], v6 offset:14336
    s_add_u32 s55, s60, 32768
    v_lshl_add_u32 v29, v0, 4, s55
    v_xor_b32 v30, 8192, v29
    v_lshlrev_b32 v44, 4, v0
    s_lshl2_add_u32 s55, s50, s51
    s_and_b32 s56, s49, 1
    s_lshl1_add_u32 s55, s55, s56
    s_lshr_b32 s56, s49, 1
    s_lshl4_add_u32 s55, s55, s56
    v_mfma_f32_16x16x32_bf16 v[216:219], a[68:71], a[104:107], v[216:219]
    buffer_load_dwordx4 v34, s[8:11], s59 offen lds
    v_mfma_f32_16x16x32_bf16 v[232:235], a[80:83], a[104:107], v[236:239]
    ds_read_b64_tr_b16 a[28:29], v7 offset:12288
    v_mfma_f32_16x16x32_bf16 v[232:235], a[88:91], a[120:123], v[232:235]
    ds_read_b64_tr_b16 a[30:31], v7 offset:14336
    v_mfma_f32_16x16x32_bf16 v[248:251], a[92:95], a[120:123], v[252:255]
    s_add_u32 s46, s46, 128
    s_sub_u32 s67, s46, 768
    s_min_u32 s46, s46, s67
    v_mfma_f32_16x16x32_bf16 v[248:251], a[84:87], a[104:107], v[248:251]
    s_add_u32 m0, s60, 32768
    ds_read_b64_tr_b16 a[32:33], v6 offset:16384
    v_mfma_f32_16x16x32_bf16 v[252:255], a[84:87], a[108:111], v[252:255]
    buffer_load_dwordx4 v8, s[4:7], s46 offen lds
    v_mfma_f32_16x16x32_bf16 v[252:255], a[92:95], a[124:127], v[252:255]
    ds_read_b64_tr_b16 a[34:35], v6 offset:18432
    v_and_b32 v40, 7, v0
    v_lshlrev_b32 v55, 2, v40
    v_lshl_add_u32 v40, v40, 1, s55
    v_mul_u32_u24 v45, 1152, v40
    v_lshrrev_b32 v41, 5, v0
    v_lshlrev_b32 v41, 7, v41
    v_bfe_u32 v43, v0, 3, 1
    v_lshl_add_u32 v41, v43, 6, v41
    v_bfe_u32 v43, v0, 4, 1
    v_mfma_f32_16x16x32_bf16 v[236:239], a[88:91], a[124:127], v[236:239]
    ds_read_b64_tr_b16 a[36:37], v7 offset:16384
    v_mfma_f32_16x16x32_bf16 v[236:239], a[80:83], a[108:111], v[236:239]
    ds_read_b64_tr_b16 a[38:39], v7 offset:18432
    v_mfma_f32_16x16x32_bf16 v[220:223], a[68:71], a[108:111], v[220:223]
    s_addk_i32 m0, 1024
    ds_read_b64_tr_b16 a[40:41], v6 offset:20480
    v_mfma_f32_16x16x32_bf16 v[220:223], a[76:79], a[124:127], v[220:223]
    buffer_load_dwordx4 v9, s[4:7], s46 offen lds
    v_mfma_f32_16x16x32_bf16 v[204:207], a[72:75], a[124:127], v[204:207]
    ds_read_b64_tr_b16 a[42:43], v6 offset:22528
    v_mfma_f32_16x16x32_bf16 v[204:207], a[64:67], a[108:111], v[204:207]
    ds_read_b64_tr_b16 a[44:45], v7 offset:20480
    v_mfma_f32_16x16x32_bf16 v[188:191], a[52:55], a[108:111], v[188:191]
    ds_read_b64_tr_b16 a[46:47], v7 offset:22528
    v_mfma_f32_16x16x32_bf16 v[188:191], a[60:63], a[124:127], v[188:191]
    v_mfma_f32_16x16x32_bf16 v[172:175], a[56:59], a[124:127], v[172:175]
    v_mfma_f32_16x16x32_bf16 v[172:175], a[48:51], a[108:111], v[172:175]
    s_waitcnt lgkmcnt(0)
    v_mfma_f32_16x16x32_bf16 v[64:67], a[0:3], a[96:99], v[64:67]
    s_addk_i32 m0, 1024
    ds_read_b128 a[104:107], v2 offset:20480
    v_mfma_f32_16x16x32_bf16 v[64:67], a[8:11], a[112:115], v[64:67]
    buffer_load_dwordx4 v10, s[4:7], s46 offen lds
    v_mfma_f32_16x16x32_bf16 v[80:83], a[12:15], a[112:115], v[80:83]
    s_addk_i32 m0, 1024
    ds_read_b128 a[120:123], v3 offset:20480
    v_lshl_add_u32 v41, v43, 5, v41
    s_lshl_b32 s56, s48, 3
    s_add_u32 s56, s56, s3
    v_add_u32 v41, s56, v41
    v_subrev_u32 v43, 1152, v41
    v_min_u32 v46, v41, v43
    v_add_u32 v41, 256, v46
    v_subrev_u32 v43, 1152, v41
    v_min_u32 v35, v41, v43
    v_add_u32 v41, 256, v35
    v_mfma_f32_16x16x32_bf16 v[80:83], a[4:7], a[96:99], v[80:83]
    buffer_load_dwordx4 v11, s[4:7], s46 offen lds
    v_mfma_f32_16x16x32_bf16 v[96:99], a[16:19], a[96:99], v[96:99]
    s_add_u32 m0, s58, 24576
    ds_read_b128 a[108:111], v2 offset:22528
    s_add_u32 s59, s47, s73
    v_mfma_f32_16x16x32_bf16 v[96:99], a[24:27], a[112:115], v[96:99]
    buffer_load_dwordx4 v1, s[8:11], s59 offen lds
    v_mfma_f32_16x16x32_bf16 v[112:115], a[28:31], a[112:115], v[112:115]
    ds_read_b128 a[124:127], v3 offset:22528
    v_mfma_f32_16x16x32_bf16 v[112:115], a[20:23], a[96:99], v[112:115]
    v_mfma_f32_16x16x32_bf16 v[128:131], a[32:35], a[96:99], v[128:131]
    s_waitcnt vmcnt(11)
    v_mfma_f32_16x16x32_bf16 v[128:131], a[40:43], a[112:115], v[128:131]
    s_barrier
    ds_read_b64_tr_b16 a[48:49], v6 offset:24576
    v_subrev_u32 v43, 1152, v41
    v_min_u32 v32, v41, v43
    v_add_u32 v41, 256, v32
    v_subrev_u32 v43, 1152, v41
    v_min_u32 v36, v41, v43
    v_add_u32 v41, 256, v36
    v_subrev_u32 v43, 1152, v41
    v_min_u32 v37, v41, v43
    v_and_b32 v40, 15, v0
    v_lshlrev_b32 v48, 7, v40
    s_lshl_b32 s55, s52, 7
    v_mfma_f32_16x16x32_bf16 v[144:147], a[44:47], a[112:115], v[144:147]
    ds_read_b64_tr_b16 a[50:51], v6 offset:26624
    v_mfma_f32_16x16x32_bf16 v[144:147], a[36:39], a[96:99], v[144:147]
    ds_read_b64_tr_b16 a[52:53], v7 offset:24576
    v_mfma_f32_16x16x32_bf16 v[148:151], a[36:39], a[100:103], v[148:151]
    s_addk_i32 m0, 4096
    ds_read_b64_tr_b16 a[54:55], v7 offset:26624
    s_add_u32 s59, s47, s73
    v_mfma_f32_16x16x32_bf16 v[148:151], a[44:47], a[116:119], v[148:151]
    buffer_load_dwordx4 v34, s[8:11], s59 offen lds
    v_mfma_f32_16x16x32_bf16 v[132:135], a[40:43], a[116:119], v[132:135]
    s_addk_i32 m0, 4096
    ds_read_b64_tr_b16 a[56:57], v6 offset:28672
    v_mfma_f32_16x16x32_bf16 v[132:135], a[32:35], a[100:103], v[132:135]
    s_add_u32 s59, s47, s74
    ds_read_b64_tr_b16 a[58:59], v6 offset:30720
    v_mfma_f32_16x16x32_bf16 v[116:119], a[20:23], a[100:103], v[116:119]
    buffer_load_dwordx4 v1, s[8:11], s59 offen lds
    v_mfma_f32_16x16x32_bf16 v[116:119], a[28:31], a[116:119], v[116:119]
    ds_read_b64_tr_b16 a[60:61], v7 offset:28672
    v_mfma_f32_16x16x32_bf16 v[100:103], a[24:27], a[116:119], v[100:103]
    s_addk_i32 m0, 4096
    ds_read_b64_tr_b16 a[62:63], v7 offset:30720
    v_mfma_f32_16x16x32_bf16 v[100:103], a[16:19], a[100:103], v[100:103]
    s_add_u32 s59, s47, s74
    ds_read_b64_tr_b16 a[64:65], v6 offset:32768
    v_mfma_f32_16x16x32_bf16 v[84:87], a[4:7], a[100:103], v[84:87]
    buffer_load_dwordx4 v34, s[8:11], s59 offen lds
    v_mfma_f32_16x16x32_bf16 v[84:87], a[12:15], a[116:119], v[84:87]
    ds_read_b64_tr_b16 a[66:67], v6 offset:34816
    v_mfma_f32_16x16x32_bf16 v[68:71], a[8:11], a[116:119], v[68:71]
    s_addk_i32 m0, 4096
    ds_read_b64_tr_b16 a[68:69], v7 offset:32768
    v_mfma_f32_16x16x32_bf16 v[68:71], a[0:3], a[100:103], v[68:71]
    s_waitcnt lgkmcnt(8)
    ds_read_b64_tr_b16 a[70:71], v7 offset:34816
    s_cmp_eq_u32 s48, 0
    s_cselect_b32 s55, s55, 0x40000000
    v_lshl_add_u32 v40, v0, 2, s55
    v_mov_b32 v41, 0x40000000
    v_cmp_gt_u32 vcc, 32, v0
    s_mul_i32 s55, s52, 32768
    s_add_u32 s40, s43, s55
    v_cndmask_b32 v47, v41, v40, vcc
    s_lshl_b32 s55, s54, 14
    s_add_u32 s40, s40, s55
    s_lshl_b32 s55, s53, 12
    s_add_u32 s59, s47, s75
    v_mfma_f32_16x16x32_bf16 v[72:75], a[0:3], a[104:107], v[72:75]
    buffer_load_dwordx4 v1, s[8:11], s59 offen lds
    v_mfma_f32_16x16x32_bf16 v[72:75], a[8:11], a[120:123], v[72:75]
    s_addk_i32 m0, 4096
    ds_read_b64_tr_b16 a[72:73], v6 offset:36864
    v_mfma_f32_16x16x32_bf16 v[88:91], a[12:15], a[120:123], v[88:91]
    s_add_u32 s59, s47, s75
    ds_read_b64_tr_b16 a[74:75], v6 offset:38912
    v_mfma_f32_16x16x32_bf16 v[88:91], a[4:7], a[104:107], v[88:91]
    buffer_load_dwordx4 v34, s[8:11], s59 offen lds
    v_mfma_f32_16x16x32_bf16 v[104:107], a[16:19], a[104:107], v[104:107]
    ds_read_b64_tr_b16 a[76:77], v7 offset:36864
    v_mfma_f32_16x16x32_bf16 v[104:107], a[24:27], a[120:123], v[104:107]
    ds_read_b64_tr_b16 a[78:79], v7 offset:38912
    v_mfma_f32_16x16x32_bf16 v[120:123], a[28:31], a[120:123], v[120:123]
    s_sub_u32 s59, s42, 16384
    ds_read_b64_tr_b16 a[80:81], v6 offset:40960
    s_add_u32 s40, s40, s55
    v_bfe_u32 v40, v0, 1, 3
    v_and_b32 v41, 1, v0
    v_lshlrev_b32 v41, 4, v41
    v_mov_b32 v43, 0x3f80
    v_lshlrev_b32 v41, v41, v43
    v_cmp_eq_u32 vcc, 0, v40
    v_cmp_eq_u32 s[56:57], 1, v40
    s_nop 0
    v_cndmask_b32 v56, 0, v41, vcc
    v_cndmask_b32 v57, 0, v41, s[56:57]
    v_cmp_eq_u32 vcc, 2, v40
    v_mfma_f32_16x16x32_bf16 v[120:123], a[20:23], a[104:107], v[120:123]
    buffer_store_dwordx4 v[14:17], v20, s[16:19], s59 offen sc1
    v_mfma_f32_16x16x32_bf16 v[136:139], a[32:35], a[104:107], v[136:139]
    ds_read_b64_tr_b16 a[82:83], v6 offset:43008
    v_mfma_f32_16x16x32_bf16 v[136:139], a[40:43], a[120:123], v[136:139]
    ds_read_b64_tr_b16 a[84:85], v7 offset:40960
    v_mfma_f32_16x16x32_bf16 v[152:155], a[44:47], a[120:123], v[152:155]
    ds_read_b64_tr_b16 a[86:87], v7 offset:43008
    v_mfma_f32_16x16x32_bf16 v[152:155], a[36:39], a[104:107], v[152:155]
    global_load_dword v38, v[18:19], off
    v_mfma_f32_16x16x32_bf16 v[156:159], a[36:39], a[108:111], v[156:159]
    ds_read_b64_tr_b16 a[88:89], v6 offset:45056
    v_mfma_f32_16x16x32_bf16 v[156:159], a[44:47], a[124:127], v[156:159]
    s_mov_b32 s59, 0
    ds_read_b64_tr_b16 a[90:91], v6 offset:47104
    v_cmp_eq_u32 s[56:57], 3, v40
    v_cndmask_b32 v58, 0, v41, vcc
    s_nop 0
    v_cndmask_b32 v59, 0, v41, s[56:57]
    v_cmp_eq_u32 vcc, 4, v40
    v_cmp_eq_u32 s[56:57], 5, v40
    s_nop 0
    v_cndmask_b32 v60, 0, v41, vcc
    v_cndmask_b32 v61, 0, v41, s[56:57]
    v_cmp_eq_u32 vcc, 6, v40
    v_cmp_eq_u32 s[56:57], 7, v40
    s_nop 0
    v_cndmask_b32 v62, 0, v41, vcc
    v_cndmask_b32 v63, 0, v41, s[56:57]
    v_mfma_f32_16x16x32_bf16 v[140:143], a[40:43], a[124:127], v[140:143]
    buffer_load_dword v38, v48, s[24:27], s59 offen offset:0
    v_mfma_f32_16x16x32_bf16 v[140:143], a[32:35], a[108:111], v[140:143]
    ds_read_b64_tr_b16 a[92:93], v7 offset:45056
    v_mfma_f32_16x16x32_bf16 v[124:127], a[20:23], a[108:111], v[124:127]
    s_add_u32 s46, s46, 128
    s_sub_u32 s67, s46, 768
    s_min_u32 s46, s46, s67
    v_mfma_f32_16x16x32_bf16 v[124:127], a[28:31], a[124:127], v[124:127]
    s_add_u32 m0, s60, 49152
    ds_read_b64_tr_b16 a[94:95], v7 offset:47104
    v_mfma_f32_16x16x32_bf16 v[108:111], a[24:27], a[124:127], v[108:111]
    buffer_load_dwordx4 v8, s[4:7], s46 offen lds
    v_mfma_f32_16x16x32_bf16 v[108:111], a[16:19], a[108:111], v[108:111]
    v_mfma_f32_16x16x32_bf16 v[92:95], a[4:7], a[108:111], v[92:95]
    v_mfma_f32_16x16x32_bf16 v[92:95], a[12:15], a[124:127], v[92:95]
    v_mfma_f32_16x16x32_bf16 v[76:79], a[8:11], a[124:127], v[76:79]
    s_mov_b64 exec, 0
    s_cmp_eq_u32 s48, 0
    s_cbranch_scc1 L_stubF5
    s_cmp_eq_u32 s48, 1
    s_cbranch_scc1 L_stubF6
    s_cmp_eq_u32 s48, 2
    s_cbranch_scc1 L_stubF7
    s_cmp_eq_u32 s48, 3
    s_cbranch_scc1 L_stubF8
L_jrF2:
    s_mov_b64 exec, -1
    v_mfma_f32_16x16x32_bf16 v[76:79], a[0:3], a[108:111], v[76:79]
    s_waitcnt lgkmcnt(0)
    v_mfma_f32_16x16x32_bf16 v[160:163], a[48:51], a[96:99], v[160:163]
    s_add_u32 s47, s47, 589824
    s_sub_u32 s67, s47, 3538944
    s_min_u32 s47, s47, s67
    v_mfma_f32_16x16x32_bf16 v[160:163], a[56:59], a[112:115], v[160:163]
    s_add_u32 m0, s58, 49152
    s_add_u32 s59, s47, s70
    v_mfma_f32_16x16x32_bf16 v[176:179], a[60:63], a[112:115], v[176:179]
    buffer_load_dwordx4 v1, s[8:11], s59 offen lds
    v_mfma_f32_16x16x32_bf16 v[176:179], a[52:55], a[96:99], v[176:179]
    s_addk_i32 m0, 4096
    s_add_u32 s59, s47, s70
    v_mfma_f32_16x16x32_bf16 v[192:195], a[64:67], a[96:99], v[192:195]
    buffer_load_dwordx4 v34, s[8:11], s59 offen lds
    v_mfma_f32_16x16x32_bf16 v[192:195], a[72:75], a[112:115], v[192:195]
    s_addk_i32 m0, 4096
    s_add_u32 s59, s47, s71
    v_mfma_f32_16x16x32_bf16 v[208:211], a[76:79], a[112:115], v[208:211]
    buffer_load_dwordx4 v1, s[8:11], s59 offen lds
    v_mfma_f32_16x16x32_bf16 v[208:211], a[68:71], a[96:99], v[208:211]
    v_mfma_f32_16x16x32_bf16 v[224:227], a[80:83], a[96:99], v[224:227]
    s_waitcnt vmcnt(13)
    v_mfma_f32_16x16x32_bf16 v[224:227], a[88:91], a[112:115], v[224:227]
    s_barrier
    ds_read_b64_tr_b16 a[0:1], v4 offset:0
    v_mfma_f32_16x16x32_bf16 v[240:243], a[92:95], a[112:115], v[240:243]
    ds_read_b64_tr_b16 a[2:3], v4 offset:2048
    v_mfma_f32_16x16x32_bf16 v[240:243], a[84:87], a[96:99], v[240:243]
    ds_read_b64_tr_b16 a[4:5], v5 offset:0
    v_mfma_f32_16x16x32_bf16 v[244:247], a[84:87], a[100:103], v[244:247]
    s_addk_i32 m0, 4096
    ds_read_b64_tr_b16 a[6:7], v5 offset:2048
    s_add_u32 s59, s47, s71
    v_mfma_f32_16x16x32_bf16 v[244:247], a[92:95], a[116:119], v[244:247]
    buffer_load_dwordx4 v34, s[8:11], s59 offen lds
    v_mfma_f32_16x16x32_bf16 v[228:231], a[88:91], a[116:119], v[228:231]
    s_addk_i32 m0, 4096
    ds_read_b64_tr_b16 a[8:9], v4 offset:4096
    v_mfma_f32_16x16x32_bf16 v[228:231], a[80:83], a[100:103], v[228:231]
    s_add_u32 s59, s47, s72
    ds_read_b64_tr_b16 a[10:11], v4 offset:6144
    v_mfma_f32_16x16x32_bf16 v[212:215], a[68:71], a[100:103], v[212:215]
    buffer_load_dwordx4 v1, s[8:11], s59 offen lds
    v_mfma_f32_16x16x32_bf16 v[212:215], a[76:79], a[116:119], v[212:215]
    ds_read_b64_tr_b16 a[12:13], v5 offset:4096
    v_mfma_f32_16x16x32_bf16 v[196:199], a[72:75], a[116:119], v[196:199]
    s_addk_i32 m0, 4096
    ds_read_b64_tr_b16 a[14:15], v5 offset:6144
    v_mfma_f32_16x16x32_bf16 v[196:199], a[64:67], a[100:103], v[196:199]
    s_add_u32 s59, s47, s72
    ds_read_b64_tr_b16 a[16:17], v4 offset:8192
    v_mfma_f32_16x16x32_bf16 v[180:183], a[52:55], a[100:103], v[180:183]
    buffer_load_dwordx4 v34, s[8:11], s59 offen lds
    v_mfma_f32_16x16x32_bf16 v[180:183], a[60:63], a[116:119], v[180:183]
    ds_read_b64_tr_b16 a[18:19], v4 offset:10240
    v_mfma_f32_16x16x32_bf16 v[164:167], a[56:59], a[116:119], v[164:167]
    ds_read_b64_tr_b16 a[20:21], v5 offset:8192
    v_mfma_f32_16x16x32_bf16 v[164:167], a[48:51], a[100:103], v[164:167]
    s_add_u32 m0, s60, 50176
    ds_read_b64_tr_b16 a[22:23], v5 offset:10240
    v_mfma_f32_16x16x32_bf16 v[168:171], a[48:51], a[104:107], v[168:171]
    buffer_load_dwordx4 v9, s[4:7], s46 offen lds
    v_mfma_f32_16x16x32_bf16 v[168:171], a[56:59], a[120:123], v[168:171]
    ds_read_b128 a[96:99], v2 offset:32768
    v_mfma_f32_16x16x32_bf16 v[184:187], a[60:63], a[120:123], v[184:187]
    s_addk_i32 m0, 1024
    ds_read_b128 a[112:115], v3 offset:32768
    v_mfma_f32_16x16x32_bf16 v[184:187], a[52:55], a[104:107], v[184:187]
    buffer_load_dwordx4 v10, s[4:7], s46 offen lds
    v_mfma_f32_16x16x32_bf16 v[200:203], a[64:67], a[104:107], v[200:203]
    ds_read_b128 a[100:103], v2 offset:34816
    v_mfma_f32_16x16x32_bf16 v[200:203], a[72:75], a[120:123], v[200:203]
    ds_read_b128 a[116:119], v3 offset:34816
    v_mfma_f32_16x16x32_bf16 v[216:219], a[76:79], a[120:123], v[216:219]
    s_addk_i32 m0, 1024
    ds_read_b64_tr_b16 a[24:25], v4 offset:12288
    v_mfma_f32_16x16x32_bf16 v[216:219], a[68:71], a[104:107], v[216:219]
    buffer_load_dwordx4 v11, s[4:7], s46 offen lds
    v_mfma_f32_16x16x32_bf16 v[232:235], a[80:83], a[104:107], v[232:235]
    ds_read_b64_tr_b16 a[26:27], v4 offset:14336
    v_mfma_f32_16x16x32_bf16 v[232:235], a[88:91], a[120:123], v[232:235]
    ds_read_b64_tr_b16 a[28:29], v5 offset:12288
    v_mfma_f32_16x16x32_bf16 v[248:251], a[92:95], a[120:123], v[248:251]
    ds_read_b64_tr_b16 a[30:31], v5 offset:14336
    v_mfma_f32_16x16x32_bf16 v[248:251], a[84:87], a[104:107], v[248:251]
    buffer_load_dwordx3 a[236:238], v54, s[36:39], 0 offen offset:0
    v_mfma_f32_16x16x32_bf16 v[252:255], a[84:87], a[108:111], v[252:255]
    ds_read_b64_tr_b16 a[32:33], v4 offset:16384
    v_mfma_f32_16x16x32_bf16 v[252:255], a[92:95], a[124:127], v[252:255]
    ds_read_b64_tr_b16 a[34:35], v4 offset:18432
    v_mfma_f32_16x16x32_bf16 v[236:239], a[88:91], a[124:127], v[236:239]
    buffer_load_dwordx3 a[240:242], v54, s[36:39], 0 offen offset:384
    v_mfma_f32_16x16x32_bf16 v[236:239], a[80:83], a[108:111], v[236:239]
    ds_read_b64_tr_b16 a[36:37], v5 offset:16384
    v_mfma_f32_16x16x32_bf16 v[220:223], a[68:71], a[108:111], v[220:223]
    ds_read_b64_tr_b16 a[38:39], v5 offset:18432
    v_mfma_f32_16x16x32_bf16 v[220:223], a[76:79], a[124:127], v[220:223]
    ds_read_b64_tr_b16 a[40:41], v4 offset:20480
    v_mfma_f32_16x16x32_bf16 v[204:207], a[72:75], a[124:127], v[204:207]
    buffer_load_dwordx3 a[244:246], v54, s[36:39], 0 offen offset:768
    v_mfma_f32_16x16x32_bf16 v[204:207], a[64:67], a[108:111], v[204:207]
    ds_read_b64_tr_b16 a[42:43], v4 offset:22528
    v_mfma_f32_16x16x32_bf16 v[188:191], a[52:55], a[108:111], v[188:191]
    ds_read_b64_tr_b16 a[44:45], v5 offset:20480
    v_mfma_f32_16x16x32_bf16 v[188:191], a[60:63], a[124:127], v[188:191]
    ds_read_b64_tr_b16 a[46:47], v5 offset:22528
    v_mfma_f32_16x16x32_bf16 v[172:175], a[56:59], a[124:127], v[172:175]
    v_mfma_f32_16x16x32_bf16 v[172:175], a[48:51], a[108:111], v[172:175]
    s_waitcnt vmcnt(16) lgkmcnt(0)
    s_barrier
    v_mfma_f32_16x16x32_bf16 v[64:67], a[0:3], a[96:99], v[64:67]
    s_add_u32 m0, s58, 73728
    ds_read_b128 a[104:107], v2 offset:36864
    s_add_u32 s59, s47, s73
    v_mfma_f32_16x16x32_bf16 v[64:67], a[8:11], a[112:115], v[64:67]
    buffer_load_dwordx4 v1, s[8:11], s59 offen lds
    v_mfma_f32_16x16x32_bf16 v[80:83], a[12:15], a[112:115], v[80:83]
    s_addk_i32 m0, 4096
    ds_read_b128 a[120:123], v3 offset:36864
    v_mfma_f32_16x16x32_bf16 v[80:83], a[4:7], a[96:99], v[80:83]
    s_add_u32 s59, s47, s73
    ds_read_b128 a[108:111], v2 offset:38912
    v_mfma_f32_16x16x32_bf16 v[96:99], a[16:19], a[96:99], v[96:99]
    buffer_load_dwordx4 v34, s[8:11], s59 offen lds
    v_mfma_f32_16x16x32_bf16 v[96:99], a[24:27], a[112:115], v[96:99]
    s_addk_i32 m0, 4096
    ds_read_b128 a[124:127], v3 offset:38912
    v_mfma_f32_16x16x32_bf16 v[112:115], a[28:31], a[112:115], v[112:115]
    s_add_u32 s59, s47, s74
    ds_read_b64_tr_b16 a[48:49], v4 offset:24576
    v_mfma_f32_16x16x32_bf16 v[112:115], a[20:23], a[96:99], v[112:115]
    buffer_load_dwordx4 v1, s[8:11], s59 offen lds
    v_mfma_f32_16x16x32_bf16 v[128:131], a[32:35], a[96:99], v[128:131]
    s_addk_i32 m0, 4096
    ds_read_b64_tr_b16 a[50:51], v4 offset:26624
    v_mfma_f32_16x16x32_bf16 v[128:131], a[40:43], a[112:115], v[128:131]
    s_add_u32 s59, s47, s74
    ds_read_b64_tr_b16 a[52:53], v5 offset:24576
    v_mfma_f32_16x16x32_bf16 v[144:147], a[44:47], a[112:115], v[144:147]
    buffer_load_dwordx4 v34, s[8:11], s59 offen lds
    v_mfma_f32_16x16x32_bf16 v[144:147], a[36:39], a[96:99], v[144:147]
    s_addk_i32 m0, 4096
    ds_read_b64_tr_b16 a[54:55], v5 offset:26624
    v_mfma_f32_16x16x32_bf16 v[148:151], a[36:39], a[100:103], v[148:151]
    s_add_u32 s59, s47, s75
    ds_read_b64_tr_b16 a[56:57], v4 offset:28672
    v_mfma_f32_16x16x32_bf16 v[148:151], a[44:47], a[116:119], v[148:151]
    buffer_load_dwordx4 v1, s[8:11], s59 offen lds
    v_mfma_f32_16x16x32_bf16 v[132:135], a[40:43], a[116:119], v[132:135]
    s_addk_i32 m0, 4096
    ds_read_b64_tr_b16 a[58:59], v4 offset:30720
    v_mfma_f32_16x16x32_bf16 v[132:135], a[32:35], a[100:103], v[132:135]
    s_add_u32 s59, s47, s75
    ds_read_b64_tr_b16 a[60:61], v5 offset:28672
    v_mfma_f32_16x16x32_bf16 v[116:119], a[20:23], a[100:103], v[116:119]
    buffer_load_dwordx4 v34, s[8:11], s59 offen lds
    v_mfma_f32_16x16x32_bf16 v[116:119], a[28:31], a[116:119], v[116:119]
    ds_read_b64_tr_b16 a[62:63], v5 offset:30720
    v_mfma_f32_16x16x32_bf16 v[100:103], a[24:27], a[116:119], v[100:103]
    ds_read_b64_tr_b16 a[64:65], v4 offset:32768
    v_mfma_f32_16x16x32_bf16 v[100:103], a[16:19], a[100:103], v[100:103]
    buffer_load_dwordx3 a[224:226], v53, s[4:7], 0 offen offset:0
    v_mfma_f32_16x16x32_bf16 v[84:87], a[4:7], a[100:103], v[84:87]
    ds_read_b64_tr_b16 a[66:67], v4 offset:34816
    v_mfma_f32_16x16x32_bf16 v[84:87], a[12:15], a[116:119], v[84:87]
    ds_read_b64_tr_b16 a[68:69], v5 offset:32768
    v_mfma_f32_16x16x32_bf16 v[68:71], a[8:11], a[116:119], v[68:71]
L_stubF2:
    s_cbranch_execz L_jrFs
    s_nop 0
    buffer_load_dwordx3 a[228:230], v53, s[4:7], 0 offen offset:384
    v_mfma_f32_16x16x32_bf16 v[68:71], a[0:3], a[100:103], v[68:71]
    s_waitcnt lgkmcnt(8)
    ds_read_b64_tr_b16 a[70:71], v5 offset:34816
    v_mfma_f32_16x16x32_bf16 v[72:75], a[0:3], a[104:107], v[72:75]
    ds_read_b64_tr_b16 a[72:73], v4 offset:36864
    v_mfma_f32_16x16x32_bf16 v[72:75], a[8:11], a[120:123], v[72:75]
    buffer_load_dwordx3 a[232:234], v53, s[4:7], 0 offen offset:768
    v_mfma_f32_16x16x32_bf16 v[88:91], a[12:15], a[120:123], v[88:91]
    s_add_u32 s47, s47, 589824
    s_sub_u32 s67, s47, 3538944
    s_min_u32 s47, s47, s67
    v_mfma_f32_16x16x32_bf16 v[88:91], a[4:7], a[104:107], v[88:91]
    s_add_u32 m0, s58, 0
    ds_read_b64_tr_b16 a[74:75], v4 offset:38912
    s_add_u32 s59, s47, s70
    v_mfma_f32_16x16x32_bf16 v[104:107], a[16:19], a[104:107], v[104:107]
    buffer_load_dwordx4 v1, s[8:11], s59 offen lds
    v_mfma_f32_16x16x32_bf16 v[104:107], a[24:27], a[120:123], v[104:107]
    s_addk_i32 m0, 4096
    ds_read_b64_tr_b16 a[76:77], v5 offset:36864
    v_mfma_f32_16x16x32_bf16 v[120:123], a[28:31], a[120:123], v[120:123]
    s_add_u32 s59, s47, s70
    ds_read_b64_tr_b16 a[78:79], v5 offset:38912
    v_mfma_f32_16x16x32_bf16 v[120:123], a[20:23], a[104:107], v[120:123]
    buffer_load_dwordx4 v34, s[8:11], s59 offen lds
    v_mfma_f32_16x16x32_bf16 v[136:139], a[32:35], a[104:107], v[136:139]
    s_addk_i32 m0, 4096
    ds_read_b64_tr_b16 a[80:81], v4 offset:40960
    v_mfma_f32_16x16x32_bf16 v[136:139], a[40:43], a[120:123], v[136:139]
    s_add_u32 s59, s47, s71
    ds_read_b64_tr_b16 a[82:83], v4 offset:43008
    v_mfma_f32_16x16x32_bf16 v[152:155], a[44:47], a[120:123], v[152:155]
    buffer_load_dwordx4 v1, s[8:11], s59 offen lds
    v_mfma_f32_16x16x32_bf16 v[152:155], a[36:39], a[104:107], v[152:155]
    s_addk_i32 m0, 4096
    ds_read_b64_tr_b16 a[84:85], v5 offset:40960
    v_mfma_f32_16x16x32_bf16 v[156:159], a[36:39], a[108:111], v[156:159]
    s_add_u32 s59, s47, s71
    ds_read_b64_tr_b16 a[86:87], v5 offset:43008
    v_mfma_f32_16x16x32_bf16 v[156:159], a[44:47], a[124:127], v[156:159]
    buffer_load_dwordx4 v34, s[8:11], s59 offen lds
    v_mfma_f32_16x16x32_bf16 v[140:143], a[40:43], a[124:127], v[140:143]
    ds_read_b64_tr_b16 a[88:89], v4 offset:45056
    v_mfma_f32_16x16x32_bf16 v[140:143], a[32:35], a[108:111], v[140:143]
    ds_read_b64_tr_b16 a[90:91], v4 offset:47104
    v_mfma_f32_16x16x32_bf16 v[124:127], a[20:23], a[108:111], v[124:127]
    buffer_store_dwordx4 v[14:17], v39, s[16:19], s42 offen offset:0 sc1
    v_mfma_f32_16x16x32_bf16 v[124:127], a[28:31], a[124:127], v[124:127]
    ds_read_b64_tr_b16 a[92:93], v5 offset:45056
    v_mfma_f32_16x16x32_bf16 v[108:111], a[24:27], a[124:127], v[108:111]
    ds_read_b64_tr_b16 a[94:95], v5 offset:47104
    v_mfma_f32_16x16x32_bf16 v[108:111], a[16:19], a[108:111], v[108:111]
    buffer_store_dwordx4 v[14:17], v39, s[16:19], s42 offen offset:1024 sc1
    v_mfma_f32_16x16x32_bf16 v[92:95], a[4:7], a[108:111], v[92:95]
    v_mfma_f32_16x16x32_bf16 v[92:95], a[12:15], a[124:127], v[92:95]
    v_mfma_f32_16x16x32_bf16 v[76:79], a[8:11], a[124:127], v[76:79]
    s_waitcnt vmcnt(18) lgkmcnt(0)
    v_mfma_f32_16x16x32_bf16 v[76:79], a[0:3], a[108:111], v[76:79]
    s_barrier
    v_mfma_f32_16x16x32_bf16 v[160:163], a[48:51], a[96:99], v[160:163]
    s_addk_i32 m0, 4096
    ds_read_b64_tr_b16 a[0:1], v6 offset:0
    s_add_u32 s59, s47, s72
    v_mfma_f32_16x16x32_bf16 v[160:163], a[56:59], a[112:115], v[160:163]
    buffer_load_dwordx4 v1, s[8:11], s59 offen lds
    v_mfma_f32_16x16x32_bf16 v[176:179], a[60:63], a[112:115], v[176:179]
    ds_read_b64_tr_b16 a[2:3], v6 offset:2048
    v_mfma_f32_16x16x32_bf16 v[176:179], a[52:55], a[96:99], v[176:179]
    s_addk_i32 m0, 4096
    ds_read_b64_tr_b16 a[4:5], v7 offset:0
    v_mfma_f32_16x16x32_bf16 v[192:195], a[64:67], a[96:99], v[192:195]
    s_add_u32 s59, s47, s72
    ds_read_b64_tr_b16 a[6:7], v7 offset:2048
    v_mfma_f32_16x16x32_bf16 v[192:195], a[72:75], a[112:115], v[192:195]
    buffer_load_dwordx4 v34, s[8:11], s59 offen lds
    v_mfma_f32_16x16x32_bf16 v[208:211], a[76:79], a[112:115], v[208:211]
    ds_read_b64_tr_b16 a[8:9], v6 offset:4096
    v_mfma_f32_16x16x32_bf16 v[208:211], a[68:71], a[96:99], v[208:211]
    ds_read_b64_tr_b16 a[10:11], v6 offset:6144
    v_mfma_f32_16x16x32_bf16 v[224:227], a[80:83], a[96:99], v[224:227]
    s_add_u32 s46, s46, 128
    s_sub_u32 s67, s46, 768
    s_min_u32 s46, s46, s67
    v_mfma_f32_16x16x32_bf16 v[224:227], a[88:91], a[112:115], v[224:227]
    s_add_u32 m0, s60, 0
    ds_read_b64_tr_b16 a[12:13], v7 offset:4096
    v_mfma_f32_16x16x32_bf16 v[240:243], a[92:95], a[112:115], v[240:243]
    buffer_load_dwordx4 v8, s[4:7], s46 offen lds
    v_mfma_f32_16x16x32_bf16 v[240:243], a[84:87], a[96:99], v[240:243]
    ds_read_b64_tr_b16 a[14:15], v7 offset:6144
    v_mfma_f32_16x16x32_bf16 v[244:247], a[84:87], a[100:103], v[244:247]
    ds_read_b64_tr_b16 a[16:17], v6 offset:8192
    v_mfma_f32_16x16x32_bf16 v[244:247], a[92:95], a[116:119], v[244:247]
    s_addk_i32 m0, 1024
    ds_read_b64_tr_b16 a[18:19], v6 offset:10240
    v_mfma_f32_16x16x32_bf16 v[228:231], a[88:91], a[116:119], v[228:231]
    buffer_load_dwordx4 v9, s[4:7], s46 offen lds
    v_mfma_f32_16x16x32_bf16 v[228:231], a[80:83], a[100:103], v[228:231]
    ds_read_b64_tr_b16 a[20:21], v7 offset:8192
    v_mfma_f32_16x16x32_bf16 v[212:215], a[68:71], a[100:103], v[212:215]
    ds_read_b64_tr_b16 a[22:23], v7 offset:10240
    v_mfma_f32_16x16x32_bf16 v[212:215], a[76:79], a[116:119], v[212:215]
    ds_read_b64_tr_b16 a[24:25], v6 offset:12288
    v_mfma_f32_16x16x32_bf16 v[196:199], a[72:75], a[116:119], v[196:199]
    s_addk_i32 m0, 1024
    ds_read_b64_tr_b16 a[26:27], v6 offset:14336
    v_mfma_f32_16x16x32_bf16 v[196:199], a[64:67], a[100:103], v[196:199]
    buffer_load_dwordx4 v10, s[4:7], s46 offen lds
    v_mfma_f32_16x16x32_bf16 v[180:183], a[52:55], a[100:103], v[180:183]
    ds_read_b64_tr_b16 a[28:29], v7 offset:12288
    v_mfma_f32_16x16x32_bf16 v[180:183], a[60:63], a[116:119], v[180:183]
    ds_read_b64_tr_b16 a[30:31], v7 offset:14336
    v_mfma_f32_16x16x32_bf16 v[164:167], a[56:59], a[116:119], v[164:167]
    s_addk_i32 m0, 1024
    ds_read_b64_tr_b16 a[32:33], v6 offset:16384
    v_mfma_f32_16x16x32_bf16 v[164:167], a[48:51], a[100:103], v[164:167]
    buffer_load_dwordx4 v11, s[4:7], s46 offen lds
    v_mfma_f32_16x16x32_bf16 v[168:171], a[48:51], a[104:107], v[168:171]
    ds_read_b128 a[96:99], v2 offset:49152
    v_mfma_f32_16x16x32_bf16 v[168:171], a[56:59], a[120:123], v[168:171]
    ds_read_b128 a[112:115], v3 offset:49152
    v_mfma_f32_16x16x32_bf16 v[184:187], a[60:63], a[120:123], v[184:187]
    s_add_u32 m0, s58, 24576
    ds_read_b128 a[100:103], v2 offset:51200
    v_mfma_f32_16x16x32_bf16 v[184:187], a[52:55], a[104:107], v[184:187]
    s_add_u32 s59, s47, s73
    ds_read_b128 a[116:119], v3 offset:51200
    v_mfma_f32_16x16x32_bf16 v[200:203], a[64:67], a[104:107], v[200:203]
    buffer_load_dwordx4 v1, s[8:11], s59 offen lds
    v_mfma_f32_16x16x32_bf16 v[200:203], a[72:75], a[120:123], v[200:203]
    ds_read_b64_tr_b16 a[34:35], v6 offset:18432
    v_mfma_f32_16x16x32_bf16 v[216:219], a[76:79], a[120:123], v[216:219]
    s_addk_i32 m0, 4096
    ds_read_b64_tr_b16 a[36:37], v7 offset:16384
    v_mfma_f32_16x16x32_bf16 v[216:219], a[68:71], a[104:107], v[216:219]
    s_add_u32 s59, s47, s73
    ds_read_b64_tr_b16 a[38:39], v7 offset:18432
    v_mfma_f32_16x16x32_bf16 v[232:235], a[80:83], a[104:107], v[232:235]
    buffer_load_dwordx4 v34, s[8:11], s59 offen lds
    v_mfma_f32_16x16x32_bf16 v[232:235], a[88:91], a[120:123], v[232:235]
    ds_read_b64_tr_b16 a[40:41], v6 offset:20480
    v_mfma_f32_16x16x32_bf16 v[248:251], a[92:95], a[120:123], v[248:251]
    ds_read_b64_tr_b16 a[42:43], v6 offset:22528
    v_mfma_f32_16x16x32_bf16 v[248:251], a[84:87], a[104:107], v[248:251]
    s_addk_i32 m0, 4096
    ds_read_b64_tr_b16 a[44:45], v7 offset:20480
    v_mfma_f32_16x16x32_bf16 v[252:255], a[84:87], a[108:111], v[252:255]
    s_add_u32 s59, s47, s74
    ds_read_b64_tr_b16 a[46:47], v7 offset:22528
    v_mfma_f32_16x16x32_bf16 v[252:255], a[92:95], a[124:127], v[252:255]
    buffer_load_dwordx4 v1, s[8:11], s59 offen lds
    v_mfma_f32_16x16x32_bf16 v[236:239], a[88:91], a[124:127], v[236:239]
    v_mfma_f32_16x16x32_bf16 v[236:239], a[80:83], a[108:111], v[236:239]
    s_addk_i32 m0, 4096
    v_mfma_f32_16x16x32_bf16 v[220:223], a[68:71], a[108:111], v[220:223]
    s_add_u32 s59, s47, s74
    v_mfma_f32_16x16x32_bf16 v[220:223], a[76:79], a[124:127], v[220:223]
    buffer_load_dwordx4 v34, s[8:11], s59 offen lds
    v_mfma_f32_16x16x32_bf16 v[204:207], a[72:75], a[124:127], v[204:207]
    v_mfma_f32_16x16x32_bf16 v[204:207], a[64:67], a[108:111], v[204:207]
    v_mfma_f32_16x16x32_bf16 v[188:191], a[52:55], a[108:111], v[188:191]
    v_mfma_f32_16x16x32_bf16 v[188:191], a[60:63], a[124:127], v[188:191]
    v_mfma_f32_16x16x32_bf16 v[172:175], a[56:59], a[124:127], v[172:175]
    s_waitcnt vmcnt(16) lgkmcnt(0)
    v_mfma_f32_16x16x32_bf16 v[172:175], a[48:51], a[108:111], v[172:175]
    s_barrier
    v_mfma_f32_16x16x32_bf16 v[64:67], a[0:3], a[96:99], v[64:67]
    s_addk_i32 m0, 4096
    ds_read_b128 a[104:107], v2 offset:53248
    s_add_u32 s59, s47, s75
    s_mov_b64 s[22:23], -1
    s_load_dword s22, s[20:21], 0
    s_load_dword s23, s[20:21], 8192
    v_mfma_f32_16x16x32_bf16 v[64:67], a[8:11], a[112:115], v[64:67]
    buffer_load_dwordx4 v1, s[8:11], s59 offen lds
    v_mfma_f32_16x16x32_bf16 v[80:83], a[12:15], a[112:115], v[80:83]
    ds_read_b128 a[120:123], v3 offset:53248
    v_mfma_f32_16x16x32_bf16 v[80:83], a[4:7], a[96:99], v[80:83]
    s_addk_i32 m0, 4096
    ds_read_b128 a[108:111], v2 offset:55296
    v_mfma_f32_16x16x32_bf16 v[96:99], a[16:19], a[96:99], v[96:99]
    s_add_u32 s59, s47, s75
    ds_read_b128 a[124:127], v3 offset:55296
    v_mfma_f32_16x16x32_bf16 v[96:99], a[24:27], a[112:115], v[96:99]
    buffer_load_dwordx4 v34, s[8:11], s59 offen lds
    v_mfma_f32_16x16x32_bf16 v[112:115], a[28:31], a[112:115], v[112:115]
    ds_read_b64_tr_b16 a[48:49], v6 offset:24576
    v_mfma_f32_16x16x32_bf16 v[112:115], a[20:23], a[96:99], v[112:115]
    ds_read_b64_tr_b16 a[50:51], v6 offset:26624
    v_mfma_f32_16x16x32_bf16 v[128:131], a[32:35], a[96:99], v[128:131]
    s_add_u32 s47, s47, 589824
    s_sub_u32 s67, s47, 3538944
    s_min_u32 s47, s47, s67
    v_mfma_f32_16x16x32_bf16 v[128:131], a[40:43], a[112:115], v[128:131]
    s_addk_i32 m0, 4096
    ds_read_b64_tr_b16 a[52:53], v7 offset:24576
    s_add_u32 s59, s47, s70
    v_mfma_f32_16x16x32_bf16 v[144:147], a[44:47], a[112:115], v[144:147]
    buffer_load_dwordx4 v1, s[8:11], s59 offen lds
    v_mfma_f32_16x16x32_bf16 v[144:147], a[36:39], a[96:99], v[144:147]
    ds_read_b64_tr_b16 a[54:55], v7 offset:26624
    v_mfma_f32_16x16x32_bf16 v[148:151], a[36:39], a[100:103], v[148:151]
    s_addk_i32 m0, 4096
    ds_read_b64_tr_b16 a[56:57], v6 offset:28672
    v_mfma_f32_16x16x32_bf16 v[148:151], a[44:47], a[116:119], v[148:151]
    s_add_u32 s59, s47, s70
    ds_read_b64_tr_b16 a[58:59], v6 offset:30720
    v_mfma_f32_16x16x32_bf16 v[132:135], a[40:43], a[116:119], v[132:135]
    buffer_load_dwordx4 v34, s[8:11], s59 offen lds
    v_mfma_f32_16x16x32_bf16 v[132:135], a[32:35], a[100:103], v[132:135]
    ds_read_b64_tr_b16 a[60:61], v7 offset:28672
    v_mfma_f32_16x16x32_bf16 v[116:119], a[20:23], a[100:103], v[116:119]
    ds_read_b64_tr_b16 a[62:63], v7 offset:30720
    v_mfma_f32_16x16x32_bf16 v[116:119], a[28:31], a[116:119], v[116:119]
    s_addk_i32 m0, 4096
    ds_read_b64_tr_b16 a[64:65], v6 offset:32768
    v_mfma_f32_16x16x32_bf16 v[100:103], a[24:27], a[116:119], v[100:103]
    s_add_u32 s59, s47, s71
    ds_read_b64_tr_b16 a[66:67], v6 offset:34816
    v_mfma_f32_16x16x32_bf16 v[100:103], a[16:19], a[100:103], v[100:103]
    buffer_load_dwordx4 v1, s[8:11], s59 offen lds
    v_mfma_f32_16x16x32_bf16 v[84:87], a[4:7], a[100:103], v[84:87]
    ds_read_b64_tr_b16 a[68:69], v7 offset:32768
    v_mfma_f32_16x16x32_bf16 v[84:87], a[12:15], a[116:119], v[84:87]
    s_addk_i32 m0, 4096
    ds_read_b64_tr_b16 a[70:71], v7 offset:34816
    v_mfma_f32_16x16x32_bf16 v[68:71], a[8:11], a[116:119], v[68:71]
    s_waitcnt lgkmcnt(8)
    ds_read_b64_tr_b16 a[72:73], v6 offset:36864
    s_add_u32 s59, s47, s71
    v_mfma_f32_16x16x32_bf16 v[68:71], a[0:3], a[100:103], v[68:71]
    buffer_load_dwordx4 v34, s[8:11], s59 offen lds
    v_mfma_f32_16x16x32_bf16 v[72:75], a[0:3], a[104:107], v[72:75]
    ds_read_b64_tr_b16 a[74:75], v6 offset:38912
    v_mfma_f32_16x16x32_bf16 v[72:75], a[8:11], a[120:123], v[72:75]
    ds_read_b64_tr_b16 a[76:77], v7 offset:36864
    v_mfma_f32_16x16x32_bf16 v[88:91], a[12:15], a[120:123], v[88:91]
    s_addk_i32 m0, 4096
    ds_read_b64_tr_b16 a[78:79], v7 offset:38912
    v_mfma_f32_16x16x32_bf16 v[88:91], a[4:7], a[104:107], v[88:91]
    s_add_u32 s59, s47, s72
    ds_read_b64_tr_b16 a[80:81], v6 offset:40960
    v_mfma_f32_16x16x32_bf16 v[104:107], a[16:19], a[104:107], v[104:107]
    buffer_load_dwordx4 v1, s[8:11], s59 offen lds
    v_mfma_f32_16x16x32_bf16 v[104:107], a[24:27], a[120:123], v[104:107]
    ds_read_b64_tr_b16 a[82:83], v6 offset:43008
    v_mfma_f32_16x16x32_bf16 v[120:123], a[28:31], a[120:123], v[120:123]
    s_addk_i32 m0, 4096
    ds_read_b64_tr_b16 a[84:85], v7 offset:40960
    v_mfma_f32_16x16x32_bf16 v[120:123], a[20:23], a[104:107], v[120:123]
    s_add_u32 s59, s47, s72
    ds_read_b64_tr_b16 a[86:87], v7 offset:43008
    v_mfma_f32_16x16x32_bf16 v[136:139], a[32:35], a[104:107], v[136:139]
    buffer_load_dwordx4 v34, s[8:11], s59 offen lds
    v_mfma_f32_16x16x32_bf16 v[136:139], a[40:43], a[120:123], v[136:139]
    ds_read_b64_tr_b16 a[88:89], v6 offset:45056
    v_mfma_f32_16x16x32_bf16 v[152:155], a[44:47], a[120:123], v[152:155]
    ds_read_b64_tr_b16 a[90:91], v6 offset:47104
    v_mfma_f32_16x16x32_bf16 v[152:155], a[36:39], a[104:107], v[152:155]
    s_add_u32 s46, s46, 128
    s_sub_u32 s67, s46, 768
    s_min_u32 s46, s46, s67
    v_mfma_f32_16x16x32_bf16 v[156:159], a[36:39], a[108:111], v[156:159]
    s_add_u32 m0, s60, 16384
    ds_read_b64_tr_b16 a[92:93], v7 offset:45056
    v_mfma_f32_16x16x32_bf16 v[156:159], a[44:47], a[124:127], v[156:159]
    buffer_load_dwordx4 v8, s[4:7], s46 offen lds
    v_mfma_f32_16x16x32_bf16 v[140:143], a[40:43], a[124:127], v[140:143]
    ds_read_b64_tr_b16 a[94:95], v7 offset:47104
    v_mfma_f32_16x16x32_bf16 v[140:143], a[32:35], a[108:111], v[140:143]
    v_mfma_f32_16x16x32_bf16 v[124:127], a[20:23], a[108:111], v[124:127]
    s_addk_i32 m0, 1024
    v_mfma_f32_16x16x32_bf16 v[124:127], a[28:31], a[124:127], v[124:127]
    buffer_load_dwordx4 v9, s[4:7], s46 offen lds
    v_mfma_f32_16x16x32_bf16 v[108:111], a[24:27], a[124:127], v[108:111]
    v_mfma_f32_16x16x32_bf16 v[108:111], a[16:19], a[108:111], v[108:111]
    v_mfma_f32_16x16x32_bf16 v[92:95], a[4:7], a[108:111], v[92:95]
    v_mfma_f32_16x16x32_bf16 v[92:95], a[12:15], a[124:127], v[92:95]
    v_mfma_f32_16x16x32_bf16 v[76:79], a[8:11], a[124:127], v[76:79]
    s_waitcnt vmcnt(14) lgkmcnt(0)
    v_mfma_f32_16x16x32_bf16 v[76:79], a[0:3], a[108:111], v[76:79]
    s_barrier
    v_mfma_f32_16x16x32_bf16 v[160:163], a[48:51], a[96:99], v[160:163]
    s_addk_i32 m0, 1024
    ds_read_b64_tr_b16 a[0:1], v4 offset:0
    s_mov_b64 s[22:23], -1
    s_load_dword s23, s[20:21], 8320
    s_load_dword s22, s[20:21], 128
    v_mfma_f32_16x16x32_bf16 v[160:163], a[56:59], a[112:115], v[160:163]
    buffer_load_dwordx4 v10, s[4:7], s46 offen lds
    v_mfma_f32_16x16x32_bf16 v[176:179], a[60:63], a[112:115], v[176:179]
    ds_read_b64_tr_b16 a[2:3], v4 offset:2048
    v_mfma_f32_16x16x32_bf16 v[176:179], a[52:55], a[96:99], v[176:179]
    ds_read_b64_tr_b16 a[4:5], v5 offset:0
    v_mfma_f32_16x16x32_bf16 v[192:195], a[64:67], a[96:99], v[192:195]
    s_addk_i32 m0, 1024
    ds_read_b64_tr_b16 a[6:7], v5 offset:2048
    v_mfma_f32_16x16x32_bf16 v[192:195], a[72:75], a[112:115], v[192:195]
    buffer_load_dwordx4 v11, s[4:7], s46 offen lds
    v_mfma_f32_16x16x32_bf16 v[208:211], a[76:79], a[112:115], v[208:211]
    ds_read_b64_tr_b16 a[8:9], v4 offset:4096
    v_mfma_f32_16x16x32_bf16 v[208:211], a[68:71], a[96:99], v[208:211]
    ds_read_b64_tr_b16 a[10:11], v4 offset:6144
    v_mfma_f32_16x16x32_bf16 v[224:227], a[80:83], a[96:99], v[224:227]
    ds_read_b64_tr_b16 a[12:13], v5 offset:4096
    v_mfma_f32_16x16x32_bf16 v[224:227], a[88:91], a[112:115], v[224:227]
    s_addk_i32 m0, 12544
    ds_read_b64_tr_b16 a[14:15], v5 offset:6144
    v_mfma_f32_16x16x32_bf16 v[240:243], a[92:95], a[112:115], v[240:243]
    buffer_load_dwordx4 v8, s[4:7], 0 offen offset:768 lds
    v_mfma_f32_16x16x32_bf16 v[240:243], a[84:87], a[96:99], v[240:243]
    ds_read_b64_tr_b16 a[16:17], v4 offset:8192
    v_mfma_f32_16x16x32_bf16 v[244:247], a[84:87], a[100:103], v[244:247]
    ds_read_b64_tr_b16 a[18:19], v4 offset:10240
    v_mfma_f32_16x16x32_bf16 v[244:247], a[92:95], a[116:119], v[244:247]
    s_addk_i32 m0, 1024
    ds_read_b64_tr_b16 a[20:21], v5 offset:8192
    v_mfma_f32_16x16x32_bf16 v[228:231], a[88:91], a[116:119], v[228:231]
    buffer_load_dwordx4 v9, s[4:7], 0 offen offset:768 lds
    v_mfma_f32_16x16x32_bf16 v[228:231], a[80:83], a[100:103], v[228:231]
    s_add_u32 s61, s61, s22
    s_sub_u32 s61, s61, s23
    ds_read_b64_tr_b16 a[22:23], v5 offset:10240
    v_mfma_f32_16x16x32_bf16 v[212:215], a[68:71], a[100:103], v[212:215]
    s_add_u32 s61, s61, s22
    s_sub_u32 s61, s61, s23
    ds_read_b64_tr_b16 a[24:25], v4 offset:12288
    v_mfma_f32_16x16x32_bf16 v[212:215], a[76:79], a[116:119], v[212:215]
    s_add_u32 s61, s61, s22
    s_sub_u32 s61, s61, s23
    ds_read_b64_tr_b16 a[26:27], v4 offset:14336
    v_mfma_f32_16x16x32_bf16 v[196:199], a[72:75], a[116:119], v[196:199]
    s_addk_i32 m0, 1024
    ds_read_b64_tr_b16 a[28:29], v5 offset:12288
    v_mfma_f32_16x16x32_bf16 v[196:199], a[64:67], a[100:103], v[196:199]
    buffer_load_dwordx4 v10, s[4:7], 0 offen offset:768 lds
    v_mfma_f32_16x16x32_bf16 v[180:183], a[52:55], a[100:103], v[180:183]
    s_add_u32 s61, s61, s22
    s_sub_u32 s61, s61, s23
    ds_read_b64_tr_b16 a[30:31], v5 offset:14336
    v_mfma_f32_16x16x32_bf16 v[180:183], a[60:63], a[116:119], v[180:183]
    s_add_u32 s61, s61, s22
    s_sub_u32 s61, s61, s23
    ds_read_b64_tr_b16 a[32:33], v4 offset:16384
    v_mfma_f32_16x16x32_bf16 v[164:167], a[56:59], a[116:119], v[164:167]
    s_addk_i32 m0, 1024
    ds_read_b64_tr_b16 a[34:35], v4 offset:18432
    v_mfma_f32_16x16x32_bf16 v[164:167], a[48:51], a[100:103], v[164:167]
    buffer_load_dwordx4 v11, s[4:7], 0 offen offset:768 lds
    v_mfma_f32_16x16x32_bf16 v[168:171], a[48:51], a[104:107], v[168:171]
    s_add_u32 s61, s61, s22
    s_sub_u32 s61, s61, s23
    ds_read_b128 a[96:99], v2 offset:0
    v_mfma_f32_16x16x32_bf16 v[168:171], a[56:59], a[120:123], v[168:171]
    s_add_u32 s61, s61, s22
    s_sub_u32 s61, s61, s23
    ds_read_b128 a[112:115], v3 offset:0
    v_mfma_f32_16x16x32_bf16 v[184:187], a[60:63], a[120:123], v[184:187]
    s_add_u32 m0, s58, 73728
    ds_read_b128 a[100:103], v2 offset:2048
    v_mfma_f32_16x16x32_bf16 v[184:187], a[52:55], a[104:107], v[184:187]
    s_add_u32 s59, s47, s73
    ds_read_b128 a[116:119], v3 offset:2048
    v_mfma_f32_16x16x32_bf16 v[200:203], a[64:67], a[104:107], v[200:203]
    buffer_load_dwordx4 v1, s[8:11], s59 offen lds
    v_mfma_f32_16x16x32_bf16 v[200:203], a[72:75], a[120:123], v[200:203]
    s_add_u32 s61, s61, s22
    s_sub_u32 s61, s61, s23
    ds_read_b64_tr_b16 a[36:37], v5 offset:16384
    v_mfma_f32_16x16x32_bf16 v[216:219], a[76:79], a[120:123], v[216:219]
    s_addk_i32 m0, 4096
    ds_read_b64_tr_b16 a[38:39], v5 offset:18432
    v_mfma_f32_16x16x32_bf16 v[216:219], a[68:71], a[104:107], v[216:219]
    s_add_u32 s59, s47, s73
    ds_read_b64_tr_b16 a[40:41], v4 offset:20480
    v_mfma_f32_16x16x32_bf16 v[232:235], a[80:83], a[104:107], v[232:235]
    buffer_load_dwordx4 v34, s[8:11], s59 offen lds
    v_mfma_f32_16x16x32_bf16 v[232:235], a[88:91], a[120:123], v[232:235]
    s_add_u32 s61, s61, s22
    s_sub_u32 s61, s61, s23
    ds_read_b64_tr_b16 a[42:43], v4 offset:22528
    v_mfma_f32_16x16x32_bf16 v[248:251], a[92:95], a[120:123], v[248:251]
    s_add_u32 s61, s61, s22
    s_sub_u32 s61, s61, s23
    ds_read_b64_tr_b16 a[44:45], v5 offset:20480
    v_mfma_f32_16x16x32_bf16 v[248:251], a[84:87], a[104:107], v[248:251]
    s_addk_i32 m0, 4096
    ds_read_b64_tr_b16 a[46:47], v5 offset:22528
    v_mfma_f32_16x16x32_bf16 v[252:255], a[84:87], a[108:111], v[252:255]
    s_add_u32 s59, s47, s74
    v_mfma_f32_16x16x32_bf16 v[252:255], a[92:95], a[124:127], v[252:255]
    buffer_load_dwordx4 v1, s[8:11], s59 offen lds
    v_mfma_f32_16x16x32_bf16 v[236:239], a[88:91], a[124:127], v[236:239]
    v_mfma_f32_16x16x32_bf16 v[236:239], a[80:83], a[108:111], v[236:239]
    s_addk_i32 m0, 4096
    v_mfma_f32_16x16x32_bf16 v[220:223], a[68:71], a[108:111], v[220:223]
    s_add_u32 s59, s47, s74
    v_mfma_f32_16x16x32_bf16 v[220:223], a[76:79], a[124:127], v[220:223]
    buffer_load_dwordx4 v34, s[8:11], s59 offen lds
    v_mfma_f32_16x16x32_bf16 v[204:207], a[72:75], a[124:127], v[204:207]
    v_mfma_f32_16x16x32_bf16 v[204:207], a[64:67], a[108:111], v[204:207]
    v_mfma_f32_16x16x32_bf16 v[188:191], a[52:55], a[108:111], v[188:191]
    v_mfma_f32_16x16x32_bf16 v[188:191], a[60:63], a[124:127], v[188:191]
    v_mfma_f32_16x16x32_bf16 v[172:175], a[56:59], a[124:127], v[172:175]
    s_waitcnt lgkmcnt(1)
    s_sub_u32 s57, s22, s23
    s_lshl1_add_u32 s61, s57, s61
    s_waitcnt vmcnt(18) lgkmcnt(0)
    v_mfma_f32_16x16x32_bf16 v[172:175], a[48:51], a[108:111], v[172:175]
    s_barrier
    v_mfma_f32_16x16x32_bf16 v[64:67], a[0:3], a[96:99], v[64:67]
    s_addk_i32 m0, 4096
    ds_read_b128 a[104:107], v2 offset:4096
    s_add_u32 s59, s47, s75
    s_mov_b64 s[22:23], -1
    s_load_dword s22, s[20:21], 256
    s_load_dword s23, s[20:21], 8448
    v_mfma_f32_16x16x32_bf16 v[64:67], a[8:11], a[112:115], v[64:67]
    buffer_load_dwordx4 v1, s[8:11], s59 offen lds
    v_mfma_f32_16x16x32_bf16 v[80:83], a[12:15], a[112:115], v[80:83]
    s_addk_i32 m0, 4096
    ds_read_b128 a[120:123], v3 offset:4096
    v_mfma_f32_16x16x32_bf16 v[80:83], a[4:7], a[96:99], v[80:83]
    s_add_u32 s59, s47, s75
    ds_read_b128 a[108:111], v2 offset:6144
    v_mfma_f32_16x16x32_bf16 v[96:99], a[16:19], a[96:99], v[96:99]
    buffer_load_dwordx4 v34, s[8:11], s59 offen lds
    v_mfma_f32_16x16x32_bf16 v[96:99], a[24:27], a[112:115], v[96:99]
    ds_read_b128 a[124:127], v3 offset:6144
    v_mfma_f32_16x16x32_bf16 v[112:115], a[28:31], a[112:115], v[112:115]
    ds_read_b64_tr_b16 a[48:49], v4 offset:24576
    v_mfma_f32_16x16x32_bf16 v[112:115], a[20:23], a[96:99], v[112:115]
    s_add_u32 m0, s60, 48256
    ds_read_b64_tr_b16 a[50:51], v4 offset:26624
    v_mfma_f32_16x16x32_bf16 v[128:131], a[32:35], a[96:99], v[128:131]
    buffer_load_dwordx4 v8, s[4:7], 0 offen offset:896 lds
    v_mfma_f32_16x16x32_bf16 v[128:131], a[40:43], a[112:115], v[128:131]
    ds_read_b64_tr_b16 a[52:53], v5 offset:24576
    v_mfma_f32_16x16x32_bf16 v[144:147], a[44:47], a[112:115], v[144:147]
    ds_read_b64_tr_b16 a[54:55], v5 offset:26624
    v_mfma_f32_16x16x32_bf16 v[144:147], a[36:39], a[96:99], v[144:147]
    s_addk_i32 m0, 1024
    ds_read_b64_tr_b16 a[56:57], v4 offset:28672
    v_mfma_f32_16x16x32_bf16 v[148:151], a[36:39], a[100:103], v[148:151]
    buffer_load_dwordx4 v9, s[4:7], 0 offen offset:896 lds
    v_mfma_f32_16x16x32_bf16 v[148:151], a[44:47], a[116:119], v[148:151]
    ds_read_b64_tr_b16 a[58:59], v4 offset:30720
    v_mfma_f32_16x16x32_bf16 v[132:135], a[40:43], a[116:119], v[132:135]
    s_add_u32 s61, s61, s22
    s_sub_u32 s61, s61, s23
    ds_read_b64_tr_b16 a[60:61], v5 offset:28672
    v_mfma_f32_16x16x32_bf16 v[132:135], a[32:35], a[100:103], v[132:135]
    s_addk_i32 m0, 1024
    ds_read_b64_tr_b16 a[62:63], v5 offset:30720
    v_mfma_f32_16x16x32_bf16 v[116:119], a[20:23], a[100:103], v[116:119]
    buffer_load_dwordx4 v10, s[4:7], 0 offen offset:896 lds
    v_mfma_f32_16x16x32_bf16 v[116:119], a[28:31], a[116:119], v[116:119]
    s_add_u32 s61, s61, s22
    s_sub_u32 s61, s61, s23
    ds_read_b64_tr_b16 a[64:65], v4 offset:32768
    v_mfma_f32_16x16x32_bf16 v[100:103], a[24:27], a[116:119], v[100:103]
    s_addk_i32 m0, 1024
    ds_read_b64_tr_b16 a[66:67], v4 offset:34816
    v_mfma_f32_16x16x32_bf16 v[100:103], a[16:19], a[100:103], v[100:103]
    buffer_load_dwordx4 v11, s[4:7], 0 offen offset:896 lds
    v_mfma_f32_16x16x32_bf16 v[84:87], a[4:7], a[100:103], v[84:87]
    s_add_u32 s61, s61, s22
    s_sub_u32 s61, s61, s23
    ds_read_b64_tr_b16 a[68:69], v5 offset:32768
    v_mfma_f32_16x16x32_bf16 v[84:87], a[12:15], a[116:119], v[84:87]
    s_add_u32 s61, s61, s22
    s_sub_u32 s61, s61, s23
    ds_read_b64_tr_b16 a[70:71], v5 offset:34816
    v_mfma_f32_16x16x32_bf16 v[68:71], a[8:11], a[116:119], v[68:71]
    s_waitcnt lgkmcnt(8)
    ds_read_b64_tr_b16 a[72:73], v4 offset:36864
    v_mfma_f32_16x16x32_bf16 v[68:71], a[0:3], a[100:103], v[68:71]
    buffer_store_dwordx4 v[14:17], v39, s[16:19], s42 offen offset:2048 sc1
    v_mfma_f32_16x16x32_bf16 v[72:75], a[0:3], a[104:107], v[72:75]
    s_add_u32 s61, s61, s22
    s_sub_u32 s61, s61, s23
    ds_read_b64_tr_b16 a[74:75], v4 offset:38912
    v_mfma_f32_16x16x32_bf16 v[72:75], a[8:11], a[120:123], v[72:75]
    s_add_u32 s61, s61, s22
    s_sub_u32 s61, s61, s23
    ds_read_b64_tr_b16 a[76:77], v5 offset:36864
    v_mfma_f32_16x16x32_bf16 v[88:91], a[12:15], a[120:123], v[88:91]
    s_add_u32 s61, s61, s22
    s_sub_u32 s61, s61, s23
    ds_read_b64_tr_b16 a[78:79], v5 offset:38912
    v_mfma_f32_16x16x32_bf16 v[88:91], a[4:7], a[104:107], v[88:91]
    buffer_store_dwordx4 v[14:17], v39, s[16:19], s42 offen offset:3072 sc1
    v_mfma_f32_16x16x32_bf16 v[104:107], a[16:19], a[104:107], v[104:107]
    s_add_u32 s61, s61, s22
    s_sub_u32 s61, s61, s23
    ds_read_b64_tr_b16 a[80:81], v4 offset:40960
    v_mfma_f32_16x16x32_bf16 v[104:107], a[24:27], a[120:123], v[104:107]
    s_add_u32 m0, s58, 0
    ds_read_b64_tr_b16 a[82:83], v4 offset:43008
    v_mfma_f32_16x16x32_bf16 v[120:123], a[28:31], a[120:123], v[120:123]
    s_add_u32 s59, s70, 3538944
    ds_read_b64_tr_b16 a[84:85], v5 offset:40960
    v_mfma_f32_16x16x32_bf16 v[120:123], a[20:23], a[104:107], v[120:123]
    buffer_load_dwordx4 v1, s[8:11], s59 offen lds
    v_mfma_f32_16x16x32_bf16 v[136:139], a[32:35], a[104:107], v[136:139]
    s_addk_i32 m0, 4096
    ds_read_b64_tr_b16 a[86:87], v5 offset:43008
    v_mfma_f32_16x16x32_bf16 v[136:139], a[40:43], a[120:123], v[136:139]
    s_addk_i32 s59, 0
    ds_read_b64_tr_b16 a[88:89], v4 offset:45056
    v_mfma_f32_16x16x32_bf16 v[152:155], a[44:47], a[120:123], v[152:155]
    buffer_load_dwordx4 v34, s[8:11], s59 offen lds
    v_mfma_f32_16x16x32_bf16 v[152:155], a[36:39], a[104:107], v[152:155]
    s_add_u32 s61, s61, s22
    s_sub_u32 s61, s61, s23
    ds_read_b64_tr_b16 a[90:91], v4 offset:47104
    v_mfma_f32_16x16x32_bf16 v[156:159], a[36:39], a[108:111], v[156:159]
    s_addk_i32 m0, 4096
    ds_read_b64_tr_b16 a[92:93], v5 offset:45056
    v_mfma_f32_16x16x32_bf16 v[156:159], a[44:47], a[124:127], v[156:159]
    s_add_u32 s59, s70, 4128768
    ds_read_b64_tr_b16 a[94:95], v5 offset:47104
    v_mfma_f32_16x16x32_bf16 v[140:143], a[40:43], a[124:127], v[140:143]
    buffer_load_dwordx4 v1, s[8:11], s59 offen lds
    v_mfma_f32_16x16x32_bf16 v[140:143], a[32:35], a[108:111], v[140:143]
    v_mfma_f32_16x16x32_bf16 v[124:127], a[20:23], a[108:111], v[124:127]
    s_addk_i32 m0, 4096
    v_mfma_f32_16x16x32_bf16 v[124:127], a[28:31], a[124:127], v[124:127]
    s_addk_i32 s59, 0
    v_mfma_f32_16x16x32_bf16 v[108:111], a[24:27], a[124:127], v[108:111]
    buffer_load_dwordx4 v34, s[8:11], s59 offen lds
    v_mfma_f32_16x16x32_bf16 v[108:111], a[16:19], a[108:111], v[108:111]
    v_mfma_f32_16x16x32_bf16 v[92:95], a[4:7], a[108:111], v[92:95]
    v_mfma_f32_16x16x32_bf16 v[92:95], a[12:15], a[124:127], v[92:95]
    v_mfma_f32_16x16x32_bf16 v[76:79], a[8:11], a[124:127], v[76:79]
    s_waitcnt lgkmcnt(1)
    s_sub_u32 s57, s22, s23
    s_lshl1_add_u32 s61, s57, s61
    s_waitcnt vmcnt(16) lgkmcnt(0)
    v_mfma_f32_16x16x32_bf16 v[76:79], a[0:3], a[108:111], v[76:79]
    s_barrier
    v_mfma_f32_16x16x32_bf16 v[160:163], a[48:51], a[96:99], v[160:163]
    s_addk_i32 m0, 4096
    ds_read_b64_tr_b16 a[0:1], v6 offset:0
    s_add_u32 s59, s70, 4718592
    s_mov_b64 s[22:23], -1
    s_load_dword s23, s[20:21], 8576
    s_load_dword s22, s[20:21], 384
    v_mfma_f32_16x16x32_bf16 v[160:163], a[56:59], a[112:115], v[160:163]
    buffer_load_dwordx4 v1, s[8:11], s59 offen lds
    v_mfma_f32_16x16x32_bf16 v[176:179], a[60:63], a[112:115], v[176:179]
    s_lshl_b32 s55, s54, 12
    ds_read_b64_tr_b16 a[2:3], v6 offset:2048
    v_mfma_f32_16x16x32_bf16 v[176:179], a[52:55], a[96:99], v[176:179]
    s_addk_i32 m0, 4096
    ds_read_b64_tr_b16 a[4:5], v7 offset:0
    s_xor_b32 s56, s55, 4096
    v_mfma_f32_16x16x32_bf16 v[192:195], a[64:67], a[96:99], v[192:195]
    s_addk_i32 s59, 0
    ds_read_b64_tr_b16 a[6:7], v7 offset:2048
    v_add_u32 v17, s55, v4
    v_mfma_f32_16x16x32_bf16 v[192:195], a[72:75], a[112:115], v[192:195]
    buffer_load_dwordx4 v34, s[8:11], s59 offen lds
    v_mfma_f32_16x16x32_bf16 v[208:211], a[76:79], a[112:115], v[208:211]
    ds_read_b64_tr_b16 a[8:9], v6 offset:4096
    v_add_u32 v18, s56, v4
    v_mfma_f32_16x16x32_bf16 v[208:211], a[68:71], a[96:99], v[208:211]
    ds_read_b64_tr_b16 a[10:11], v6 offset:6144
    v_add_u32 v13, 49152, v17
    v_mfma_f32_16x16x32_bf16 v[224:227], a[80:83], a[96:99], v[224:227]
    ds_read_b64_tr_b16 a[12:13], v7 offset:4096
    v_add_u32 v14, 49152, v18
    v_mfma_f32_16x16x32_bf16 v[224:227], a[88:91], a[112:115], v[224:227]
    s_add_u32 m0, s60, -1024
    ds_read_b64_tr_b16 a[14:15], v7 offset:6144
    v_add_u32 v21, 98304, v17
    v_mfma_f32_16x16x32_bf16 v[240:243], a[92:95], a[112:115], v[240:243]
    buffer_load_dwordx4 v8, s[4:7], 0 offen offset:1024 lds
L_stubF3:
    s_cbranch_execz L_jrF0
    s_nop 0
    v_mfma_f32_16x16x32_bf16 v[240:243], a[84:87], a[96:99], v[240:243]
    ds_read_b64_tr_b16 a[16:17], v6 offset:8192
    v_add_u32 v22, 98304, v18
    v_mfma_f32_16x16x32_bf16 v[244:247], a[84:87], a[100:103], v[244:247]
    ds_read_b64_tr_b16 a[18:19], v6 offset:10240
    v_add_u32 v19, s55, v5
    v_mfma_f32_16x16x32_bf16 v[244:247], a[92:95], a[116:119], v[244:247]
    s_add_u32 m0, s60, 0
    ds_read_b64_tr_b16 a[20:21], v7 offset:8192
    v_add_u32 v20, s56, v5
    v_mfma_f32_16x16x32_bf16 v[228:231], a[88:91], a[116:119], v[228:231]
    buffer_load_dwordx4 v9, s[4:7], 0 offen offset:1024 lds
    v_mfma_f32_16x16x32_bf16 v[228:231], a[80:83], a[100:103], v[228:231]
    ds_read_b64_tr_b16 a[22:23], v7 offset:10240
    v_add_u32 v15, 49152, v19
    v_mfma_f32_16x16x32_bf16 v[212:215], a[68:71], a[100:103], v[212:215]
    ds_read_b64_tr_b16 a[24:25], v6 offset:12288
    v_add_u32 v16, 49152, v20
    v_mfma_f32_16x16x32_bf16 v[212:215], a[76:79], a[116:119], v[212:215]
    ds_read_b64_tr_b16 a[26:27], v6 offset:14336
    v_add_u32 v23, 98304, v19
    v_mfma_f32_16x16x32_bf16 v[196:199], a[72:75], a[116:119], v[196:199]
    s_addk_i32 m0, 1024
    ds_read_b64_tr_b16 a[28:29], v7 offset:12288
    v_add_u32 v24, 98304, v20
    v_mfma_f32_16x16x32_bf16 v[196:199], a[64:67], a[100:103], v[196:199]
    buffer_load_dwordx4 v10, s[4:7], 0 offen offset:1024 lds
    v_mfma_f32_16x16x32_bf16 v[180:183], a[52:55], a[100:103], v[180:183]
    s_add_u32 s61, s61, s22
    s_sub_u32 s61, s61, s23
    ds_read_b64_tr_b16 a[30:31], v7 offset:14336
    v_mfma_f32_16x16x32_bf16 v[180:183], a[60:63], a[116:119], v[180:183]
    s_add_u32 s61, s61, s22
    s_sub_u32 s61, s61, s23
    ds_read_b64_tr_b16 a[32:33], v6 offset:16384
    v_mfma_f32_16x16x32_bf16 v[164:167], a[56:59], a[116:119], v[164:167]
    s_addk_i32 m0, 1024
    ds_read_b64_tr_b16 a[34:35], v6 offset:18432
    v_mfma_f32_16x16x32_bf16 v[164:167], a[48:51], a[100:103], v[164:167]
    buffer_load_dwordx4 v11, s[4:7], 0 offen offset:1024 lds
    v_mfma_f32_16x16x32_bf16 v[168:171], a[48:51], a[104:107], v[168:171]
    s_add_u32 s61, s61, s22
    s_sub_u32 s61, s61, s23
    ds_read_b128 a[96:99], v2 offset:16384
    v_mfma_f32_16x16x32_bf16 v[168:171], a[56:59], a[120:123], v[168:171]
    s_add_u32 s61, s61, s22
    s_sub_u32 s61, s61, s23
    ds_read_b128 a[112:115], v3 offset:16384
    v_mfma_f32_16x16x32_bf16 v[184:187], a[60:63], a[120:123], v[184:187]
    s_add_u32 m0, s58, 24576
    ds_read_b128 a[100:103], v2 offset:18432
    v_mfma_f32_16x16x32_bf16 v[184:187], a[52:55], a[104:107], v[184:187]
    s_add_u32 s59, s71, 3538944
    ds_read_b128 a[116:119], v3 offset:18432
    v_mfma_f32_16x16x32_bf16 v[200:203], a[64:67], a[104:107], v[200:203]
    buffer_load_dwordx4 v1, s[8:11], s59 offen lds
    v_mfma_f32_16x16x32_bf16 v[200:203], a[72:75], a[120:123], v[200:203]
    s_add_u32 s61, s61, s22
    s_sub_u32 s61, s61, s23
    ds_read_b64_tr_b16 a[36:37], v7 offset:16384
    v_mfma_f32_16x16x32_bf16 v[216:219], a[76:79], a[120:123], v[216:219]
    s_addk_i32 m0, 4096
    ds_read_b64_tr_b16 a[38:39], v7 offset:18432
    v_mfma_f32_16x16x32_bf16 v[216:219], a[68:71], a[104:107], v[216:219]
    s_addk_i32 s59, 0
    ds_read_b64_tr_b16 a[40:41], v6 offset:20480
    v_mfma_f32_16x16x32_bf16 v[232:235], a[80:83], a[104:107], v[232:235]
    buffer_load_dwordx4 v34, s[8:11], s59 offen lds
    v_mfma_f32_16x16x32_bf16 v[232:235], a[88:91], a[120:123], v[232:235]
    s_add_u32 s61, s61, s22
    s_sub_u32 s61, s61, s23
    ds_read_b64_tr_b16 a[42:43], v6 offset:22528
    v_mfma_f32_16x16x32_bf16 v[248:251], a[92:95], a[120:123], v[248:251]
    s_add_u32 s61, s61, s22
    s_sub_u32 s61, s61, s23
    ds_read_b64_tr_b16 a[44:45], v7 offset:20480
    v_mfma_f32_16x16x32_bf16 v[248:251], a[84:87], a[104:107], v[248:251]
    s_addk_i32 m0, 4096
    ds_read_b64_tr_b16 a[46:47], v7 offset:22528
    v_mfma_f32_16x16x32_bf16 v[252:255], a[84:87], a[108:111], v[252:255]
    s_add_u32 s59, s71, 4128768
    ds_read_b128 a[128:131], v2 offset:32768
    v_mfma_f32_16x16x32_bf16 v[252:255], a[92:95], a[124:127], v[252:255]
    buffer_load_dwordx4 v1, s[8:11], s59 offen lds
    v_mfma_f32_16x16x32_bf16 v[236:239], a[88:91], a[124:127], v[236:239]
    ds_read_b128 a[132:135], v2 offset:34816
    v_mfma_f32_16x16x32_bf16 v[236:239], a[80:83], a[108:111], v[236:239]
    s_addk_i32 m0, 4096
    ds_read_b128 a[136:139], v2 offset:36864
    v_mfma_f32_16x16x32_bf16 v[220:223], a[68:71], a[108:111], v[220:223]
    s_addk_i32 s59, 0
    ds_read_b128 a[140:143], v2 offset:38912
    v_mfma_f32_16x16x32_bf16 v[220:223], a[76:79], a[124:127], v[220:223]
    buffer_load_dwordx4 v34, s[8:11], s59 offen lds
    v_mfma_f32_16x16x32_bf16 v[204:207], a[72:75], a[124:127], v[204:207]
    v_mfma_f32_16x16x32_bf16 v[204:207], a[64:67], a[108:111], v[204:207]
    v_mfma_f32_16x16x32_bf16 v[188:191], a[52:55], a[108:111], v[188:191]
    v_mfma_f32_16x16x32_bf16 v[188:191], a[60:63], a[124:127], v[188:191]
    v_mfma_f32_16x16x32_bf16 v[172:175], a[56:59], a[124:127], v[172:175]
    s_waitcnt lgkmcnt(1)
    s_sub_u32 s57, s22, s23
    s_lshl1_add_u32 s61, s57, s61
    s_waitcnt vmcnt(16) lgkmcnt(0)
    v_mfma_f32_16x16x32_bf16 v[172:175], a[48:51], a[108:111], v[172:175]
    s_barrier
    v_mfma_f32_16x16x32_bf16 v[64:67], a[0:3], a[96:99], v[64:67]
    s_addk_i32 m0, 4096
    ds_read_b128 a[104:107], v2 offset:20480
    s_add_u32 s59, s71, 4718592
    s_mov_b64 s[22:23], -1
    s_load_dword s22, s[20:21], 512
    s_load_dword s23, s[20:21], 8704
    v_mfma_f32_16x16x32_bf16 v[64:67], a[8:11], a[112:115], v[64:67]
    buffer_load_dwordx4 v1, s[8:11], s59 offen lds
    v_mfma_f32_16x16x32_bf16 v[80:83], a[12:15], a[112:115], v[80:83]
    ds_read_b128 a[120:123], v3 offset:20480
    v_mov_b32 v51, 0
    v_mfma_f32_16x16x32_bf16 v[80:83], a[4:7], a[96:99], v[80:83]
    ds_read_b128 a[108:111], v2 offset:22528
    v_accvgpr_read_b32 v42, a224
    v_mfma_f32_16x16x32_bf16 v[96:99], a[16:19], a[96:99], v[96:99]
    s_addk_i32 m0, 4096
    ds_read_b128 a[124:127], v3 offset:22528
    v_accvgpr_read_b32 v43, a236
    v_mfma_f32_16x16x32_bf16 v[96:99], a[24:27], a[112:115], v[96:99]
    s_addk_i32 s59, 0
    ds_read_b64_tr_b16 a[48:49], v6 offset:24576
    v_lshlrev_b32 v40, 16, v42
    v_mfma_f32_16x16x32_bf16 v[112:115], a[28:31], a[112:115], v[112:115]
    buffer_load_dwordx4 v34, s[8:11], s59 offen lds
    v_mfma_f32_16x16x32_bf16 v[112:115], a[20:23], a[96:99], v[112:115]
    ds_read_b64_tr_b16 a[50:51], v6 offset:26624
    v_lshlrev_b32 v41, 16, v43
    v_mfma_f32_16x16x32_bf16 v[128:131], a[32:35], a[96:99], v[128:131]
    ds_read_b64_tr_b16 a[52:53], v7 offset:24576
    v_and_b32 v42, s83, v42
    v_mfma_f32_16x16x32_bf16 v[128:131], a[40:43], a[112:115], v[128:131]
    ds_read_b64_tr_b16 a[54:55], v7 offset:26624
    v_and_b32 v43, s83, v43
    v_mfma_f32_16x16x32_bf16 v[144:147], a[44:47], a[112:115], v[144:147]
    s_addk_i32 m0, 4096
    ds_read_b64_tr_b16 a[56:57], v6 offset:28672
    v_fmac_f32 v51, v40, v41
    v_mfma_f32_16x16x32_bf16 v[144:147], a[36:39], a[96:99], v[144:147]
    s_add_u32 s59, s72, 3538944
    ds_read_b64_tr_b16 a[58:59], v6 offset:30720
    v_fmac_f32 v51, v42, v43
    v_mfma_f32_16x16x32_bf16 v[148:151], a[36:39], a[100:103], v[148:151]
    buffer_load_dwordx4 v1, s[8:11], s59 offen lds
    v_mfma_f32_16x16x32_bf16 v[148:151], a[44:47], a[116:119], v[148:151]
    ds_read_b64_tr_b16 a[60:61], v7 offset:28672
    v_accvgpr_read_b32 v42, a225
    v_mfma_f32_16x16x32_bf16 v[132:135], a[40:43], a[116:119], v[132:135]
    s_add_u32 s61, s61, s22
    s_sub_u32 s61, s61, s23
    ds_read_b64_tr_b16 a[62:63], v7 offset:30720
    v_accvgpr_read_b32 v43, a237
    v_mfma_f32_16x16x32_bf16 v[132:135], a[32:35], a[100:103], v[132:135]
    s_addk_i32 m0, 4096
    ds_read_b64_tr_b16 a[64:65], v6 offset:32768
    v_lshlrev_b32 v40, 16, v42
    v_mfma_f32_16x16x32_bf16 v[116:119], a[20:23], a[100:103], v[116:119]
    s_addk_i32 s59, 0
    ds_read_b64_tr_b16 a[66:67], v6 offset:34816
    v_lshlrev_b32 v41, 16, v43
    v_mfma_f32_16x16x32_bf16 v[116:119], a[28:31], a[116:119], v[116:119]
    buffer_load_dwordx4 v34, s[8:11], s59 offen lds
    v_mfma_f32_16x16x32_bf16 v[100:103], a[24:27], a[116:119], v[100:103]
    s_add_u32 s61, s61, s22
    s_sub_u32 s61, s61, s23
    ds_read_b64_tr_b16 a[68:69], v7 offset:32768
    v_and_b32 v42, s83, v42
    v_mfma_f32_16x16x32_bf16 v[100:103], a[16:19], a[100:103], v[100:103]
    s_add_u32 s61, s61, s22
    s_sub_u32 s61, s61, s23
    ds_read_b64_tr_b16 a[70:71], v7 offset:34816
    v_and_b32 v43, s83, v43
    v_mfma_f32_16x16x32_bf16 v[84:87], a[4:7], a[100:103], v[84:87]
    s_add_u32 s61, s61, s22
    s_sub_u32 s61, s61, s23
    ds_read_b64_tr_b16 a[72:73], v6 offset:36864
    v_fmac_f32 v51, v40, v41
    v_mfma_f32_16x16x32_bf16 v[84:87], a[12:15], a[116:119], v[84:87]
    s_addk_i32 m0, 4096
    ds_read_b64_tr_b16 a[74:75], v6 offset:38912
    v_fmac_f32 v51, v42, v43
    v_mfma_f32_16x16x32_bf16 v[68:71], a[8:11], a[116:119], v[68:71]
    s_waitcnt lgkmcnt(8)
    ds_read_b64_tr_b16 a[76:77], v7 offset:36864
    s_add_u32 s59, s72, 4128768
    v_mfma_f32_16x16x32_bf16 v[68:71], a[0:3], a[100:103], v[68:71]
    buffer_load_dwordx4 v1, s[8:11], s59 offen lds
    v_mfma_f32_16x16x32_bf16 v[72:75], a[0:3], a[104:107], v[72:75]
    s_add_u32 s61, s61, s22
    s_sub_u32 s61, s61, s23
    ds_read_b64_tr_b16 a[78:79], v7 offset:38912
    v_accvgpr_read_b32 v42, a226
    v_mfma_f32_16x16x32_bf16 v[72:75], a[8:11], a[120:123], v[72:75]
    s_add_u32 s61, s61, s22
    s_sub_u32 s61, s61, s23
    ds_read_b64_tr_b16 a[80:81], v6 offset:40960
    v_accvgpr_read_b32 v43, a238
    v_mfma_f32_16x16x32_bf16 v[88:91], a[12:15], a[120:123], v[88:91]
    s_add_u32 s61, s61, s22
    s_sub_u32 s61, s61, s23
    ds_read_b64_tr_b16 a[82:83], v6 offset:43008
    v_lshlrev_b32 v40, 16, v42
    v_mfma_f32_16x16x32_bf16 v[88:91], a[4:7], a[104:107], v[88:91]
    s_addk_i32 m0, 4096
    ds_read_b64_tr_b16 a[84:85], v7 offset:40960
    v_lshlrev_b32 v41, 16, v43
    v_mfma_f32_16x16x32_bf16 v[104:107], a[16:19], a[104:107], v[104:107]
    s_addk_i32 s59, 0
    ds_read_b64_tr_b16 a[86:87], v7 offset:43008
    v_and_b32 v42, s83, v42
    v_mfma_f32_16x16x32_bf16 v[104:107], a[24:27], a[120:123], v[104:107]
    buffer_load_dwordx4 v34, s[8:11], s59 offen lds
    v_mfma_f32_16x16x32_bf16 v[120:123], a[28:31], a[120:123], v[120:123]
    s_add_u32 s61, s61, s22
    s_sub_u32 s61, s61, s23
    ds_read_b64_tr_b16 a[88:89], v6 offset:45056
    v_and_b32 v43, s83, v43
    v_mfma_f32_16x16x32_bf16 v[120:123], a[20:23], a[104:107], v[120:123]
    s_add_u32 s61, s61, s22
    s_sub_u32 s61, s61, s23
    ds_read_b64_tr_b16 a[90:91], v6 offset:47104
    v_fmac_f32 v51, v40, v41
    v_mfma_f32_16x16x32_bf16 v[136:139], a[32:35], a[104:107], v[136:139]
    s_addk_i32 m0, 4096
    ds_read_b64_tr_b16 a[92:93], v7 offset:45056
    v_fmac_f32 v51, v42, v43
    v_mfma_f32_16x16x32_bf16 v[136:139], a[40:43], a[120:123], v[136:139]
    s_add_u32 s59, s72, 4718592
    ds_read_b64_tr_b16 a[94:95], v7 offset:47104
    v_accvgpr_read_b32 v42, a228
    v_mfma_f32_16x16x32_bf16 v[152:155], a[44:47], a[120:123], v[152:155]
    buffer_load_dwordx4 v1, s[8:11], s59 offen lds
    v_mfma_f32_16x16x32_bf16 v[152:155], a[36:39], a[104:107], v[152:155]
    s_add_u32 s61, s61, s22
    s_sub_u32 s61, s61, s23
    ds_read_b128 a[144:147], v3 offset:32768
    v_accvgpr_read_b32 v43, a240
    v_mfma_f32_16x16x32_bf16 v[156:159], a[36:39], a[108:111], v[156:159]
    ds_read_b128 a[148:151], v3 offset:34816
    v_lshlrev_b32 v40, 16, v42
    v_mfma_f32_16x16x32_bf16 v[156:159], a[44:47], a[124:127], v[156:159]
    ds_read_b128 a[152:155], v3 offset:36864
    v_lshlrev_b32 v41, 16, v43
    v_mfma_f32_16x16x32_bf16 v[140:143], a[40:43], a[124:127], v[140:143]
    s_addk_i32 m0, 4096
    ds_read_b128 a[156:159], v3 offset:38912
    v_and_b32 v42, s83, v42
    v_mfma_f32_16x16x32_bf16 v[140:143], a[32:35], a[108:111], v[140:143]
    s_addk_i32 s59, 0
    ds_read_b128 a[160:163], v2 offset:49152
    v_and_b32 v43, s83, v43
    v_mfma_f32_16x16x32_bf16 v[124:127], a[20:23], a[108:111], v[124:127]
    buffer_load_dwordx4 v34, s[8:11], s59 offen lds
    v_mfma_f32_16x16x32_bf16 v[124:127], a[28:31], a[124:127], v[124:127]
    ds_read_b128 a[164:167], v2 offset:51200
    v_fmac_f32 v51, v40, v41
    v_mfma_f32_16x16x32_bf16 v[108:111], a[24:27], a[124:127], v[108:111]
    ds_read_b128 a[168:171], v2 offset:53248
    v_fmac_f32 v51, v42, v43
    v_mfma_f32_16x16x32_bf16 v[108:111], a[16:19], a[108:111], v[108:111]
    ds_read_b128 a[172:175], v2 offset:55296
    v_accvgpr_read_b32 v42, a229
    v_mfma_f32_16x16x32_bf16 v[92:95], a[4:7], a[108:111], v[92:95]
    v_accvgpr_read_b32 v43, a241
    v_lshlrev_b32 v40, 16, v42
    v_mfma_f32_16x16x32_bf16 v[92:95], a[12:15], a[124:127], v[92:95]
    v_lshlrev_b32 v41, 16, v43
    v_and_b32 v42, s83, v42
    v_mfma_f32_16x16x32_bf16 v[76:79], a[8:11], a[124:127], v[76:79]
    s_waitcnt lgkmcnt(1)
    s_sub_u32 s57, s22, s23
    s_lshl1_add_u32 s61, s57, s61
    s_waitcnt vmcnt(12) lgkmcnt(0)
    v_mfma_f32_16x16x32_bf16 v[76:79], a[0:3], a[108:111], v[76:79]
    s_barrier
    v_mfma_f32_16x16x32_bf16 v[160:163], a[48:51], a[96:99], v[160:163]
    s_addk_i32 m0, 4096
    ds_read_b64_tr_b16 a[0:1], v4 offset:0
    s_add_u32 s59, s73, 3538944
    v_mfma_f32_16x16x32_bf16 v[160:163], a[56:59], a[112:115], v[160:163]
    buffer_load_dwordx4 v1, s[8:11], s59 offen lds
    v_mfma_f32_16x16x32_bf16 v[176:179], a[60:63], a[112:115], v[176:179]
    s_sub_u32 s55, 0, s61
    ds_read_b64_tr_b16 a[2:3], v4 offset:2048
    v_and_b32 v43, s83, v43
    v_mfma_f32_16x16x32_bf16 v[176:179], a[52:55], a[96:99], v[176:179]
    s_lshr_b32 s56, s50, 3
    ds_read_b64_tr_b16 a[4:5], v5 offset:0
    v_fmac_f32 v51, v40, v41
    v_mfma_f32_16x16x32_bf16 v[192:195], a[64:67], a[96:99], v[192:195]
    s_xor_b32 s56, s56, s50
    ds_read_b64_tr_b16 a[6:7], v5 offset:2048
    v_fmac_f32 v51, v42, v43
    v_mfma_f32_16x16x32_bf16 v[192:195], a[72:75], a[112:115], v[192:195]
    s_and_b32 s56, s56, 1
    s_cselect_b32 s55, s55, s61
    ds_read_b64_tr_b16 a[8:9], v4 offset:4096
    v_accvgpr_read_b32 v42, a230
    v_mfma_f32_16x16x32_bf16 v[208:211], a[76:79], a[112:115], v[208:211]
    s_addk_i32 m0, 4096
    ds_read_b64_tr_b16 a[10:11], v4 offset:6144
    s_lshl_b32 s55, s55, 16
    v_mfma_f32_16x16x32_bf16 v[208:211], a[68:71], a[96:99], v[208:211]
    s_addk_i32 s59, 0
    ds_read_b64_tr_b16 a[12:13], v5 offset:4096
    s_or_b32 s55, s55, 1
    v_mfma_f32_16x16x32_bf16 v[224:227], a[80:83], a[96:99], v[224:227]
    buffer_load_dwordx4 v34, s[8:11], s59 offen lds
    v_mfma_f32_16x16x32_bf16 v[224:227], a[88:91], a[112:115], v[224:227]
    ds_read_b64_tr_b16 a[14:15], v5 offset:6144
    v_mov_b32 v49, s55
    v_mfma_f32_16x16x32_bf16 v[240:243], a[92:95], a[112:115], v[240:243]
    ds_read_b64_tr_b16 a[16:17], v4 offset:8192
    v_mov_b32 v50, 1
    v_mfma_f32_16x16x32_bf16 v[240:243], a[84:87], a[96:99], v[240:243]
    ds_read_b64_tr_b16 a[18:19], v4 offset:10240
    v_and_b32 v39, 12, v55
    v_mfma_f32_16x16x32_bf16 v[244:247], a[84:87], a[100:103], v[244:247]
    ds_read_b64_tr_b16 a[20:21], v5 offset:8192
    v_accvgpr_read_b32 v43, a242
    v_mfma_f32_16x16x32_bf16 v[244:247], a[92:95], a[116:119], v[244:247]
    ds_read_b64_tr_b16 a[22:23], v5 offset:10240
    v_lshlrev_b32 v40, 16, v42
    v_mfma_f32_16x16x32_bf16 v[228:231], a[88:91], a[116:119], v[228:231]
    s_addk_i32 m0, 4096
    ds_read_b64_tr_b16 a[24:25], v4 offset:12288
    v_lshlrev_b32 v41, 16, v43
    v_mfma_f32_16x16x32_bf16 v[228:231], a[80:83], a[100:103], v[228:231]
    s_add_u32 s59, s73, 4128768
    ds_read_b64_tr_b16 a[26:27], v4 offset:14336
    v_and_b32 v42, s83, v42
    v_mfma_f32_16x16x32_bf16 v[212:215], a[68:71], a[100:103], v[212:215]
    buffer_load_dwordx4 v1, s[8:11], s59 offen lds
    v_mfma_f32_16x16x32_bf16 v[212:215], a[76:79], a[116:119], v[212:215]
    ds_read_b64_tr_b16 a[28:29], v5 offset:12288
    v_and_b32 v43, s83, v43
    v_mfma_f32_16x16x32_bf16 v[196:199], a[72:75], a[116:119], v[196:199]
    ds_read_b64_tr_b16 a[30:31], v5 offset:14336
    v_fmac_f32 v51, v40, v41
    v_mfma_f32_16x16x32_bf16 v[196:199], a[64:67], a[100:103], v[196:199]
    ds_read_b64_tr_b16 a[32:33], v4 offset:16384
    v_fmac_f32 v51, v42, v43
    v_mfma_f32_16x16x32_bf16 v[180:183], a[52:55], a[100:103], v[180:183]
    ds_read_b64_tr_b16 a[34:35], v4 offset:18432
    v_accvgpr_read_b32 v42, a232
    v_mfma_f32_16x16x32_bf16 v[180:183], a[60:63], a[116:119], v[180:183]
    s_addk_i32 m0, 4096
    ds_read_b64_tr_b16 a[36:37], v5 offset:16384
    v_accvgpr_read_b32 v43, a244
    v_mfma_f32_16x16x32_bf16 v[164:167], a[56:59], a[116:119], v[164:167]
    s_addk_i32 s59, 0
    ds_read_b64_tr_b16 a[38:39], v5 offset:18432
    v_lshlrev_b32 v40, 16, v42
    v_mfma_f32_16x16x32_bf16 v[164:167], a[48:51], a[100:103], v[164:167]
    buffer_load_dwordx4 v34, s[8:11], s59 offen lds
    v_mfma_f32_16x16x32_bf16 v[168:171], a[48:51], a[104:107], v[168:171]
    ds_read_b64_tr_b16 a[40:41], v4 offset:20480
    v_lshlrev_b32 v41, 16, v43
    v_mfma_f32_16x16x32_bf16 v[168:171], a[56:59], a[120:123], v[168:171]
    ds_read_b64_tr_b16 a[42:43], v4 offset:22528
    v_and_b32 v42, s83, v42
    v_mfma_f32_16x16x32_bf16 v[184:187], a[60:63], a[120:123], v[184:187]
    ds_read_b64_tr_b16 a[44:45], v5 offset:20480
    v_and_b32 v43, s83, v43
    v_mfma_f32_16x16x32_bf16 v[184:187], a[52:55], a[104:107], v[184:187]
    ds_read_b64_tr_b16 a[46:47], v5 offset:22528
    v_fmac_f32 v51, v40, v41
    v_mfma_f32_16x16x32_bf16 v[200:203], a[64:67], a[104:107], v[200:203]
    ds_read_b128 a[176:179], v3 offset:49152
    v_fmac_f32 v51, v42, v43
    v_mfma_f32_16x16x32_bf16 v[200:203], a[72:75], a[120:123], v[200:203]
    s_addk_i32 m0, 4096
    ds_read_b128 a[180:183], v3 offset:51200
    v_accvgpr_read_b32 v42, a233
    v_mfma_f32_16x16x32_bf16 v[216:219], a[76:79], a[120:123], v[216:219]
    s_add_u32 s59, s73, 4718592
    ds_read_b128 a[184:187], v3 offset:53248
    v_accvgpr_read_b32 v43, a245
    v_mfma_f32_16x16x32_bf16 v[216:219], a[68:71], a[104:107], v[216:219]
    buffer_load_dwordx4 v1, s[8:11], s59 offen lds
    v_mfma_f32_16x16x32_bf16 v[232:235], a[80:83], a[104:107], v[232:235]
    ds_read_b128 a[188:191], v3 offset:55296
    v_lshlrev_b32 v40, 16, v42
    v_mfma_f32_16x16x32_bf16 v[232:235], a[88:91], a[120:123], v[232:235]
    ds_read_b128 a[192:195], v2 offset:0
    v_lshlrev_b32 v41, 16, v43
    v_mfma_f32_16x16x32_bf16 v[248:251], a[92:95], a[120:123], v[248:251]
    ds_read_b128 a[196:199], v2 offset:2048
    v_and_b32 v42, s83, v42
    v_mfma_f32_16x16x32_bf16 v[248:251], a[84:87], a[104:107], v[248:251]
    ds_read_b128 a[200:203], v2 offset:4096
    v_and_b32 v43, s83, v43
    v_mfma_f32_16x16x32_bf16 v[252:255], a[84:87], a[108:111], v[252:255]
    s_addk_i32 m0, 4096
    ds_read_b128 a[204:207], v2 offset:6144
    v_fmac_f32 v51, v40, v41
    v_mfma_f32_16x16x32_bf16 v[252:255], a[92:95], a[124:127], v[252:255]
    s_addk_i32 s59, 0
    ds_read_b128 a[208:211], v3 offset:0
    v_fmac_f32 v51, v42, v43
    v_mfma_f32_16x16x32_bf16 v[236:239], a[88:91], a[124:127], v[236:239]
    buffer_load_dwordx4 v34, s[8:11], s59 offen lds
    v_mfma_f32_16x16x32_bf16 v[236:239], a[80:83], a[108:111], v[236:239]
    ds_read_b128 a[212:215], v3 offset:2048
    v_accvgpr_read_b32 v42, a234
    v_mfma_f32_16x16x32_bf16 v[220:223], a[68:71], a[108:111], v[220:223]
    ds_read_b128 a[216:219], v3 offset:4096
    v_accvgpr_read_b32 v43, a246
    v_mfma_f32_16x16x32_bf16 v[220:223], a[76:79], a[124:127], v[220:223]
    ds_read_b128 a[220:223], v3 offset:6144
    v_lshlrev_b32 v40, 16, v42
    v_mfma_f32_16x16x32_bf16 v[204:207], a[72:75], a[124:127], v[204:207]
    v_lshlrev_b32 v41, 16, v43
    v_and_b32 v42, s83, v42
    v_mfma_f32_16x16x32_bf16 v[204:207], a[64:67], a[108:111], v[204:207]
    v_and_b32 v43, s83, v43
    v_fmac_f32 v51, v40, v41
    v_mfma_f32_16x16x32_bf16 v[188:191], a[52:55], a[108:111], v[188:191]
    v_fmac_f32 v51, v42, v43
    v_mfma_f32_16x16x32_bf16 v[188:191], a[60:63], a[124:127], v[188:191]
    v_mfma_f32_16x16x32_bf16 v[172:175], a[56:59], a[124:127], v[172:175]
    s_waitcnt vmcnt(12) lgkmcnt(0)
    v_mfma_f32_16x16x32_bf16 v[172:175], a[48:51], a[108:111], v[172:175]
    s_barrier
    v_mfma_f32_16x16x32_bf16 v[64:67], a[0:3], a[128:131], v[64:67]
    ds_read_b64_tr_b16 a[48:49], v4 offset:24576
    v_mfma_f32_16x16x32_bf16 v[64:67], a[8:11], a[144:147], v[64:67]
    buffer_store_dword v49, v31, s[28:31], s44 offen sc1
    v_mfma_f32_16x16x32_bf16 v[64:67], a[16:19], a[160:163], v[64:67]
    ds_read_b64_tr_b16 a[50:51], v4 offset:26624
    v_mfma_f32_16x16x32_bf16 v[64:67], a[24:27], a[176:179], v[64:67]
    ds_read_b64_tr_b16 a[52:53], v5 offset:24576
    v_mfma_f32_16x16x32_bf16 v[64:67], a[32:35], a[192:195], v[64:67]
    ds_read_b64_tr_b16 a[54:55], v5 offset:26624
    v_mfma_f32_16x16x32_bf16 v[64:67], a[40:43], a[208:211], v[64:67]
    s_add_u32 m0, s58, 0
    ds_read_b64_tr_b16 a[56:57], v4 offset:28672
    v_mfma_f32_16x16x32_bf16 v[80:83], a[44:47], a[208:211], v[80:83]
    s_add_u32 s59, s74, 3538944
    ds_read_b64_tr_b16 a[58:59], v4 offset:30720
    v_mfma_f32_16x16x32_bf16 v[80:83], a[36:39], a[192:195], v[80:83]
    buffer_load_dwordx4 v1, s[8:11], s59 offen lds
    v_mfma_f32_16x16x32_bf16 v[80:83], a[28:31], a[176:179], v[80:83]
    ds_read_b64_tr_b16 a[60:61], v5 offset:28672
    v_mfma_f32_16x16x32_bf16 v[80:83], a[20:23], a[160:163], v[80:83]
    ds_read_b64_tr_b16 a[62:63], v5 offset:30720
    v_mfma_f32_16x16x32_bf16 v[80:83], a[12:15], a[144:147], v[80:83]
    ds_read_b64_tr_b16 a[64:65], v4 offset:32768
    v_mfma_f32_16x16x32_bf16 v[80:83], a[4:7], a[128:131], v[80:83]
    s_addk_i32 m0, 4096
    ds_read_b64_tr_b16 a[66:67], v4 offset:34816
    v_mfma_f32_16x16x32_bf16 v[68:71], a[0:3], a[132:135], v[68:71]
    s_addk_i32 s59, 0
    ds_read_b64_tr_b16 a[68:69], v5 offset:32768
    v_mfma_f32_16x16x32_bf16 v[68:71], a[8:11], a[148:151], v[68:71]
    buffer_load_dwordx4 v34, s[8:11], s59 offen lds
    v_mfma_f32_16x16x32_bf16 v[68:71], a[16:19], a[164:167], v[68:71]
    ds_read_b64_tr_b16 a[70:71], v5 offset:34816
    v_mul_f32 v64, v64, |v64|
    v_mul_f32 v65, v65, |v65|
    v_mfma_f32_16x16x32_bf16 v[68:71], a[24:27], a[180:183], v[68:71]
    ds_read_b64_tr_b16 a[72:73], v4 offset:36864
    v_mul_f32 v66, v66, |v66|
    v_mul_f32 v67, v67, |v67|
    v_mfma_f32_16x16x32_bf16 v[68:71], a[32:35], a[196:199], v[68:71]
    ds_read_b64_tr_b16 a[74:75], v4 offset:38912
    v_mul_f32 v80, v80, |v80|
    v_mul_f32 v81, v81, |v81|
    v_mfma_f32_16x16x32_bf16 v[68:71], a[40:43], a[212:215], v[68:71]
    ds_read_b64_tr_b16 a[76:77], v5 offset:36864
    v_mul_f32 v82, v82, |v82|
    v_mul_f32 v83, v83, |v83|
    v_mfma_f32_16x16x32_bf16 v[84:87], a[44:47], a[212:215], v[84:87]
    s_addk_i32 m0, 4096
    ds_read_b64_tr_b16 a[78:79], v5 offset:38912
    v_cvt_pk_bf16_f32 v64, v64, v65
    v_mfma_f32_16x16x32_bf16 v[84:87], a[36:39], a[196:199], v[84:87]
    s_add_u32 s59, s74, 4128768
    ds_read_b64_tr_b16 a[80:81], v4 offset:40960
    v_cvt_pk_bf16_f32 v65, v66, v67
    v_cvt_pk_bf16_f32 v66, v80, v81
    v_mfma_f32_16x16x32_bf16 v[84:87], a[28:31], a[180:183], v[84:87]
    buffer_load_dwordx4 v1, s[8:11], s59 offen lds
    v_mfma_f32_16x16x32_bf16 v[84:87], a[20:23], a[164:167], v[84:87]
    ds_read_b64_tr_b16 a[82:83], v4 offset:43008
    v_cvt_pk_bf16_f32 v67, v82, v83
    v_pk_max_i16 v64, v64, 0
    v_mfma_f32_16x16x32_bf16 v[84:87], a[12:15], a[148:151], v[84:87]
    ds_read_b64_tr_b16 a[84:85], v5 offset:40960
    v_pk_max_i16 v65, v65, 0
    v_pk_max_i16 v66, v66, 0
    v_mfma_f32_16x16x32_bf16 v[84:87], a[4:7], a[132:135], v[84:87]
    ds_read_b64_tr_b16 a[86:87], v5 offset:43008
    v_pk_max_i16 v67, v67, 0
    v_mfma_f32_16x16x32_bf16 v[72:75], a[0:3], a[136:139], v[72:75]
    ds_write_b128 v29, v[64:67] offset:0
    v_mfma_f32_16x16x32_bf16 v[72:75], a[8:11], a[152:155], v[72:75]
    s_addk_i32 m0, 4096
    v_mul_f32 v68, v68, |v68|
    v_mul_f32 v69, v69, |v69|
    s_addk_i32 s59, 0
    v_mfma_f32_16x16x32_bf16 v[72:75], a[16:19], a[168:171], v[72:75]
    buffer_load_dwordx4 v34, s[8:11], s59 offen lds
    v_mfma_f32_16x16x32_bf16 v[72:75], a[24:27], a[184:187], v[72:75]
    ds_read_b64_tr_b16 a[88:89], v4 offset:45056
    v_mul_f32 v70, v70, |v70|
    v_mfma_f32_16x16x32_bf16 v[72:75], a[32:35], a[200:203], v[72:75]
    ds_read_b64_tr_b16 a[90:91], v4 offset:47104
    v_mul_f32 v71, v71, |v71|
    v_mfma_f32_16x16x32_bf16 v[72:75], a[40:43], a[216:219], v[72:75]
    ds_read_b64_tr_b16 a[92:93], v5 offset:45056
    v_mul_f32 v84, v84, |v84|
    v_mul_f32 v85, v85, |v85|
    v_mfma_f32_16x16x32_bf16 v[88:91], a[44:47], a[216:219], v[88:91]
    ds_read_b64_tr_b16 a[94:95], v5 offset:47104
    v_mul_f32 v86, v86, |v86|
    v_mfma_f32_16x16x32_bf16 v[88:91], a[36:39], a[200:203], v[88:91]
    s_addk_i32 m0, 4096
    v_mul_f32 v87, v87, |v87|
    v_cvt_pk_bf16_f32 v68, v68, v69
    v_mfma_f32_16x16x32_bf16 v[88:91], a[28:31], a[184:187], v[88:91]
    s_add_u32 s59, s74, 4718592
    v_cvt_pk_bf16_f32 v69, v70, v71
    v_cvt_pk_bf16_f32 v70, v84, v85
    v_cvt_pk_bf16_f32 v71, v86, v87
    v_mfma_f32_16x16x32_bf16 v[88:91], a[20:23], a[168:171], v[88:91]
    buffer_load_dwordx4 v1, s[8:11], s59 offen lds
    v_mfma_f32_16x16x32_bf16 v[88:91], a[12:15], a[152:155], v[88:91]
    v_pk_max_i16 v68, v68, 0
    v_pk_max_i16 v69, v69, 0
    v_mfma_f32_16x16x32_bf16 v[88:91], a[4:7], a[136:139], v[88:91]
    v_pk_max_i16 v70, v70, 0
    v_pk_max_i16 v71, v71, 0
    v_mfma_f32_16x16x32_bf16 v[76:79], a[0:3], a[140:143], v[76:79]
    ds_write_b128 v29, v[68:71] offset:1024
    v_mfma_f32_16x16x32_bf16 v[76:79], a[8:11], a[156:159], v[76:79]
    s_addk_i32 m0, 4096
    v_mul_f32 v72, v72, |v72|
    v_mul_f32 v73, v73, |v73|
    v_mfma_f32_16x16x32_bf16 v[76:79], a[16:19], a[172:175], v[76:79]
    s_addk_i32 s59, 0
    v_mul_f32 v74, v74, |v74|
    v_mul_f32 v75, v75, |v75|
    v_mfma_f32_16x16x32_bf16 v[76:79], a[24:27], a[188:191], v[76:79]
    buffer_load_dwordx4 v34, s[8:11], s59 offen lds
    v_mfma_f32_16x16x32_bf16 v[76:79], a[32:35], a[204:207], v[76:79]
    v_mul_f32 v88, v88, |v88|
    v_mul_f32 v89, v89, |v89|
    v_mfma_f32_16x16x32_bf16 v[76:79], a[40:43], a[220:223], v[76:79]
    v_mul_f32 v90, v90, |v90|
    v_mul_f32 v91, v91, |v91|
    v_mfma_f32_16x16x32_bf16 v[92:95], a[44:47], a[220:223], v[92:95]
    v_cvt_pk_bf16_f32 v72, v72, v73
    v_cvt_pk_bf16_f32 v73, v74, v75
    v_mfma_f32_16x16x32_bf16 v[92:95], a[36:39], a[204:207], v[92:95]
    v_cvt_pk_bf16_f32 v74, v88, v89
    v_cvt_pk_bf16_f32 v75, v90, v91
    v_mfma_f32_16x16x32_bf16 v[92:95], a[28:31], a[188:191], v[92:95]
    v_pk_max_i16 v72, v72, 0
    v_pk_max_i16 v73, v73, 0
    v_mfma_f32_16x16x32_bf16 v[92:95], a[20:23], a[172:175], v[92:95]
    v_pk_max_i16 v74, v74, 0
    v_pk_max_i16 v75, v75, 0
    v_mfma_f32_16x16x32_bf16 v[92:95], a[12:15], a[156:159], v[92:95]
    s_waitcnt vmcnt(13) lgkmcnt(0)
    v_mfma_f32_16x16x32_bf16 v[92:95], a[4:7], a[140:143], v[92:95]
    s_barrier
    v_mfma_f32_16x16x32_bf16 v[96:99], a[48:51], a[128:131], v[96:99]
    ds_read_b128 a[224:227], v30 offset:0
    v_mfma_f32_16x16x32_bf16 v[96:99], a[56:59], a[144:147], v[96:99]
    ds_write_b128 v29, v[72:75] offset:2048
    v_mfma_f32_16x16x32_bf16 v[96:99], a[64:67], a[160:163], v[96:99]
    s_addk_i32 m0, 4096
    v_mul_f32 v76, v76, |v76|
    v_mul_f32 v77, v77, |v77|
    s_add_u32 s59, s75, 3538944
    v_mfma_f32_16x16x32_bf16 v[96:99], a[72:75], a[176:179], v[96:99]
    buffer_load_dwordx4 v1, s[8:11], s59 offen lds
    v_mfma_f32_16x16x32_bf16 v[96:99], a[80:83], a[192:195], v[96:99]
    ds_read_b128 a[228:231], v30 offset:1024
    v_mul_f32 v78, v78, |v78|
    v_mul_f32 v79, v79, |v79|
    v_mfma_f32_16x16x32_bf16 v[96:99], a[88:91], a[208:211], v[96:99]
    ds_read_b64_tr_b16 a[0:1], v6 offset:0
L_stubF4:
    s_cbranch_execz L_jrF0
    s_nop 0
    v_mul_f32 v92, v92, |v92|
    v_mul_f32 v93, v93, |v93|
    v_mfma_f32_16x16x32_bf16 v[112:115], a[92:95], a[208:211], v[112:115]
    s_addk_i32 m0, 4096
    ds_read_b64_tr_b16 a[2:3], v6 offset:2048
    v_mul_f32 v94, v94, |v94|
    v_mul_f32 v95, v95, |v95|
    v_mfma_f32_16x16x32_bf16 v[112:115], a[84:87], a[192:195], v[112:115]
    s_addk_i32 s59, 0
    ds_read_b64_tr_b16 a[4:5], v7 offset:0
    v_cvt_pk_bf16_f32 v76, v76, v77
    v_cvt_pk_bf16_f32 v77, v78, v79
    v_mfma_f32_16x16x32_bf16 v[112:115], a[76:79], a[176:179], v[112:115]
    buffer_load_dwordx4 v34, s[8:11], s59 offen lds
    v_mfma_f32_16x16x32_bf16 v[112:115], a[68:71], a[160:163], v[112:115]
    ds_read_b64_tr_b16 a[6:7], v7 offset:2048
    v_cvt_pk_bf16_f32 v78, v92, v93
    v_cvt_pk_bf16_f32 v79, v94, v95
    v_mfma_f32_16x16x32_bf16 v[112:115], a[60:63], a[144:147], v[112:115]
    ds_read_b64_tr_b16 a[8:9], v6 offset:4096
    v_pk_max_i16 v76, v76, 0
    v_pk_max_i16 v77, v77, 0
    v_mfma_f32_16x16x32_bf16 v[112:115], a[52:55], a[128:131], v[112:115]
    ds_read_b64_tr_b16 a[10:11], v6 offset:6144
    v_pk_max_i16 v78, v78, 0
    v_pk_max_i16 v79, v79, 0
    v_mfma_f32_16x16x32_bf16 v[100:103], a[48:51], a[132:135], v[100:103]
    ds_write_b128 v29, v[76:79] offset:3072
    v_mfma_f32_16x16x32_bf16 v[100:103], a[56:59], a[148:151], v[100:103]
    v_mul_f32 v96, v96, |v96|
    v_mul_f32 v97, v97, |v97|
    v_mul_f32 v98, v98, |v98|
    v_mfma_f32_16x16x32_bf16 v[100:103], a[64:67], a[164:167], v[100:103]
    s_addk_i32 m0, 4096
    ds_read_b64_tr_b16 a[12:13], v7 offset:4096
    v_mul_f32 v99, v99, |v99|
    v_mul_f32 v112, v112, |v112|
    v_mfma_f32_16x16x32_bf16 v[100:103], a[72:75], a[180:183], v[100:103]
    s_add_u32 s59, s75, 4128768
    ds_read_b64_tr_b16 a[14:15], v7 offset:6144
    v_mul_f32 v113, v113, |v113|
    v_mfma_f32_16x16x32_bf16 v[100:103], a[80:83], a[196:199], v[100:103]
    buffer_load_dwordx4 v1, s[8:11], s59 offen lds
    v_mfma_f32_16x16x32_bf16 v[100:103], a[88:91], a[212:215], v[100:103]
    ds_read_b64_tr_b16 a[16:17], v6 offset:8192
    v_mul_f32 v114, v114, |v114|
    v_mul_f32 v115, v115, |v115|
    v_mfma_f32_16x16x32_bf16 v[116:119], a[92:95], a[212:215], v[116:119]
    ds_read_b64_tr_b16 a[18:19], v6 offset:10240
    v_cvt_pk_bf16_f32 v96, v96, v97
    v_cvt_pk_bf16_f32 v97, v98, v99
    v_mfma_f32_16x16x32_bf16 v[116:119], a[84:87], a[196:199], v[116:119]
    ds_read_b64_tr_b16 a[20:21], v7 offset:8192
    v_cvt_pk_bf16_f32 v98, v112, v113
    v_mfma_f32_16x16x32_bf16 v[116:119], a[76:79], a[180:183], v[116:119]
    ds_read_b64_tr_b16 a[22:23], v7 offset:10240
    v_cvt_pk_bf16_f32 v99, v114, v115
    v_pk_max_i16 v96, v96, 0
    v_mfma_f32_16x16x32_bf16 v[116:119], a[68:71], a[164:167], v[116:119]
    s_addk_i32 m0, 4096
    ds_read_b64_tr_b16 a[24:25], v6 offset:12288
    v_pk_max_i16 v97, v97, 0
    v_pk_max_i16 v98, v98, 0
    v_mfma_f32_16x16x32_bf16 v[116:119], a[60:63], a[148:151], v[116:119]
    s_addk_i32 s59, 0
    ds_read_b64_tr_b16 a[26:27], v6 offset:14336
    v_pk_max_i16 v99, v99, 0
    v_mfma_f32_16x16x32_bf16 v[116:119], a[52:55], a[132:135], v[116:119]
    buffer_load_dwordx4 v34, s[8:11], s59 offen lds
    v_mfma_f32_16x16x32_bf16 v[104:107], a[48:51], a[136:139], v[104:107]
    ds_write_b128 v29, v[96:99] offset:16384
    v_mfma_f32_16x16x32_bf16 v[104:107], a[56:59], a[152:155], v[104:107]
    v_mul_f32 v100, v100, |v100|
    v_mul_f32 v101, v101, |v101|
    v_mul_f32 v102, v102, |v102|
    v_mfma_f32_16x16x32_bf16 v[104:107], a[64:67], a[168:171], v[104:107]
    ds_read_b64_tr_b16 a[28:29], v7 offset:12288
    v_mul_f32 v103, v103, |v103|
    v_mfma_f32_16x16x32_bf16 v[104:107], a[72:75], a[184:187], v[104:107]
    ds_read_b64_tr_b16 a[30:31], v7 offset:14336
    v_mul_f32 v116, v116, |v116|
    v_mul_f32 v117, v117, |v117|
    v_mfma_f32_16x16x32_bf16 v[104:107], a[80:83], a[200:203], v[104:107]
    ds_read_b64_tr_b16 a[32:33], v6 offset:16384
    v_mul_f32 v118, v118, |v118|
    v_mfma_f32_16x16x32_bf16 v[104:107], a[88:91], a[216:219], v[104:107]
    s_addk_i32 m0, 4096
    ds_read_b64_tr_b16 a[34:35], v6 offset:18432
    v_mul_f32 v119, v119, |v119|
    v_cvt_pk_bf16_f32 v100, v100, v101
    v_mfma_f32_16x16x32_bf16 v[120:123], a[92:95], a[216:219], v[120:123]
    s_add_u32 s59, s75, 4718592
    ds_read_b64_tr_b16 a[36:37], v7 offset:16384
    v_cvt_pk_bf16_f32 v101, v102, v103
    v_mfma_f32_16x16x32_bf16 v[120:123], a[84:87], a[200:203], v[120:123]
    buffer_load_dwordx4 v1, s[8:11], s59 offen lds
    v_mfma_f32_16x16x32_bf16 v[120:123], a[76:79], a[184:187], v[120:123]
    ds_read_b64_tr_b16 a[38:39], v7 offset:18432
    v_cvt_pk_bf16_f32 v102, v116, v117
    v_cvt_pk_bf16_f32 v103, v118, v119
    v_mfma_f32_16x16x32_bf16 v[120:123], a[68:71], a[168:171], v[120:123]
    ds_read_b64_tr_b16 a[40:41], v6 offset:20480
    v_pk_max_i16 v100, v100, 0
    v_mfma_f32_16x16x32_bf16 v[120:123], a[60:63], a[152:155], v[120:123]
    ds_read_b64_tr_b16 a[42:43], v6 offset:22528
    v_pk_max_i16 v101, v101, 0
    v_pk_max_i16 v102, v102, 0
    v_mfma_f32_16x16x32_bf16 v[120:123], a[52:55], a[136:139], v[120:123]
    ds_read_b64_tr_b16 a[44:45], v7 offset:20480
    v_pk_max_i16 v103, v103, 0
    v_mfma_f32_16x16x32_bf16 v[108:111], a[48:51], a[140:143], v[108:111]
    ds_write_b128 v29, v[100:103] offset:17408
    v_mfma_f32_16x16x32_bf16 v[108:111], a[56:59], a[156:159], v[108:111]
    s_addk_i32 m0, 4096
    v_mul_f32 v104, v104, |v104|
    s_addk_i32 s59, 0
    v_mfma_f32_16x16x32_bf16 v[108:111], a[64:67], a[172:175], v[108:111]
    buffer_load_dwordx4 v34, s[8:11], s59 offen lds
    v_mfma_f32_16x16x32_bf16 v[108:111], a[72:75], a[188:191], v[108:111]
    ds_read_b64_tr_b16 a[46:47], v7 offset:22528
    v_mul_f32 v105, v105, |v105|
    v_mfma_f32_16x16x32_bf16 v[108:111], a[80:83], a[204:207], v[108:111]
    v_mul_f32 v106, v106, |v106|
    v_mul_f32 v107, v107, |v107|
    v_mfma_f32_16x16x32_bf16 v[108:111], a[88:91], a[220:223], v[108:111]
    v_mul_f32 v120, v120, |v120|
    v_mul_f32 v121, v121, |v121|
    v_mfma_f32_16x16x32_bf16 v[124:127], a[92:95], a[220:223], v[124:127]
    v_mul_f32 v122, v122, |v122|
    v_mul_f32 v123, v123, |v123|
    v_mfma_f32_16x16x32_bf16 v[124:127], a[84:87], a[204:207], v[124:127]
    v_cvt_pk_bf16_f32 v104, v104, v105
    v_cvt_pk_bf16_f32 v105, v106, v107
    v_mfma_f32_16x16x32_bf16 v[124:127], a[76:79], a[188:191], v[124:127]
    v_cvt_pk_bf16_f32 v106, v120, v121
    v_cvt_pk_bf16_f32 v107, v122, v123
    v_mfma_f32_16x16x32_bf16 v[124:127], a[68:71], a[172:175], v[124:127]
    v_pk_max_i16 v104, v104, 0
    v_pk_max_i16 v105, v105, 0
    v_mfma_f32_16x16x32_bf16 v[124:127], a[60:63], a[156:159], v[124:127]
    s_waitcnt vmcnt(13) lgkmcnt(0)
    v_pk_max_i16 v106, v106, 0
    v_pk_max_i16 v107, v107, 0
    v_mfma_f32_16x16x32_bf16 v[124:127], a[52:55], a[140:143], v[124:127]
    s_barrier
    v_mfma_f32_16x16x32_bf16 v[128:131], a[0:3], a[128:131], v[128:131]
    ds_read_b128 a[232:235], v30 offset:2048
    v_mfma_f32_16x16x32_bf16 v[128:131], a[8:11], a[144:147], v[128:131]
    ds_write_b128 v29, v[104:107] offset:18432
    v_mfma_f32_16x16x32_bf16 v[128:131], a[16:19], a[160:163], v[128:131]
    s_add_u32 m0, s62, 49152
    v_mul_f32 v108, v108, |v108|
    v_mul_f32 v109, v109, |v109|
    s_add_u32 s59, s3, s76
    v_mfma_f32_16x16x32_bf16 v[128:131], a[24:27], a[176:179], v[128:131]
    buffer_load_dwordx4 v12, s[12:15], s59 offen lds
    v_mfma_f32_16x16x32_bf16 v[128:131], a[32:35], a[192:195], v[128:131]
    ds_read_b128 a[236:239], v30 offset:3072
    v_mul_f32 v110, v110, |v110|
    v_mul_f32 v111, v111, |v111|
    v_mfma_f32_16x16x32_bf16 v[128:131], a[40:43], a[208:211], v[128:131]
    ds_read_b128 a[240:243], v30 offset:16384
    v_mul_f32 v124, v124, |v124|
    v_mul_f32 v125, v125, |v125|
    v_mfma_f32_16x16x32_bf16 v[144:147], a[44:47], a[208:211], v[144:147]
    s_addk_i32 m0, 1024
    ds_read_b128 a[244:247], v30 offset:17408
    v_mul_f32 v126, v126, |v126|
    v_mul_f32 v127, v127, |v127|
    v_mfma_f32_16x16x32_bf16 v[144:147], a[36:39], a[192:195], v[144:147]
    s_add_u32 s59, s3, s76
    ds_read_b64_tr_b16 a[48:49], v6 offset:24576
    v_cvt_pk_bf16_f32 v108, v108, v109
    v_cvt_pk_bf16_f32 v109, v110, v111
    v_mfma_f32_16x16x32_bf16 v[144:147], a[28:31], a[176:179], v[144:147]
    buffer_load_dwordx4 v33, s[12:15], s59 offen lds
    v_mfma_f32_16x16x32_bf16 v[144:147], a[20:23], a[160:163], v[144:147]
    ds_read_b64_tr_b16 a[50:51], v6 offset:26624
    v_cvt_pk_bf16_f32 v110, v124, v125
    v_cvt_pk_bf16_f32 v111, v126, v127
    v_mfma_f32_16x16x32_bf16 v[144:147], a[12:15], a[144:147], v[144:147]
    ds_read_b64_tr_b16 a[52:53], v7 offset:24576
    v_pk_max_i16 v108, v108, 0
    v_pk_max_i16 v109, v109, 0
    v_mfma_f32_16x16x32_bf16 v[144:147], a[4:7], a[128:131], v[144:147]
    ds_read_b64_tr_b16 a[54:55], v7 offset:26624
    v_pk_max_i16 v110, v110, 0
    v_pk_max_i16 v111, v111, 0
    v_mfma_f32_16x16x32_bf16 v[132:135], a[0:3], a[132:135], v[132:135]
    ds_write_b128 v29, v[108:111] offset:19456
    v_mfma_f32_16x16x32_bf16 v[132:135], a[8:11], a[148:151], v[132:135]
    v_mul_f32 v128, v128, |v128|
    v_mul_f32 v129, v129, |v129|
    v_mul_f32 v130, v130, |v130|
    v_mfma_f32_16x16x32_bf16 v[132:135], a[16:19], a[164:167], v[132:135]
    s_addk_i32 m0, 7168
    ds_read_b64_tr_b16 a[56:57], v6 offset:28672
    v_mul_f32 v131, v131, |v131|
    v_mul_f32 v144, v144, |v144|
    v_mfma_f32_16x16x32_bf16 v[132:135], a[24:27], a[180:183], v[132:135]
    s_add_u32 s59, s3, s77
    ds_read_b64_tr_b16 a[58:59], v6 offset:30720
    v_mul_f32 v145, v145, |v145|
    v_mfma_f32_16x16x32_bf16 v[132:135], a[32:35], a[196:199], v[132:135]
    buffer_load_dwordx4 v12, s[12:15], s59 offen lds
    v_mfma_f32_16x16x32_bf16 v[132:135], a[40:43], a[212:215], v[132:135]
    ds_read_b64_tr_b16 a[60:61], v7 offset:28672
    v_mul_f32 v146, v146, |v146|
    v_mul_f32 v147, v147, |v147|
    v_mfma_f32_16x16x32_bf16 v[148:151], a[44:47], a[212:215], v[148:151]
    ds_read_b64_tr_b16 a[62:63], v7 offset:30720
    v_cvt_pk_bf16_f32 v128, v128, v129
    v_cvt_pk_bf16_f32 v129, v130, v131
    v_mfma_f32_16x16x32_bf16 v[148:151], a[36:39], a[196:199], v[148:151]
    ds_read_b64_tr_b16 a[64:65], v6 offset:32768
    v_cvt_pk_bf16_f32 v130, v144, v145
    v_mfma_f32_16x16x32_bf16 v[148:151], a[28:31], a[180:183], v[148:151]
    ds_read_b64_tr_b16 a[66:67], v6 offset:34816
    v_cvt_pk_bf16_f32 v131, v146, v147
    v_pk_max_i16 v128, v128, 0
    v_mfma_f32_16x16x32_bf16 v[148:151], a[20:23], a[164:167], v[148:151]
    s_addk_i32 m0, 1024
    ds_read_b64_tr_b16 a[68:69], v7 offset:32768
    v_pk_max_i16 v129, v129, 0
    v_pk_max_i16 v130, v130, 0
    v_mfma_f32_16x16x32_bf16 v[148:151], a[12:15], a[148:151], v[148:151]
    s_add_u32 s59, s3, s77
    ds_read_b64_tr_b16 a[70:71], v7 offset:34816
    v_pk_max_i16 v131, v131, 0
    v_mfma_f32_16x16x32_bf16 v[148:151], a[4:7], a[132:135], v[148:151]
    buffer_load_dwordx4 v33, s[12:15], s59 offen lds
    v_mfma_f32_16x16x32_bf16 v[136:139], a[0:3], a[136:139], v[136:139]
    ds_write_b128 v29, v[128:131] offset:0
    v_mfma_f32_16x16x32_bf16 v[136:139], a[8:11], a[152:155], v[136:139]
    v_mul_f32 v132, v132, |v132|
    v_mul_f32 v133, v133, |v133|
    v_mul_f32 v134, v134, |v134|
    v_mfma_f32_16x16x32_bf16 v[136:139], a[16:19], a[168:171], v[136:139]
    ds_read_b64_tr_b16 a[72:73], v6 offset:36864
    v_mul_f32 v135, v135, |v135|
    v_mfma_f32_16x16x32_bf16 v[136:139], a[24:27], a[184:187], v[136:139]
    ds_read_b64_tr_b16 a[74:75], v6 offset:38912
    v_mul_f32 v148, v148, |v148|
    v_mul_f32 v149, v149, |v149|
    v_mfma_f32_16x16x32_bf16 v[136:139], a[32:35], a[200:203], v[136:139]
    ds_read_b64_tr_b16 a[76:77], v7 offset:36864
    v_mul_f32 v150, v150, |v150|
    v_mfma_f32_16x16x32_bf16 v[136:139], a[40:43], a[216:219], v[136:139]
    s_addk_i32 m0, 7168
    ds_read_b64_tr_b16 a[78:79], v7 offset:38912
    v_mul_f32 v151, v151, |v151|
    v_cvt_pk_bf16_f32 v132, v132, v133
    v_mfma_f32_16x16x32_bf16 v[152:155], a[44:47], a[216:219], v[152:155]
    s_add_u32 s59, s3, s78
    ds_read_b64_tr_b16 a[80:81], v6 offset:40960
    v_cvt_pk_bf16_f32 v133, v134, v135
    v_mfma_f32_16x16x32_bf16 v[152:155], a[36:39], a[200:203], v[152:155]
    buffer_load_dwordx4 v12, s[12:15], s59 offen lds
    v_mfma_f32_16x16x32_bf16 v[152:155], a[28:31], a[184:187], v[152:155]
    ds_read_b64_tr_b16 a[82:83], v6 offset:43008
    v_cvt_pk_bf16_f32 v134, v148, v149
    v_cvt_pk_bf16_f32 v135, v150, v151
    v_mfma_f32_16x16x32_bf16 v[152:155], a[20:23], a[168:171], v[152:155]
    ds_read_b64_tr_b16 a[84:85], v7 offset:40960
    v_pk_max_i16 v132, v132, 0
    v_mfma_f32_16x16x32_bf16 v[152:155], a[12:15], a[152:155], v[152:155]
    ds_read_b64_tr_b16 a[86:87], v7 offset:43008
    v_pk_max_i16 v133, v133, 0
    v_pk_max_i16 v134, v134, 0
    v_mfma_f32_16x16x32_bf16 v[152:155], a[4:7], a[136:139], v[152:155]
    ds_read_b64_tr_b16 a[88:89], v6 offset:45056
    v_pk_max_i16 v135, v135, 0
    v_mfma_f32_16x16x32_bf16 v[140:143], a[0:3], a[140:143], v[140:143]
    ds_write_b128 v29, v[132:135] offset:1024
    v_mfma_f32_16x16x32_bf16 v[140:143], a[8:11], a[156:159], v[140:143]
    s_addk_i32 m0, 1024
    v_mul_f32 v136, v136, |v136|
    s_add_u32 s59, s3, s78
    v_mfma_f32_16x16x32_bf16 v[140:143], a[16:19], a[172:175], v[140:143]
    buffer_load_dwordx4 v33, s[12:15], s59 offen lds
    v_mfma_f32_16x16x32_bf16 v[140:143], a[24:27], a[188:191], v[140:143]
    ds_read_b64_tr_b16 a[90:91], v6 offset:47104
    v_mul_f32 v137, v137, |v137|
    v_mfma_f32_16x16x32_bf16 v[140:143], a[32:35], a[204:207], v[140:143]
    ds_read_b64_tr_b16 a[92:93], v7 offset:45056
    v_mul_f32 v138, v138, |v138|
    v_mfma_f32_16x16x32_bf16 v[140:143], a[40:43], a[220:223], v[140:143]
    ds_read_b64_tr_b16 a[94:95], v7 offset:47104
    v_mul_f32 v139, v139, |v139|
    v_mfma_f32_16x16x32_bf16 v[156:159], a[44:47], a[220:223], v[156:159]
    v_mul_f32 v152, v152, |v152|
    v_mul_f32 v153, v153, |v153|
    v_mfma_f32_16x16x32_bf16 v[156:159], a[36:39], a[204:207], v[156:159]
    v_mul_f32 v154, v154, |v154|
    v_mul_f32 v155, v155, |v155|
    v_mfma_f32_16x16x32_bf16 v[156:159], a[28:31], a[188:191], v[156:159]
    v_cvt_pk_bf16_f32 v136, v136, v137
    v_cvt_pk_bf16_f32 v137, v138, v139
    v_mfma_f32_16x16x32_bf16 v[156:159], a[20:23], a[172:175], v[156:159]
    v_cvt_pk_bf16_f32 v138, v152, v153
    v_cvt_pk_bf16_f32 v139, v154, v155
    v_mfma_f32_16x16x32_bf16 v[156:159], a[12:15], a[156:159], v[156:159]
    s_waitcnt vmcnt(12) lgkmcnt(0)
    v_pk_max_i16 v136, v136, 0
    v_pk_max_i16 v137, v137, 0
    v_mfma_f32_16x16x32_bf16 v[156:159], a[4:7], a[140:143], v[156:159]
    s_barrier
    v_pk_max_i16 v138, v138, 0
    v_pk_max_i16 v139, v139, 0
    v_mfma_f32_16x16x32_bf16 v[160:163], a[48:51], a[128:131], v[160:163]
    ds_read_b128 a[248:251], v30 offset:18432
    v_mfma_f32_16x16x32_bf16 v[160:163], a[56:59], a[144:147], v[160:163]
    ds_write_b128 v29, v[136:139] offset:2048
    v_mfma_f32_16x16x32_bf16 v[160:163], a[64:67], a[160:163], v[160:163]
    s_addk_i32 m0, 7168
    v_mul_f32 v140, v140, |v140|
    v_mul_f32 v141, v141, |v141|
    s_add_u32 s59, s3, s79
    v_mfma_f32_16x16x32_bf16 v[160:163], a[72:75], a[176:179], v[160:163]
    buffer_load_dwordx4 v12, s[12:15], s59 offen lds
    v_mfma_f32_16x16x32_bf16 v[160:163], a[80:83], a[192:195], v[160:163]
    ds_read_b128 a[252:255], v30 offset:19456
    v_mul_f32 v142, v142, |v142|
    v_mul_f32 v143, v143, |v143|
    v_mfma_f32_16x16x32_bf16 v[160:163], a[88:91], a[208:211], v[160:163]
    s_addk_i32 m0, 1024
    ds_read_b128 a[96:99], v30 offset:0
    v_mul_f32 v156, v156, |v156|
    v_mul_f32 v157, v157, |v157|
    v_mfma_f32_16x16x32_bf16 v[176:179], a[92:95], a[208:211], v[176:179]
    s_add_u32 s59, s3, s79
    ds_read_b128 a[100:103], v30 offset:1024
    v_mul_f32 v158, v158, |v158|
    v_mul_f32 v159, v159, |v159|
    v_mfma_f32_16x16x32_bf16 v[176:179], a[84:87], a[192:195], v[176:179]
    buffer_load_dwordx4 v33, s[12:15], s59 offen lds
    v_mfma_f32_16x16x32_bf16 v[176:179], a[76:79], a[176:179], v[176:179]
    ds_read_b64_tr_b16 a[0:1], v4 offset:0
    v_cvt_pk_bf16_f32 v140, v140, v141
    v_cvt_pk_bf16_f32 v141, v142, v143
    v_mfma_f32_16x16x32_bf16 v[176:179], a[68:71], a[160:163], v[176:179]
    ds_read_b64_tr_b16 a[2:3], v4 offset:2048
    v_cvt_pk_bf16_f32 v142, v156, v157
    v_cvt_pk_bf16_f32 v143, v158, v159
    v_mfma_f32_16x16x32_bf16 v[176:179], a[60:63], a[144:147], v[176:179]
    ds_read_b64_tr_b16 a[4:5], v5 offset:0
    v_pk_max_i16 v140, v140, 0
    v_pk_max_i16 v141, v141, 0
    v_mfma_f32_16x16x32_bf16 v[176:179], a[52:55], a[128:131], v[176:179]
    ds_read_b64_tr_b16 a[6:7], v5 offset:2048
    v_pk_max_i16 v142, v142, 0
    v_pk_max_i16 v143, v143, 0
    v_mfma_f32_16x16x32_bf16 v[164:167], a[48:51], a[132:135], v[164:167]
    ds_write_b128 v29, v[140:143] offset:3072
    v_mfma_f32_16x16x32_bf16 v[164:167], a[56:59], a[148:151], v[164:167]
    s_addk_i32 m0, 7168
    v_mul_f32 v160, v160, |v160|
    v_mul_f32 v161, v161, |v161|
    s_add_u32 s59, s3, s80
    v_mfma_f32_16x16x32_bf16 v[164:167], a[64:67], a[164:167], v[164:167]
    buffer_load_dwordx4 v12, s[12:15], s59 offen lds
    v_mfma_f32_16x16x32_bf16 v[164:167], a[72:75], a[180:183], v[164:167]
    ds_read_b64_tr_b16 a[8:9], v4 offset:4096
    v_mul_f32 v162, v162, |v162|
    v_mul_f32 v163, v163, |v163|
    v_mfma_f32_16x16x32_bf16 v[164:167], a[80:83], a[196:199], v[164:167]
    ds_read_b64_tr_b16 a[10:11], v4 offset:6144
    v_mul_f32 v176, v176, |v176|
    v_mul_f32 v177, v177, |v177|
    v_mfma_f32_16x16x32_bf16 v[164:167], a[88:91], a[212:215], v[164:167]
    ds_read_b64_tr_b16 a[12:13], v5 offset:4096
    v_mul_f32 v178, v178, |v178|
    v_mul_f32 v179, v179, |v179|
    v_mfma_f32_16x16x32_bf16 v[180:183], a[92:95], a[212:215], v[180:183]
    s_addk_i32 m0, 1024
    ds_read_b64_tr_b16 a[14:15], v5 offset:6144
    v_cvt_pk_bf16_f32 v160, v160, v161
    v_mfma_f32_16x16x32_bf16 v[180:183], a[84:87], a[196:199], v[180:183]
    s_add_u32 s59, s3, s80
    ds_read_b64_tr_b16 a[16:17], v4 offset:8192
    v_cvt_pk_bf16_f32 v161, v162, v163
    v_cvt_pk_bf16_f32 v162, v176, v177
    v_mfma_f32_16x16x32_bf16 v[180:183], a[76:79], a[180:183], v[180:183]
    buffer_load_dwordx4 v33, s[12:15], s59 offen lds
    v_mfma_f32_16x16x32_bf16 v[180:183], a[68:71], a[164:167], v[180:183]
    ds_read_b64_tr_b16 a[18:19], v4 offset:10240
    v_cvt_pk_bf16_f32 v163, v178, v179
    v_pk_max_i16 v160, v160, 0
    v_mfma_f32_16x16x32_bf16 v[180:183], a[60:63], a[148:151], v[180:183]
    ds_read_b64_tr_b16 a[20:21], v5 offset:8192
    v_pk_max_i16 v161, v161, 0
    v_pk_max_i16 v162, v162, 0
    v_mfma_f32_16x16x32_bf16 v[180:183], a[52:55], a[132:135], v[180:183]
    ds_read_b64_tr_b16 a[22:23], v5 offset:10240
    v_pk_max_i16 v163, v163, 0
    v_mfma_f32_16x16x32_bf16 v[168:171], a[48:51], a[136:139], v[168:171]
    ds_write_b128 v29, v[160:163] offset:16384
    v_mfma_f32_16x16x32_bf16 v[168:171], a[56:59], a[152:155], v[168:171]
    s_addk_i32 m0, 7168
    v_mul_f32 v164, v164, |v164|
    v_mul_f32 v165, v165, |v165|
    s_add_u32 s59, s3, s81
    v_mfma_f32_16x16x32_bf16 v[168:171], a[64:67], a[168:171], v[168:171]
    buffer_load_dwordx4 v12, s[12:15], s59 offen lds
    v_mfma_f32_16x16x32_bf16 v[168:171], a[72:75], a[184:187], v[168:171]
    ds_read_b64_tr_b16 a[24:25], v4 offset:12288
    v_mul_f32 v166, v166, |v166|
    v_mul_f32 v167, v167, |v167|
    v_mfma_f32_16x16x32_bf16 v[168:171], a[80:83], a[200:203], v[168:171]
    ds_read_b64_tr_b16 a[26:27], v4 offset:14336
    v_mul_f32 v180, v180, |v180|
    v_mul_f32 v181, v181, |v181|
    v_mfma_f32_16x16x32_bf16 v[168:171], a[88:91], a[216:219], v[168:171]
    ds_read_b64_tr_b16 a[28:29], v5 offset:12288
    v_mul_f32 v182, v182, |v182|
    v_mul_f32 v183, v183, |v183|
    v_mfma_f32_16x16x32_bf16 v[184:187], a[92:95], a[216:219], v[184:187]
    ds_read_b64_tr_b16 a[30:31], v5 offset:14336
    v_cvt_pk_bf16_f32 v164, v164, v165
    v_mfma_f32_16x16x32_bf16 v[184:187], a[84:87], a[200:203], v[184:187]
    s_addk_i32 m0, 1024
    ds_read_b64_tr_b16 a[32:33], v4 offset:16384
    v_cvt_pk_bf16_f32 v165, v166, v167
    v_cvt_pk_bf16_f32 v166, v180, v181
    v_mfma_f32_16x16x32_bf16 v[184:187], a[76:79], a[184:187], v[184:187]
    s_add_u32 s59, s3, s81
    ds_read_b64_tr_b16 a[34:35], v4 offset:18432
    v_cvt_pk_bf16_f32 v167, v182, v183
    v_pk_max_i16 v164, v164, 0
    v_mfma_f32_16x16x32_bf16 v[184:187], a[68:71], a[168:171], v[184:187]
    buffer_load_dwordx4 v33, s[12:15], s59 offen lds
    v_mfma_f32_16x16x32_bf16 v[184:187], a[60:63], a[152:155], v[184:187]
    ds_read_b64_tr_b16 a[36:37], v5 offset:16384
    v_pk_max_i16 v165, v165, 0
    v_pk_max_i16 v166, v166, 0
    v_mfma_f32_16x16x32_bf16 v[184:187], a[52:55], a[136:139], v[184:187]
    ds_read_b64_tr_b16 a[38:39], v5 offset:18432
    v_pk_max_i16 v167, v167, 0
    v_mfma_f32_16x16x32_bf16 v[172:175], a[48:51], a[140:143], v[172:175]
    ds_write_b128 v29, v[164:167] offset:17408
    v_mfma_f32_16x16x32_bf16 v[172:175], a[56:59], a[156:159], v[172:175]
    v_mul_f32 v168, v168, |v168|
    v_mul_f32 v169, v169, |v169|
    v_mfma_f32_16x16x32_bf16 v[172:175], a[64:67], a[172:175], v[172:175]
    s_and_b32 s44, s44, 48
    ds_read_b64_tr_b16 a[40:41], v4 offset:20480
    v_mul_f32 v170, v170, |v170|
    v_mfma_f32_16x16x32_bf16 v[172:175], a[72:75], a[188:191], v[172:175]
    buffer_load_dword v49, v39, s[28:31], s44 offen sc1
    v_mfma_f32_16x16x32_bf16 v[172:175], a[80:83], a[204:207], v[172:175]
    ds_read_b64_tr_b16 a[42:43], v4 offset:22528
    v_mul_f32 v171, v171, |v171|
    v_mfma_f32_16x16x32_bf16 v[172:175], a[88:91], a[220:223], v[172:175]
    ds_read_b64_tr_b16 a[44:45], v5 offset:20480
    v_mul_f32 v184, v184, |v184|
    v_mfma_f32_16x16x32_bf16 v[188:191], a[92:95], a[220:223], v[188:191]
    ds_read_b64_tr_b16 a[46:47], v5 offset:22528
    v_mul_f32 v185, v185, |v185|
    v_mfma_f32_16x16x32_bf16 v[188:191], a[84:87], a[204:207], v[188:191]
    v_mul_f32 v186, v186, |v186|
    v_mul_f32 v187, v187, |v187|
    v_mfma_f32_16x16x32_bf16 v[188:191], a[76:79], a[188:191], v[188:191]
    v_cvt_pk_bf16_f32 v168, v168, v169
    v_cvt_pk_bf16_f32 v169, v170, v171
    v_mfma_f32_16x16x32_bf16 v[188:191], a[68:71], a[172:175], v[188:191]
    v_cvt_pk_bf16_f32 v170, v184, v185
    v_cvt_pk_bf16_f32 v171, v186, v187
    v_mfma_f32_16x16x32_bf16 v[188:191], a[60:63], a[156:159], v[188:191]
    s_waitcnt vmcnt(13) lgkmcnt(0)
    v_pk_max_i16 v168, v168, 0
    v_pk_max_i16 v169, v169, 0
    v_mfma_f32_16x16x32_bf16 v[188:191], a[52:55], a[140:143], v[188:191]
    s_barrier
    v_pk_max_i16 v170, v170, 0
    v_pk_max_i16 v171, v171, 0
    v_mfma_f32_16x16x32_bf16 v[192:195], a[0:3], a[128:131], v[192:195]
    ds_read_b128 a[104:107], v30 offset:2048
    v_mfma_f32_16x16x32_bf16 v[192:195], a[8:11], a[144:147], v[192:195]
    ds_write_b128 v29, v[168:171] offset:18432
    v_mfma_f32_16x16x32_bf16 v[192:195], a[16:19], a[160:163], v[192:195]
    s_add_u32 s3, s3, 128
    v_mul_f32 v172, v172, |v172|
    v_mul_f32 v173, v173, |v173|
    s_sub_u32 s67, s3, 1152
    s_min_u32 s3, s3, s67
    v_mfma_f32_16x16x32_bf16 v[192:195], a[24:27], a[176:179], v[192:195]
    s_add_u32 m0, s62, 0
    ds_read_b128 a[108:111], v30 offset:3072
    v_mul_f32 v174, v174, |v174|
    s_add_u32 s59, s3, s76
    v_mfma_f32_16x16x32_bf16 v[192:195], a[32:35], a[192:195], v[192:195]
    buffer_load_dwordx4 v12, s[12:15], s59 offen lds
    v_mfma_f32_16x16x32_bf16 v[192:195], a[40:43], a[208:211], v[192:195]
    ds_read_b128 a[112:115], v30 offset:16384
    v_mul_f32 v175, v175, |v175|
    v_mul_f32 v188, v188, |v188|
    v_mfma_f32_16x16x32_bf16 v[208:211], a[44:47], a[208:211], v[208:211]
    s_addk_i32 m0, 1024
    ds_read_b128 a[116:119], v30 offset:17408
    v_mul_f32 v189, v189, |v189|
    v_mul_f32 v190, v190, |v190|
    v_mfma_f32_16x16x32_bf16 v[208:211], a[36:39], a[192:195], v[208:211]
    s_add_u32 s59, s3, s76
    ds_read_b64_tr_b16 a[48:49], v4 offset:24576
    v_mul_f32 v191, v191, |v191|
    v_cvt_pk_bf16_f32 v172, v172, v173
    v_cvt_pk_bf16_f32 v173, v174, v175
    v_mfma_f32_16x16x32_bf16 v[208:211], a[28:31], a[176:179], v[208:211]
    buffer_load_dwordx4 v33, s[12:15], s59 offen lds
    v_mfma_f32_16x16x32_bf16 v[208:211], a[20:23], a[160:163], v[208:211]
    ds_read_b64_tr_b16 a[50:51], v4 offset:26624
    v_cvt_pk_bf16_f32 v174, v188, v189
    v_cvt_pk_bf16_f32 v175, v190, v191
    v_mfma_f32_16x16x32_bf16 v[208:211], a[12:15], a[144:147], v[208:211]
    ds_read_b64_tr_b16 a[52:53], v5 offset:24576
    v_pk_max_i16 v172, v172, 0
    v_pk_max_i16 v173, v173, 0
    v_mfma_f32_16x16x32_bf16 v[208:211], a[4:7], a[128:131], v[208:211]
    ds_read_b64_tr_b16 a[54:55], v5 offset:26624
    v_pk_max_i16 v174, v174, 0
    v_pk_max_i16 v175, v175, 0
    v_mfma_f32_16x16x32_bf16 v[196:199], a[0:3], a[132:135], v[196:199]
    ds_write_b128 v29, v[172:175] offset:19456
    v_mfma_f32_16x16x32_bf16 v[196:199], a[8:11], a[148:151], v[196:199]
    v_mul_f32 v192, v192, |v192|
    v_mul_f32 v193, v193, |v193|
    v_mul_f32 v194, v194, |v194|
    v_mfma_f32_16x16x32_bf16 v[196:199], a[16:19], a[164:167], v[196:199]
    s_addk_i32 m0, 7168
    ds_read_b64_tr_b16 a[56:57], v4 offset:28672
    v_mul_f32 v195, v195, |v195|
    v_mul_f32 v208, v208, |v208|
    v_mfma_f32_16x16x32_bf16 v[196:199], a[24:27], a[180:183], v[196:199]
L_stubF5:
    s_cbranch_execz L_jrF2
    s_nop 0
    s_add_u32 s59, s3, s77
    ds_read_b64_tr_b16 a[58:59], v4 offset:30720
    v_mul_f32 v209, v209, |v209|
    v_mfma_f32_16x16x32_bf16 v[196:199], a[32:35], a[196:199], v[196:199]
    buffer_load_dwordx4 v12, s[12:15], s59 offen lds
    v_mfma_f32_16x16x32_bf16 v[196:199], a[40:43], a[212:215], v[196:199]
    ds_read_b64_tr_b16 a[60:61], v5 offset:28672
    v_mul_f32 v210, v210, |v210|
    v_mul_f32 v211, v211, |v211|
    v_mfma_f32_16x16x32_bf16 v[212:215], a[44:47], a[212:215], v[212:215]
    ds_read_b64_tr_b16 a[62:63], v5 offset:30720
    v_cvt_pk_bf16_f32 v192, v192, v193
    v_cvt_pk_bf16_f32 v193, v194, v195
    v_mfma_f32_16x16x32_bf16 v[212:215], a[36:39], a[196:199], v[212:215]
    ds_read_b64_tr_b16 a[64:65], v4 offset:32768
    v_cvt_pk_bf16_f32 v194, v208, v209
    v_mfma_f32_16x16x32_bf16 v[212:215], a[28:31], a[180:183], v[212:215]
    ds_read_b64_tr_b16 a[66:67], v4 offset:34816
    v_cvt_pk_bf16_f32 v195, v210, v211
    v_pk_max_i16 v192, v192, 0
    v_mfma_f32_16x16x32_bf16 v[212:215], a[20:23], a[164:167], v[212:215]
    s_addk_i32 m0, 1024
    ds_read_b64_tr_b16 a[68:69], v5 offset:32768
    v_pk_max_i16 v193, v193, 0
    v_pk_max_i16 v194, v194, 0
    v_mfma_f32_16x16x32_bf16 v[212:215], a[12:15], a[148:151], v[212:215]
    s_add_u32 s59, s3, s77
    ds_read_b64_tr_b16 a[70:71], v5 offset:34816
    v_pk_max_i16 v195, v195, 0
    v_mfma_f32_16x16x32_bf16 v[212:215], a[4:7], a[132:135], v[212:215]
    buffer_load_dwordx4 v33, s[12:15], s59 offen lds
    v_mfma_f32_16x16x32_bf16 v[200:203], a[0:3], a[136:139], v[200:203]
    ds_write_b128 v29, v[192:195] offset:0
    v_mfma_f32_16x16x32_bf16 v[200:203], a[8:11], a[152:155], v[200:203]
    v_mul_f32 v196, v196, |v196|
    v_mul_f32 v197, v197, |v197|
    v_mul_f32 v198, v198, |v198|
    v_mfma_f32_16x16x32_bf16 v[200:203], a[16:19], a[168:171], v[200:203]
    ds_read_b64_tr_b16 a[72:73], v4 offset:36864
    v_mul_f32 v199, v199, |v199|
    v_mfma_f32_16x16x32_bf16 v[200:203], a[24:27], a[184:187], v[200:203]
    ds_read_b64_tr_b16 a[74:75], v4 offset:38912
    v_mul_f32 v212, v212, |v212|
    v_mul_f32 v213, v213, |v213|
    v_mfma_f32_16x16x32_bf16 v[200:203], a[32:35], a[200:203], v[200:203]
    ds_read_b64_tr_b16 a[76:77], v5 offset:36864
    v_mul_f32 v214, v214, |v214|
    v_mfma_f32_16x16x32_bf16 v[200:203], a[40:43], a[216:219], v[200:203]
    s_addk_i32 m0, 7168
    ds_read_b64_tr_b16 a[78:79], v5 offset:38912
    v_mul_f32 v215, v215, |v215|
    v_cvt_pk_bf16_f32 v196, v196, v197
    v_mfma_f32_16x16x32_bf16 v[216:219], a[44:47], a[216:219], v[216:219]
    s_add_u32 s59, s3, s78
    ds_read_b64_tr_b16 a[80:81], v4 offset:40960
    v_cvt_pk_bf16_f32 v197, v198, v199
    v_mfma_f32_16x16x32_bf16 v[216:219], a[36:39], a[200:203], v[216:219]
    buffer_load_dwordx4 v12, s[12:15], s59 offen lds
    v_mfma_f32_16x16x32_bf16 v[216:219], a[28:31], a[184:187], v[216:219]
    ds_read_b64_tr_b16 a[82:83], v4 offset:43008
    v_cvt_pk_bf16_f32 v198, v212, v213
    v_cvt_pk_bf16_f32 v199, v214, v215
    v_mfma_f32_16x16x32_bf16 v[216:219], a[20:23], a[168:171], v[216:219]
    ds_read_b64_tr_b16 a[84:85], v5 offset:40960
    v_pk_max_i16 v196, v196, 0
    v_mfma_f32_16x16x32_bf16 v[216:219], a[12:15], a[152:155], v[216:219]
    ds_read_b64_tr_b16 a[86:87], v5 offset:43008
    v_pk_max_i16 v197, v197, 0
    v_pk_max_i16 v198, v198, 0
    v_mfma_f32_16x16x32_bf16 v[216:219], a[4:7], a[136:139], v[216:219]
    ds_read_b64_tr_b16 a[88:89], v4 offset:45056
    v_pk_max_i16 v199, v199, 0
    v_mfma_f32_16x16x32_bf16 v[204:207], a[0:3], a[140:143], v[204:207]
    ds_write_b128 v29, v[196:199] offset:1024
    v_mfma_f32_16x16x32_bf16 v[204:207], a[8:11], a[156:159], v[204:207]
    s_addk_i32 m0, 1024
    v_mul_f32 v200, v200, |v200|
    s_add_u32 s59, s3, s78
    v_mfma_f32_16x16x32_bf16 v[204:207], a[16:19], a[172:175], v[204:207]
    buffer_load_dwordx4 v33, s[12:15], s59 offen lds
    v_mfma_f32_16x16x32_bf16 v[204:207], a[24:27], a[188:191], v[204:207]
    ds_read_b64_tr_b16 a[90:91], v4 offset:47104
    v_mul_f32 v201, v201, |v201|
    v_mfma_f32_16x16x32_bf16 v[204:207], a[32:35], a[204:207], v[204:207]
    ds_read_b64_tr_b16 a[92:93], v5 offset:45056
    v_mul_f32 v202, v202, |v202|
    v_mfma_f32_16x16x32_bf16 v[204:207], a[40:43], a[220:223], v[204:207]
    ds_read_b64_tr_b16 a[94:95], v5 offset:47104
    v_mul_f32 v203, v203, |v203|
    v_mfma_f32_16x16x32_bf16 v[220:223], a[44:47], a[220:223], v[220:223]
    v_mul_f32 v216, v216, |v216|
    v_mul_f32 v217, v217, |v217|
    v_mfma_f32_16x16x32_bf16 v[220:223], a[36:39], a[204:207], v[220:223]
    v_mul_f32 v218, v218, |v218|
    v_mul_f32 v219, v219, |v219|
    v_mfma_f32_16x16x32_bf16 v[220:223], a[28:31], a[188:191], v[220:223]
    v_cvt_pk_bf16_f32 v200, v200, v201
    v_cvt_pk_bf16_f32 v201, v202, v203
    v_mfma_f32_16x16x32_bf16 v[220:223], a[20:23], a[172:175], v[220:223]
    v_cvt_pk_bf16_f32 v202, v216, v217
    v_cvt_pk_bf16_f32 v203, v218, v219
    v_mfma_f32_16x16x32_bf16 v[220:223], a[12:15], a[156:159], v[220:223]
    s_waitcnt vmcnt(7) lgkmcnt(0)
    v_pk_max_i16 v200, v200, 0
    v_pk_max_i16 v201, v201, 0
    v_mfma_f32_16x16x32_bf16 v[220:223], a[4:7], a[140:143], v[220:223]
    s_barrier
    v_pk_max_i16 v202, v202, 0
    v_pk_max_i16 v203, v203, 0
    v_mfma_f32_16x16x32_bf16 v[224:227], a[48:51], a[128:131], v[224:227]
    ds_read_b128 a[120:123], v30 offset:18432
    v_mfma_f32_16x16x32_bf16 v[224:227], a[56:59], a[144:147], v[224:227]
    ds_write_b128 v29, v[200:203] offset:2048
    v_mfma_f32_16x16x32_bf16 v[224:227], a[64:67], a[160:163], v[224:227]
    s_addk_i32 m0, 7168
    v_mul_f32 v204, v204, |v204|
    v_mul_f32 v205, v205, |v205|
    s_add_u32 s59, s3, s79
    v_mfma_f32_16x16x32_bf16 v[224:227], a[72:75], a[176:179], v[224:227]
    buffer_load_dwordx4 v12, s[12:15], s59 offen lds
    v_mfma_f32_16x16x32_bf16 v[224:227], a[80:83], a[192:195], v[224:227]
    ds_read_b128 a[124:127], v30 offset:19456
    v_mul_f32 v206, v206, |v206|
    v_mul_f32 v207, v207, |v207|
    v_mfma_f32_16x16x32_bf16 v[224:227], a[88:91], a[208:211], v[224:227]
    ds_read_b64_tr_b16 a[0:1], v13 offset:0
    v_mul_f32 v220, v220, |v220|
    v_mul_f32 v221, v221, |v221|
    v_mfma_f32_16x16x32_bf16 v[240:243], a[92:95], a[208:211], v[240:243]
    s_addk_i32 m0, 1024
    ds_read_b64_tr_b16 a[2:3], v13 offset:2048
    v_mul_f32 v222, v222, |v222|
    v_mul_f32 v223, v223, |v223|
    v_mfma_f32_16x16x32_bf16 v[240:243], a[84:87], a[192:195], v[240:243]
    s_add_u32 s59, s3, s79
    ds_read_b64_tr_b16 a[4:5], v13 offset:8192
    v_cvt_pk_bf16_f32 v204, v204, v205
    v_cvt_pk_bf16_f32 v205, v206, v207
    v_mfma_f32_16x16x32_bf16 v[240:243], a[76:79], a[176:179], v[240:243]
    buffer_load_dwordx4 v33, s[12:15], s59 offen lds
    v_mfma_f32_16x16x32_bf16 v[240:243], a[68:71], a[160:163], v[240:243]
    ds_read_b64_tr_b16 a[6:7], v13 offset:10240
    v_cvt_pk_bf16_f32 v206, v220, v221
    v_cvt_pk_bf16_f32 v207, v222, v223
    v_mfma_f32_16x16x32_bf16 v[240:243], a[60:63], a[144:147], v[240:243]
    ds_read_b64_tr_b16 a[8:9], v13 offset:16384
    v_pk_max_i16 v204, v204, 0
    v_pk_max_i16 v205, v205, 0
    v_mfma_f32_16x16x32_bf16 v[240:243], a[52:55], a[128:131], v[240:243]
    ds_read_b64_tr_b16 a[10:11], v13 offset:18432
    v_pk_max_i16 v206, v206, 0
    v_pk_max_i16 v207, v207, 0
    v_mfma_f32_16x16x32_bf16 v[228:231], a[48:51], a[132:135], v[228:231]
    ds_write_b128 v29, v[204:207] offset:3072
    v_mfma_f32_16x16x32_bf16 v[228:231], a[56:59], a[148:151], v[228:231]
    v_mul_f32 v224, v224, |v224|
    v_mul_f32 v225, v225, |v225|
    v_mul_f32 v226, v226, |v226|
    v_mfma_f32_16x16x32_bf16 v[228:231], a[64:67], a[164:167], v[228:231]
    s_addk_i32 m0, 7168
    ds_read_b64_tr_b16 a[12:13], v13 offset:24576
    v_mul_f32 v227, v227, |v227|
    v_mul_f32 v240, v240, |v240|
    v_mfma_f32_16x16x32_bf16 v[228:231], a[72:75], a[180:183], v[228:231]
    s_add_u32 s59, s3, s80
    ds_read_b64_tr_b16 a[14:15], v13 offset:26624
    v_mul_f32 v241, v241, |v241|
    v_mfma_f32_16x16x32_bf16 v[228:231], a[80:83], a[196:199], v[228:231]
    buffer_load_dwordx4 v12, s[12:15], s59 offen lds
    v_mfma_f32_16x16x32_bf16 v[228:231], a[88:91], a[212:215], v[228:231]
    ds_read_b64_tr_b16 a[16:17], v13 offset:32768
    v_mul_f32 v242, v242, |v242|
    v_mul_f32 v243, v243, |v243|
    v_mfma_f32_16x16x32_bf16 v[244:247], a[92:95], a[212:215], v[244:247]
    ds_read_b64_tr_b16 a[18:19], v13 offset:34816
    v_cvt_pk_bf16_f32 v224, v224, v225
    v_cvt_pk_bf16_f32 v225, v226, v227
    v_mfma_f32_16x16x32_bf16 v[244:247], a[84:87], a[196:199], v[244:247]
    ds_read_b64_tr_b16 a[24:25], v14 offset:0
    v_cvt_pk_bf16_f32 v226, v240, v241
    v_mfma_f32_16x16x32_bf16 v[244:247], a[76:79], a[180:183], v[244:247]
    ds_read_b64_tr_b16 a[26:27], v14 offset:2048
    v_cvt_pk_bf16_f32 v227, v242, v243
    v_pk_max_i16 v224, v224, 0
    v_mfma_f32_16x16x32_bf16 v[244:247], a[68:71], a[164:167], v[244:247]
    s_addk_i32 m0, 1024
    ds_read_b64_tr_b16 a[28:29], v14 offset:8192
    v_pk_max_i16 v225, v225, 0
    v_pk_max_i16 v226, v226, 0
    v_mfma_f32_16x16x32_bf16 v[244:247], a[60:63], a[148:151], v[244:247]
    s_add_u32 s59, s3, s80
    ds_read_b64_tr_b16 a[30:31], v14 offset:10240
    v_pk_max_i16 v227, v227, 0
    v_mfma_f32_16x16x32_bf16 v[244:247], a[52:55], a[132:135], v[244:247]
    buffer_load_dwordx4 v33, s[12:15], s59 offen lds
    v_mfma_f32_16x16x32_bf16 v[232:235], a[48:51], a[136:139], v[232:235]
    ds_write_b128 v29, v[224:227] offset:16384
    v_mfma_f32_16x16x32_bf16 v[232:235], a[56:59], a[152:155], v[232:235]
    v_mul_f32 v228, v228, |v228|
    v_mul_f32 v229, v229, |v229|
    v_mul_f32 v230, v230, |v230|
    v_mfma_f32_16x16x32_bf16 v[232:235], a[64:67], a[168:171], v[232:235]
    ds_read_b128 a[128:131], v30 offset:0
    v_mul_f32 v231, v231, |v231|
    v_mfma_f32_16x16x32_bf16 v[232:235], a[72:75], a[184:187], v[232:235]
    ds_read_b128 a[144:147], v30 offset:1024
    v_mul_f32 v244, v244, |v244|
    v_mul_f32 v245, v245, |v245|
    v_mfma_f32_16x16x32_bf16 v[232:235], a[80:83], a[200:203], v[232:235]
    ds_read_b64_tr_b16 a[32:33], v14 offset:16384
    v_mul_f32 v246, v246, |v246|
    v_mfma_f32_16x16x32_bf16 v[232:235], a[88:91], a[216:219], v[232:235]
    s_addk_i32 m0, 7168
    ds_read_b64_tr_b16 a[34:35], v14 offset:18432
    v_mul_f32 v247, v247, |v247|
    v_cvt_pk_bf16_f32 v228, v228, v229
    v_mfma_f32_16x16x32_bf16 v[248:251], a[92:95], a[216:219], v[248:251]
    s_add_u32 s59, s3, s81
    ds_read_b64_tr_b16 a[36:37], v14 offset:24576
    v_cvt_pk_bf16_f32 v229, v230, v231
    v_mfma_f32_16x16x32_bf16 v[248:251], a[84:87], a[200:203], v[248:251]
    buffer_load_dwordx4 v12, s[12:15], s59 offen lds
    v_mfma_f32_16x16x32_bf16 v[248:251], a[76:79], a[184:187], v[248:251]
    ds_read_b64_tr_b16 a[38:39], v14 offset:26624
    v_cvt_pk_bf16_f32 v230, v244, v245
    v_cvt_pk_bf16_f32 v231, v246, v247
    v_mfma_f32_16x16x32_bf16 v[248:251], a[68:71], a[168:171], v[248:251]
    ds_read_b64_tr_b16 a[40:41], v14 offset:32768
    v_pk_max_i16 v228, v228, 0
    v_mfma_f32_16x16x32_bf16 v[248:251], a[60:63], a[152:155], v[248:251]
    ds_read_b64_tr_b16 a[42:43], v14 offset:34816
    v_pk_max_i16 v229, v229, 0
    v_pk_max_i16 v230, v230, 0
    v_mfma_f32_16x16x32_bf16 v[248:251], a[52:55], a[136:139], v[248:251]
    ds_read_b64_tr_b16 a[20:21], v13 offset:40960
    v_pk_max_i16 v231, v231, 0
    v_mfma_f32_16x16x32_bf16 v[236:239], a[48:51], a[140:143], v[236:239]
    ds_write_b128 v29, v[228:231] offset:17408
    v_mfma_f32_16x16x32_bf16 v[236:239], a[56:59], a[156:159], v[236:239]
    s_addk_i32 m0, 1024
    v_mul_f32 v232, v232, |v232|
    s_add_u32 s59, s3, s81
    v_mfma_f32_16x16x32_bf16 v[236:239], a[64:67], a[172:175], v[236:239]
    buffer_load_dwordx4 v33, s[12:15], s59 offen lds
    v_mfma_f32_16x16x32_bf16 v[236:239], a[72:75], a[188:191], v[236:239]
    ds_read_b64_tr_b16 a[22:23], v13 offset:43008
    v_mul_f32 v233, v233, |v233|
    v_mfma_f32_16x16x32_bf16 v[236:239], a[80:83], a[204:207], v[236:239]
    ds_read_b64_tr_b16 a[44:45], v14 offset:40960
    v_mul_f32 v234, v234, |v234|
    v_mfma_f32_16x16x32_bf16 v[236:239], a[88:91], a[220:223], v[236:239]
    ds_read_b64_tr_b16 a[46:47], v14 offset:43008
    v_mul_f32 v235, v235, |v235|
    v_mfma_f32_16x16x32_bf16 v[252:255], a[92:95], a[220:223], v[252:255]
    v_mul_f32 v248, v248, |v248|
    v_mul_f32 v249, v249, |v249|
    v_mfma_f32_16x16x32_bf16 v[252:255], a[84:87], a[204:207], v[252:255]
    v_mul_f32 v250, v250, |v250|
    v_mul_f32 v251, v251, |v251|
    v_mfma_f32_16x16x32_bf16 v[252:255], a[76:79], a[188:191], v[252:255]
    v_cvt_pk_bf16_f32 v232, v232, v233
    v_cvt_pk_bf16_f32 v233, v234, v235
    v_mfma_f32_16x16x32_bf16 v[252:255], a[68:71], a[172:175], v[252:255]
    v_cvt_pk_bf16_f32 v234, v248, v249
    v_cvt_pk_bf16_f32 v235, v250, v251
    v_mfma_f32_16x16x32_bf16 v[252:255], a[60:63], a[156:159], v[252:255]
    s_waitcnt vmcnt(12) lgkmcnt(0)
    v_pk_max_i16 v232, v232, 0
    v_pk_max_i16 v233, v233, 0
    v_mfma_f32_16x16x32_bf16 v[252:255], a[52:55], a[140:143], v[252:255]
    s_barrier
    v_pk_max_i16 v234, v234, 0
    v_pk_max_i16 v235, v235, 0
    v_mfma_f32_16x16x32_bf16 v[80:83], a[0:3], v[64:67], 0
    ds_read_b128 a[140:143], v30 offset:16384
    v_cmp_gt_u32 vcc, 1, v49
    v_mfma_f32_16x16x32_bf16 v[80:83], a[4:7], v[96:99], v[80:83]
    ds_read_b128 a[148:151], v30 offset:17408
    v_mfma_f32_16x16x32_bf16 v[80:83], a[8:11], v[128:131], v[80:83]
    s_and_b32 s55, vcc_lo, 0xffff
    ds_read_b128 a[132:135], v30 offset:2048
    s_cbranch_scc0 L_spF1r
    s_mov_b32 s41, 0
L_spF1b:
    buffer_load_dword v49, v39, s[28:31], s44 offen sc1
    s_add_u32 s41, s41, 1
    s_cmp_gt_u32 s41, 200000
    s_cbranch_scc1 L_spF1r
    s_waitcnt vmcnt(0)
    v_cmp_gt_u32 vcc, 1, v49
    s_nop 1
    s_and_b32 s55, vcc_lo, 0xffff
    s_cbranch_scc1 L_spF1b
L_spF1r:
    v_mfma_f32_16x16x32_bf16 v[80:83], a[12:15], v[160:163], v[80:83]
    ds_read_b128 a[136:139], v30 offset:3072
    v_mfma_f32_16x16x32_bf16 v[80:83], a[16:19], v[192:195], v[80:83]
    ds_write_b128 v29, v[232:235] offset:18432
    v_mfma_f32_16x16x32_bf16 v[80:83], a[24:27], a[224:227], v[80:83]
    v_mul_f32 v236, v236, |v236|
    v_mul_f32 v237, v237, |v237|
    v_mul_f32 v238, v238, |v238|
    v_mfma_f32_16x16x32_bf16 v[80:83], a[28:31], a[240:243], v[80:83]
    ds_read_b64_tr_b16 a[48:49], v15 offset:0
    v_mul_f32 v239, v239, |v239|
    v_mfma_f32_16x16x32_bf16 v[80:83], a[32:35], a[96:99], v[80:83]
    ds_read_b64_tr_b16 a[50:51], v15 offset:2048
    v_mul_f32 v252, v252, |v252|
    v_mul_f32 v253, v253, |v253|
    v_mfma_f32_16x16x32_bf16 v[80:83], a[36:39], a[112:115], v[80:83]
    ds_read_b64_tr_b16 a[52:53], v15 offset:8192
    v_mul_f32 v254, v254, |v254|
    v_mfma_f32_16x16x32_bf16 v[80:83], a[40:43], a[128:131], v[80:83]
    ds_read_b64_tr_b16 a[54:55], v15 offset:10240
    v_mul_f32 v255, v255, |v255|
    v_cvt_pk_bf16_f32 v236, v236, v237
    v_mfma_f32_16x16x32_bf16 v[80:83], a[20:23], v[224:227], v[80:83]
    s_waitcnt lgkmcnt(5)
    ds_read_b64_tr_b16 a[56:57], v15 offset:16384
    v_cvt_pk_bf16_f32 v237, v238, v239
    v_mfma_f32_16x16x32_bf16 v[80:83], a[44:47], a[140:143], v[80:83]
    ds_read_b64_tr_b16 a[58:59], v15 offset:18432
    v_cvt_pk_bf16_f32 v238, v252, v253
    v_cvt_pk_bf16_f32 v239, v254, v255
    v_mfma_f32_16x16x32_bf16 v[84:87], a[0:3], v[68:71], 0
    ds_read_b64_tr_b16 a[60:61], v15 offset:24576
    v_pk_max_i16 v236, v236, 0
    v_mfma_f32_16x16x32_bf16 v[84:87], a[4:7], v[100:103], v[84:87]
    ds_read_b64_tr_b16 a[62:63], v15 offset:26624
    v_pk_max_i16 v237, v237, 0
    v_pk_max_i16 v238, v238, 0
    v_mfma_f32_16x16x32_bf16 v[84:87], a[8:11], v[132:135], v[84:87]
    ds_read_b64_tr_b16 a[64:65], v15 offset:32768
    v_pk_max_i16 v239, v239, 0
    v_mfma_f32_16x16x32_bf16 v[84:87], a[12:15], v[164:167], v[84:87]
    ds_write_b128 v29, v[236:239] offset:19456
    v_mfma_f32_16x16x32_bf16 v[84:87], a[16:19], v[196:199], v[84:87]
    v_mfma_f32_16x16x32_bf16 v[84:87], a[24:27], a[228:231], v[84:87]
    ds_read_b64_tr_b16 a[66:67], v15 offset:34816
    v_cvt_pk_bf16_f32 v144, v80, v81
    v_mfma_f32_16x16x32_bf16 v[84:87], a[28:31], a[244:247], v[84:87]
    ds_read_b64_tr_b16 a[72:73], v16 offset:0
    v_cvt_pk_bf16_f32 v145, v82, v83
    v_mfma_f32_16x16x32_bf16 v[84:87], a[32:35], a[100:103], v[84:87]
    s_waitcnt lgkmcnt(2)
    ds_read_b64_tr_b16 a[74:75], v16 offset:2048
    v_cvt_pk_bf16_f32 v176, v80, v81
    v_mfma_f32_16x16x32_bf16 v[84:87], a[36:39], a[116:119], v[84:87]
    s_barrier
    ds_read_b128 a[152:155], v30 offset:18432
    v_cvt_pk_bf16_f32 v177, v82, v83
    v_mfma_f32_16x16x32_bf16 v[84:87], a[40:43], a[144:147], v[84:87]
    ds_read_b128 a[156:159], v30 offset:19456
    v_mfma_f32_16x16x32_bf16 v[84:87], a[20:23], v[228:231], v[84:87]
    ds_read_b64_tr_b16 a[76:77], v16 offset:8192
    v_mfma_f32_16x16x32_bf16 v[84:87], a[44:47], a[148:151], v[84:87]
    ds_read_b64_tr_b16 a[78:79], v16 offset:10240
    v_add_u32_dpp v49, v49, v49 quad_perm:[1,0,3,2] row_mask:0xf bank_mask:0xf
    v_mfma_f32_16x16x32_bf16 v[88:91], a[0:3], v[72:75], 0
    ds_read_b64_tr_b16 a[80:81], v16 offset:16384
    v_add_u32_dpp v49, v49, v49 quad_perm:[2,3,0,1] row_mask:0xf bank_mask:0xf
    v_mfma_f32_16x16x32_bf16 v[88:91], a[4:7], v[104:107], v[88:91]
    ds_read_b64_tr_b16 a[82:83], v16 offset:18432
    v_readfirstlane_b32 s56, v49
    v_mfma_f32_16x16x32_bf16 v[88:91], a[8:11], v[136:139], v[88:91]
    s_nop 0
    s_add_u32 s55, s56, 0x20000
    ds_read_b64_tr_b16 a[84:85], v16 offset:24576
    v_mfma_f32_16x16x32_bf16 v[88:91], a[12:15], v[168:171], v[88:91]
    s_lshr_b32 s56, s56, 31
    ds_read_b64_tr_b16 a[86:87], v16 offset:26624
    v_mfma_f32_16x16x32_bf16 v[88:91], a[16:19], v[200:203], v[88:91]
    s_xor_b32 s56, s56, s50
    ds_read_b64_tr_b16 a[88:89], v16 offset:32768
    v_mfma_f32_16x16x32_bf16 v[88:91], a[24:27], a[232:235], v[88:91]
    s_cmp_lt_u32 s55, 0x50000
    s_cselect_b32 s56, 0, s56
    ds_read_b64_tr_b16 a[90:91], v16 offset:34816
    v_cvt_pk_bf16_f32 v148, v84, v85
    v_mfma_f32_16x16x32_bf16 v[88:91], a[28:31], a[248:251], v[88:91]
    s_lshr_b32 s55, s50, 3
    ds_read_b64_tr_b16 a[68:69], v15 offset:40960
    v_cvt_pk_bf16_f32 v149, v86, v87
    v_mfma_f32_16x16x32_bf16 v[88:91], a[32:35], a[104:107], v[88:91]
    s_xor_b32 s56, s56, s55
    ds_read_b64_tr_b16 a[70:71], v15 offset:43008
    v_mfma_f32_16x16x32_bf16 v[88:91], a[36:39], a[120:123], v[88:91]
    s_and_b32 s56, s56, 1
    ds_read_b64_tr_b16 a[92:93], v16 offset:40960
    v_mfma_f32_16x16x32_bf16 v[88:91], a[40:43], a[132:135], v[88:91]
    s_lshl_b32 s56, s56, 13
    ds_read_b64_tr_b16 a[94:95], v16 offset:43008
    v_mfma_f32_16x16x32_bf16 v[88:91], a[20:23], v[232:235], v[88:91]
    s_waitcnt lgkmcnt(8)
    s_add_u32 s43, s43, s56
    v_mfma_f32_16x16x32_bf16 v[88:91], a[44:47], a[152:155], v[88:91]
    s_add_u32 s40, s40, s56
    v_mfma_f32_16x16x32_bf16 v[92:95], a[0:3], v[76:79], 0
    s_add_u32 s42, s42, s56
    v_mfma_f32_16x16x32_bf16 v[92:95], a[4:7], v[108:111], v[92:95]
    v_mfma_f32_16x16x32_bf16 v[92:95], a[8:11], v[140:143], v[92:95]
    v_mfma_f32_16x16x32_bf16 v[92:95], a[12:15], v[172:175], v[92:95]
    v_mfma_f32_16x16x32_bf16 v[92:95], a[16:19], v[204:207], v[92:95]
    v_mfma_f32_16x16x32_bf16 v[92:95], a[24:27], a[236:239], v[92:95]
    v_cvt_pk_bf16_f32 v152, v88, v89
    v_mfma_f32_16x16x32_bf16 v[92:95], a[28:31], a[252:255], v[92:95]
    v_cvt_pk_bf16_f32 v153, v90, v91
    v_mfma_f32_16x16x32_bf16 v[92:95], a[32:35], a[108:111], v[92:95]
    v_mfma_f32_16x16x32_bf16 v[92:95], a[36:39], a[124:127], v[92:95]
    v_mfma_f32_16x16x32_bf16 v[92:95], a[40:43], a[136:139], v[92:95]
    v_mfma_f32_16x16x32_bf16 v[92:95], a[20:23], v[236:239], v[92:95]
    s_waitcnt vmcnt(0) lgkmcnt(0)
    v_mfma_f32_16x16x32_bf16 v[92:95], a[44:47], a[156:159], v[92:95]
    s_barrier
    v_mfma_f32_16x16x32_bf16 v[112:115], a[48:51], v[64:67], 0
    s_add_u32 s3, s3, 128
    s_sub_u32 s67, s3, 1152
    s_min_u32 s3, s3, s67
    v_mfma_f32_16x16x32_bf16 v[112:115], a[52:55], v[96:99], v[112:115]
    s_add_u32 m0, s62, 98304
    ds_read_b64_tr_b16 a[0:1], v17 offset:0
    s_add_u32 s59, s3, s76
    v_mfma_f32_16x16x32_bf16 v[112:115], a[56:59], v[128:131], v[112:115]
    buffer_load_dwordx4 v12, s[12:15], s59 offen lds
    v_mfma_f32_16x16x32_bf16 v[112:115], a[60:63], v[160:163], v[112:115]
    s_addk_i32 m0, 1024
    ds_read_b64_tr_b16 a[2:3], v17 offset:2048
    s_add_u32 s59, s3, s76
    v_mfma_f32_16x16x32_bf16 v[112:115], a[64:67], v[192:195], v[112:115]
    buffer_load_dwordx4 v33, s[12:15], s59 offen lds
    v_mfma_f32_16x16x32_bf16 v[112:115], a[72:75], a[224:227], v[112:115]
    ds_read_b64_tr_b16 a[4:5], v17 offset:8192
    v_cvt_pk_bf16_f32 v156, v92, v93
    v_mfma_f32_16x16x32_bf16 v[112:115], a[76:79], a[240:243], v[112:115]
    s_addk_i32 m0, 7168
    ds_read_b64_tr_b16 a[6:7], v17 offset:10240
    v_cvt_pk_bf16_f32 v157, v94, v95
    v_mfma_f32_16x16x32_bf16 v[112:115], a[80:83], a[96:99], v[112:115]
    s_add_u32 s59, s3, s77
    ds_read_b64_tr_b16 a[8:9], v17 offset:16384
    v_mfma_f32_16x16x32_bf16 v[112:115], a[84:87], a[112:115], v[112:115]
    buffer_load_dwordx4 v12, s[12:15], s59 offen lds
    v_mfma_f32_16x16x32_bf16 v[112:115], a[88:91], a[128:131], v[112:115]
    ds_read_b64_tr_b16 a[10:11], v17 offset:18432
    v_mfma_f32_16x16x32_bf16 v[112:115], a[68:71], v[224:227], v[112:115]
    s_addk_i32 m0, 1024
    ds_read_b64_tr_b16 a[12:13], v17 offset:24576
    v_mfma_f32_16x16x32_bf16 v[112:115], a[92:95], a[140:143], v[112:115]
    s_add_u32 s59, s3, s77
    ds_read_b64_tr_b16 a[14:15], v17 offset:26624
    v_mfma_f32_16x16x32_bf16 v[116:119], a[92:95], a[148:151], 0
    buffer_load_dwordx4 v33, s[12:15], s59 offen lds
    v_mfma_f32_16x16x32_bf16 v[116:119], a[68:71], v[228:231], v[116:119]
    ds_read_b64_tr_b16 a[16:17], v17 offset:32768
    v_mfma_f32_16x16x32_bf16 v[116:119], a[88:91], a[144:147], v[116:119]
    s_addk_i32 m0, 7168
    ds_read_b64_tr_b16 a[18:19], v17 offset:34816
    v_mfma_f32_16x16x32_bf16 v[116:119], a[84:87], a[116:119], v[116:119]
    s_add_u32 s59, s3, s78
    ds_read_b64_tr_b16 a[24:25], v18 offset:0
    v_mfma_f32_16x16x32_bf16 v[116:119], a[80:83], a[100:103], v[116:119]
    buffer_load_dwordx4 v12, s[12:15], s59 offen lds
    v_mfma_f32_16x16x32_bf16 v[116:119], a[76:79], a[244:247], v[116:119]
    ds_read_b64_tr_b16 a[26:27], v18 offset:2048
    v_cvt_pk_bf16_f32 v146, v112, v113
    v_mfma_f32_16x16x32_bf16 v[116:119], a[72:75], a[228:231], v[116:119]
    ds_read_b64_tr_b16 a[28:29], v18 offset:8192
    v_cvt_pk_bf16_f32 v147, v114, v115
    v_mfma_f32_16x16x32_bf16 v[116:119], a[64:67], v[196:199], v[116:119]
    buffer_store_dwordx4 v[144:147], v25, s[16:19], s43 offen sc1
    v_mfma_f32_16x16x32_bf16 v[116:119], a[60:63], v[164:167], v[116:119]
    s_addk_i32 m0, 1024
    ds_read_b64_tr_b16 a[30:31], v18 offset:10240
    s_add_u32 s59, s3, s78
    v_mfma_f32_16x16x32_bf16 v[116:119], a[56:59], v[132:135], v[116:119]
    buffer_load_dwordx4 v33, s[12:15], s59 offen lds
    v_mfma_f32_16x16x32_bf16 v[116:119], a[52:55], v[100:103], v[116:119]
    s_addk_i32 m0, 7168
    ds_read_b64_tr_b16 a[32:33], v18 offset:16384
    s_add_u32 s59, s3, s79
    v_mfma_f32_16x16x32_bf16 v[116:119], a[48:51], v[68:71], v[116:119]
    buffer_load_dwordx4 v12, s[12:15], s59 offen lds
    v_mfma_f32_16x16x32_bf16 v[120:123], a[48:51], v[72:75], 0
    ds_read_b64_tr_b16 a[34:35], v18 offset:18432
    v_cvt_pk_bf16_f32 v178, v112, v113
    v_mfma_f32_16x16x32_bf16 v[120:123], a[52:55], v[104:107], v[120:123]
    s_addk_i32 m0, 1024
    ds_read_b64_tr_b16 a[36:37], v18 offset:24576
    v_cvt_pk_bf16_f32 v179, v114, v115
    v_mfma_f32_16x16x32_bf16 v[120:123], a[56:59], v[136:139], v[120:123]
    s_add_u32 s59, s3, s79
    ds_read_b64_tr_b16 a[38:39], v18 offset:26624
    v_mfma_f32_16x16x32_bf16 v[120:123], a[60:63], v[168:171], v[120:123]
    buffer_load_dwordx4 v33, s[12:15], s59 offen lds
    v_mfma_f32_16x16x32_bf16 v[120:123], a[64:67], v[200:203], v[120:123]
    ds_read_b64_tr_b16 a[40:41], v18 offset:32768
    v_mfma_f32_16x16x32_bf16 v[120:123], a[72:75], a[232:235], v[120:123]
    ds_read_b64_tr_b16 a[42:43], v18 offset:34816
    v_cvt_pk_bf16_f32 v150, v116, v117
    v_mfma_f32_16x16x32_bf16 v[120:123], a[76:79], a[248:251], v[120:123]
    ds_read_b64_tr_b16 a[20:21], v17 offset:40960
    v_cvt_pk_bf16_f32 v151, v118, v119
    v_mfma_f32_16x16x32_bf16 v[120:123], a[80:83], a[104:107], v[120:123]
    buffer_store_dwordx4 v[148:151], v26, s[16:19], s43 offen sc1
    v_mfma_f32_16x16x32_bf16 v[120:123], a[84:87], a[120:123], v[120:123]
    s_addk_i32 m0, 7168
    ds_read_b64_tr_b16 a[22:23], v17 offset:43008
    s_add_u32 s59, s3, s80
    v_mfma_f32_16x16x32_bf16 v[120:123], a[88:91], a[132:135], v[120:123]
    buffer_load_dwordx4 v12, s[12:15], s59 offen lds
    v_mfma_f32_16x16x32_bf16 v[120:123], a[68:71], v[232:235], v[120:123]
    s_addk_i32 m0, 1024
    ds_read_b64_tr_b16 a[44:45], v18 offset:40960
    s_add_u32 s59, s3, s80
    v_mfma_f32_16x16x32_bf16 v[120:123], a[92:95], a[152:155], v[120:123]
    buffer_load_dwordx4 v33, s[12:15], s59 offen lds
    v_mfma_f32_16x16x32_bf16 v[124:127], a[92:95], a[156:159], 0
    s_addk_i32 m0, 7168
    ds_read_b64_tr_b16 a[46:47], v18 offset:43008
    v_mfma_f32_16x16x32_bf16 v[124:127], a[68:71], v[236:239], v[124:127]
    s_add_u32 s59, s3, s81
    v_mfma_f32_16x16x32_bf16 v[124:127], a[88:91], a[136:139], v[124:127]
    buffer_load_dwordx4 v12, s[12:15], s59 offen lds
    v_mfma_f32_16x16x32_bf16 v[124:127], a[84:87], a[124:127], v[124:127]
    v_mfma_f32_16x16x32_bf16 v[124:127], a[80:83], a[108:111], v[124:127]
    v_mfma_f32_16x16x32_bf16 v[124:127], a[76:79], a[252:255], v[124:127]
    v_cvt_pk_bf16_f32 v154, v120, v121
    v_mfma_f32_16x16x32_bf16 v[124:127], a[72:75], a[236:239], v[124:127]
    v_cvt_pk_bf16_f32 v155, v122, v123
    v_mfma_f32_16x16x32_bf16 v[124:127], a[64:67], v[204:207], v[124:127]
    buffer_store_dwordx4 v[152:155], v27, s[16:19], s43 offen sc1
    v_mfma_f32_16x16x32_bf16 v[124:127], a[60:63], v[172:175], v[124:127]
    s_addk_i32 m0, 1024
    s_add_u32 s59, s3, s81
    v_mfma_f32_16x16x32_bf16 v[124:127], a[56:59], v[140:143], v[124:127]
    buffer_load_dwordx4 v33, s[12:15], s59 offen lds
    v_mfma_f32_16x16x32_bf16 v[124:127], a[52:55], v[108:111], v[124:127]
    v_mfma_f32_16x16x32_bf16 v[124:127], a[48:51], v[76:79], v[124:127]
    s_waitcnt lgkmcnt(0)
    v_mfma_f32_16x16x32_bf16 v[80:83], a[0:3], v[64:67], 0
    s_add_u32 s3, s3, 128
    s_sub_u32 s67, s3, 1152
    s_min_u32 s3, s3, s67
    v_mfma_f32_16x16x32_bf16 v[80:83], a[4:7], v[96:99], v[80:83]
    s_add_u32 m0, s62, 49152
    ds_read_b64_tr_b16 a[48:49], v19 offset:0
    s_add_u32 s59, s3, s76
    v_mfma_f32_16x16x32_bf16 v[80:83], a[8:11], v[128:131], v[80:83]
    buffer_load_dwordx4 v12, s[12:15], s59 offen lds
    v_mfma_f32_16x16x32_bf16 v[80:83], a[12:15], v[160:163], v[80:83]
    ds_read_b64_tr_b16 a[50:51], v19 offset:2048
    v_mfma_f32_16x16x32_bf16 v[80:83], a[16:19], v[192:195], v[80:83]
L_stubF6:
    s_cbranch_execz L_stubF9
    s_nop 0
    ds_read_b64_tr_b16 a[52:53], v19 offset:8192
    v_lshrrev_b32 v40, 4, v0
    v_mfma_f32_16x16x32_bf16 v[80:83], a[24:27], a[224:227], v[80:83]
    ds_read_b64_tr_b16 a[54:55], v19 offset:10240
    v_cvt_pk_bf16_f32 v158, v124, v125
    v_mfma_f32_16x16x32_bf16 v[80:83], a[28:31], a[240:243], v[80:83]
    ds_read_b64_tr_b16 a[56:57], v19 offset:16384
    v_cvt_pk_bf16_f32 v159, v126, v127
    v_mfma_f32_16x16x32_bf16 v[80:83], a[32:35], a[96:99], v[80:83]
    buffer_store_dwordx4 v[156:159], v28, s[16:19], s43 offen sc1
    v_mfma_f32_16x16x32_bf16 v[80:83], a[36:39], a[112:115], v[80:83]
    s_add_u32 s43, s43, 524288
    s_addk_i32 m0, 1024
    s_add_u32 s59, s3, s76
    v_mfma_f32_16x16x32_bf16 v[80:83], a[40:43], a[128:131], v[80:83]
    buffer_load_dwordx4 v33, s[12:15], s59 offen lds
    v_mfma_f32_16x16x32_bf16 v[80:83], a[20:23], v[224:227], v[80:83]
    s_addk_i32 m0, 7168
    ds_read_b64_tr_b16 a[58:59], v19 offset:18432
    s_add_u32 s59, s3, s77
    v_mfma_f32_16x16x32_bf16 v[80:83], a[44:47], a[140:143], v[80:83]
    buffer_load_dwordx4 v12, s[12:15], s59 offen lds
    v_mfma_f32_16x16x32_bf16 v[84:87], a[44:47], a[148:151], 0
    ds_read_b64_tr_b16 a[60:61], v19 offset:24576
    v_xor_b32 v40, s48, v40
    v_mfma_f32_16x16x32_bf16 v[84:87], a[20:23], v[228:231], v[84:87]
    ds_read_b64_tr_b16 a[62:63], v19 offset:26624
    v_sub_u32 v40, s52, v40
    v_mfma_f32_16x16x32_bf16 v[84:87], a[40:43], a[144:147], v[84:87]
    s_addk_i32 m0, 1024
    ds_read_b64_tr_b16 a[64:65], v19 offset:32768
    v_mov_b32 v41, 0x40000000
    v_mfma_f32_16x16x32_bf16 v[84:87], a[36:39], a[116:119], v[84:87]
    s_add_u32 s59, s3, s77
    ds_read_b64_tr_b16 a[66:67], v19 offset:34816
    v_cmp_eq_u32 vcc, 0, v40
    v_mfma_f32_16x16x32_bf16 v[84:87], a[32:35], a[100:103], v[84:87]
    buffer_load_dwordx4 v33, s[12:15], s59 offen lds
    v_mfma_f32_16x16x32_bf16 v[84:87], a[28:31], a[244:247], v[84:87]
    ds_read_b64_tr_b16 a[72:73], v20 offset:0
    v_cvt_pk_bf16_f32 v144, v80, v81
    v_mfma_f32_16x16x32_bf16 v[84:87], a[24:27], a[228:231], v[84:87]
    ds_read_b64_tr_b16 a[74:75], v20 offset:2048
    v_cvt_pk_bf16_f32 v145, v82, v83
    v_mfma_f32_16x16x32_bf16 v[84:87], a[16:19], v[196:199], v[84:87]
    s_addk_i32 m0, 7168
    ds_read_b64_tr_b16 a[76:77], v20 offset:8192
    v_cvt_pk_bf16_f32 v180, v80, v81
    v_mfma_f32_16x16x32_bf16 v[84:87], a[12:15], v[164:167], v[84:87]
    s_add_u32 s59, s3, s78
    ds_read_b64_tr_b16 a[78:79], v20 offset:10240
    v_cvt_pk_bf16_f32 v181, v82, v83
    v_mfma_f32_16x16x32_bf16 v[84:87], a[8:11], v[132:135], v[84:87]
    buffer_load_dwordx4 v12, s[12:15], s59 offen lds
    v_mfma_f32_16x16x32_bf16 v[84:87], a[4:7], v[100:103], v[84:87]
    ds_read_b64_tr_b16 a[80:81], v20 offset:16384
    v_cndmask_b32 v1, v44, v41, vcc
    v_mfma_f32_16x16x32_bf16 v[84:87], a[0:3], v[68:71], v[84:87]
    ds_read_b64_tr_b16 a[82:83], v20 offset:18432
    v_cmp_eq_u32 vcc, 4, v40
    v_mfma_f32_16x16x32_bf16 v[88:91], a[0:3], v[72:75], 0
    s_addk_i32 m0, 1024
    ds_read_b64_tr_b16 a[84:85], v20 offset:24576
    v_cndmask_b32 v34, v44, v41, vcc
    v_mfma_f32_16x16x32_bf16 v[88:91], a[4:7], v[104:107], v[88:91]
    s_add_u32 s59, s3, s78
    ds_read_b64_tr_b16 a[86:87], v20 offset:26624
    v_cmp_eq_u32 vcc, 8, v40
    v_mfma_f32_16x16x32_bf16 v[88:91], a[8:11], v[136:139], v[88:91]
    buffer_load_dwordx4 v33, s[12:15], s59 offen lds
    v_mfma_f32_16x16x32_bf16 v[88:91], a[12:15], v[168:171], v[88:91]
    ds_read_b64_tr_b16 a[88:89], v20 offset:32768
    v_cndmask_b32 v31, v44, v41, vcc
    v_mfma_f32_16x16x32_bf16 v[88:91], a[16:19], v[200:203], v[88:91]
    ds_read_b64_tr_b16 a[90:91], v20 offset:34816
    v_mfma_f32_16x16x32_bf16 v[88:91], a[24:27], a[232:235], v[88:91]
    s_addk_i32 m0, 7168
    ds_read_b64_tr_b16 a[68:69], v19 offset:40960
    v_cvt_pk_bf16_f32 v148, v84, v85
    v_mfma_f32_16x16x32_bf16 v[88:91], a[28:31], a[248:251], v[88:91]
    s_add_u32 s59, s3, s79
    ds_read_b64_tr_b16 a[70:71], v19 offset:43008
    v_cvt_pk_bf16_f32 v149, v86, v87
    v_mfma_f32_16x16x32_bf16 v[88:91], a[32:35], a[104:107], v[88:91]
    buffer_load_dwordx4 v12, s[12:15], s59 offen lds
    v_mfma_f32_16x16x32_bf16 v[88:91], a[36:39], a[120:123], v[88:91]
    ds_read_b64_tr_b16 a[92:93], v20 offset:40960
    v_mfma_f32_16x16x32_bf16 v[88:91], a[40:43], a[132:135], v[88:91]
    ds_read_b64_tr_b16 a[94:95], v20 offset:43008
    v_mfma_f32_16x16x32_bf16 v[88:91], a[20:23], v[232:235], v[88:91]
    s_addk_i32 m0, 1024
    v_mfma_f32_16x16x32_bf16 v[88:91], a[44:47], a[152:155], v[88:91]
    s_add_u32 s59, s3, s79
    v_mfma_f32_16x16x32_bf16 v[92:95], a[44:47], a[156:159], 0
    buffer_load_dwordx4 v33, s[12:15], s59 offen lds
    v_mfma_f32_16x16x32_bf16 v[92:95], a[20:23], v[236:239], v[92:95]
    v_mfma_f32_16x16x32_bf16 v[92:95], a[40:43], a[136:139], v[92:95]
    v_mfma_f32_16x16x32_bf16 v[92:95], a[36:39], a[124:127], v[92:95]
    v_mfma_f32_16x16x32_bf16 v[92:95], a[32:35], a[108:111], v[92:95]
    v_mfma_f32_16x16x32_bf16 v[92:95], a[28:31], a[252:255], v[92:95]
    s_addk_i32 m0, 7168
    v_cvt_pk_bf16_f32 v152, v88, v89
    v_mfma_f32_16x16x32_bf16 v[92:95], a[24:27], a[236:239], v[92:95]
    s_add_u32 s59, s3, s80
    v_cvt_pk_bf16_f32 v153, v90, v91
    v_mfma_f32_16x16x32_bf16 v[92:95], a[16:19], v[204:207], v[92:95]
    buffer_load_dwordx4 v12, s[12:15], s59 offen lds
    v_mfma_f32_16x16x32_bf16 v[92:95], a[12:15], v[172:175], v[92:95]
    v_mfma_f32_16x16x32_bf16 v[92:95], a[8:11], v[140:143], v[92:95]
    v_mfma_f32_16x16x32_bf16 v[92:95], a[4:7], v[108:111], v[92:95]
    s_waitcnt vmcnt(10) lgkmcnt(0)
    v_mfma_f32_16x16x32_bf16 v[92:95], a[0:3], v[76:79], v[92:95]
    s_barrier
    v_mfma_f32_16x16x32_bf16 v[112:115], a[48:51], v[64:67], 0
    s_addk_i32 m0, 1024
    ds_read_b64_tr_b16 a[0:1], v21 offset:0
    s_add_u32 s59, s3, s80
    v_mfma_f32_16x16x32_bf16 v[112:115], a[52:55], v[96:99], v[112:115]
    buffer_load_dwordx4 v33, s[12:15], s59 offen lds
    v_mfma_f32_16x16x32_bf16 v[112:115], a[56:59], v[128:131], v[112:115]
    ds_read_b64_tr_b16 a[2:3], v21 offset:2048
    v_mfma_f32_16x16x32_bf16 v[112:115], a[60:63], v[160:163], v[112:115]
    ds_read_b64_tr_b16 a[4:5], v21 offset:8192
    v_mfma_f32_16x16x32_bf16 v[112:115], a[64:67], v[192:195], v[112:115]
    ds_read_b64_tr_b16 a[6:7], v21 offset:10240
    v_mfma_f32_16x16x32_bf16 v[112:115], a[72:75], a[224:227], v[112:115]
    s_addk_i32 m0, 7168
    ds_read_b64_tr_b16 a[8:9], v21 offset:16384
    v_cvt_pk_bf16_f32 v156, v92, v93
    v_mfma_f32_16x16x32_bf16 v[112:115], a[76:79], a[240:243], v[112:115]
    s_add_u32 s59, s3, s81
    ds_read_b64_tr_b16 a[10:11], v21 offset:18432
    v_cvt_pk_bf16_f32 v157, v94, v95
    v_mfma_f32_16x16x32_bf16 v[112:115], a[80:83], a[96:99], v[112:115]
    buffer_load_dwordx4 v12, s[12:15], s59 offen lds
    v_mfma_f32_16x16x32_bf16 v[112:115], a[84:87], a[112:115], v[112:115]
    ds_read_b64_tr_b16 a[12:13], v21 offset:24576
    v_add_f32_dpp v51, v51, v51 quad_perm:[1,0,3,2] row_mask:0xf bank_mask:0xf
    v_mfma_f32_16x16x32_bf16 v[112:115], a[88:91], a[128:131], v[112:115]
    ds_read_b64_tr_b16 a[14:15], v21 offset:26624
    v_add_f32_dpp v51, v51, v51 quad_perm:[2,3,0,1] row_mask:0xf bank_mask:0xf
    v_mfma_f32_16x16x32_bf16 v[112:115], a[68:71], v[224:227], v[112:115]
    ds_read_b64_tr_b16 a[16:17], v21 offset:32768
    v_add_f32_dpp v51, v51, v51 row_half_mirror row_mask:0xf bank_mask:0xf
    v_mfma_f32_16x16x32_bf16 v[112:115], a[92:95], a[140:143], v[112:115]
    s_addk_i32 m0, 1024
    ds_read_b64_tr_b16 a[18:19], v21 offset:34816
    v_add_f32_dpp v51, v51, v51 row_mirror row_mask:0xf bank_mask:0xf
    v_mfma_f32_16x16x32_bf16 v[116:119], a[92:95], a[148:151], 0
    s_add_u32 s59, s3, s81
    ds_read_b64_tr_b16 a[24:25], v22 offset:0
    v_mov_b32 v52, v51
    v_mfma_f32_16x16x32_bf16 v[116:119], a[68:71], v[228:231], v[116:119]
    buffer_load_dwordx4 v33, s[12:15], s59 offen lds
    v_mfma_f32_16x16x32_bf16 v[116:119], a[88:91], a[144:147], v[116:119]
    ds_read_b64_tr_b16 a[26:27], v22 offset:2048
    v_mfma_f32_16x16x32_bf16 v[116:119], a[84:87], a[116:119], v[116:119]
    ds_read_b64_tr_b16 a[28:29], v22 offset:8192
    v_mfma_f32_16x16x32_bf16 v[116:119], a[80:83], a[100:103], v[116:119]
    ds_read_b64_tr_b16 a[30:31], v22 offset:10240
    v_mfma_f32_16x16x32_bf16 v[116:119], a[76:79], a[244:247], v[116:119]
    ds_read_b64_tr_b16 a[32:33], v22 offset:16384
    v_cvt_pk_bf16_f32 v146, v112, v113
    v_mfma_f32_16x16x32_bf16 v[116:119], a[72:75], a[228:231], v[116:119]
    ds_read_b64_tr_b16 a[34:35], v22 offset:18432
    v_cvt_pk_bf16_f32 v147, v114, v115
    v_mfma_f32_16x16x32_bf16 v[116:119], a[64:67], v[196:199], v[116:119]
    buffer_store_dwordx4 v[144:147], v25, s[16:19], s43 offen sc1
    v_mfma_f32_16x16x32_bf16 v[116:119], a[60:63], v[164:167], v[116:119]
    s_add_u32 s3, s3, 128
    s_sub_u32 s67, s3, 1152
    s_min_u32 s3, s3, s67
    v_mfma_f32_16x16x32_bf16 v[116:119], a[56:59], v[132:135], v[116:119]
    s_add_u32 m0, s62, 0
    ds_read_b64_tr_b16 a[36:37], v22 offset:24576
    s_add_u32 s59, s3, s76
    v_mfma_f32_16x16x32_bf16 v[116:119], a[52:55], v[100:103], v[116:119]
    buffer_load_dwordx4 v12, s[12:15], s59 offen lds
    v_mfma_f32_16x16x32_bf16 v[116:119], a[48:51], v[68:71], v[116:119]
    ds_read_b64_tr_b16 a[38:39], v22 offset:26624
    v_cvt_pk_bf16_f32 v182, v112, v113
    v_mfma_f32_16x16x32_bf16 v[120:123], a[48:51], v[72:75], 0
    s_addk_i32 m0, 1024
    ds_read_b64_tr_b16 a[40:41], v22 offset:32768
    v_cvt_pk_bf16_f32 v183, v114, v115
    v_mfma_f32_16x16x32_bf16 v[120:123], a[52:55], v[104:107], v[120:123]
    s_add_u32 s59, s3, s76
    ds_read_b64_tr_b16 a[42:43], v22 offset:34816
    v_mfma_f32_16x16x32_bf16 v[120:123], a[56:59], v[136:139], v[120:123]
    buffer_load_dwordx4 v33, s[12:15], s59 offen lds
    v_mfma_f32_16x16x32_bf16 v[120:123], a[60:63], v[168:171], v[120:123]
    ds_read_b64_tr_b16 a[20:21], v21 offset:40960
    v_mfma_f32_16x16x32_bf16 v[120:123], a[64:67], v[200:203], v[120:123]
    ds_read_b64_tr_b16 a[22:23], v21 offset:43008
    v_mfma_f32_16x16x32_bf16 v[120:123], a[72:75], a[232:235], v[120:123]
    ds_read_b64_tr_b16 a[44:45], v22 offset:40960
    v_cvt_pk_bf16_f32 v150, v116, v117
    v_mfma_f32_16x16x32_bf16 v[120:123], a[76:79], a[248:251], v[120:123]
    ds_read_b64_tr_b16 a[46:47], v22 offset:43008
    v_cvt_pk_bf16_f32 v151, v118, v119
    v_mfma_f32_16x16x32_bf16 v[120:123], a[80:83], a[104:107], v[120:123]
    buffer_store_dwordx4 v[148:151], v26, s[16:19], s43 offen sc1
    v_mfma_f32_16x16x32_bf16 v[120:123], a[84:87], a[120:123], v[120:123]
    s_addk_i32 m0, 7168
    s_add_u32 s59, s3, s77
    v_mfma_f32_16x16x32_bf16 v[120:123], a[88:91], a[132:135], v[120:123]
    buffer_load_dwordx4 v12, s[12:15], s59 offen lds
    v_mfma_f32_16x16x32_bf16 v[120:123], a[68:71], v[232:235], v[120:123]
    v_permlane16_swap_b32 v51, v52
    v_mfma_f32_16x16x32_bf16 v[120:123], a[92:95], a[152:155], v[120:123]
    v_add_f32 v51, v51, v52
    v_mul_f32 v51, 0xbfb8aa3b, v51
    v_mfma_f32_16x16x32_bf16 v[124:127], a[92:95], a[156:159], 0
    v_exp_f32 v51, v51
    v_mfma_f32_16x16x32_bf16 v[124:127], a[68:71], v[236:239], v[124:127]
    s_addk_i32 m0, 1024
    s_lshl_b32 s57, s48, 3
    v_mfma_f32_16x16x32_bf16 v[124:127], a[88:91], a[136:139], v[124:127]
    s_add_u32 s59, s3, s77
    v_lshrrev_b32 v52, 5, v0
    v_add_f32 v51, 1.0, v51
    v_mfma_f32_16x16x32_bf16 v[124:127], a[84:87], a[124:127], v[124:127]
    buffer_load_dwordx4 v33, s[12:15], s59 offen lds
    v_mfma_f32_16x16x32_bf16 v[124:127], a[80:83], a[108:111], v[124:127]
    v_rcp_f32 v51, v51
    v_mfma_f32_16x16x32_bf16 v[124:127], a[76:79], a[252:255], v[124:127]
    v_cvt_pk_bf16_f32 v154, v120, v121
    v_lshl_add_u32 v52, v52, 2, s57
    v_mfma_f32_16x16x32_bf16 v[124:127], a[72:75], a[236:239], v[124:127]
    v_cvt_pk_bf16_f32 v155, v122, v123
    v_add_u32 v52, 159744, v52
    v_mfma_f32_16x16x32_bf16 v[124:127], a[64:67], v[204:207], v[124:127]
    buffer_store_dwordx4 v[152:155], v27, s[16:19], s43 offen sc1
    v_mfma_f32_16x16x32_bf16 v[124:127], a[60:63], v[172:175], v[124:127]
    v_add_u32 v55, 159744, v55
    v_mfma_f32_16x16x32_bf16 v[124:127], a[56:59], v[140:143], v[124:127]
    v_mfma_f32_16x16x32_bf16 v[124:127], a[52:55], v[108:111], v[124:127]
    v_mfma_f32_16x16x32_bf16 v[124:127], a[48:51], v[76:79], v[124:127]
    s_waitcnt lgkmcnt(0)
    v_mfma_f32_16x16x32_bf16 v[80:83], a[0:3], v[64:67], 0
    s_addk_i32 m0, 7168
    ds_read_b64_tr_b16 a[48:49], v23 offset:0
    s_add_u32 s59, s3, s78
    v_mfma_f32_16x16x32_bf16 v[80:83], a[4:7], v[96:99], v[80:83]
    buffer_load_dwordx4 v12, s[12:15], s59 offen lds
    v_mfma_f32_16x16x32_bf16 v[80:83], a[8:11], v[128:131], v[80:83]
    ds_read_b64_tr_b16 a[50:51], v23 offset:2048
    v_mfma_f32_16x16x32_bf16 v[80:83], a[12:15], v[160:163], v[80:83]
    ds_read_b64_tr_b16 a[52:53], v23 offset:8192
    v_mfma_f32_16x16x32_bf16 v[80:83], a[16:19], v[192:195], v[80:83]
    ds_read_b64_tr_b16 a[54:55], v23 offset:10240
    v_mfma_f32_16x16x32_bf16 v[80:83], a[24:27], a[224:227], v[80:83]
    ds_read_b64_tr_b16 a[56:57], v23 offset:16384
    v_cvt_pk_bf16_f32 v158, v124, v125
    v_mfma_f32_16x16x32_bf16 v[80:83], a[28:31], a[240:243], v[80:83]
    ds_read_b64_tr_b16 a[58:59], v23 offset:18432
    v_cvt_pk_bf16_f32 v159, v126, v127
    v_mfma_f32_16x16x32_bf16 v[80:83], a[32:35], a[96:99], v[80:83]
    buffer_store_dwordx4 v[156:159], v28, s[16:19], s43 offen sc1
    v_mfma_f32_16x16x32_bf16 v[80:83], a[36:39], a[112:115], v[80:83]
    s_add_u32 s43, s43, 524288
    s_addk_i32 m0, 1024
    s_add_u32 s59, s3, s78
    v_mfma_f32_16x16x32_bf16 v[80:83], a[40:43], a[128:131], v[80:83]
    buffer_load_dwordx4 v33, s[12:15], s59 offen lds
    v_mfma_f32_16x16x32_bf16 v[80:83], a[20:23], v[224:227], v[80:83]
    s_addk_i32 m0, 7168
    ds_read_b64_tr_b16 a[60:61], v23 offset:24576
    v_mfma_f32_16x16x32_bf16 v[80:83], a[44:47], a[140:143], v[80:83]
    s_add_u32 s59, s3, s79
    ds_read_b64_tr_b16 a[62:63], v23 offset:26624
    v_mfma_f32_16x16x32_bf16 v[84:87], a[44:47], a[148:151], 0
    buffer_load_dwordx4 v12, s[12:15], s59 offen lds
    v_mfma_f32_16x16x32_bf16 v[84:87], a[20:23], v[228:231], v[84:87]
    ds_read_b64_tr_b16 a[64:65], v23 offset:32768
    v_mfma_f32_16x16x32_bf16 v[84:87], a[40:43], a[144:147], v[84:87]
    ds_read_b64_tr_b16 a[66:67], v23 offset:34816
    v_mfma_f32_16x16x32_bf16 v[84:87], a[36:39], a[116:119], v[84:87]
    ds_read_b64_tr_b16 a[72:73], v24 offset:0
    v_mfma_f32_16x16x32_bf16 v[84:87], a[32:35], a[100:103], v[84:87]
    ds_read_b64_tr_b16 a[74:75], v24 offset:2048
    v_mfma_f32_16x16x32_bf16 v[84:87], a[28:31], a[244:247], v[84:87]
    s_addk_i32 m0, 1024
    ds_read_b64_tr_b16 a[76:77], v24 offset:8192
    v_cvt_pk_bf16_f32 v144, v80, v81
    v_mfma_f32_16x16x32_bf16 v[84:87], a[24:27], a[228:231], v[84:87]
    s_add_u32 s59, s3, s79
    ds_read_b64_tr_b16 a[78:79], v24 offset:10240
    v_cvt_pk_bf16_f32 v145, v82, v83
    v_mfma_f32_16x16x32_bf16 v[84:87], a[16:19], v[196:199], v[84:87]
    buffer_load_dwordx4 v33, s[12:15], s59 offen lds
    v_mfma_f32_16x16x32_bf16 v[84:87], a[12:15], v[164:167], v[84:87]
    ds_read_b64_tr_b16 a[80:81], v24 offset:16384
    v_cvt_pk_bf16_f32 v184, v80, v81
    v_mfma_f32_16x16x32_bf16 v[84:87], a[8:11], v[132:135], v[84:87]
    s_addk_i32 m0, 7168
    ds_read_b64_tr_b16 a[82:83], v24 offset:18432
    v_cvt_pk_bf16_f32 v185, v82, v83
    v_mfma_f32_16x16x32_bf16 v[84:87], a[4:7], v[100:103], v[84:87]
    s_add_u32 s59, s3, s80
    ds_read_b64_tr_b16 a[84:85], v24 offset:24576
    v_mfma_f32_16x16x32_bf16 v[84:87], a[0:3], v[68:71], v[84:87]
    buffer_load_dwordx4 v12, s[12:15], s59 offen lds
    v_mfma_f32_16x16x32_bf16 v[88:91], a[0:3], v[72:75], 0
    ds_read_b64_tr_b16 a[86:87], v24 offset:26624
    v_mfma_f32_16x16x32_bf16 v[88:91], a[4:7], v[104:107], v[88:91]
    ds_read_b64_tr_b16 a[88:89], v24 offset:32768
    v_mfma_f32_16x16x32_bf16 v[88:91], a[8:11], v[136:139], v[88:91]
    ds_read_b64_tr_b16 a[90:91], v24 offset:34816
    v_mfma_f32_16x16x32_bf16 v[88:91], a[12:15], v[168:171], v[88:91]
    ds_read_b64_tr_b16 a[68:69], v23 offset:40960
    v_mfma_f32_16x16x32_bf16 v[88:91], a[16:19], v[200:203], v[88:91]
    ds_read_b64_tr_b16 a[70:71], v23 offset:43008
    v_mfma_f32_16x16x32_bf16 v[88:91], a[24:27], a[232:235], v[88:91]
    s_addk_i32 m0, 1024
    ds_read_b64_tr_b16 a[92:93], v24 offset:40960
    v_cvt_pk_bf16_f32 v148, v84, v85
    v_mfma_f32_16x16x32_bf16 v[88:91], a[28:31], a[248:251], v[88:91]
    s_add_u32 s59, s3, s80
    ds_read_b64_tr_b16 a[94:95], v24 offset:43008
    v_cvt_pk_bf16_f32 v149, v86, v87
    v_mfma_f32_16x16x32_bf16 v[88:91], a[32:35], a[104:107], v[88:91]
    buffer_load_dwordx4 v33, s[12:15], s59 offen lds
    v_mfma_f32_16x16x32_bf16 v[88:91], a[36:39], a[120:123], v[88:91]
    s_addk_i32 m0, 7168
    v_mfma_f32_16x16x32_bf16 v[88:91], a[40:43], a[132:135], v[88:91]
    s_add_u32 s59, s3, s81
    v_mfma_f32_16x16x32_bf16 v[88:91], a[20:23], v[232:235], v[88:91]
    buffer_load_dwordx4 v12, s[12:15], s59 offen lds
    v_mfma_f32_16x16x32_bf16 v[88:91], a[44:47], a[152:155], v[88:91]
    ds_write_b32 v52, v51
    v_mfma_f32_16x16x32_bf16 v[92:95], a[44:47], a[156:159], 0
    v_mfma_f32_16x16x32_bf16 v[92:95], a[20:23], v[236:239], v[92:95]
    v_mfma_f32_16x16x32_bf16 v[92:95], a[40:43], a[136:139], v[92:95]
    s_addk_i32 m0, 1024
    v_mfma_f32_16x16x32_bf16 v[92:95], a[36:39], a[124:127], v[92:95]
    s_add_u32 s59, s3, s81
    v_mfma_f32_16x16x32_bf16 v[92:95], a[32:35], a[108:111], v[92:95]
    buffer_load_dwordx4 v33, s[12:15], s59 offen lds
    v_mfma_f32_16x16x32_bf16 v[92:95], a[28:31], a[252:255], v[92:95]
    v_cvt_pk_bf16_f32 v152, v88, v89
    v_mfma_f32_16x16x32_bf16 v[92:95], a[24:27], a[236:239], v[92:95]
    v_cvt_pk_bf16_f32 v153, v90, v91
    v_mfma_f32_16x16x32_bf16 v[92:95], a[16:19], v[204:207], v[92:95]
    v_mfma_f32_16x16x32_bf16 v[92:95], a[12:15], v[172:175], v[92:95]
    v_mfma_f32_16x16x32_bf16 v[92:95], a[8:11], v[140:143], v[92:95]
    v_mfma_f32_16x16x32_bf16 v[92:95], a[4:7], v[108:111], v[92:95]
    s_waitcnt vmcnt(16) lgkmcnt(0)
    v_mfma_f32_16x16x32_bf16 v[92:95], a[0:3], v[76:79], v[92:95]
    s_barrier
    v_mfma_f32_16x16x32_bf16 v[112:115], a[48:51], v[64:67], 0
    s_add_u32 s3, s3, 128
    s_sub_u32 s67, s3, 1152
    s_min_u32 s3, s3, s67
    v_mfma_f32_16x16x32_bf16 v[112:115], a[52:55], v[96:99], v[112:115]
    s_add_u32 m0, s62, 98304
    ds_read_b32 v51, v55
    s_add_u32 s59, s3, s76
    v_mfma_f32_16x16x32_bf16 v[112:115], a[56:59], v[128:131], v[112:115]
    buffer_load_dwordx4 v12, s[12:15], s59 offen lds
    v_mfma_f32_16x16x32_bf16 v[112:115], a[60:63], v[160:163], v[112:115]
    ds_read_b64_tr_b16 a[0:1], v13 offset:0
    v_mfma_f32_16x16x32_bf16 v[112:115], a[64:67], v[192:195], v[112:115]
    ds_read_b64_tr_b16 a[2:3], v13 offset:2048
    v_mfma_f32_16x16x32_bf16 v[112:115], a[72:75], a[224:227], v[112:115]
    s_addk_i32 m0, 1024
    ds_read_b64_tr_b16 a[4:5], v13 offset:8192
    v_cvt_pk_bf16_f32 v156, v92, v93
    v_mfma_f32_16x16x32_bf16 v[112:115], a[76:79], a[240:243], v[112:115]
    s_add_u32 s59, s3, s76
    ds_read_b64_tr_b16 a[6:7], v13 offset:10240
    v_cvt_pk_bf16_f32 v157, v94, v95
    v_mfma_f32_16x16x32_bf16 v[112:115], a[80:83], a[96:99], v[112:115]
    buffer_load_dwordx4 v33, s[12:15], s59 offen lds
    v_mfma_f32_16x16x32_bf16 v[112:115], a[84:87], a[112:115], v[112:115]
    ds_read_b64_tr_b16 a[8:9], v13 offset:16384
    v_mfma_f32_16x16x32_bf16 v[112:115], a[88:91], a[128:131], v[112:115]
    ds_read_b64_tr_b16 a[10:11], v13 offset:18432
    v_mfma_f32_16x16x32_bf16 v[112:115], a[68:71], v[224:227], v[112:115]
    ds_read_b64_tr_b16 a[12:13], v13 offset:24576
    v_mfma_f32_16x16x32_bf16 v[112:115], a[92:95], a[140:143], v[112:115]
    s_addk_i32 m0, 7168
    ds_read_b64_tr_b16 a[14:15], v13 offset:26624
    v_mfma_f32_16x16x32_bf16 v[116:119], a[92:95], a[148:151], 0
    s_add_u32 s59, s3, s77
    ds_read_b64_tr_b16 a[16:17], v13 offset:32768
    v_mfma_f32_16x16x32_bf16 v[116:119], a[68:71], v[228:231], v[116:119]
    buffer_load_dwordx4 v12, s[12:15], s59 offen lds
    v_mfma_f32_16x16x32_bf16 v[116:119], a[88:91], a[144:147], v[116:119]
    ds_read_b64_tr_b16 a[18:19], v13 offset:34816
    v_mfma_f32_16x16x32_bf16 v[116:119], a[84:87], a[116:119], v[116:119]
    ds_read_b64_tr_b16 a[24:25], v14 offset:0
    v_mfma_f32_16x16x32_bf16 v[116:119], a[80:83], a[100:103], v[116:119]
    ds_read_b64_tr_b16 a[26:27], v14 offset:2048
    v_mfma_f32_16x16x32_bf16 v[116:119], a[76:79], a[244:247], v[116:119]
    ds_read_b64_tr_b16 a[28:29], v14 offset:8192
    v_cvt_pk_bf16_f32 v146, v112, v113
    v_mfma_f32_16x16x32_bf16 v[116:119], a[72:75], a[228:231], v[116:119]
    ds_read_b64_tr_b16 a[30:31], v14 offset:10240
    v_cvt_pk_bf16_f32 v147, v114, v115
    v_mfma_f32_16x16x32_bf16 v[116:119], a[64:67], v[196:199], v[116:119]
    buffer_store_dwordx4 v[144:147], v25, s[16:19], s43 offen sc1
    v_mfma_f32_16x16x32_bf16 v[116:119], a[60:63], v[164:167], v[116:119]
    s_addk_i32 m0, 1024
    ds_read_b64_tr_b16 a[32:33], v14 offset:16384
    s_add_u32 s59, s3, s77
    v_mfma_f32_16x16x32_bf16 v[116:119], a[56:59], v[132:135], v[116:119]
    buffer_load_dwordx4 v33, s[12:15], s59 offen lds
    v_mfma_f32_16x16x32_bf16 v[116:119], a[52:55], v[100:103], v[116:119]
    ds_read_b64_tr_b16 a[34:35], v14 offset:18432
    v_cvt_pk_bf16_f32 v186, v112, v113
    v_mfma_f32_16x16x32_bf16 v[116:119], a[48:51], v[68:71], v[116:119]
    ds_read_b64_tr_b16 a[36:37], v14 offset:24576
    v_cvt_pk_bf16_f32 v187, v114, v115
    v_mfma_f32_16x16x32_bf16 v[120:123], a[48:51], v[72:75], 0
    s_addk_i32 m0, 7168
    ds_read_b64_tr_b16 a[38:39], v14 offset:26624
    v_mfma_f32_16x16x32_bf16 v[120:123], a[52:55], v[104:107], v[120:123]
    s_add_u32 s59, s3, s78
    ds_read_b64_tr_b16 a[40:41], v14 offset:32768
    v_mfma_f32_16x16x32_bf16 v[120:123], a[56:59], v[136:139], v[120:123]
    buffer_load_dwordx4 v12, s[12:15], s59 offen lds
    v_mfma_f32_16x16x32_bf16 v[120:123], a[60:63], v[168:171], v[120:123]
    ds_read_b64_tr_b16 a[42:43], v14 offset:34816
    v_mfma_f32_16x16x32_bf16 v[120:123], a[64:67], v[200:203], v[120:123]
    ds_read_b64_tr_b16 a[20:21], v13 offset:40960
    v_mfma_f32_16x16x32_bf16 v[120:123], a[72:75], a[232:235], v[120:123]
    ds_read_b64_tr_b16 a[22:23], v13 offset:43008
    v_cvt_pk_bf16_f32 v150, v116, v117
    v_mfma_f32_16x16x32_bf16 v[120:123], a[76:79], a[248:251], v[120:123]
    ds_read_b64_tr_b16 a[44:45], v14 offset:40960
    v_cvt_pk_bf16_f32 v151, v118, v119
    v_mfma_f32_16x16x32_bf16 v[120:123], a[80:83], a[104:107], v[120:123]
    buffer_store_dwordx4 v[148:151], v26, s[16:19], s43 offen sc1
    v_mfma_f32_16x16x32_bf16 v[120:123], a[84:87], a[120:123], v[120:123]
    s_addk_i32 m0, 1024
    ds_read_b64_tr_b16 a[46:47], v14 offset:43008
    s_add_u32 s59, s3, s78
    v_mfma_f32_16x16x32_bf16 v[120:123], a[88:91], a[132:135], v[120:123]
    buffer_load_dwordx4 v33, s[12:15], s59 offen lds
    v_mfma_f32_16x16x32_bf16 v[120:123], a[68:71], v[232:235], v[120:123]
    v_mfma_f32_16x16x32_bf16 v[120:123], a[92:95], a[152:155], v[120:123]
    v_mfma_f32_16x16x32_bf16 v[124:127], a[92:95], a[156:159], 0
    v_mfma_f32_16x16x32_bf16 v[124:127], a[68:71], v[236:239], v[124:127]
    s_addk_i32 m0, 7168
    v_mfma_f32_16x16x32_bf16 v[124:127], a[88:91], a[136:139], v[124:127]
    s_add_u32 s59, s3, s79
    v_mfma_f32_16x16x32_bf16 v[124:127], a[84:87], a[124:127], v[124:127]
    buffer_load_dwordx4 v12, s[12:15], s59 offen lds
    v_mfma_f32_16x16x32_bf16 v[124:127], a[80:83], a[108:111], v[124:127]
    v_mfma_f32_16x16x32_bf16 v[124:127], a[76:79], a[252:255], v[124:127]
    v_cvt_pk_bf16_f32 v154, v120, v121
    v_mfma_f32_16x16x32_bf16 v[124:127], a[72:75], a[236:239], v[124:127]
    v_cvt_pk_bf16_f32 v155, v122, v123
    v_mfma_f32_16x16x32_bf16 v[124:127], a[64:67], v[204:207], v[124:127]
    buffer_store_dwordx4 v[152:155], v27, s[16:19], s43 offen sc1
    v_mfma_f32_16x16x32_bf16 v[124:127], a[60:63], v[172:175], v[124:127]
    v_mfma_f32_16x16x32_bf16 v[124:127], a[56:59], v[140:143], v[124:127]
    v_mfma_f32_16x16x32_bf16 v[124:127], a[52:55], v[108:111], v[124:127]
    v_mfma_f32_16x16x32_bf16 v[124:127], a[48:51], v[76:79], v[124:127]
    s_waitcnt lgkmcnt(0)
    v_mfma_f32_16x16x32_bf16 v[80:83], a[0:3], v[64:67], 0
    s_addk_i32 m0, 1024
    ds_read_b64_tr_b16 a[48:49], v15 offset:0
    s_add_u32 s59, s3, s79
    v_mfma_f32_16x16x32_bf16 v[80:83], a[4:7], v[96:99], v[80:83]
    buffer_load_dwordx4 v33, s[12:15], s59 offen lds
    v_mfma_f32_16x16x32_bf16 v[80:83], a[8:11], v[128:131], v[80:83]
    ds_read_b64_tr_b16 a[50:51], v15 offset:2048
    v_mfma_f32_16x16x32_bf16 v[80:83], a[12:15], v[160:163], v[80:83]
    ds_read_b64_tr_b16 a[52:53], v15 offset:8192
    v_mfma_f32_16x16x32_bf16 v[80:83], a[16:19], v[192:195], v[80:83]
    ds_read_b64_tr_b16 a[54:55], v15 offset:10240
    v_mfma_f32_16x16x32_bf16 v[80:83], a[24:27], a[224:227], v[80:83]
    ds_read_b64_tr_b16 a[56:57], v15 offset:16384
    v_cvt_pk_bf16_f32 v158, v124, v125
    v_mfma_f32_16x16x32_bf16 v[80:83], a[28:31], a[240:243], v[80:83]
    ds_read_b64_tr_b16 a[58:59], v15 offset:18432
    v_cvt_pk_bf16_f32 v159, v126, v127
    v_mfma_f32_16x16x32_bf16 v[80:83], a[32:35], a[96:99], v[80:83]
    buffer_store_dwordx4 v[156:159], v28, s[16:19], s43 offen sc1
    v_mfma_f32_16x16x32_bf16 v[80:83], a[36:39], a[112:115], v[80:83]
    s_add_u32 s43, s43, 524288
    ds_read_b64_tr_b16 a[60:61], v15 offset:24576
    v_mfma_f32_16x16x32_bf16 v[80:83], a[40:43], a[128:131], v[80:83]
    s_addk_i32 m0, 7168
    ds_read_b64_tr_b16 a[62:63], v15 offset:26624
    s_add_u32 s59, s3, s80
    v_mfma_f32_16x16x32_bf16 v[80:83], a[20:23], v[224:227], v[80:83]
    buffer_load_dwordx4 v12, s[12:15], s59 offen lds
    v_mfma_f32_16x16x32_bf16 v[80:83], a[44:47], a[140:143], v[80:83]
    ds_read_b64_tr_b16 a[64:65], v15 offset:32768
    v_mfma_f32_16x16x32_bf16 v[84:87], a[44:47], a[148:151], 0
    ds_read_b64_tr_b16 a[66:67], v15 offset:34816
    v_mfma_f32_16x16x32_bf16 v[84:87], a[20:23], v[228:231], v[84:87]
    ds_read_b64_tr_b16 a[72:73], v16 offset:0
    v_mfma_f32_16x16x32_bf16 v[84:87], a[40:43], a[144:147], v[84:87]
    ds_read_b64_tr_b16 a[74:75], v16 offset:2048
    v_mfma_f32_16x16x32_bf16 v[84:87], a[36:39], a[116:119], v[84:87]
    ds_read_b64_tr_b16 a[76:77], v16 offset:8192
    v_mfma_f32_16x16x32_bf16 v[84:87], a[32:35], a[100:103], v[84:87]
    ds_read_b64_tr_b16 a[78:79], v16 offset:10240
    v_mfma_f32_16x16x32_bf16 v[84:87], a[28:31], a[244:247], v[84:87]
    s_addk_i32 m0, 1024
    ds_read_b64_tr_b16 a[80:81], v16 offset:16384
    v_cvt_pk_bf16_f32 v144, v80, v81
    v_mfma_f32_16x16x32_bf16 v[84:87], a[24:27], a[228:231], v[84:87]
    s_add_u32 s59, s3, s80
    ds_read_b64_tr_b16 a[82:83], v16 offset:18432
    v_cvt_pk_bf16_f32 v145, v82, v83
    v_mfma_f32_16x16x32_bf16 v[84:87], a[16:19], v[196:199], v[84:87]
    buffer_load_dwordx4 v33, s[12:15], s59 offen lds
    v_mfma_f32_16x16x32_bf16 v[84:87], a[12:15], v[164:167], v[84:87]
    ds_read_b64_tr_b16 a[84:85], v16 offset:24576
    v_cvt_pk_bf16_f32 v188, v80, v81
    v_mfma_f32_16x16x32_bf16 v[84:87], a[8:11], v[132:135], v[84:87]
    ds_read_b64_tr_b16 a[86:87], v16 offset:26624
    v_cvt_pk_bf16_f32 v189, v82, v83
    v_mfma_f32_16x16x32_bf16 v[84:87], a[4:7], v[100:103], v[84:87]
    ds_read_b64_tr_b16 a[88:89], v16 offset:32768
    v_mfma_f32_16x16x32_bf16 v[84:87], a[0:3], v[68:71], v[84:87]
    ds_read_b64_tr_b16 a[90:91], v16 offset:34816
    v_mfma_f32_16x16x32_bf16 v[88:91], a[0:3], v[72:75], 0
    ds_read_b64_tr_b16 a[68:69], v15 offset:40960
    v_mfma_f32_16x16x32_bf16 v[88:91], a[4:7], v[104:107], v[88:91]
    ds_read_b64_tr_b16 a[70:71], v15 offset:43008
    v_mfma_f32_16x16x32_bf16 v[88:91], a[8:11], v[136:139], v[88:91]
    s_addk_i32 m0, 7168
    ds_read_b64_tr_b16 a[92:93], v16 offset:40960
    v_mfma_f32_16x16x32_bf16 v[88:91], a[12:15], v[168:171], v[88:91]
    s_add_u32 s59, s3, s81
    ds_read_b64_tr_b16 a[94:95], v16 offset:43008
    v_mfma_f32_16x16x32_bf16 v[88:91], a[16:19], v[200:203], v[88:91]
    buffer_load_dwordx4 v12, s[12:15], s59 offen lds
    v_mfma_f32_16x16x32_bf16 v[88:91], a[24:27], a[232:235], v[88:91]
    v_cvt_pk_bf16_f32 v148, v84, v85
    v_mfma_f32_16x16x32_bf16 v[88:91], a[28:31], a[248:251], v[88:91]
    v_cvt_pk_bf16_f32 v149, v86, v87
    v_mfma_f32_16x16x32_bf16 v[88:91], a[32:35], a[104:107], v[88:91]
    v_mfma_f32_16x16x32_bf16 v[88:91], a[36:39], a[120:123], v[88:91]
    v_mfma_f32_16x16x32_bf16 v[88:91], a[40:43], a[132:135], v[88:91]
    v_mfma_f32_16x16x32_bf16 v[88:91], a[20:23], v[232:235], v[88:91]
    v_mfma_f32_16x16x32_bf16 v[88:91], a[44:47], a[152:155], v[88:91]
    s_addk_i32 m0, 1024
    v_mfma_f32_16x16x32_bf16 v[92:95], a[44:47], a[156:159], 0
    s_add_u32 s59, s3, s81
    v_mfma_f32_16x16x32_bf16 v[92:95], a[20:23], v[236:239], v[92:95]
    buffer_load_dwordx4 v33, s[12:15], s59 offen lds
    v_mfma_f32_16x16x32_bf16 v[92:95], a[40:43], a[136:139], v[92:95]
    v_mfma_f32_16x16x32_bf16 v[92:95], a[36:39], a[124:127], v[92:95]
    v_mfma_f32_16x16x32_bf16 v[92:95], a[32:35], a[108:111], v[92:95]
    v_mfma_f32_16x16x32_bf16 v[92:95], a[28:31], a[252:255], v[92:95]
    v_cvt_pk_bf16_f32 v152, v88, v89
    v_mfma_f32_16x16x32_bf16 v[92:95], a[24:27], a[236:239], v[92:95]
    v_cvt_pk_bf16_f32 v153, v90, v91
    v_mfma_f32_16x16x32_bf16 v[92:95], a[16:19], v[204:207], v[92:95]
    v_mfma_f32_16x16x32_bf16 v[92:95], a[12:15], v[172:175], v[92:95]
    v_mfma_f32_16x16x32_bf16 v[92:95], a[8:11], v[140:143], v[92:95]
L_stubF7:
    s_cbranch_execz L_stubF10
    s_nop 0
    v_mfma_f32_16x16x32_bf16 v[92:95], a[4:7], v[108:111], v[92:95]
    s_waitcnt vmcnt(4) lgkmcnt(0)
    v_mfma_f32_16x16x32_bf16 v[92:95], a[0:3], v[76:79], v[92:95]
    s_barrier
    v_mfma_f32_16x16x32_bf16 v[112:115], a[48:51], v[64:67], 0
    s_add_u32 s59, s42, 0
    ds_read_b64_tr_b16 a[0:1], v17 offset:0
    v_mfma_f32_16x16x32_bf16 v[112:115], a[52:55], v[96:99], v[112:115]
    buffer_store_dword v50, v47, s[16:19], s59 offen sc1
    v_mfma_f32_16x16x32_bf16 v[112:115], a[56:59], v[128:131], v[112:115]
    s_add_u32 s3, s3, 128
    s_sub_u32 s67, s3, 1152
    s_min_u32 s3, s3, s67
    v_mfma_f32_16x16x32_bf16 v[112:115], a[60:63], v[160:163], v[112:115]
    s_add_u32 m0, s62, 49152
    ds_read_b64_tr_b16 a[2:3], v17 offset:2048
    s_add_u32 s59, s3, s76
    v_mfma_f32_16x16x32_bf16 v[112:115], a[64:67], v[192:195], v[112:115]
    buffer_load_dwordx4 v12, s[12:15], s59 offen lds
    v_mfma_f32_16x16x32_bf16 v[112:115], a[72:75], a[224:227], v[112:115]
    ds_read_b64_tr_b16 a[4:5], v17 offset:8192
    v_cvt_pk_bf16_f32 v156, v92, v93
    v_mfma_f32_16x16x32_bf16 v[112:115], a[76:79], a[240:243], v[112:115]
    ds_read_b64_tr_b16 a[6:7], v17 offset:10240
    v_cvt_pk_bf16_f32 v157, v94, v95
    v_mfma_f32_16x16x32_bf16 v[112:115], a[80:83], a[96:99], v[112:115]
    ds_read_b64_tr_b16 a[8:9], v17 offset:16384
    v_mfma_f32_16x16x32_bf16 v[112:115], a[84:87], a[112:115], v[112:115]
    s_addk_i32 m0, 1024
    ds_read_b64_tr_b16 a[10:11], v17 offset:18432
    v_mfma_f32_16x16x32_bf16 v[112:115], a[88:91], a[128:131], v[112:115]
    s_add_u32 s59, s3, s76
    ds_read_b64_tr_b16 a[12:13], v17 offset:24576
    v_mfma_f32_16x16x32_bf16 v[112:115], a[68:71], v[224:227], v[112:115]
    buffer_load_dwordx4 v33, s[12:15], s59 offen lds
    v_mfma_f32_16x16x32_bf16 v[112:115], a[92:95], a[140:143], v[112:115]
    ds_read_b64_tr_b16 a[14:15], v17 offset:26624
    v_mfma_f32_16x16x32_bf16 v[116:119], a[92:95], a[148:151], 0
    ds_read_b64_tr_b16 a[16:17], v17 offset:32768
    v_mfma_f32_16x16x32_bf16 v[116:119], a[68:71], v[228:231], v[116:119]
    ds_read_b64_tr_b16 a[18:19], v17 offset:34816
    v_mfma_f32_16x16x32_bf16 v[116:119], a[88:91], a[144:147], v[116:119]
    ds_read_b64_tr_b16 a[24:25], v18 offset:0
    v_mfma_f32_16x16x32_bf16 v[116:119], a[84:87], a[116:119], v[116:119]
    ds_read_b64_tr_b16 a[26:27], v18 offset:2048
    v_mfma_f32_16x16x32_bf16 v[116:119], a[80:83], a[100:103], v[116:119]
    ds_read_b64_tr_b16 a[28:29], v18 offset:8192
    v_mfma_f32_16x16x32_bf16 v[116:119], a[76:79], a[244:247], v[116:119]
    ds_read_b64_tr_b16 a[30:31], v18 offset:10240
    v_cvt_pk_bf16_f32 v146, v112, v113
    v_mfma_f32_16x16x32_bf16 v[116:119], a[72:75], a[228:231], v[116:119]
    ds_read_b64_tr_b16 a[32:33], v18 offset:16384
    v_cvt_pk_bf16_f32 v147, v114, v115
    v_mfma_f32_16x16x32_bf16 v[116:119], a[64:67], v[196:199], v[116:119]
    buffer_store_dwordx4 v[144:147], v25, s[16:19], s43 offen sc1
    v_mfma_f32_16x16x32_bf16 v[116:119], a[60:63], v[164:167], v[116:119]
    s_addk_i32 m0, 7168
    ds_read_b64_tr_b16 a[34:35], v18 offset:18432
    s_add_u32 s59, s3, s77
    v_mfma_f32_16x16x32_bf16 v[116:119], a[56:59], v[132:135], v[116:119]
    buffer_load_dwordx4 v12, s[12:15], s59 offen lds
    v_mfma_f32_16x16x32_bf16 v[116:119], a[52:55], v[100:103], v[116:119]
    s_addk_i32 m0, 1024
    ds_read_b64_tr_b16 a[36:37], v18 offset:24576
    v_cvt_pk_bf16_f32 v190, v112, v113
    v_mfma_f32_16x16x32_bf16 v[116:119], a[48:51], v[68:71], v[116:119]
    s_add_u32 s59, s3, s77
    ds_read_b64_tr_b16 a[38:39], v18 offset:26624
    v_cvt_pk_bf16_f32 v191, v114, v115
    v_mfma_f32_16x16x32_bf16 v[120:123], a[48:51], v[72:75], 0
    buffer_load_dwordx4 v33, s[12:15], s59 offen lds
    v_mfma_f32_16x16x32_bf16 v[120:123], a[52:55], v[104:107], v[120:123]
    ds_read_b64_tr_b16 a[40:41], v18 offset:32768
    v_mfma_f32_16x16x32_bf16 v[120:123], a[56:59], v[136:139], v[120:123]
    ds_read_b64_tr_b16 a[42:43], v18 offset:34816
    v_mfma_f32_16x16x32_bf16 v[120:123], a[60:63], v[168:171], v[120:123]
    ds_read_b64_tr_b16 a[20:21], v17 offset:40960
    v_mfma_f32_16x16x32_bf16 v[120:123], a[64:67], v[200:203], v[120:123]
    ds_read_b64_tr_b16 a[22:23], v17 offset:43008
    v_mfma_f32_16x16x32_bf16 v[120:123], a[72:75], a[232:235], v[120:123]
    ds_read_b64_tr_b16 a[44:45], v18 offset:40960
    v_cvt_pk_bf16_f32 v150, v116, v117
    v_mfma_f32_16x16x32_bf16 v[120:123], a[76:79], a[248:251], v[120:123]
    ds_read_b64_tr_b16 a[46:47], v18 offset:43008
    v_cvt_pk_bf16_f32 v151, v118, v119
    v_mfma_f32_16x16x32_bf16 v[120:123], a[80:83], a[104:107], v[120:123]
    buffer_store_dwordx4 v[148:151], v26, s[16:19], s43 offen sc1
    v_mfma_f32_16x16x32_bf16 v[120:123], a[84:87], a[120:123], v[120:123]
    s_addk_i32 m0, 7168
    s_add_u32 s59, s3, s78
    v_mfma_f32_16x16x32_bf16 v[120:123], a[88:91], a[132:135], v[120:123]
    buffer_load_dwordx4 v12, s[12:15], s59 offen lds
    v_mfma_f32_16x16x32_bf16 v[120:123], a[68:71], v[232:235], v[120:123]
    v_mfma_f32_16x16x32_bf16 v[120:123], a[92:95], a[152:155], v[120:123]
    v_mfma_f32_16x16x32_bf16 v[124:127], a[92:95], a[156:159], 0
    s_addk_i32 m0, 1024
    v_mfma_f32_16x16x32_bf16 v[124:127], a[68:71], v[236:239], v[124:127]
    s_add_u32 s59, s3, s78
    v_mfma_f32_16x16x32_bf16 v[124:127], a[88:91], a[136:139], v[124:127]
    buffer_load_dwordx4 v33, s[12:15], s59 offen lds
    v_mfma_f32_16x16x32_bf16 v[124:127], a[84:87], a[124:127], v[124:127]
    v_mfma_f32_16x16x32_bf16 v[124:127], a[80:83], a[108:111], v[124:127]
    v_mfma_f32_16x16x32_bf16 v[124:127], a[76:79], a[252:255], v[124:127]
    v_cvt_pk_bf16_f32 v154, v120, v121
    v_mfma_f32_16x16x32_bf16 v[124:127], a[72:75], a[236:239], v[124:127]
    v_cvt_pk_bf16_f32 v155, v122, v123
    v_mfma_f32_16x16x32_bf16 v[124:127], a[64:67], v[204:207], v[124:127]
    buffer_store_dwordx4 v[152:155], v27, s[16:19], s43 offen sc1
    v_mfma_f32_16x16x32_bf16 v[124:127], a[60:63], v[172:175], v[124:127]
    v_mfma_f32_16x16x32_bf16 v[124:127], a[56:59], v[140:143], v[124:127]
    v_mfma_f32_16x16x32_bf16 v[124:127], a[52:55], v[108:111], v[124:127]
    v_mfma_f32_16x16x32_bf16 v[124:127], a[48:51], v[76:79], v[124:127]
    s_waitcnt lgkmcnt(0)
    v_mfma_f32_16x16x32_bf16 v[80:83], a[0:3], v[64:67], 0
    s_addk_i32 m0, 7168
    ds_read_b64_tr_b16 a[48:49], v19 offset:0
    s_add_u32 s59, s3, s79
    v_mfma_f32_16x16x32_bf16 v[80:83], a[4:7], v[96:99], v[80:83]
    buffer_load_dwordx4 v12, s[12:15], s59 offen lds
    v_mfma_f32_16x16x32_bf16 v[80:83], a[8:11], v[128:131], v[80:83]
    ds_read_b64_tr_b16 a[50:51], v19 offset:2048
    v_mfma_f32_16x16x32_bf16 v[80:83], a[12:15], v[160:163], v[80:83]
    ds_read_b64_tr_b16 a[52:53], v19 offset:8192
    v_mfma_f32_16x16x32_bf16 v[80:83], a[16:19], v[192:195], v[80:83]
    ds_read_b64_tr_b16 a[54:55], v19 offset:10240
    v_mfma_f32_16x16x32_bf16 v[80:83], a[24:27], a[224:227], v[80:83]
    ds_read_b64_tr_b16 a[56:57], v19 offset:16384
    v_cvt_pk_bf16_f32 v158, v124, v125
    v_mfma_f32_16x16x32_bf16 v[80:83], a[28:31], a[240:243], v[80:83]
    ds_read_b64_tr_b16 a[58:59], v19 offset:18432
    v_cvt_pk_bf16_f32 v159, v126, v127
    v_mfma_f32_16x16x32_bf16 v[80:83], a[32:35], a[96:99], v[80:83]
    buffer_store_dwordx4 v[156:159], v28, s[16:19], s43 offen sc1
    v_mfma_f32_16x16x32_bf16 v[80:83], a[36:39], a[112:115], v[80:83]
    s_add_u32 s43, s43, 2621440
    s_addk_i32 m0, 1024
    s_add_u32 s59, s3, s79
    v_mfma_f32_16x16x32_bf16 v[80:83], a[40:43], a[128:131], v[80:83]
    buffer_load_dwordx4 v33, s[12:15], s59 offen lds
    v_mfma_f32_16x16x32_bf16 v[80:83], a[20:23], v[224:227], v[80:83]
    ds_read_b64_tr_b16 a[60:61], v19 offset:24576
    v_mfma_f32_16x16x32_bf16 v[80:83], a[44:47], a[140:143], v[80:83]
    ds_read_b64_tr_b16 a[62:63], v19 offset:26624
    v_mfma_f32_16x16x32_bf16 v[84:87], a[44:47], a[148:151], 0
    ds_read_b64_tr_b16 a[64:65], v19 offset:32768
    v_mfma_f32_16x16x32_bf16 v[84:87], a[20:23], v[228:231], v[84:87]
    ds_read_b64_tr_b16 a[66:67], v19 offset:34816
    v_mfma_f32_16x16x32_bf16 v[84:87], a[40:43], a[144:147], v[84:87]
    s_addk_i32 m0, 7168
    ds_read_b64_tr_b16 a[72:73], v20 offset:0
    v_mfma_f32_16x16x32_bf16 v[84:87], a[36:39], a[116:119], v[84:87]
    s_add_u32 s59, s3, s80
    ds_read_b64_tr_b16 a[74:75], v20 offset:2048
    v_mfma_f32_16x16x32_bf16 v[84:87], a[32:35], a[100:103], v[84:87]
    buffer_load_dwordx4 v12, s[12:15], s59 offen lds
    v_mfma_f32_16x16x32_bf16 v[84:87], a[28:31], a[244:247], v[84:87]
    ds_read_b64_tr_b16 a[76:77], v20 offset:8192
    v_cvt_pk_bf16_f32 v144, v80, v81
    v_mfma_f32_16x16x32_bf16 v[84:87], a[24:27], a[228:231], v[84:87]
    ds_read_b64_tr_b16 a[78:79], v20 offset:10240
    v_cvt_pk_bf16_f32 v145, v82, v83
    v_mfma_f32_16x16x32_bf16 v[84:87], a[16:19], v[196:199], v[84:87]
    ds_read_b64_tr_b16 a[80:81], v20 offset:16384
    v_cvt_pk_bf16_f32 v208, v80, v81
    v_mfma_f32_16x16x32_bf16 v[84:87], a[12:15], v[164:167], v[84:87]
    ds_read_b64_tr_b16 a[82:83], v20 offset:18432
    v_cvt_pk_bf16_f32 v209, v82, v83
    v_mfma_f32_16x16x32_bf16 v[84:87], a[8:11], v[132:135], v[84:87]
    s_addk_i32 m0, 1024
    ds_read_b64_tr_b16 a[84:85], v20 offset:24576
    v_mfma_f32_16x16x32_bf16 v[84:87], a[4:7], v[100:103], v[84:87]
    s_add_u32 s59, s3, s80
    ds_read_b64_tr_b16 a[86:87], v20 offset:26624
    v_mfma_f32_16x16x32_bf16 v[84:87], a[0:3], v[68:71], v[84:87]
    buffer_load_dwordx4 v33, s[12:15], s59 offen lds
    v_mfma_f32_16x16x32_bf16 v[88:91], a[0:3], v[72:75], 0
    ds_read_b64_tr_b16 a[88:89], v20 offset:32768
    v_mfma_f32_16x16x32_bf16 v[88:91], a[4:7], v[104:107], v[88:91]
    ds_read_b64_tr_b16 a[90:91], v20 offset:34816
    v_mfma_f32_16x16x32_bf16 v[88:91], a[8:11], v[136:139], v[88:91]
    ds_read_b64_tr_b16 a[68:69], v19 offset:40960
    v_mfma_f32_16x16x32_bf16 v[88:91], a[12:15], v[168:171], v[88:91]
    ds_read_b64_tr_b16 a[70:71], v19 offset:43008
    v_mfma_f32_16x16x32_bf16 v[88:91], a[16:19], v[200:203], v[88:91]
    ds_read_b64_tr_b16 a[92:93], v20 offset:40960
    v_mfma_f32_16x16x32_bf16 v[88:91], a[24:27], a[232:235], v[88:91]
    s_addk_i32 m0, 7168
    ds_read_b64_tr_b16 a[94:95], v20 offset:43008
    v_cvt_pk_bf16_f32 v148, v84, v85
    v_mfma_f32_16x16x32_bf16 v[88:91], a[28:31], a[248:251], v[88:91]
    s_add_u32 s59, s3, s81
    v_cvt_pk_bf16_f32 v149, v86, v87
    v_mfma_f32_16x16x32_bf16 v[88:91], a[32:35], a[104:107], v[88:91]
    buffer_load_dwordx4 v12, s[12:15], s59 offen lds
    v_mfma_f32_16x16x32_bf16 v[88:91], a[36:39], a[120:123], v[88:91]
    v_mfma_f32_16x16x32_bf16 v[88:91], a[40:43], a[132:135], v[88:91]
    v_mfma_f32_16x16x32_bf16 v[88:91], a[20:23], v[232:235], v[88:91]
    v_mfma_f32_16x16x32_bf16 v[88:91], a[44:47], a[152:155], v[88:91]
    v_mfma_f32_16x16x32_bf16 v[92:95], a[44:47], a[156:159], 0
    s_addk_i32 m0, 1024
    v_mfma_f32_16x16x32_bf16 v[92:95], a[20:23], v[236:239], v[92:95]
    s_add_u32 s59, s3, s81
    v_mfma_f32_16x16x32_bf16 v[92:95], a[40:43], a[136:139], v[92:95]
    buffer_load_dwordx4 v33, s[12:15], s59 offen lds
    v_mfma_f32_16x16x32_bf16 v[92:95], a[36:39], a[124:127], v[92:95]
    v_mfma_f32_16x16x32_bf16 v[92:95], a[32:35], a[108:111], v[92:95]
    v_mfma_f32_16x16x32_bf16 v[92:95], a[28:31], a[252:255], v[92:95]
    v_cvt_pk_bf16_f32 v152, v88, v89
    v_mfma_f32_16x16x32_bf16 v[92:95], a[24:27], a[236:239], v[92:95]
    v_cvt_pk_bf16_f32 v153, v90, v91
    v_mfma_f32_16x16x32_bf16 v[92:95], a[16:19], v[204:207], v[92:95]
    v_mfma_f32_16x16x32_bf16 v[92:95], a[12:15], v[172:175], v[92:95]
    v_mfma_f32_16x16x32_bf16 v[92:95], a[8:11], v[140:143], v[92:95]
    v_mfma_f32_16x16x32_bf16 v[92:95], a[4:7], v[108:111], v[92:95]
    s_waitcnt vmcnt(17) lgkmcnt(0)
    v_mfma_f32_16x16x32_bf16 v[92:95], a[0:3], v[76:79], v[92:95]
    s_barrier
    v_mfma_f32_16x16x32_bf16 v[112:115], a[48:51], v[64:67], 0
    s_add_u32 s45, s42, 0
    ds_read_b64_tr_b16 a[0:1], v21 offset:0
    v_mfma_f32_16x16x32_bf16 v[112:115], a[52:55], v[96:99], v[112:115]
    buffer_load_dword v49, v48, s[16:19], s45 offen sc1
    v_mfma_f32_16x16x32_bf16 v[112:115], a[56:59], v[128:131], v[112:115]
    s_add_u32 s3, s3, 128
    s_sub_u32 s67, s3, 1152
    s_min_u32 s3, s3, s67
    v_mfma_f32_16x16x32_bf16 v[112:115], a[60:63], v[160:163], v[112:115]
    s_add_u32 m0, s62, 0
    ds_read_b64_tr_b16 a[2:3], v21 offset:2048
    s_add_u32 s59, s3, s76
    v_mfma_f32_16x16x32_bf16 v[112:115], a[64:67], v[192:195], v[112:115]
    buffer_load_dwordx4 v12, s[12:15], s59 offen lds
    v_mfma_f32_16x16x32_bf16 v[112:115], a[72:75], a[224:227], v[112:115]
    ds_read_b64_tr_b16 a[4:5], v21 offset:8192
    v_cvt_pk_bf16_f32 v156, v92, v93
    v_mfma_f32_16x16x32_bf16 v[112:115], a[76:79], a[240:243], v[112:115]
    ds_read_b64_tr_b16 a[6:7], v21 offset:10240
    v_cvt_pk_bf16_f32 v157, v94, v95
    v_mfma_f32_16x16x32_bf16 v[112:115], a[80:83], a[96:99], v[112:115]
    ds_read_b64_tr_b16 a[8:9], v21 offset:16384
    v_mfma_f32_16x16x32_bf16 v[112:115], a[84:87], a[112:115], v[112:115]
    s_addk_i32 m0, 1024
    ds_read_b64_tr_b16 a[10:11], v21 offset:18432
    v_mfma_f32_16x16x32_bf16 v[112:115], a[88:91], a[128:131], v[112:115]
    s_add_u32 s59, s3, s76
    ds_read_b64_tr_b16 a[12:13], v21 offset:24576
    v_mfma_f32_16x16x32_bf16 v[112:115], a[68:71], v[224:227], v[112:115]
    buffer_load_dwordx4 v33, s[12:15], s59 offen lds
    v_mfma_f32_16x16x32_bf16 v[112:115], a[92:95], a[140:143], v[112:115]
    ds_read_b64_tr_b16 a[14:15], v21 offset:26624
    v_mfma_f32_16x16x32_bf16 v[116:119], a[92:95], a[148:151], 0
    ds_read_b64_tr_b16 a[16:17], v21 offset:32768
    v_mfma_f32_16x16x32_bf16 v[116:119], a[68:71], v[228:231], v[116:119]
    ds_read_b64_tr_b16 a[18:19], v21 offset:34816
    v_mfma_f32_16x16x32_bf16 v[116:119], a[88:91], a[144:147], v[116:119]
    ds_read_b64_tr_b16 a[24:25], v22 offset:0
    v_mfma_f32_16x16x32_bf16 v[116:119], a[84:87], a[116:119], v[116:119]
    ds_read_b64_tr_b16 a[26:27], v22 offset:2048
    v_mfma_f32_16x16x32_bf16 v[116:119], a[80:83], a[100:103], v[116:119]
    ds_read_b64_tr_b16 a[28:29], v22 offset:8192
    v_mfma_f32_16x16x32_bf16 v[116:119], a[76:79], a[244:247], v[116:119]
    ds_read_b64_tr_b16 a[30:31], v22 offset:10240
    v_cvt_pk_bf16_f32 v146, v112, v113
    v_mfma_f32_16x16x32_bf16 v[116:119], a[72:75], a[228:231], v[116:119]
    ds_read_b64_tr_b16 a[32:33], v22 offset:16384
    v_cvt_pk_bf16_f32 v147, v114, v115
    v_mfma_f32_16x16x32_bf16 v[116:119], a[64:67], v[196:199], v[116:119]
    buffer_store_dwordx4 v[144:147], v25, s[16:19], s43 offen sc1
    v_mfma_f32_16x16x32_bf16 v[116:119], a[60:63], v[164:167], v[116:119]
    s_addk_i32 m0, 7168
    ds_read_b64_tr_b16 a[34:35], v22 offset:18432
    s_add_u32 s59, s3, s77
    v_mfma_f32_16x16x32_bf16 v[116:119], a[56:59], v[132:135], v[116:119]
    buffer_load_dwordx4 v12, s[12:15], s59 offen lds
    v_mfma_f32_16x16x32_bf16 v[116:119], a[52:55], v[100:103], v[116:119]
    s_addk_i32 m0, 1024
    ds_read_b64_tr_b16 a[36:37], v22 offset:24576
    v_cvt_pk_bf16_f32 v210, v112, v113
    v_mfma_f32_16x16x32_bf16 v[116:119], a[48:51], v[68:71], v[116:119]
    s_add_u32 s59, s3, s77
    ds_read_b64_tr_b16 a[38:39], v22 offset:26624
    v_cvt_pk_bf16_f32 v211, v114, v115
    v_mfma_f32_16x16x32_bf16 v[120:123], a[48:51], v[72:75], 0
    buffer_load_dwordx4 v33, s[12:15], s59 offen lds
    v_mfma_f32_16x16x32_bf16 v[120:123], a[52:55], v[104:107], v[120:123]
    ds_read_b64_tr_b16 a[40:41], v22 offset:32768
    v_mfma_f32_16x16x32_bf16 v[120:123], a[56:59], v[136:139], v[120:123]
    ds_read_b64_tr_b16 a[42:43], v22 offset:34816
    v_mfma_f32_16x16x32_bf16 v[120:123], a[60:63], v[168:171], v[120:123]
    ds_read_b64_tr_b16 a[20:21], v21 offset:40960
    v_mfma_f32_16x16x32_bf16 v[120:123], a[64:67], v[200:203], v[120:123]
    ds_read_b64_tr_b16 a[22:23], v21 offset:43008
    v_mfma_f32_16x16x32_bf16 v[120:123], a[72:75], a[232:235], v[120:123]
    ds_read_b64_tr_b16 a[44:45], v22 offset:40960
    v_cvt_pk_bf16_f32 v150, v116, v117
    v_mfma_f32_16x16x32_bf16 v[120:123], a[76:79], a[248:251], v[120:123]
    ds_read_b64_tr_b16 a[46:47], v22 offset:43008
    v_cvt_pk_bf16_f32 v151, v118, v119
    v_mfma_f32_16x16x32_bf16 v[120:123], a[80:83], a[104:107], v[120:123]
    buffer_store_dwordx4 v[148:151], v26, s[16:19], s43 offen sc1
    v_mfma_f32_16x16x32_bf16 v[120:123], a[84:87], a[120:123], v[120:123]
    s_addk_i32 m0, 7168
    s_add_u32 s59, s3, s78
    v_mfma_f32_16x16x32_bf16 v[120:123], a[88:91], a[132:135], v[120:123]
    buffer_load_dwordx4 v12, s[12:15], s59 offen lds
    v_mfma_f32_16x16x32_bf16 v[120:123], a[68:71], v[232:235], v[120:123]
    v_mfma_f32_16x16x32_bf16 v[120:123], a[92:95], a[152:155], v[120:123]
    v_mfma_f32_16x16x32_bf16 v[124:127], a[92:95], a[156:159], 0
    s_addk_i32 m0, 1024
    v_mfma_f32_16x16x32_bf16 v[124:127], a[68:71], v[236:239], v[124:127]
    s_add_u32 s59, s3, s78
    v_mfma_f32_16x16x32_bf16 v[124:127], a[88:91], a[136:139], v[124:127]
    buffer_load_dwordx4 v33, s[12:15], s59 offen lds
    v_mfma_f32_16x16x32_bf16 v[124:127], a[84:87], a[124:127], v[124:127]
    v_mfma_f32_16x16x32_bf16 v[124:127], a[80:83], a[108:111], v[124:127]
    v_mfma_f32_16x16x32_bf16 v[124:127], a[76:79], a[252:255], v[124:127]
    v_cvt_pk_bf16_f32 v154, v120, v121
    v_mfma_f32_16x16x32_bf16 v[124:127], a[72:75], a[236:239], v[124:127]
    v_cvt_pk_bf16_f32 v155, v122, v123
    v_mfma_f32_16x16x32_bf16 v[124:127], a[64:67], v[204:207], v[124:127]
    buffer_store_dwordx4 v[152:155], v27, s[16:19], s43 offen sc1
    v_mfma_f32_16x16x32_bf16 v[124:127], a[60:63], v[172:175], v[124:127]
    v_mfma_f32_16x16x32_bf16 v[124:127], a[56:59], v[140:143], v[124:127]
    v_mfma_f32_16x16x32_bf16 v[124:127], a[52:55], v[108:111], v[124:127]
    v_mfma_f32_16x16x32_bf16 v[124:127], a[48:51], v[76:79], v[124:127]
    s_waitcnt lgkmcnt(0)
    v_mfma_f32_16x16x32_bf16 v[80:83], a[0:3], v[64:67], 0
    s_addk_i32 m0, 7168
    ds_read_b64_tr_b16 a[48:49], v23 offset:0
    s_add_u32 s59, s3, s79
    v_mfma_f32_16x16x32_bf16 v[80:83], a[4:7], v[96:99], v[80:83]
    buffer_load_dwordx4 v12, s[12:15], s59 offen lds
    v_mfma_f32_16x16x32_bf16 v[80:83], a[8:11], v[128:131], v[80:83]
    ds_read_b64_tr_b16 a[50:51], v23 offset:2048
    v_mfma_f32_16x16x32_bf16 v[80:83], a[12:15], v[160:163], v[80:83]
    ds_read_b64_tr_b16 a[52:53], v23 offset:8192
    v_mfma_f32_16x16x32_bf16 v[80:83], a[16:19], v[192:195], v[80:83]
    ds_read_b64_tr_b16 a[54:55], v23 offset:10240
    v_mfma_f32_16x16x32_bf16 v[80:83], a[24:27], a[224:227], v[80:83]
    ds_read_b64_tr_b16 a[56:57], v23 offset:16384
    v_cvt_pk_bf16_f32 v158, v124, v125
    v_mfma_f32_16x16x32_bf16 v[80:83], a[28:31], a[240:243], v[80:83]
    ds_read_b64_tr_b16 a[58:59], v23 offset:18432
    v_cvt_pk_bf16_f32 v159, v126, v127
    v_mfma_f32_16x16x32_bf16 v[80:83], a[32:35], a[96:99], v[80:83]
    buffer_store_dwordx4 v[156:159], v28, s[16:19], s43 offen sc1
    v_mfma_f32_16x16x32_bf16 v[80:83], a[36:39], a[112:115], v[80:83]
    s_add_u32 s43, s43, 524288
    s_addk_i32 m0, 1024
    s_add_u32 s59, s3, s79
    v_mfma_f32_16x16x32_bf16 v[80:83], a[40:43], a[128:131], v[80:83]
    buffer_load_dwordx4 v33, s[12:15], s59 offen lds
    v_mfma_f32_16x16x32_bf16 v[80:83], a[20:23], v[224:227], v[80:83]
    ds_read_b64_tr_b16 a[60:61], v23 offset:24576
    v_mfma_f32_16x16x32_bf16 v[80:83], a[44:47], a[140:143], v[80:83]
    ds_read_b64_tr_b16 a[62:63], v23 offset:26624
    v_mfma_f32_16x16x32_bf16 v[84:87], a[44:47], a[148:151], 0
    ds_read_b64_tr_b16 a[64:65], v23 offset:32768
    v_mfma_f32_16x16x32_bf16 v[84:87], a[20:23], v[228:231], v[84:87]
    ds_read_b64_tr_b16 a[66:67], v23 offset:34816
    v_mfma_f32_16x16x32_bf16 v[84:87], a[40:43], a[144:147], v[84:87]
    s_addk_i32 m0, 7168
    ds_read_b64_tr_b16 a[72:73], v24 offset:0
    v_mfma_f32_16x16x32_bf16 v[84:87], a[36:39], a[116:119], v[84:87]
    s_add_u32 s59, s3, s80
    ds_read_b64_tr_b16 a[74:75], v24 offset:2048
    v_mfma_f32_16x16x32_bf16 v[84:87], a[32:35], a[100:103], v[84:87]
    buffer_load_dwordx4 v12, s[12:15], s59 offen lds
    v_mfma_f32_16x16x32_bf16 v[84:87], a[28:31], a[244:247], v[84:87]
    ds_read_b64_tr_b16 a[76:77], v24 offset:8192
    v_cvt_pk_bf16_f32 v144, v80, v81
    v_mfma_f32_16x16x32_bf16 v[84:87], a[24:27], a[228:231], v[84:87]
    ds_read_b64_tr_b16 a[78:79], v24 offset:10240
    v_cvt_pk_bf16_f32 v145, v82, v83
    v_mfma_f32_16x16x32_bf16 v[84:87], a[16:19], v[196:199], v[84:87]
    ds_read_b64_tr_b16 a[80:81], v24 offset:16384
    v_cvt_pk_bf16_f32 v212, v80, v81
    v_mfma_f32_16x16x32_bf16 v[84:87], a[12:15], v[164:167], v[84:87]
    ds_read_b64_tr_b16 a[82:83], v24 offset:18432
    v_cvt_pk_bf16_f32 v213, v82, v83
    v_mfma_f32_16x16x32_bf16 v[84:87], a[8:11], v[132:135], v[84:87]
    s_addk_i32 m0, 1024
    ds_read_b64_tr_b16 a[84:85], v24 offset:24576
    v_mfma_f32_16x16x32_bf16 v[84:87], a[4:7], v[100:103], v[84:87]
    s_add_u32 s59, s3, s80
    ds_read_b64_tr_b16 a[86:87], v24 offset:26624
    v_mfma_f32_16x16x32_bf16 v[84:87], a[0:3], v[68:71], v[84:87]
    buffer_load_dwordx4 v33, s[12:15], s59 offen lds
    v_mfma_f32_16x16x32_bf16 v[88:91], a[0:3], v[72:75], 0
    ds_read_b64_tr_b16 a[88:89], v24 offset:32768
    v_mfma_f32_16x16x32_bf16 v[88:91], a[4:7], v[104:107], v[88:91]
    ds_read_b64_tr_b16 a[90:91], v24 offset:34816
    v_mfma_f32_16x16x32_bf16 v[88:91], a[8:11], v[136:139], v[88:91]
    ds_read_b64_tr_b16 a[68:69], v23 offset:40960
    v_mfma_f32_16x16x32_bf16 v[88:91], a[12:15], v[168:171], v[88:91]
    ds_read_b64_tr_b16 a[70:71], v23 offset:43008
    v_mfma_f32_16x16x32_bf16 v[88:91], a[16:19], v[200:203], v[88:91]
    ds_read_b64_tr_b16 a[92:93], v24 offset:40960
    v_mfma_f32_16x16x32_bf16 v[88:91], a[24:27], a[232:235], v[88:91]
    s_addk_i32 m0, 7168
    ds_read_b64_tr_b16 a[94:95], v24 offset:43008
    v_cvt_pk_bf16_f32 v148, v84, v85
    v_mfma_f32_16x16x32_bf16 v[88:91], a[28:31], a[248:251], v[88:91]
    s_add_u32 s59, s3, s81
    v_cvt_pk_bf16_f32 v149, v86, v87
    v_mfma_f32_16x16x32_bf16 v[88:91], a[32:35], a[104:107], v[88:91]
    buffer_load_dwordx4 v12, s[12:15], s59 offen lds
    v_mfma_f32_16x16x32_bf16 v[88:91], a[36:39], a[120:123], v[88:91]
    v_mfma_f32_16x16x32_bf16 v[88:91], a[40:43], a[132:135], v[88:91]
    v_mfma_f32_16x16x32_bf16 v[88:91], a[20:23], v[232:235], v[88:91]
    v_mfma_f32_16x16x32_bf16 v[88:91], a[44:47], a[152:155], v[88:91]
    v_mfma_f32_16x16x32_bf16 v[92:95], a[44:47], a[156:159], 0
    s_addk_i32 m0, 1024
    v_mfma_f32_16x16x32_bf16 v[92:95], a[20:23], v[236:239], v[92:95]
    s_add_u32 s59, s3, s81
    v_mfma_f32_16x16x32_bf16 v[92:95], a[40:43], a[136:139], v[92:95]
    buffer_load_dwordx4 v33, s[12:15], s59 offen lds
    v_mfma_f32_16x16x32_bf16 v[92:95], a[36:39], a[124:127], v[92:95]
    v_mfma_f32_16x16x32_bf16 v[92:95], a[32:35], a[108:111], v[92:95]
    v_mfma_f32_16x16x32_bf16 v[92:95], a[28:31], a[252:255], v[92:95]
    v_cvt_pk_bf16_f32 v152, v88, v89
    v_mfma_f32_16x16x32_bf16 v[92:95], a[24:27], a[236:239], v[92:95]
    v_cvt_pk_bf16_f32 v153, v90, v91
    v_mfma_f32_16x16x32_bf16 v[92:95], a[16:19], v[204:207], v[92:95]
    v_mfma_f32_16x16x32_bf16 v[92:95], a[12:15], v[172:175], v[92:95]
    v_mfma_f32_16x16x32_bf16 v[92:95], a[8:11], v[140:143], v[92:95]
    v_mfma_f32_16x16x32_bf16 v[92:95], a[4:7], v[108:111], v[92:95]
    s_waitcnt vmcnt(5) lgkmcnt(0)
    v_mfma_f32_16x16x32_bf16 v[92:95], a[0:3], v[76:79], v[92:95]
    s_barrier
    v_mfma_f32_16x16x32_bf16 v[112:115], a[48:51], v[64:67], 0
    ds_read_b64_tr_b16 a[0:1], v13 offset:0
    v_cmp_gt_u32 vcc, 1, v49
    v_mfma_f32_16x16x32_bf16 v[112:115], a[52:55], v[96:99], v[112:115]
    ds_read_b64_tr_b16 a[2:3], v13 offset:2048
    v_mfma_f32_16x16x32_bf16 v[112:115], a[56:59], v[128:131], v[112:115]
    s_and_b32 s55, vcc_lo, 0xfff
    ds_read_b64_tr_b16 a[4:5], v13 offset:8192
    s_cbranch_scc0 L_spF2r
    s_mov_b32 s41, 0
L_spF2b:
    buffer_load_dword v49, v48, s[16:19], s45 offen sc1
    s_add_u32 s41, s41, 1
    s_cmp_gt_u32 s41, 200000
    s_cbranch_scc1 L_spF2r
    s_waitcnt vmcnt(0)
    v_cmp_gt_u32 vcc, 1, v49
    s_nop 1
    s_and_b32 s55, vcc_lo, 0xfff
    s_cbranch_scc1 L_spF2b
L_spF2r:
    v_mfma_f32_16x16x32_bf16 v[112:115], a[60:63], v[160:163], v[112:115]
    s_add_u32 s59, s42, 2048
    ds_read_b64_tr_b16 a[6:7], v13 offset:10240
    v_mfma_f32_16x16x32_bf16 v[112:115], a[64:67], v[192:195], v[112:115]
    buffer_store_dword v50, v47, s[16:19], s59 offen sc1
    v_mfma_f32_16x16x32_bf16 v[112:115], a[72:75], a[224:227], v[112:115]
    ds_read_b64_tr_b16 a[8:9], v13 offset:16384
    v_cvt_pk_bf16_f32 v156, v92, v93
    v_mfma_f32_16x16x32_bf16 v[112:115], a[76:79], a[240:243], v[112:115]
    s_add_u32 s59, s40, 0
    ds_read_b64_tr_b16 a[10:11], v13 offset:18432
    v_cvt_pk_bf16_f32 v157, v94, v95
    v_mfma_f32_16x16x32_bf16 v[112:115], a[80:83], a[96:99], v[112:115]
    buffer_load_dwordx4 a[160:163], v1, s[16:19], s59 offen offset:0 sc1
    v_mfma_f32_16x16x32_bf16 v[112:115], a[84:87], a[112:115], v[112:115]
    ds_read_b64_tr_b16 a[12:13], v13 offset:24576
    v_mfma_f32_16x16x32_bf16 v[112:115], a[88:91], a[128:131], v[112:115]
    s_add_u32 s59, s40, 0
    ds_read_b64_tr_b16 a[14:15], v13 offset:26624
    v_mfma_f32_16x16x32_bf16 v[112:115], a[68:71], v[224:227], v[112:115]
    buffer_load_dwordx4 a[164:167], v34, s[16:19], s59 offen offset:1024 sc1
    v_mfma_f32_16x16x32_bf16 v[112:115], a[92:95], a[140:143], v[112:115]
    ds_read_b64_tr_b16 a[16:17], v13 offset:32768
    v_mfma_f32_16x16x32_bf16 v[116:119], a[92:95], a[148:151], 0
    ds_read_b64_tr_b16 a[18:19], v13 offset:34816
    v_mfma_f32_16x16x32_bf16 v[116:119], a[68:71], v[228:231], v[116:119]
    s_add_u32 s59, s40, 0
    ds_read_b64_tr_b16 a[24:25], v14 offset:0
    v_mfma_f32_16x16x32_bf16 v[116:119], a[88:91], a[144:147], v[116:119]
    buffer_load_dwordx4 a[168:171], v31, s[16:19], s59 offen offset:2048 sc1
    v_mfma_f32_16x16x32_bf16 v[116:119], a[84:87], a[116:119], v[116:119]
    ds_read_b64_tr_b16 a[26:27], v14 offset:2048
    v_mfma_f32_16x16x32_bf16 v[116:119], a[80:83], a[100:103], v[116:119]
    ds_read_b64_tr_b16 a[28:29], v14 offset:8192
    v_mfma_f32_16x16x32_bf16 v[116:119], a[76:79], a[244:247], v[116:119]
    ds_read_b64_tr_b16 a[30:31], v14 offset:10240
    v_cvt_pk_bf16_f32 v146, v112, v113
    v_mfma_f32_16x16x32_bf16 v[116:119], a[72:75], a[228:231], v[116:119]
    ds_read_b64_tr_b16 a[32:33], v14 offset:16384
    v_cvt_pk_bf16_f32 v147, v114, v115
    v_mfma_f32_16x16x32_bf16 v[116:119], a[64:67], v[196:199], v[116:119]
    buffer_store_dwordx4 v[144:147], v25, s[16:19], s43 offen sc1
    v_mfma_f32_16x16x32_bf16 v[116:119], a[60:63], v[164:167], v[116:119]
    s_add_u32 s3, s3, 128
    s_sub_u32 s67, s3, 1152
    s_min_u32 s3, s3, s67
    v_mfma_f32_16x16x32_bf16 v[116:119], a[56:59], v[132:135], v[116:119]
    s_add_u32 m0, s62, 98304
    ds_read_b64_tr_b16 a[34:35], v14 offset:18432
    s_add_u32 s59, s3, s76
    v_mfma_f32_16x16x32_bf16 v[116:119], a[52:55], v[100:103], v[116:119]
    buffer_load_dwordx4 v12, s[12:15], s59 offen lds
    v_mfma_f32_16x16x32_bf16 v[116:119], a[48:51], v[68:71], v[116:119]
    s_addk_i32 m0, 1024
    ds_read_b64_tr_b16 a[36:37], v14 offset:24576
    s_add_u32 s59, s3, s76
    v_mfma_f32_16x16x32_bf16 v[120:123], a[48:51], v[72:75], 0
    buffer_load_dwordx4 v33, s[12:15], s59 offen lds
    v_mfma_f32_16x16x32_bf16 v[120:123], a[52:55], v[104:107], v[120:123]
    ds_read_b64_tr_b16 a[38:39], v14 offset:26624
    v_cvt_pk_bf16_f32 v214, v112, v113
    v_mfma_f32_16x16x32_bf16 v[120:123], a[56:59], v[136:139], v[120:123]
    s_addk_i32 m0, 7168
    ds_read_b64_tr_b16 a[40:41], v14 offset:32768
    v_cvt_pk_bf16_f32 v215, v114, v115
    v_mfma_f32_16x16x32_bf16 v[120:123], a[60:63], v[168:171], v[120:123]
    s_add_u32 s59, s3, s77
    ds_read_b64_tr_b16 a[42:43], v14 offset:34816
    v_mfma_f32_16x16x32_bf16 v[120:123], a[64:67], v[200:203], v[120:123]
    buffer_load_dwordx4 v12, s[12:15], s59 offen lds
    v_mfma_f32_16x16x32_bf16 v[120:123], a[72:75], a[232:235], v[120:123]
    ds_read_b64_tr_b16 a[20:21], v13 offset:40960
    v_cvt_pk_bf16_f32 v150, v116, v117
    v_mfma_f32_16x16x32_bf16 v[120:123], a[76:79], a[248:251], v[120:123]
    ds_read_b64_tr_b16 a[22:23], v13 offset:43008
    v_cvt_pk_bf16_f32 v151, v118, v119
    v_mfma_f32_16x16x32_bf16 v[120:123], a[80:83], a[104:107], v[120:123]
    buffer_store_dwordx4 v[148:151], v26, s[16:19], s43 offen sc1
    v_mfma_f32_16x16x32_bf16 v[120:123], a[84:87], a[120:123], v[120:123]
    s_addk_i32 m0, 1024
    ds_read_b64_tr_b16 a[44:45], v14 offset:40960
    s_add_u32 s59, s3, s77
    v_mfma_f32_16x16x32_bf16 v[120:123], a[88:91], a[132:135], v[120:123]
    buffer_load_dwordx4 v33, s[12:15], s59 offen lds
    v_mfma_f32_16x16x32_bf16 v[120:123], a[68:71], v[232:235], v[120:123]
    ds_read_b64_tr_b16 a[46:47], v14 offset:43008
    v_mfma_f32_16x16x32_bf16 v[120:123], a[92:95], a[152:155], v[120:123]
    s_addk_i32 m0, 7168
    v_mfma_f32_16x16x32_bf16 v[124:127], a[92:95], a[156:159], 0
    s_add_u32 s59, s3, s78
    v_mfma_f32_16x16x32_bf16 v[124:127], a[68:71], v[236:239], v[124:127]
    buffer_load_dwordx4 v12, s[12:15], s59 offen lds
    v_mfma_f32_16x16x32_bf16 v[124:127], a[88:91], a[136:139], v[124:127]
    v_mfma_f32_16x16x32_bf16 v[124:127], a[84:87], a[124:127], v[124:127]
    v_mfma_f32_16x16x32_bf16 v[124:127], a[80:83], a[108:111], v[124:127]
    v_mfma_f32_16x16x32_bf16 v[124:127], a[76:79], a[252:255], v[124:127]
    v_cvt_pk_bf16_f32 v154, v120, v121
    v_mfma_f32_16x16x32_bf16 v[124:127], a[72:75], a[236:239], v[124:127]
    v_cvt_pk_bf16_f32 v155, v122, v123
    v_mfma_f32_16x16x32_bf16 v[124:127], a[64:67], v[204:207], v[124:127]
    buffer_store_dwordx4 v[152:155], v27, s[16:19], s43 offen sc1
    v_mfma_f32_16x16x32_bf16 v[124:127], a[60:63], v[172:175], v[124:127]
    s_addk_i32 m0, 1024
L_stubF8:
    s_cbranch_execz L_stubF11
    s_nop 0
    s_add_u32 s59, s3, s78
    v_mfma_f32_16x16x32_bf16 v[124:127], a[56:59], v[140:143], v[124:127]
    buffer_load_dwordx4 v33, s[12:15], s59 offen lds
    v_mfma_f32_16x16x32_bf16 v[124:127], a[52:55], v[108:111], v[124:127]
    v_mfma_f32_16x16x32_bf16 v[124:127], a[48:51], v[76:79], v[124:127]
    s_waitcnt lgkmcnt(0)
    v_mfma_f32_16x16x32_bf16 v[80:83], a[0:3], v[64:67], 0
    s_addk_i32 m0, 7168
    ds_read_b64_tr_b16 a[48:49], v15 offset:0
    s_add_u32 s59, s3, s79
    v_mfma_f32_16x16x32_bf16 v[80:83], a[4:7], v[96:99], v[80:83]
    buffer_load_dwordx4 v12, s[12:15], s59 offen lds
    v_mfma_f32_16x16x32_bf16 v[80:83], a[8:11], v[128:131], v[80:83]
    ds_read_b64_tr_b16 a[50:51], v15 offset:2048
    v_mfma_f32_16x16x32_bf16 v[80:83], a[12:15], v[160:163], v[80:83]
    ds_read_b64_tr_b16 a[52:53], v15 offset:8192
    v_mfma_f32_16x16x32_bf16 v[80:83], a[16:19], v[192:195], v[80:83]
    ds_read_b64_tr_b16 a[54:55], v15 offset:10240
    v_mfma_f32_16x16x32_bf16 v[80:83], a[24:27], a[224:227], v[80:83]
    ds_read_b64_tr_b16 a[56:57], v15 offset:16384
    v_cvt_pk_bf16_f32 v158, v124, v125
    v_mfma_f32_16x16x32_bf16 v[80:83], a[28:31], a[240:243], v[80:83]
    ds_read_b64_tr_b16 a[58:59], v15 offset:18432
    v_cvt_pk_bf16_f32 v159, v126, v127
    v_mfma_f32_16x16x32_bf16 v[80:83], a[32:35], a[96:99], v[80:83]
    buffer_store_dwordx4 v[156:159], v28, s[16:19], s43 offen sc1
    v_mfma_f32_16x16x32_bf16 v[80:83], a[36:39], a[112:115], v[80:83]
    s_add_u32 s43, s43, 524288
    s_addk_i32 m0, 1024
    s_add_u32 s59, s3, s79
    v_mfma_f32_16x16x32_bf16 v[80:83], a[40:43], a[128:131], v[80:83]
    buffer_load_dwordx4 v33, s[12:15], s59 offen lds
    v_mfma_f32_16x16x32_bf16 v[80:83], a[20:23], v[224:227], v[80:83]
    s_addk_i32 m0, 7168
    ds_read_b64_tr_b16 a[60:61], v15 offset:24576
    v_mfma_f32_16x16x32_bf16 v[80:83], a[44:47], a[140:143], v[80:83]
    s_add_u32 s59, s3, s80
    ds_read_b64_tr_b16 a[62:63], v15 offset:26624
    v_mfma_f32_16x16x32_bf16 v[84:87], a[44:47], a[148:151], 0
    buffer_load_dwordx4 v12, s[12:15], s59 offen lds
    v_mfma_f32_16x16x32_bf16 v[84:87], a[20:23], v[228:231], v[84:87]
    ds_read_b64_tr_b16 a[64:65], v15 offset:32768
    v_mfma_f32_16x16x32_bf16 v[84:87], a[40:43], a[144:147], v[84:87]
    ds_read_b64_tr_b16 a[66:67], v15 offset:34816
    v_mfma_f32_16x16x32_bf16 v[84:87], a[36:39], a[116:119], v[84:87]
    ds_read_b64_tr_b16 a[72:73], v16 offset:0
    v_mfma_f32_16x16x32_bf16 v[84:87], a[32:35], a[100:103], v[84:87]
    ds_read_b64_tr_b16 a[74:75], v16 offset:2048
    v_mfma_f32_16x16x32_bf16 v[84:87], a[28:31], a[244:247], v[84:87]
    s_addk_i32 m0, 1024
    ds_read_b64_tr_b16 a[76:77], v16 offset:8192
    v_cvt_pk_bf16_f32 v144, v80, v81
    v_mfma_f32_16x16x32_bf16 v[84:87], a[24:27], a[228:231], v[84:87]
    s_add_u32 s59, s3, s80
    ds_read_b64_tr_b16 a[78:79], v16 offset:10240
    v_cvt_pk_bf16_f32 v145, v82, v83
    v_mfma_f32_16x16x32_bf16 v[84:87], a[16:19], v[196:199], v[84:87]
    buffer_load_dwordx4 v33, s[12:15], s59 offen lds
    v_mfma_f32_16x16x32_bf16 v[84:87], a[12:15], v[164:167], v[84:87]
    ds_read_b64_tr_b16 a[80:81], v16 offset:16384
    v_cvt_pk_bf16_f32 v216, v80, v81
    v_mfma_f32_16x16x32_bf16 v[84:87], a[8:11], v[132:135], v[84:87]
    s_addk_i32 m0, 7168
    ds_read_b64_tr_b16 a[82:83], v16 offset:18432
    v_cvt_pk_bf16_f32 v217, v82, v83
    v_mfma_f32_16x16x32_bf16 v[84:87], a[4:7], v[100:103], v[84:87]
    s_add_u32 s59, s3, s81
    ds_read_b64_tr_b16 a[84:85], v16 offset:24576
    v_mfma_f32_16x16x32_bf16 v[84:87], a[0:3], v[68:71], v[84:87]
    buffer_load_dwordx4 v12, s[12:15], s59 offen lds
    v_mfma_f32_16x16x32_bf16 v[88:91], a[0:3], v[72:75], 0
    ds_read_b64_tr_b16 a[86:87], v16 offset:26624
    v_mfma_f32_16x16x32_bf16 v[88:91], a[4:7], v[104:107], v[88:91]
    ds_read_b64_tr_b16 a[88:89], v16 offset:32768
    v_mfma_f32_16x16x32_bf16 v[88:91], a[8:11], v[136:139], v[88:91]
    ds_read_b64_tr_b16 a[90:91], v16 offset:34816
    v_mfma_f32_16x16x32_bf16 v[88:91], a[12:15], v[168:171], v[88:91]
    ds_read_b64_tr_b16 a[68:69], v15 offset:40960
    v_mfma_f32_16x16x32_bf16 v[88:91], a[16:19], v[200:203], v[88:91]
    ds_read_b64_tr_b16 a[70:71], v15 offset:43008
    v_mfma_f32_16x16x32_bf16 v[88:91], a[24:27], a[232:235], v[88:91]
    s_addk_i32 m0, 1024
    ds_read_b64_tr_b16 a[92:93], v16 offset:40960
    v_cvt_pk_bf16_f32 v148, v84, v85
    v_mfma_f32_16x16x32_bf16 v[88:91], a[28:31], a[248:251], v[88:91]
    s_add_u32 s59, s3, s81
    ds_read_b64_tr_b16 a[94:95], v16 offset:43008
    v_cvt_pk_bf16_f32 v149, v86, v87
    v_mfma_f32_16x16x32_bf16 v[88:91], a[32:35], a[104:107], v[88:91]
    buffer_load_dwordx4 v33, s[12:15], s59 offen lds
    v_mfma_f32_16x16x32_bf16 v[88:91], a[36:39], a[120:123], v[88:91]
    v_mfma_f32_16x16x32_bf16 v[88:91], a[40:43], a[132:135], v[88:91]
    s_add_u32 s59, s40, 524288
    v_mfma_f32_16x16x32_bf16 v[88:91], a[20:23], v[232:235], v[88:91]
    buffer_load_dwordx4 a[172:175], v1, s[16:19], s59 offen offset:0 sc1
    v_mfma_f32_16x16x32_bf16 v[88:91], a[44:47], a[152:155], v[88:91]
    v_mfma_f32_16x16x32_bf16 v[92:95], a[44:47], a[156:159], 0
    v_mfma_f32_16x16x32_bf16 v[92:95], a[20:23], v[236:239], v[92:95]
    v_mfma_f32_16x16x32_bf16 v[92:95], a[40:43], a[136:139], v[92:95]
    v_mfma_f32_16x16x32_bf16 v[92:95], a[36:39], a[124:127], v[92:95]
    s_addk_i32 s59, 0
    v_mfma_f32_16x16x32_bf16 v[92:95], a[32:35], a[108:111], v[92:95]
    buffer_load_dwordx4 a[176:179], v34, s[16:19], s59 offen offset:1024 sc1
    v_mfma_f32_16x16x32_bf16 v[92:95], a[28:31], a[252:255], v[92:95]
    v_cvt_pk_bf16_f32 v152, v88, v89
    v_mfma_f32_16x16x32_bf16 v[92:95], a[24:27], a[236:239], v[92:95]
    v_cvt_pk_bf16_f32 v153, v90, v91
    v_mfma_f32_16x16x32_bf16 v[92:95], a[16:19], v[204:207], v[92:95]
    v_mfma_f32_16x16x32_bf16 v[92:95], a[12:15], v[172:175], v[92:95]
    v_mfma_f32_16x16x32_bf16 v[92:95], a[8:11], v[140:143], v[92:95]
    v_mfma_f32_16x16x32_bf16 v[92:95], a[4:7], v[108:111], v[92:95]
    s_waitcnt vmcnt(22) lgkmcnt(0)
    v_mfma_f32_16x16x32_bf16 v[92:95], a[0:3], v[76:79], v[92:95]
    s_barrier
    v_mfma_f32_16x16x32_bf16 v[112:115], a[48:51], v[64:67], 0
    s_add_u32 s45, s42, 2048
    ds_read_b64_tr_b16 a[0:1], v17 offset:0
    v_mfma_f32_16x16x32_bf16 v[112:115], a[52:55], v[96:99], v[112:115]
    buffer_load_dword v49, v48, s[16:19], s45 offen sc1
    v_mfma_f32_16x16x32_bf16 v[112:115], a[56:59], v[128:131], v[112:115]
    s_addk_i32 s59, 0
    ds_read_b64_tr_b16 a[2:3], v17 offset:2048
    v_mfma_f32_16x16x32_bf16 v[112:115], a[60:63], v[160:163], v[112:115]
    buffer_load_dwordx4 a[180:183], v31, s[16:19], s59 offen offset:2048 sc1
    v_mfma_f32_16x16x32_bf16 v[112:115], a[64:67], v[192:195], v[112:115]
    ds_read_b64_tr_b16 a[4:5], v17 offset:8192
    v_mfma_f32_16x16x32_bf16 v[112:115], a[72:75], a[224:227], v[112:115]
    ds_read_b64_tr_b16 a[6:7], v17 offset:10240
    v_cvt_pk_bf16_f32 v156, v92, v93
    v_mfma_f32_16x16x32_bf16 v[112:115], a[76:79], a[240:243], v[112:115]
    ds_read_b64_tr_b16 a[8:9], v17 offset:16384
    v_cvt_pk_bf16_f32 v157, v94, v95
    v_mfma_f32_16x16x32_bf16 v[112:115], a[80:83], a[96:99], v[112:115]
    ds_read_b64_tr_b16 a[10:11], v17 offset:18432
    v_mfma_f32_16x16x32_bf16 v[112:115], a[84:87], a[112:115], v[112:115]
    ds_read_b64_tr_b16 a[12:13], v17 offset:24576
    v_mfma_f32_16x16x32_bf16 v[112:115], a[88:91], a[128:131], v[112:115]
    ds_read_b64_tr_b16 a[14:15], v17 offset:26624
    v_mfma_f32_16x16x32_bf16 v[112:115], a[68:71], v[224:227], v[112:115]
    ds_read_b64_tr_b16 a[16:17], v17 offset:32768
    v_mfma_f32_16x16x32_bf16 v[112:115], a[92:95], a[140:143], v[112:115]
    ds_read_b64_tr_b16 a[18:19], v17 offset:34816
    v_mfma_f32_16x16x32_bf16 v[116:119], a[92:95], a[148:151], 0
    ds_read_b64_tr_b16 a[24:25], v18 offset:0
    v_mfma_f32_16x16x32_bf16 v[116:119], a[68:71], v[228:231], v[116:119]
    ds_read_b64_tr_b16 a[26:27], v18 offset:2048
    v_mfma_f32_16x16x32_bf16 v[116:119], a[88:91], a[144:147], v[116:119]
    ds_read_b64_tr_b16 a[28:29], v18 offset:8192
    v_mfma_f32_16x16x32_bf16 v[116:119], a[84:87], a[116:119], v[116:119]
    ds_read_b64_tr_b16 a[30:31], v18 offset:10240
    v_mfma_f32_16x16x32_bf16 v[116:119], a[80:83], a[100:103], v[116:119]
    ds_read_b64_tr_b16 a[32:33], v18 offset:16384
    v_mfma_f32_16x16x32_bf16 v[116:119], a[76:79], a[244:247], v[116:119]
    ds_read_b64_tr_b16 a[34:35], v18 offset:18432
    v_cvt_pk_bf16_f32 v146, v112, v113
    v_mfma_f32_16x16x32_bf16 v[116:119], a[72:75], a[228:231], v[116:119]
    ds_read_b64_tr_b16 a[36:37], v18 offset:24576
    v_cvt_pk_bf16_f32 v147, v114, v115
    v_mfma_f32_16x16x32_bf16 v[116:119], a[64:67], v[196:199], v[116:119]
    buffer_store_dwordx4 v[144:147], v25, s[16:19], s43 offen sc1
    v_mfma_f32_16x16x32_bf16 v[116:119], a[60:63], v[164:167], v[116:119]
    ds_read_b64_tr_b16 a[38:39], v18 offset:26624
    v_cvt_pk_bf16_f32 v218, v112, v113
    v_mfma_f32_16x16x32_bf16 v[116:119], a[56:59], v[132:135], v[116:119]
    ds_read_b64_tr_b16 a[40:41], v18 offset:32768
    v_cvt_pk_bf16_f32 v219, v114, v115
    v_mfma_f32_16x16x32_bf16 v[116:119], a[52:55], v[100:103], v[116:119]
    ds_read_b64_tr_b16 a[42:43], v18 offset:34816
    v_mfma_f32_16x16x32_bf16 v[116:119], a[48:51], v[68:71], v[116:119]
    s_add_u32 s59, s40, 1048576
    ds_read_b64_tr_b16 a[20:21], v17 offset:40960
    v_mfma_f32_16x16x32_bf16 v[120:123], a[48:51], v[72:75], 0
    buffer_load_dwordx4 a[184:187], v1, s[16:19], s59 offen offset:0 sc1
    v_mfma_f32_16x16x32_bf16 v[120:123], a[52:55], v[104:107], v[120:123]
    ds_read_b64_tr_b16 a[22:23], v17 offset:43008
    v_mfma_f32_16x16x32_bf16 v[120:123], a[56:59], v[136:139], v[120:123]
    ds_read_b64_tr_b16 a[44:45], v18 offset:40960
    v_mfma_f32_16x16x32_bf16 v[120:123], a[60:63], v[168:171], v[120:123]
    ds_read_b64_tr_b16 a[46:47], v18 offset:43008
    v_mfma_f32_16x16x32_bf16 v[120:123], a[64:67], v[200:203], v[120:123]
    v_mfma_f32_16x16x32_bf16 v[120:123], a[72:75], a[232:235], v[120:123]
    v_cvt_pk_bf16_f32 v150, v116, v117
    v_mfma_f32_16x16x32_bf16 v[120:123], a[76:79], a[248:251], v[120:123]
    v_cvt_pk_bf16_f32 v151, v118, v119
    v_mfma_f32_16x16x32_bf16 v[120:123], a[80:83], a[104:107], v[120:123]
    buffer_store_dwordx4 v[148:151], v26, s[16:19], s43 offen sc1
    v_mfma_f32_16x16x32_bf16 v[120:123], a[84:87], a[120:123], v[120:123]
    v_mfma_f32_16x16x32_bf16 v[120:123], a[88:91], a[132:135], v[120:123]
    v_mfma_f32_16x16x32_bf16 v[120:123], a[68:71], v[232:235], v[120:123]
    v_mfma_f32_16x16x32_bf16 v[120:123], a[92:95], a[152:155], v[120:123]
    v_mfma_f32_16x16x32_bf16 v[124:127], a[92:95], a[156:159], 0
    v_mfma_f32_16x16x32_bf16 v[124:127], a[68:71], v[236:239], v[124:127]
    v_mfma_f32_16x16x32_bf16 v[124:127], a[88:91], a[136:139], v[124:127]
    v_mfma_f32_16x16x32_bf16 v[124:127], a[84:87], a[124:127], v[124:127]
    v_mfma_f32_16x16x32_bf16 v[124:127], a[80:83], a[108:111], v[124:127]
    s_nop 0
    v_mfma_f32_16x16x32_bf16 v[124:127], a[76:79], a[252:255], v[124:127]
    s_nop 0
    v_cvt_pk_bf16_f32 v154, v120, v121
    v_mfma_f32_16x16x32_bf16 v[124:127], a[72:75], a[236:239], v[124:127]
    v_cvt_pk_bf16_f32 v155, v122, v123
    v_mfma_f32_16x16x32_bf16 v[124:127], a[64:67], v[204:207], v[124:127]
    buffer_store_dwordx4 v[152:155], v27, s[16:19], s43 offen sc1
    v_mfma_f32_16x16x32_bf16 v[124:127], a[60:63], v[172:175], v[124:127]
    v_mfma_f32_16x16x32_bf16 v[124:127], a[56:59], v[140:143], v[124:127]
    v_mfma_f32_16x16x32_bf16 v[124:127], a[52:55], v[108:111], v[124:127]
    v_mfma_f32_16x16x32_bf16 v[124:127], a[48:51], v[76:79], v[124:127]
    s_waitcnt lgkmcnt(0)
    v_mfma_f32_16x16x32_bf16 v[80:83], a[0:3], v[64:67], 0
    s_addk_i32 s59, 0
    ds_read_b64_tr_b16 a[48:49], v19 offset:0
    v_mfma_f32_16x16x32_bf16 v[80:83], a[4:7], v[96:99], v[80:83]
    buffer_load_dwordx4 a[188:191], v34, s[16:19], s59 offen offset:1024 sc1
    v_mfma_f32_16x16x32_bf16 v[80:83], a[8:11], v[128:131], v[80:83]
    ds_read_b64_tr_b16 a[50:51], v19 offset:2048
    v_mfma_f32_16x16x32_bf16 v[80:83], a[12:15], v[160:163], v[80:83]
    ds_read_b64_tr_b16 a[52:53], v19 offset:8192
    v_mfma_f32_16x16x32_bf16 v[80:83], a[16:19], v[192:195], v[80:83]
    ds_read_b64_tr_b16 a[54:55], v19 offset:10240
    v_mfma_f32_16x16x32_bf16 v[80:83], a[24:27], a[224:227], v[80:83]
    ds_read_b64_tr_b16 a[56:57], v19 offset:16384
    v_cvt_pk_bf16_f32 v158, v124, v125
    v_mfma_f32_16x16x32_bf16 v[80:83], a[28:31], a[240:243], v[80:83]
    ds_read_b64_tr_b16 a[58:59], v19 offset:18432
    v_cvt_pk_bf16_f32 v159, v126, v127
    v_mfma_f32_16x16x32_bf16 v[80:83], a[32:35], a[96:99], v[80:83]
    buffer_store_dwordx4 v[156:159], v28, s[16:19], s43 offen sc1
    v_mfma_f32_16x16x32_bf16 v[80:83], a[36:39], a[112:115], v[80:83]
    s_add_u32 s43, s43, 524288
    ds_read_b64_tr_b16 a[60:61], v19 offset:24576
    v_mfma_f32_16x16x32_bf16 v[80:83], a[40:43], a[128:131], v[80:83]
    ds_read_b64_tr_b16 a[62:63], v19 offset:26624
    v_mfma_f32_16x16x32_bf16 v[80:83], a[20:23], v[224:227], v[80:83]
    ds_read_b64_tr_b16 a[64:65], v19 offset:32768
    v_mfma_f32_16x16x32_bf16 v[80:83], a[44:47], a[140:143], v[80:83]
    ds_read_b64_tr_b16 a[66:67], v19 offset:34816
    v_mfma_f32_16x16x32_bf16 v[84:87], a[44:47], a[148:151], 0
    ds_read_b64_tr_b16 a[72:73], v20 offset:0
    v_mfma_f32_16x16x32_bf16 v[84:87], a[20:23], v[228:231], v[84:87]
    ds_read_b64_tr_b16 a[74:75], v20 offset:2048
    v_mfma_f32_16x16x32_bf16 v[84:87], a[40:43], a[144:147], v[84:87]
    ds_read_b64_tr_b16 a[76:77], v20 offset:8192
    v_mfma_f32_16x16x32_bf16 v[84:87], a[36:39], a[116:119], v[84:87]
    ds_read_b64_tr_b16 a[78:79], v20 offset:10240
    v_mfma_f32_16x16x32_bf16 v[84:87], a[32:35], a[100:103], v[84:87]
    ds_read_b64_tr_b16 a[80:81], v20 offset:16384
    v_mfma_f32_16x16x32_bf16 v[84:87], a[28:31], a[244:247], v[84:87]
    ds_read_b64_tr_b16 a[82:83], v20 offset:18432
    v_cvt_pk_bf16_f32 v144, v80, v81
    v_mfma_f32_16x16x32_bf16 v[84:87], a[24:27], a[228:231], v[84:87]
    ds_read_b64_tr_b16 a[84:85], v20 offset:24576
    v_cvt_pk_bf16_f32 v145, v82, v83
    v_mfma_f32_16x16x32_bf16 v[84:87], a[16:19], v[196:199], v[84:87]
    ds_read_b64_tr_b16 a[86:87], v20 offset:26624
    v_cvt_pk_bf16_f32 v220, v80, v81
    v_mfma_f32_16x16x32_bf16 v[84:87], a[12:15], v[164:167], v[84:87]
    ds_read_b64_tr_b16 a[88:89], v20 offset:32768
    v_cvt_pk_bf16_f32 v221, v82, v83
    v_mfma_f32_16x16x32_bf16 v[84:87], a[8:11], v[132:135], v[84:87]
    ds_read_b64_tr_b16 a[90:91], v20 offset:34816
    v_mfma_f32_16x16x32_bf16 v[84:87], a[4:7], v[100:103], v[84:87]
    s_addk_i32 s59, 0
    ds_read_b64_tr_b16 a[68:69], v19 offset:40960
    v_mfma_f32_16x16x32_bf16 v[84:87], a[0:3], v[68:71], v[84:87]
    buffer_load_dwordx4 a[192:195], v31, s[16:19], s59 offen offset:2048 sc1
    v_mfma_f32_16x16x32_bf16 v[88:91], a[0:3], v[72:75], 0
    ds_read_b64_tr_b16 a[70:71], v19 offset:43008
    v_mfma_f32_16x16x32_bf16 v[88:91], a[4:7], v[104:107], v[88:91]
    ds_read_b64_tr_b16 a[92:93], v20 offset:40960
    v_mfma_f32_16x16x32_bf16 v[88:91], a[8:11], v[136:139], v[88:91]
    ds_read_b64_tr_b16 a[94:95], v20 offset:43008
    v_mfma_f32_16x16x32_bf16 v[88:91], a[12:15], v[168:171], v[88:91]
    v_mfma_f32_16x16x32_bf16 v[88:91], a[16:19], v[200:203], v[88:91]
    v_mfma_f32_16x16x32_bf16 v[88:91], a[24:27], a[232:235], v[88:91]
    v_cvt_pk_bf16_f32 v148, v84, v85
    v_mfma_f32_16x16x32_bf16 v[88:91], a[28:31], a[248:251], v[88:91]
    v_cvt_pk_bf16_f32 v149, v86, v87
    v_mfma_f32_16x16x32_bf16 v[88:91], a[32:35], a[104:107], v[88:91]
    v_mfma_f32_16x16x32_bf16 v[88:91], a[36:39], a[120:123], v[88:91]
    v_mfma_f32_16x16x32_bf16 v[88:91], a[40:43], a[132:135], v[88:91]
    v_mfma_f32_16x16x32_bf16 v[88:91], a[20:23], v[232:235], v[88:91]
    v_mfma_f32_16x16x32_bf16 v[88:91], a[44:47], a[152:155], v[88:91]
    v_mfma_f32_16x16x32_bf16 v[92:95], a[44:47], a[156:159], 0
    v_mfma_f32_16x16x32_bf16 v[92:95], a[20:23], v[236:239], v[92:95]
    v_mfma_f32_16x16x32_bf16 v[92:95], a[40:43], a[136:139], v[92:95]
    v_mfma_f32_16x16x32_bf16 v[92:95], a[36:39], a[124:127], v[92:95]
    v_mfma_f32_16x16x32_bf16 v[92:95], a[32:35], a[108:111], v[92:95]
    s_nop 0
    v_mfma_f32_16x16x32_bf16 v[92:95], a[28:31], a[252:255], v[92:95]
    s_nop 0
    v_cvt_pk_bf16_f32 v152, v88, v89
    v_mfma_f32_16x16x32_bf16 v[92:95], a[24:27], a[236:239], v[92:95]
    v_cvt_pk_bf16_f32 v153, v90, v91
    v_mfma_f32_16x16x32_bf16 v[92:95], a[16:19], v[204:207], v[92:95]
    v_mfma_f32_16x16x32_bf16 v[92:95], a[12:15], v[172:175], v[92:95]
    v_mfma_f32_16x16x32_bf16 v[92:95], a[8:11], v[140:143], v[92:95]
    v_mfma_f32_16x16x32_bf16 v[92:95], a[4:7], v[108:111], v[92:95]
    s_waitcnt vmcnt(8) lgkmcnt(0)
    v_mfma_f32_16x16x32_bf16 v[92:95], a[0:3], v[76:79], v[92:95]
    s_barrier
    v_mfma_f32_16x16x32_bf16 v[112:115], a[48:51], v[64:67], 0
    ds_read_b64_tr_b16 a[0:1], v21 offset:0
    v_cmp_gt_u32 vcc, 1, v49
    v_mfma_f32_16x16x32_bf16 v[112:115], a[52:55], v[96:99], v[112:115]
    ds_read_b64_tr_b16 a[2:3], v21 offset:2048
    v_mfma_f32_16x16x32_bf16 v[112:115], a[56:59], v[128:131], v[112:115]
    s_and_b32 s55, vcc_lo, 0xfff
    ds_read_b64_tr_b16 a[4:5], v21 offset:8192
    s_cbranch_scc0 L_spF3r
    s_mov_b32 s41, 0
L_spF3b:
    buffer_load_dword v49, v48, s[16:19], s45 offen sc1
    s_add_u32 s41, s41, 1
    s_cmp_gt_u32 s41, 200000
    s_cbranch_scc1 L_spF3r
    s_waitcnt vmcnt(0)
    v_cmp_gt_u32 vcc, 1, v49
    s_nop 1
    s_and_b32 s55, vcc_lo, 0xfff
    s_cbranch_scc1 L_spF3b
L_spF3r:
    v_mfma_f32_16x16x32_bf16 v[112:115], a[60:63], v[160:163], v[112:115]
    s_add_u32 s59, s40, 1572864
    ds_read_b64_tr_b16 a[6:7], v21 offset:10240
    v_mfma_f32_16x16x32_bf16 v[112:115], a[64:67], v[192:195], v[112:115]
    buffer_load_dwordx4 a[196:199], v1, s[16:19], s59 offen offset:0 sc1
    v_mfma_f32_16x16x32_bf16 v[112:115], a[72:75], a[224:227], v[112:115]
    ds_read_b64_tr_b16 a[8:9], v21 offset:16384
    v_cvt_pk_bf16_f32 v156, v92, v93
    v_mfma_f32_16x16x32_bf16 v[112:115], a[76:79], a[240:243], v[112:115]
    ds_read_b64_tr_b16 a[10:11], v21 offset:18432
    v_cvt_pk_bf16_f32 v157, v94, v95
    v_mfma_f32_16x16x32_bf16 v[112:115], a[80:83], a[96:99], v[112:115]
    ds_read_b64_tr_b16 a[12:13], v21 offset:24576
    v_mfma_f32_16x16x32_bf16 v[112:115], a[84:87], a[112:115], v[112:115]
    ds_read_b64_tr_b16 a[14:15], v21 offset:26624
    v_mfma_f32_16x16x32_bf16 v[112:115], a[88:91], a[128:131], v[112:115]
    ds_read_b64_tr_b16 a[16:17], v21 offset:32768
    v_mfma_f32_16x16x32_bf16 v[112:115], a[68:71], v[224:227], v[112:115]
    ds_read_b64_tr_b16 a[18:19], v21 offset:34816
    v_mfma_f32_16x16x32_bf16 v[112:115], a[92:95], a[140:143], v[112:115]
    ds_read_b64_tr_b16 a[24:25], v22 offset:0
    v_mfma_f32_16x16x32_bf16 v[116:119], a[92:95], a[148:151], 0
    ds_read_b64_tr_b16 a[26:27], v22 offset:2048
    v_mfma_f32_16x16x32_bf16 v[116:119], a[68:71], v[228:231], v[116:119]
    ds_read_b64_tr_b16 a[28:29], v22 offset:8192
    v_mfma_f32_16x16x32_bf16 v[116:119], a[88:91], a[144:147], v[116:119]
    ds_read_b64_tr_b16 a[30:31], v22 offset:10240
    v_mfma_f32_16x16x32_bf16 v[116:119], a[84:87], a[116:119], v[116:119]
    ds_read_b64_tr_b16 a[32:33], v22 offset:16384
    v_mfma_f32_16x16x32_bf16 v[116:119], a[80:83], a[100:103], v[116:119]
    ds_read_b64_tr_b16 a[34:35], v22 offset:18432
    v_mfma_f32_16x16x32_bf16 v[116:119], a[76:79], a[244:247], v[116:119]
    ds_read_b64_tr_b16 a[36:37], v22 offset:24576
    v_cvt_pk_bf16_f32 v146, v112, v113
    v_mfma_f32_16x16x32_bf16 v[116:119], a[72:75], a[228:231], v[116:119]
    ds_read_b64_tr_b16 a[38:39], v22 offset:26624
    v_cvt_pk_bf16_f32 v147, v114, v115
    v_mfma_f32_16x16x32_bf16 v[116:119], a[64:67], v[196:199], v[116:119]
    buffer_store_dwordx4 v[144:147], v25, s[16:19], s43 offen sc1
    v_mfma_f32_16x16x32_bf16 v[116:119], a[60:63], v[164:167], v[116:119]
    ds_read_b64_tr_b16 a[40:41], v22 offset:32768
    v_cvt_pk_bf16_f32 v222, v112, v113
    v_mfma_f32_16x16x32_bf16 v[116:119], a[56:59], v[132:135], v[116:119]
    ds_read_b64_tr_b16 a[42:43], v22 offset:34816
    v_cvt_pk_bf16_f32 v223, v114, v115
    v_mfma_f32_16x16x32_bf16 v[116:119], a[52:55], v[100:103], v[116:119]
    ds_read_b64_tr_b16 a[20:21], v21 offset:40960
    v_mfma_f32_16x16x32_bf16 v[116:119], a[48:51], v[68:71], v[116:119]
    ds_read_b64_tr_b16 a[22:23], v21 offset:43008
    v_mfma_f32_16x16x32_bf16 v[120:123], a[48:51], v[72:75], 0
    s_addk_i32 s59, 0
    ds_read_b64_tr_b16 a[44:45], v22 offset:40960
    v_mfma_f32_16x16x32_bf16 v[120:123], a[52:55], v[104:107], v[120:123]
    buffer_load_dwordx4 a[200:203], v34, s[16:19], s59 offen offset:1024 sc1
    v_mfma_f32_16x16x32_bf16 v[120:123], a[56:59], v[136:139], v[120:123]
    ds_read_b64_tr_b16 a[46:47], v22 offset:43008
    v_mfma_f32_16x16x32_bf16 v[120:123], a[60:63], v[168:171], v[120:123]
    v_mfma_f32_16x16x32_bf16 v[120:123], a[64:67], v[200:203], v[120:123]
    v_mfma_f32_16x16x32_bf16 v[120:123], a[72:75], a[232:235], v[120:123]
    v_cvt_pk_bf16_f32 v150, v116, v117
    v_mfma_f32_16x16x32_bf16 v[120:123], a[76:79], a[248:251], v[120:123]
    v_cvt_pk_bf16_f32 v151, v118, v119
    v_mfma_f32_16x16x32_bf16 v[120:123], a[80:83], a[104:107], v[120:123]
    buffer_store_dwordx4 v[148:151], v26, s[16:19], s43 offen sc1
    v_mfma_f32_16x16x32_bf16 v[120:123], a[84:87], a[120:123], v[120:123]
    v_mfma_f32_16x16x32_bf16 v[120:123], a[88:91], a[132:135], v[120:123]
    v_mfma_f32_16x16x32_bf16 v[120:123], a[68:71], v[232:235], v[120:123]
    v_mfma_f32_16x16x32_bf16 v[120:123], a[92:95], a[152:155], v[120:123]
    v_mfma_f32_16x16x32_bf16 v[124:127], a[92:95], a[156:159], 0
    v_mfma_f32_16x16x32_bf16 v[124:127], a[68:71], v[236:239], v[124:127]
    v_mfma_f32_16x16x32_bf16 v[124:127], a[88:91], a[136:139], v[124:127]
    v_mfma_f32_16x16x32_bf16 v[124:127], a[84:87], a[124:127], v[124:127]
    v_mfma_f32_16x16x32_bf16 v[124:127], a[80:83], a[108:111], v[124:127]
    s_nop 0
    v_mfma_f32_16x16x32_bf16 v[124:127], a[76:79], a[252:255], v[124:127]
    s_nop 0
    v_cvt_pk_bf16_f32 v154, v120, v121
    v_mfma_f32_16x16x32_bf16 v[124:127], a[72:75], a[236:239], v[124:127]
    v_cvt_pk_bf16_f32 v155, v122, v123
    v_mfma_f32_16x16x32_bf16 v[124:127], a[64:67], v[204:207], v[124:127]
    buffer_store_dwordx4 v[152:155], v27, s[16:19], s43 offen sc1
    v_mfma_f32_16x16x32_bf16 v[124:127], a[60:63], v[172:175], v[124:127]
    v_mfma_f32_16x16x32_bf16 v[124:127], a[56:59], v[140:143], v[124:127]
    v_mfma_f32_16x16x32_bf16 v[124:127], a[52:55], v[108:111], v[124:127]
    s_waitcnt vmcnt(6) lgkmcnt(0)
    v_mfma_f32_16x16x32_bf16 v[124:127], a[48:51], v[76:79], v[124:127]
    s_barrier
    v_mfma_f32_16x16x32_bf16 v[80:83], a[0:3], v[64:67], 0
    s_add_u32 s59, s42, 4096
    ds_read_b64_tr_b16 a[48:49], v23 offset:0
    v_mfma_f32_16x16x32_bf16 v[80:83], a[4:7], v[96:99], v[80:83]
    buffer_store_dword v50, v47, s[16:19], s59 offen sc1
    v_mfma_f32_16x16x32_bf16 v[80:83], a[8:11], v[128:131], v[80:83]
    s_add_u32 s59, s40, 1572864
    ds_read_b64_tr_b16 a[50:51], v23 offset:2048
    v_mfma_f32_16x16x32_bf16 v[80:83], a[12:15], v[160:163], v[80:83]
    buffer_load_dwordx4 a[204:207], v31, s[16:19], s59 offen offset:2048 sc1
    v_mfma_f32_16x16x32_bf16 v[80:83], a[16:19], v[192:195], v[80:83]
    ds_read_b64_tr_b16 a[52:53], v23 offset:8192
    v_mfma_f32_16x16x32_bf16 v[80:83], a[24:27], a[224:227], v[80:83]
    ds_read_b64_tr_b16 a[54:55], v23 offset:10240
    v_cvt_pk_bf16_f32 v158, v124, v125
    v_mfma_f32_16x16x32_bf16 v[80:83], a[28:31], a[240:243], v[80:83]
    ds_read_b64_tr_b16 a[56:57], v23 offset:16384
    v_cvt_pk_bf16_f32 v159, v126, v127
    v_mfma_f32_16x16x32_bf16 v[80:83], a[32:35], a[96:99], v[80:83]
    buffer_store_dwordx4 v[156:159], v28, s[16:19], s43 offen sc1
    v_mfma_f32_16x16x32_bf16 v[80:83], a[36:39], a[112:115], v[80:83]
    s_add_u32 s43, s43, 2621440
    ds_read_b64_tr_b16 a[58:59], v23 offset:18432
    v_mfma_f32_16x16x32_bf16 v[80:83], a[40:43], a[128:131], v[80:83]
    ds_read_b64_tr_b16 a[60:61], v23 offset:24576
    v_mfma_f32_16x16x32_bf16 v[80:83], a[20:23], v[224:227], v[80:83]
    ds_read_b64_tr_b16 a[62:63], v23 offset:26624
    v_mfma_f32_16x16x32_bf16 v[80:83], a[44:47], a[140:143], v[80:83]
    ds_read_b64_tr_b16 a[64:65], v23 offset:32768
    v_mfma_f32_16x16x32_bf16 v[84:87], a[44:47], a[148:151], 0
    ds_read_b64_tr_b16 a[66:67], v23 offset:34816
    v_mfma_f32_16x16x32_bf16 v[84:87], a[20:23], v[228:231], v[84:87]
    ds_read_b64_tr_b16 a[72:73], v24 offset:0
    v_mfma_f32_16x16x32_bf16 v[84:87], a[40:43], a[144:147], v[84:87]
    ds_read_b64_tr_b16 a[74:75], v24 offset:2048
    v_mfma_f32_16x16x32_bf16 v[84:87], a[36:39], a[116:119], v[84:87]
    ds_read_b64_tr_b16 a[76:77], v24 offset:8192
    v_mfma_f32_16x16x32_bf16 v[84:87], a[32:35], a[100:103], v[84:87]
    ds_read_b64_tr_b16 a[78:79], v24 offset:10240
    v_mfma_f32_16x16x32_bf16 v[84:87], a[28:31], a[244:247], v[84:87]
    ds_read_b64_tr_b16 a[80:81], v24 offset:16384
    v_cvt_pk_bf16_f32 v144, v80, v81
    v_mfma_f32_16x16x32_bf16 v[84:87], a[24:27], a[228:231], v[84:87]
    ds_read_b64_tr_b16 a[82:83], v24 offset:18432
    v_cvt_pk_bf16_f32 v145, v82, v83
    v_mfma_f32_16x16x32_bf16 v[84:87], a[16:19], v[196:199], v[84:87]
    ds_read_b64_tr_b16 a[84:85], v24 offset:24576
    v_cvt_pk_bf16_f32 v240, v80, v81
    v_mfma_f32_16x16x32_bf16 v[84:87], a[12:15], v[164:167], v[84:87]
    ds_read_b64_tr_b16 a[86:87], v24 offset:26624
    v_cvt_pk_bf16_f32 v241, v82, v83
    v_mfma_f32_16x16x32_bf16 v[84:87], a[8:11], v[132:135], v[84:87]
    ds_read_b64_tr_b16 a[88:89], v24 offset:32768
    v_mfma_f32_16x16x32_bf16 v[84:87], a[4:7], v[100:103], v[84:87]
    ds_read_b64_tr_b16 a[90:91], v24 offset:34816
    v_mfma_f32_16x16x32_bf16 v[84:87], a[0:3], v[68:71], v[84:87]
    s_add_u32 s59, s40, 4194304
    ds_read_b64_tr_b16 a[68:69], v23 offset:40960
    v_mfma_f32_16x16x32_bf16 v[88:91], a[0:3], v[72:75], 0
    buffer_load_dwordx4 a[208:211], v1, s[16:19], s59 offen offset:0 sc1
    v_mfma_f32_16x16x32_bf16 v[88:91], a[4:7], v[104:107], v[88:91]
    ds_read_b64_tr_b16 a[70:71], v23 offset:43008
    v_mfma_f32_16x16x32_bf16 v[88:91], a[8:11], v[136:139], v[88:91]
    ds_read_b64_tr_b16 a[92:93], v24 offset:40960
    v_mfma_f32_16x16x32_bf16 v[88:91], a[12:15], v[168:171], v[88:91]
    ds_read_b64_tr_b16 a[94:95], v24 offset:43008
    v_mfma_f32_16x16x32_bf16 v[88:91], a[16:19], v[200:203], v[88:91]
    v_mfma_f32_16x16x32_bf16 v[88:91], a[24:27], a[232:235], v[88:91]
    v_cvt_pk_bf16_f32 v148, v84, v85
    v_mfma_f32_16x16x32_bf16 v[88:91], a[28:31], a[248:251], v[88:91]
    v_cvt_pk_bf16_f32 v149, v86, v87
    v_mfma_f32_16x16x32_bf16 v[88:91], a[32:35], a[104:107], v[88:91]
    v_mfma_f32_16x16x32_bf16 v[88:91], a[36:39], a[120:123], v[88:91]
    v_mfma_f32_16x16x32_bf16 v[88:91], a[40:43], a[132:135], v[88:91]
    v_mfma_f32_16x16x32_bf16 v[88:91], a[20:23], v[232:235], v[88:91]
    v_mfma_f32_16x16x32_bf16 v[88:91], a[44:47], a[152:155], v[88:91]
    v_mfma_f32_16x16x32_bf16 v[92:95], a[44:47], a[156:159], 0
    v_mfma_f32_16x16x32_bf16 v[92:95], a[20:23], v[236:239], v[92:95]
    v_mfma_f32_16x16x32_bf16 v[92:95], a[40:43], a[136:139], v[92:95]
    v_mfma_f32_16x16x32_bf16 v[92:95], a[36:39], a[124:127], v[92:95]
    v_mfma_f32_16x16x32_bf16 v[92:95], a[32:35], a[108:111], v[92:95]
    s_nop 0
    v_mfma_f32_16x16x32_bf16 v[92:95], a[28:31], a[252:255], v[92:95]
    s_nop 0
    v_cvt_pk_bf16_f32 v152, v88, v89
    v_mfma_f32_16x16x32_bf16 v[92:95], a[24:27], a[236:239], v[92:95]
    v_cvt_pk_bf16_f32 v153, v90, v91
    v_mfma_f32_16x16x32_bf16 v[92:95], a[16:19], v[204:207], v[92:95]
    v_mfma_f32_16x16x32_bf16 v[92:95], a[12:15], v[172:175], v[92:95]
    v_mfma_f32_16x16x32_bf16 v[92:95], a[8:11], v[140:143], v[92:95]
    v_mfma_f32_16x16x32_bf16 v[92:95], a[4:7], v[108:111], v[92:95]
    v_mfma_f32_16x16x32_bf16 v[92:95], a[0:3], v[76:79], v[92:95]
    s_waitcnt vmcnt(20) lgkmcnt(0)
    v_mfma_f32_16x16x32_bf16 v[112:115], a[48:51], v[64:67], 0
    v_mfma_f32_16x16x32_bf16 v[112:115], a[52:55], v[96:99], v[112:115]
    buffer_load_dwordx2 v[2:3], v46, s[24:27], 0 offen
    v_mfma_f32_16x16x32_bf16 v[112:115], a[56:59], v[128:131], v[112:115]
    v_mfma_f32_16x16x32_bf16 v[112:115], a[60:63], v[160:163], v[112:115]
    v_mfma_f32_16x16x32_bf16 v[112:115], a[64:67], v[192:195], v[112:115]
    v_mfma_f32_16x16x32_bf16 v[112:115], a[72:75], a[224:227], v[112:115]
    s_nop 0
    v_cvt_pk_bf16_f32 v156, v92, v93
    v_mfma_f32_16x16x32_bf16 v[112:115], a[76:79], a[240:243], v[112:115]
    v_cvt_pk_bf16_f32 v157, v94, v95
    v_mfma_f32_16x16x32_bf16 v[112:115], a[80:83], a[96:99], v[112:115]
    buffer_load_dwordx2 v[4:5], v35, s[24:27], 0 offen
    v_mfma_f32_16x16x32_bf16 v[112:115], a[84:87], a[112:115], v[112:115]
    v_mfma_f32_16x16x32_bf16 v[112:115], a[88:91], a[128:131], v[112:115]
    v_mfma_f32_16x16x32_bf16 v[112:115], a[68:71], v[224:227], v[112:115]
    v_mfma_f32_16x16x32_bf16 v[112:115], a[92:95], a[140:143], v[112:115]
    v_mfma_f32_16x16x32_bf16 v[116:119], a[92:95], a[148:151], 0
    v_mfma_f32_16x16x32_bf16 v[116:119], a[68:71], v[228:231], v[116:119]
    buffer_load_dwordx2 v[6:7], v32, s[24:27], 0 offen
    v_mfma_f32_16x16x32_bf16 v[116:119], a[88:91], a[144:147], v[116:119]
    v_mfma_f32_16x16x32_bf16 v[116:119], a[84:87], a[116:119], v[116:119]
    v_mfma_f32_16x16x32_bf16 v[116:119], a[80:83], a[100:103], v[116:119]
    v_mfma_f32_16x16x32_bf16 v[116:119], a[76:79], a[244:247], v[116:119]
    s_nop 0
    v_cvt_pk_bf16_f32 v146, v112, v113
    v_mfma_f32_16x16x32_bf16 v[116:119], a[72:75], a[228:231], v[116:119]
    v_cvt_pk_bf16_f32 v147, v114, v115
    v_mfma_f32_16x16x32_bf16 v[116:119], a[64:67], v[196:199], v[116:119]
    buffer_store_dwordx4 v[144:147], v25, s[16:19], s43 offen sc1
    v_mfma_f32_16x16x32_bf16 v[116:119], a[60:63], v[164:167], v[116:119]
    buffer_load_dwordx2 v[8:9], v36, s[24:27], 0 offen
    v_mfma_f32_16x16x32_bf16 v[116:119], a[56:59], v[132:135], v[116:119]
    v_cvt_pk_bf16_f32 v242, v112, v113
    v_cvt_pk_bf16_f32 v243, v114, v115
L_stubF9:
    s_cbranch_execz L_jrF2
    s_nop 0
    v_mfma_f32_16x16x32_bf16 v[116:119], a[52:55], v[100:103], v[116:119]
    v_mfma_f32_16x16x32_bf16 v[116:119], a[48:51], v[68:71], v[116:119]
    v_mfma_f32_16x16x32_bf16 v[120:123], a[48:51], v[72:75], 0
    v_mfma_f32_16x16x32_bf16 v[120:123], a[52:55], v[104:107], v[120:123]
    v_mfma_f32_16x16x32_bf16 v[120:123], a[56:59], v[136:139], v[120:123]
    buffer_load_dwordx2 v[10:11], v37, s[24:27], 0 offen
    v_mfma_f32_16x16x32_bf16 v[120:123], a[60:63], v[168:171], v[120:123]
    v_mfma_f32_16x16x32_bf16 v[120:123], a[64:67], v[200:203], v[120:123]
    v_mfma_f32_16x16x32_bf16 v[120:123], a[72:75], a[232:235], v[120:123]
    s_nop 0
    v_cvt_pk_bf16_f32 v150, v116, v117
    v_mfma_f32_16x16x32_bf16 v[120:123], a[76:79], a[248:251], v[120:123]
    v_cvt_pk_bf16_f32 v151, v118, v119
    v_mfma_f32_16x16x32_bf16 v[120:123], a[80:83], a[104:107], v[120:123]
    buffer_store_dwordx4 v[148:151], v26, s[16:19], s43 offen sc1
    v_mfma_f32_16x16x32_bf16 v[120:123], a[84:87], a[120:123], v[120:123]
    s_addk_i32 s59, 0
    v_mfma_f32_16x16x32_bf16 v[120:123], a[88:91], a[132:135], v[120:123]
    buffer_load_dwordx4 a[212:215], v34, s[16:19], s59 offen offset:1024 sc1
    v_mfma_f32_16x16x32_bf16 v[120:123], a[68:71], v[232:235], v[120:123]
    v_mfma_f32_16x16x32_bf16 v[120:123], a[92:95], a[152:155], v[120:123]
    v_mfma_f32_16x16x32_bf16 v[124:127], a[92:95], a[156:159], 0
    v_mfma_f32_16x16x32_bf16 v[124:127], a[68:71], v[236:239], v[124:127]
    v_mfma_f32_16x16x32_bf16 v[124:127], a[88:91], a[136:139], v[124:127]
    s_addk_i32 s59, 0
    v_mfma_f32_16x16x32_bf16 v[124:127], a[84:87], a[124:127], v[124:127]
    buffer_load_dwordx4 a[216:219], v31, s[16:19], s59 offen offset:2048 sc1
    v_mfma_f32_16x16x32_bf16 v[124:127], a[80:83], a[108:111], v[124:127]
    v_mfma_f32_16x16x32_bf16 v[124:127], a[76:79], a[252:255], v[124:127]
    v_cvt_pk_bf16_f32 v154, v120, v121
    v_mfma_f32_16x16x32_bf16 v[124:127], a[72:75], a[236:239], v[124:127]
    v_cvt_pk_bf16_f32 v155, v122, v123
    v_mfma_f32_16x16x32_bf16 v[124:127], a[64:67], v[204:207], v[124:127]
    buffer_store_dwordx4 v[152:155], v27, s[16:19], s43 offen sc1
    v_mfma_f32_16x16x32_bf16 v[124:127], a[60:63], v[172:175], v[124:127]
    v_mfma_f32_16x16x32_bf16 v[124:127], a[56:59], v[140:143], v[124:127]
    v_mfma_f32_16x16x32_bf16 v[124:127], a[52:55], v[108:111], v[124:127]
    v_mfma_f32_16x16x32_bf16 v[124:127], a[48:51], v[76:79], v[124:127]
    s_nop 7
    v_cvt_pk_bf16_f32 v158, v124, v125
    v_cvt_pk_bf16_f32 v159, v126, v127
    buffer_store_dwordx4 v[156:159], v28, s[16:19], s43 offen sc1
    s_add_u32 s45, s42, 4096
    buffer_load_dword v49, v48, s[16:19], s45 offen sc1
    s_branch L_tailF
L_tailF:
L_stubF10:
    s_cbranch_execz L_jrF2
    s_nop 0
    v_lshrrev_b32 v100, 4, v0
    v_xor_b32 v100, s48, v100
    v_and_b32 v100, 1, v100
    v_cmp_eq_u32 vcc, 1, v100
    v_mov_b32 v100, 0
    v_mov_b32 v101, 0
    v_cndmask_b32 v102, v56, v58, vcc
    v_cndmask_b32 v103, v57, v59, vcc
    v_cndmask_b32 v96, v56, v60, vcc
    v_cndmask_b32 v97, v57, v61, vcc
    v_cndmask_b32 v98, v58, v62, vcc
    v_cndmask_b32 v99, v59, v63, vcc
    s_lshr_b32 s55, s52, 3
    s_xor_b32 s55, s55, s53
    s_cbranch_scc1 L_noown
    s_lshl_b32 s55, s54, 10
    v_add_u32 v76, s55, v44
    ds_write_b128 v76, v[176:179] offset:16384
    ds_write_b128 v76, v[180:183] offset:18432
    ds_write_b128 v76, v[184:187] offset:20480
    ds_write_b128 v76, v[188:191] offset:22528
    ds_write_b128 v76, v[208:211] offset:24576
    ds_write_b128 v76, v[212:215] offset:26624
    ds_write_b128 v76, v[216:219] offset:28672
    ds_write_b128 v76, v[220:223] offset:30720
    ds_write_b128 v76, v[240:243] offset:32768
L_noown:
    v_lshrrev_b32 v77, 4, v0
    v_bfe_u32 v78, v0, 3, 1
    v_and_b32 v79, 7, v0
    v_lshlrev_b32 v78, 10, v78
    v_lshl_add_u32 v78, v79, 4, v78
    s_and_b32 s55, s52, 1
    s_lshl1_add_u32 s55, s48, s55
    s_lshl_b32 s55, s55, 7
    v_add_u32 v78, s55, v78
    v_lshl_add_u32 v76, v77, 11, v78
    v_and_b32 v77, 1, v77
    v_cmp_eq_u32 vcc, 1, v77
    v_cmp_gt_u32 s[64:65], 32, v0
    s_nop 0
    v_cndmask_b32 v108, v56, v60, vcc
    v_cndmask_b32 v109, v57, v61, vcc
    v_cndmask_b32 v110, v58, v62, vcc
    v_cndmask_b32 v111, v59, v63, vcc
    v_cndmask_b32 v104, 0, v108, s[64:65]
    v_cndmask_b32 v105, 0, v109, s[64:65]
    v_cndmask_b32 v106, 0, v110, s[64:65]
    v_cndmask_b32 v107, 0, v111, s[64:65]
    v_xor_b32 v108, v108, v104
    v_xor_b32 v109, v109, v105
    v_xor_b32 v110, v110, v106
    v_xor_b32 v111, v111, v107
    v_and_b32 v64, 7, v0
    v_mul_u32_u24 v64, 144, v64
    v_bfe_u32 v65, v0, 3, 1
    v_lshl_add_u32 v64, v65, 6, v64
    v_bfe_u32 v65, v0, 4, 1
    v_lshl_add_u32 v64, v65, 5, v64
    v_lshrrev_b32 v65, 5, v0
    v_mul_u32_u24 v65, 1152, v65
    s_lshl_b32 s55, s48, 3
    v_add3_u32 v53, v64, v65, s55
    v_lshrrev_b32 v64, 3, v0
    v_lshlrev_b32 v65, 4, v64
    s_mul_i32 s55, s48, 1152
    v_add3_u32 v54, v65, v44, s55
    v_readfirstlane_b32 s56, v45
    v_mul_u32_u24 v64, 2176, v64
    s_lshl_b32 s55, s48, 7
    s_add_u32 s55, s55, s3
    v_add3_u32 v55, v64, v44, s56
    s_add_u32 s70, s55, 128
    s_sub_u32 s67, s70, 1152
    s_min_u32 s70, s70, s67
    s_add_u32 s71, s55, 640
    s_sub_u32 s67, s71, 1152
    s_min_u32 s71, s71, s67
    s_cmp_lt_u32 s48, 2
    s_cselect_b32 s71, s71, 0x40000000
    s_add_u32 s72, s55, 896
    s_sub_u32 s67, s72, 1152
    s_min_u32 s72, s72, s67
    s_cmp_lt_u32 s48, 3
    s_cselect_b32 s72, s72, 0x40000000
    s_waitcnt vmcnt(1) lgkmcnt(0)
    s_barrier
    s_add_u32 s59, s42, 6144
    buffer_store_dword v50, v47, s[16:19], s59 offen sc1
    ds_read_b128 v[80:83], v76 offset:16384
    ds_read_b128 v[84:87], v76 offset:24576
    ds_read_b128 v[88:91], v78 offset:32768
    s_waitcnt vmcnt(1)
    s_mov_b32 s41, 0
    s_branch L_siF4c
L_siF4b:
    buffer_load_dword v49, v48, s[16:19], s45 offen sc1
    s_add_u32 s41, s41, 1
    s_cmp_gt_u32 s41, 200000
    s_cbranch_scc1 L_siF4r
    s_waitcnt vmcnt(0)
L_siF4c:
    v_cmp_gt_u32 vcc, 1, v49
    s_nop 1
    s_and_b32 s55, vcc_lo, 0xfff
    s_cbranch_scc1 L_siF4b
L_siF4r:
    s_add_u32 s59, s40, 4718592
    buffer_load_dwordx4 a[0:3], v1, s[16:19], s59 offen offset:0 sc1
    s_addk_i32 s59, 0
    buffer_load_dwordx4 a[4:7], v34, s[16:19], s59 offen offset:1024 sc1
    s_addk_i32 s59, 0
    buffer_load_dwordx4 a[8:11], v31, s[16:19], s59 offen offset:2048 sc1
    s_add_u32 s59, s40, 5242880
    buffer_load_dwordx4 a[12:15], v1, s[16:19], s59 offen offset:0 sc1
    s_addk_i32 s59, 0
    buffer_load_dwordx4 a[16:19], v34, s[16:19], s59 offen offset:1024 sc1
    s_addk_i32 s59, 0
    buffer_load_dwordx4 a[20:23], v31, s[16:19], s59 offen offset:2048 sc1
    s_mov_b32 s41, 0
    s_branch L_siF5c
L_siF5b:
    buffer_load_dword v49, v48, s[16:19], s45 offen sc1
    s_add_u32 s41, s41, 1
    s_cmp_gt_u32 s41, 200000
    s_cbranch_scc1 L_siF5r
    s_waitcnt vmcnt(0)
L_siF5c:
    v_cmp_gt_u32 vcc, 1, v49
    s_nop 1
    s_and_b32 s55, vcc_lo, 0xf000
    s_cbranch_scc1 L_siF5b
L_siF5r:
    s_add_u32 s59, s40, 0
    buffer_load_dwordx4 a[24:27], v44, s[16:19], s59 offen offset:3072 sc1
    s_add_u32 s59, s40, 1048576
    buffer_load_dwordx4 a[28:31], v44, s[16:19], s59 offen offset:3072 sc1
    s_add_u32 s59, s40, 4194304
    buffer_load_dwordx4 a[32:35], v44, s[16:19], s59 offen offset:3072 sc1
    s_add_u32 s59, s40, 5242880
    buffer_load_dwordx4 a[36:39], v44, s[16:19], s59 offen offset:3072 sc1
    s_add_u32 s59, s40, 8388608
    buffer_load_dwordx4 a[40:43], v44, s[16:19], s59 offen offset:3072 sc1
    s_add_u32 s45, s42, 6144
    buffer_load_dword v49, v48, s[16:19], s45 offen sc1
    s_waitcnt lgkmcnt(0)
    v_mfma_f32_16x16x32_bf16 v[192:195], v[104:107], v[80:83], 0
    v_mfma_f32_16x16x32_bf16 v[196:199], v[108:111], v[80:83], 0
    v_mfma_f32_16x16x32_bf16 v[200:203], v[104:107], v[84:87], 0
    v_mfma_f32_16x16x32_bf16 v[204:207], v[108:111], v[84:87], 0
    v_mfma_f32_16x16x32_bf16 v[224:227], v[104:107], v[88:91], 0
    v_mfma_f32_16x16x32_bf16 v[192:195], v[56:59], a[160:163], v[192:195]
    v_lshlrev_b32 v128, 16, v2
    v_and_b32 v129, s83, v2
    v_mfma_f32_16x16x32_bf16 v[192:195], v[56:59], a[164:167], v[192:195]
    v_lshlrev_b32 v130, 16, v3
    v_and_b32 v131, s83, v3
    v_mfma_f32_16x16x32_bf16 v[192:195], v[56:59], a[168:171], v[192:195]
    v_lshlrev_b32 v132, 16, v4
    v_and_b32 v133, s83, v4
    v_mfma_f32_16x16x32_bf16 v[192:195], v[60:63], a[172:175], v[192:195]
    v_lshlrev_b32 v134, 16, v5
    v_and_b32 v135, s83, v5
    v_mfma_f32_16x16x32_bf16 v[192:195], v[60:63], a[176:179], v[192:195]
    v_lshlrev_b32 v136, 16, v6
    v_and_b32 v137, s83, v6
    v_mfma_f32_16x16x32_bf16 v[192:195], v[60:63], a[180:183], v[192:195]
    v_lshlrev_b32 v138, 16, v7
    v_and_b32 v139, s83, v7
    v_mfma_f32_16x16x32_bf16 v[196:199], v[56:59], a[184:187], v[196:199]
    v_lshlrev_b32 v140, 16, v8
    v_and_b32 v141, s83, v8
    v_mfma_f32_16x16x32_bf16 v[196:199], v[56:59], a[188:191], v[196:199]
    v_lshlrev_b32 v142, 16, v9
    v_and_b32 v143, s83, v9
    v_mfma_f32_16x16x32_bf16 v[196:199], v[56:59], a[192:195], v[196:199]
    v_lshlrev_b32 v168, 16, v10
    v_and_b32 v169, s83, v10
    v_mfma_f32_16x16x32_bf16 v[196:199], v[60:63], a[196:199], v[196:199]
    v_lshlrev_b32 v170, 16, v11
    v_and_b32 v171, s83, v11
    v_mfma_f32_16x16x32_bf16 v[196:199], v[60:63], a[200:203], v[196:199]
    v_sub_f32 v52, 1.0, v51
    v_mul_f32 v128, v128, v52
    v_mfma_f32_16x16x32_bf16 v[196:199], v[60:63], a[204:207], v[196:199]
    v_mul_f32 v129, v129, v52
    v_mul_f32 v130, v130, v52
    v_mfma_f32_16x16x32_bf16 v[200:203], v[56:59], a[208:211], v[200:203]
    v_mul_f32 v131, v131, v52
    v_mul_f32 v132, v132, v52
    v_mfma_f32_16x16x32_bf16 v[200:203], v[56:59], a[212:215], v[200:203]
    v_mul_f32 v133, v133, v52
    v_mul_f32 v134, v134, v52
    v_mfma_f32_16x16x32_bf16 v[200:203], v[56:59], a[216:219], v[200:203]
    v_mul_f32 v135, v135, v52
    v_mul_f32 v136, v136, v52
    v_mul_f32 v137, v137, v52
    v_mul_f32 v138, v138, v52
    v_mul_f32 v139, v139, v52
    v_mul_f32 v140, v140, v52
    v_mul_f32 v141, v141, v52
    v_mul_f32 v142, v142, v52
    v_mul_f32 v143, v143, v52
    v_mul_f32 v168, v168, v52
    v_mul_f32 v169, v169, v52
    v_mul_f32 v170, v170, v52
    v_mul_f32 v171, v171, v52
    s_waitcnt vmcnt(11)
    v_mfma_f32_16x16x32_bf16 v[200:203], v[60:63], a[0:3], v[200:203]
    s_waitcnt vmcnt(10)
    v_mfma_f32_16x16x32_bf16 v[200:203], v[60:63], a[4:7], v[200:203]
    s_waitcnt vmcnt(9)
    v_mfma_f32_16x16x32_bf16 v[200:203], v[60:63], a[8:11], v[200:203]
    s_waitcnt vmcnt(8)
    v_mfma_f32_16x16x32_bf16 v[204:207], v[56:59], a[12:15], v[204:207]
    s_waitcnt vmcnt(7)
    v_mfma_f32_16x16x32_bf16 v[204:207], v[56:59], a[16:19], v[204:207]
    s_waitcnt vmcnt(6)
    v_mfma_f32_16x16x32_bf16 v[204:207], v[56:59], a[20:23], v[204:207]
    s_waitcnt vmcnt(5)
    v_mfma_f32_16x16x32_bf16 v[228:231], v[96:99], a[24:27], 0
    s_waitcnt vmcnt(4)
    v_mfma_f32_16x16x32_bf16 v[232:235], v[96:99], a[28:31], 0
L_stubF11:
    s_cbranch_execz L_jrF2
    s_nop 0
    s_waitcnt vmcnt(0)
    s_mov_b32 s41, 0
    s_branch L_siF6c
L_siF6b:
    buffer_load_dword v49, v48, s[16:19], s45 offen sc1
    s_add_u32 s41, s41, 1
    s_cmp_gt_u32 s41, 200000
    s_cbranch_scc1 L_siF6r
    s_waitcnt vmcnt(0)
L_siF6c:
    v_cmp_gt_u32 vcc, 1, v49
    s_nop 1
    s_and_b32 s55, vcc_lo, 0xfff
    s_cbranch_scc1 L_siF6b
L_siF6r:
    s_add_u32 s59, s40, 5767168
    buffer_load_dwordx4 a[44:47], v1, s[16:19], s59 offen offset:0 sc1
    s_addk_i32 s59, 0
    buffer_load_dwordx4 a[48:51], v34, s[16:19], s59 offen offset:1024 sc1
    s_addk_i32 s59, 0
    buffer_load_dwordx4 a[52:55], v31, s[16:19], s59 offen offset:2048 sc1
    s_add_u32 s59, s40, 8388608
    buffer_load_dwordx4 a[56:59], v1, s[16:19], s59 offen offset:0 sc1
    s_addk_i32 s59, 0
    buffer_load_dwordx4 a[60:63], v34, s[16:19], s59 offen offset:1024 sc1
    s_addk_i32 s59, 0
    buffer_load_dwordx4 a[64:67], v31, s[16:19], s59 offen offset:2048 sc1
    v_mfma_f32_16x16x32_bf16 v[236:239], v[96:99], a[32:35], 0
    v_mfma_f32_16x16x32_bf16 v[160:163], v[96:99], a[36:39], 0
    v_mfma_f32_16x16x32_bf16 v[164:167], v[100:103], a[40:43], 0
    v_fmac_f32 v128, v192, v52
    v_fmac_f32 v129, v193, v52
    v_fmac_f32 v130, v194, v52
    v_fmac_f32 v131, v195, v52
    v_fmac_f32 v128, v228, v51
    v_fmac_f32 v129, v229, v51
    v_fmac_f32 v130, v230, v51
    v_fmac_f32 v131, v231, v51
    v_cvt_pk_bf16_f32 v128, v128, v129
    v_cvt_pk_bf16_f32 v129, v130, v131
    ds_write_b64 v53, v[128:129] offset:0
    v_fmac_f32 v132, v196, v52
    v_fmac_f32 v133, v197, v52
    v_fmac_f32 v134, v198, v52
    v_fmac_f32 v135, v199, v52
    v_fmac_f32 v132, v232, v51
    v_fmac_f32 v133, v233, v51
    v_fmac_f32 v134, v234, v51
    v_fmac_f32 v135, v235, v51
    v_cvt_pk_bf16_f32 v132, v132, v133
    v_cvt_pk_bf16_f32 v133, v134, v135
    ds_write_b64 v53, v[132:133] offset:2304
    v_fmac_f32 v136, v200, v52
    v_fmac_f32 v137, v201, v52
    v_fmac_f32 v138, v202, v52
    v_fmac_f32 v139, v203, v52
    v_fmac_f32 v136, v236, v51
    v_fmac_f32 v137, v237, v51
    v_fmac_f32 v138, v238, v51
    v_fmac_f32 v139, v239, v51
    v_cvt_pk_bf16_f32 v136, v136, v137
    v_cvt_pk_bf16_f32 v137, v138, v139
    ds_write_b64 v53, v[136:137] offset:4608
    s_waitcnt lgkmcnt(0)
    s_barrier
    ds_read_b128 v[64:67], v54 offset:0
    ds_read_b128 v[68:71], v54 offset:4608
    s_waitcnt lgkmcnt(1)
    buffer_store_dwordx4 v[64:67], v55, s[32:35], s70 offen sc1
    s_waitcnt lgkmcnt(0)
    buffer_store_dwordx4 v[68:71], v55, s[32:35], s71 offen sc1
    s_waitcnt vmcnt(5)
    v_mfma_f32_16x16x32_bf16 v[204:207], v[60:63], a[44:47], v[204:207]
    v_mfma_f32_16x16x32_bf16 v[204:207], v[60:63], a[48:51], v[204:207]
    v_mfma_f32_16x16x32_bf16 v[204:207], v[60:63], a[52:55], v[204:207]
    s_waitcnt vmcnt(2)
    v_mfma_f32_16x16x32_bf16 v[224:227], v[56:59], a[56:59], v[224:227]
    v_mfma_f32_16x16x32_bf16 v[224:227], v[56:59], a[60:63], v[224:227]
    v_mfma_f32_16x16x32_bf16 v[224:227], v[56:59], a[64:67], v[224:227]
    s_nop 3
    v_fmac_f32 v140, v204, v52
    v_fmac_f32 v141, v205, v52
    v_fmac_f32 v142, v206, v52
    v_fmac_f32 v143, v207, v52
    v_fmac_f32 v140, v160, v51
    v_fmac_f32 v141, v161, v51
    v_fmac_f32 v142, v162, v51
    v_fmac_f32 v143, v163, v51
    v_cvt_pk_bf16_f32 v140, v140, v141
    v_cvt_pk_bf16_f32 v141, v142, v143
    ds_write_b64 v53, v[140:141] offset:6912
    v_fmac_f32 v168, v224, v52
    v_fmac_f32 v169, v225, v52
    v_fmac_f32 v170, v226, v52
    v_fmac_f32 v171, v227, v52
    v_fmac_f32 v168, v164, v51
    v_fmac_f32 v169, v165, v51
    v_fmac_f32 v170, v166, v51
    v_fmac_f32 v171, v167, v51
    v_cvt_pk_bf16_f32 v168, v168, v169
    v_cvt_pk_bf16_f32 v169, v170, v171
    ds_write_b64 v53, v[168:169] offset:9216
    s_waitcnt lgkmcnt(0)
    s_barrier
    ds_read_b128 v[72:75], v54 offset:6912
    s_waitcnt lgkmcnt(0)
    buffer_store_dwordx4 v[72:75], v55, s[32:35], s72 offen sc1
    s_endpgm
.p2align 12
L_splitA:
L_stubA1:
    s_cbranch_execz L_jrAs
    s_nop 0
    s_mov_b32 s14, 663552
    s_mov_b32 s15, 0x20000
    s_mov_b32 s18, 134217728
    s_mov_b32 s19, 0x20000
    s_mov_b32 s26, 1152
    s_mov_b32 s27, 0x20000
    s_mov_b32 s30, 256
    s_mov_b32 s31, 0x20000
    s_mov_b32 s34, 2359296
    s_mov_b32 s35, 0x20000
    s_mov_b32 s38, 1152
    s_mov_b32 s39, 0x20000
    s_addk_i32 m0, 1024
    s_nop 0
    buffer_load_dwordx4 v7, s[8:11], s47 offen lds
    v_lshrrev_b32 v32, 2, v0
    s_mul_i32 s55, s48, 72
    v_mul_u32_u24 v32, 864, v32
    s_add_u32 s47, s47, s68
    s_addk_i32 m0, 21760
    s_nop 0
    buffer_load_dwordx4 v1, s[8:11], s47 offen lds
    v_add_u32 v32, s55, v32
    v_and_b32 v33, 3, v0
    v_lshl_add_u32 v13, v33, 3, v32
    s_addk_i32 m0, 1024
    s_nop 0
    buffer_load_dwordx4 v2, s[8:11], s47 offen lds
    v_add_u32 v14, 55808, v13
    v_add_u32 v34, 1, v33
    v_cmp_eq_u32 vcc, 2, v33
    s_addk_i32 m0, 1024
    s_nop 0
    buffer_load_dwordx4 v3, s[8:11], s47 offen lds
    v_cndmask_b32 v34, v34, 0, vcc
    v_mul_u32_u24 v34, 288, v34
    v_add3_u32 v15, v32, v34, 32
    s_addk_i32 m0, 1024
    s_nop 0
    buffer_load_dwordx4 v4, s[8:11], s47 offen lds
    v_add_u32 v16, 13824, v15
    v_mov_b32 v34, 27648
    v_cmp_eq_u32 vcc, 3, v33
    s_addk_i32 m0, 1024
    s_nop 0
    buffer_load_dwordx4 v5, s[8:11], s47 offen lds
    v_cndmask_b32 v15, v15, v34, vcc
    v_cndmask_b32 v16, v16, v34, vcc
    v_add_u32 v17, 55808, v15
    s_addk_i32 m0, 1024
    s_nop 0
    buffer_load_dwordx4 v6, s[8:11], s47 offen lds
    v_add_u32 v18, 55808, v16
    v_and_b32 v32, 15, v0
    v_bfe_u32 v33, v0, 1, 3
    s_addk_i32 m0, 1024
    s_nop 0
    buffer_load_dwordx4 v7, s[8:11], s47 offen lds
    v_lshrrev_b32 v34, 4, v0
    v_xor_b32 v33, v33, v34
    v_lshlrev_b32 v33, 4, v33
    s_add_u32 s46, s46, 128
    s_sub_u32 s67, s46, 768
    s_min_u32 s46, s46, s67
    s_add_u32 m0, s60, 18432
    s_nop 0
    buffer_load_dwordx4 v8, s[4:7], s46 offen lds
    v_lshl_add_u32 v32, v32, 7, v33
    s_lshl_b32 s55, s66, 6
    v_xor_b32 v32, s55, v32
    s_addk_i32 m0, 1024
    s_nop 0
    buffer_load_dwordx4 v9, s[4:7], s46 offen lds
    v_add_u32 v19, 111616, v32
    v_xor_b32 v32, 64, v32
    v_add_u32 v20, 111616, v32
    s_addk_i32 m0, 1024
    s_nop 0
    buffer_load_dwordx4 v10, s[4:7], s46 offen lds
    s_waitcnt vmcnt(10)
    s_barrier
    ds_read_b128 a[56:59], v19 offset:0
    ds_read_b128 a[60:63], v19 offset:2048
    ds_read_b128 a[64:67], v19 offset:4096
    ds_read_b128 a[68:71], v19 offset:6144
    ds_read_b128 a[72:75], v19 offset:8192
    ds_read_b128 a[76:79], v19 offset:10240
    ds_read_b128 a[80:83], v19 offset:12288
    ds_read_b128 a[84:87], v19 offset:14336
    ds_read_b128 a[88:91], v19 offset:16384
    ds_read_b64_tr_b16 a[0:1], v13 offset:0
    ds_read_b64_tr_b16 a[2:3], v13 offset:13824
    ds_read_b64_tr_b16 a[4:5], v13 offset:40
    ds_read_b64_tr_b16 a[6:7], v13 offset:13864
    ds_read_b64_tr_b16 a[8:9], v13 offset:288
    ds_read_b64_tr_b16 a[10:11], v13 offset:14112
    ds_read_b64_tr_b16 a[12:13], v13 offset:328
    ds_read_b64_tr_b16 a[14:15], v13 offset:14152
    ds_read_b64_tr_b16 a[16:17], v13 offset:576
    ds_read_b64_tr_b16 a[18:19], v13 offset:14400
    ds_read_b64_tr_b16 a[20:21], v13 offset:616
    ds_read_b64_tr_b16 a[22:23], v13 offset:14440
    ds_read_b64_tr_b16 a[24:25], v15 offset:0
    ds_read_b64_tr_b16 a[26:27], v16 offset:0
    s_waitcnt lgkmcnt(0)
    v_mfma_f32_16x16x32_bf16 v[32:35], a[0:3], a[56:59], 0
    s_addk_i32 m0, 1024
    s_mul_i32 s55, s48, 2304
    v_mfma_f32_16x16x32_bf16 v[40:43], a[0:3], a[60:63], 0
    buffer_load_dwordx4 v11, s[4:7], s46 offen lds
    v_mfma_f32_16x16x32_bf16 v[48:51], a[0:3], a[64:67], 0
    s_add_u32 s55, s55, 148480
    v_mfma_f32_16x16x32_bf16 v[56:59], a[0:3], a[68:71], 0
    v_lshl_add_u32 v21, v0, 4, s55
    v_mov_b32 v22, 0x3f80
    v_mfma_f32_16x16x32_bf16 v[64:67], a[0:3], a[72:75], 0
    ds_write2_b32 v21, v22, v22 offset0:1 offset1:3
    v_mfma_f32_16x16x32_bf16 v[72:75], a[0:3], a[76:79], 0
    s_add_u32 m0, s61, 18432
    v_add_u32 v21, 1024, v21
    v_mfma_f32_16x16x32_bf16 v[80:83], a[0:3], a[80:83], 0
    buffer_load_dwordx4 v12, s[4:7], s46 offen lds
    v_mfma_f32_16x16x32_bf16 v[88:91], a[0:3], a[84:87], 0
    ds_write2_b32 v21, v22, v22 offset0:1 offset1:3
    v_mfma_f32_16x16x32_bf16 v[92:95], a[4:7], a[84:87], 0
    v_add_u32 v21, 256, v21
    v_mfma_f32_16x16x32_bf16 v[84:87], a[4:7], a[80:83], 0
    s_add_u32 s47, s47, s69
    s_sub_u32 s67, s47, 1327104
    s_min_u32 s47, s47, s67
    v_mfma_f32_16x16x32_bf16 v[76:79], a[4:7], a[76:79], 0
    s_add_u32 m0, s58, 55808
    v_mfma_f32_16x16x32_bf16 v[68:71], a[4:7], a[72:75], 0
    buffer_load_dwordx4 v1, s[8:11], s47 offen lds
    v_mfma_f32_16x16x32_bf16 v[60:63], a[4:7], a[68:71], 0
    ds_write2_b32 v21, v22, v22 offset0:1 offset1:3
    v_mfma_f32_16x16x32_bf16 v[52:55], a[4:7], a[64:67], 0
    v_and_b32 v22, 15, v0
    v_lshrrev_b32 v21, 4, v0
    v_mfma_f32_16x16x32_bf16 v[44:47], a[4:7], a[60:63], 0
    v_cmp_eq_u32 vcc, 1, v21
    v_mov_b32 v21, s55
    v_mfma_f32_16x16x32_bf16 v[36:39], a[4:7], a[56:59], 0
    s_addk_i32 m0, 1024
    v_mov_b32 v23, 157696
    v_cndmask_b32 v21, v23, v21, vcc
    v_mfma_f32_16x16x32_bf16 a[128:131], a[8:11], a[88:91], 0
    buffer_load_dwordx4 v2, s[8:11], s47 offen lds
    v_mfma_f32_16x16x32_bf16 v[96:99], a[8:11], a[56:59], 0
    v_lshl_add_u32 v21, v22, 4, v21
    v_accvgpr_write_b32 a206, v21
    v_mfma_f32_16x16x32_bf16 v[108:111], a[8:11], a[60:63], 0
    v_lshrrev_b32 v23, 2, v0
    v_lshl_add_u32 v23, v23, 4, s55
    v_mfma_f32_16x16x32_bf16 v[120:123], a[8:11], a[64:67], 0
    v_accvgpr_write_b32 a207, v23
    v_mfma_f32_16x16x32_bf16 v[132:135], a[8:11], a[68:71], 0
    s_addk_i32 m0, 1024
    s_lshl_b32 s55, s48, 13
    v_mfma_f32_16x16x32_bf16 v[144:147], a[8:11], a[72:75], 0
    buffer_load_dwordx4 v3, s[8:11], s47 offen lds
    v_mfma_f32_16x16x32_bf16 v[156:159], a[8:11], a[76:79], 0
    s_add_u32 s55, s55, 111616
    v_mfma_f32_16x16x32_bf16 v[168:171], a[8:11], a[80:83], 0
    s_waitcnt vmcnt(8)
    v_lshl_add_u32 v24, v0, 4, s55
    v_accvgpr_write_b32 a208, v24
    v_mfma_f32_16x16x32_bf16 v[180:183], a[8:11], a[84:87], 0
    s_barrier
    ds_read_b128 a[92:95], v20 offset:0
    s_lshl_b32 s55, s48, 8
    v_mfma_f32_16x16x32_bf16 v[188:191], a[12:15], a[84:87], 0
    s_addk_i32 m0, 1024
    ds_read_b128 a[96:99], v20 offset:2048
    s_add_u32 s55, s55, 144384
    v_mfma_f32_16x16x32_bf16 v[176:179], a[12:15], a[80:83], 0
    buffer_load_dwordx4 v4, s[8:11], s47 offen lds
    v_mfma_f32_16x16x32_bf16 v[164:167], a[12:15], a[76:79], 0
    ds_read_b128 a[100:103], v20 offset:4096
    v_lshl_add_u32 v25, v22, 4, s55
    v_mfma_f32_16x16x32_bf16 v[152:155], a[12:15], a[72:75], 0
    ds_read_b128 a[104:107], v20 offset:6144
    v_accvgpr_write_b32 a209, v25
    v_mfma_f32_16x16x32_bf16 v[140:143], a[12:15], a[68:71], 0
    ds_read_b128 a[108:111], v20 offset:8192
    v_lshrrev_b32 v26, 4, v0
    v_mfma_f32_16x16x32_bf16 v[128:131], a[12:15], a[64:67], 0
    ds_read_b128 a[112:115], v20 offset:10240
    v_lshlrev_b32 v26, 2, v26
    v_mfma_f32_16x16x32_bf16 v[116:119], a[12:15], a[60:63], 0
    s_addk_i32 m0, 1024
    ds_read_b128 a[116:119], v20 offset:12288
    v_sub_u32 v26, v22, v26
    v_mfma_f32_16x16x32_bf16 v[104:107], a[12:15], a[56:59], 0
    buffer_load_dwordx4 v5, s[8:11], s47 offen lds
    v_mfma_f32_16x16x32_bf16 a[136:139], a[12:15], a[88:91], 0
    ds_read_b128 a[120:123], v20 offset:14336
    v_mov_b32 v22, 0xf149f2ca
    v_mfma_f32_16x16x32_bf16 a[140:143], a[88:91], a[16:19], 0
    s_cmp_eq_u32 s50, 0
    s_cselect_b32 s55, 0xf149f2ca, 0
    ds_read_b128 a[124:127], v20 offset:16384
    v_mfma_f32_16x16x32_bf16 v[192:195], a[56:59], a[16:19], 0
    ds_read_b64_tr_b16 a[28:29], v13 offset:27904
    v_mov_b32 v28, 0
    v_mfma_f32_16x16x32_bf16 v[208:211], a[60:63], a[16:19], 0
    s_addk_i32 m0, 1024
    ds_read_b64_tr_b16 a[30:31], v13 offset:41728
    v_mov_b32 v29, 0
    v_mfma_f32_16x16x32_bf16 v[196:199], a[64:67], a[16:19], 0
    buffer_load_dwordx4 v6, s[8:11], s47 offen lds
    v_mfma_f32_16x16x32_bf16 v[212:215], a[68:71], a[16:19], 0
    ds_read_b64_tr_b16 a[32:33], v13 offset:27944
    v_mov_b32 v30, s55
    v_mfma_f32_16x16x32_bf16 v[200:203], a[72:75], a[16:19], 0
    ds_read_b64_tr_b16 a[34:35], v13 offset:41768
    v_cmp_gt_u32 vcc, 32, v0
    v_mfma_f32_16x16x32_bf16 v[216:219], a[76:79], a[16:19], 0
    ds_read_b64_tr_b16 a[36:37], v13 offset:28192
    v_cndmask_b32 v31, v22, v30, vcc
    v_mfma_f32_16x16x32_bf16 v[204:207], a[80:83], a[16:19], 0
    s_addk_i32 m0, 1024
    ds_read_b64_tr_b16 a[38:39], v13 offset:42016
    v_subrev_u32 v21, 0, v26
    v_mfma_f32_16x16x32_bf16 v[220:223], a[84:87], a[16:19], 0
    buffer_load_dwordx4 v7, s[8:11], s47 offen lds
    v_mfma_f32_16x16x32_bf16 v[252:255], a[84:87], a[20:23], 0
    ds_read_b64_tr_b16 a[40:41], v13 offset:28232
    v_mov_b32 v23, 0xffff
    v_mfma_f32_16x16x32_bf16 v[236:239], a[80:83], a[20:23], 0
    ds_read_b64_tr_b16 a[42:43], v13 offset:42056
    v_cmp_gt_u32 s[64:65], 8, v21
    v_mfma_f32_16x16x32_bf16 v[248:251], a[76:79], a[20:23], 0
    s_add_u32 s47, s47, s68
    ds_read_b64_tr_b16 a[44:45], v13 offset:28480
    v_cmp_ge_i32 s[20:21], -9, v21
    v_mfma_f32_16x16x32_bf16 v[232:235], a[72:75], a[20:23], 0
    s_addk_i32 m0, 21760
    ds_read_b64_tr_b16 a[46:47], v13 offset:42304
    v_cmp_gt_i32 vcc, 0, v21
    v_mfma_f32_16x16x32_bf16 v[244:247], a[68:71], a[20:23], 0
    buffer_load_dwordx4 v1, s[8:11], s47 offen lds
    v_mfma_f32_16x16x32_bf16 v[228:231], a[64:67], a[20:23], 0
    ds_read_b64_tr_b16 a[48:49], v13 offset:28520
    v_cndmask_b32 v21, v22, 0, s[64:65]
    v_mfma_f32_16x16x32_bf16 v[240:243], a[60:63], a[20:23], 0
    ds_read_b64_tr_b16 a[50:51], v13 offset:42344
    v_accvgpr_write_b32 a188, v21
    v_mfma_f32_16x16x32_bf16 v[224:227], a[56:59], a[20:23], 0
    ds_read_b64_tr_b16 a[52:53], v15 offset:27904
    v_cndmask_b32 v24, v22, 0, s[20:21]
    v_mfma_f32_16x16x32_bf16 a[144:147], a[88:91], a[20:23], 0
    s_addk_i32 m0, 1024
    ds_read_b64_tr_b16 a[54:55], v16 offset:27904
    v_accvgpr_write_b32 a192, v24
    v_mfma_f32_16x16x32_bf16 a[132:135], a[24:27], a[88:91], 0
    buffer_load_dwordx4 v2, s[8:11], s47 offen lds
    v_mfma_f32_16x16x32_bf16 v[100:103], a[24:27], a[56:59], 0
    v_cndmask_b32 v25, v22, v30, s[20:21]
    v_accvgpr_write_b32 a196, v25
    v_mfma_f32_16x16x32_bf16 v[112:115], a[24:27], a[60:63], 0
    v_cndmask_b32 v21, v22, v31, vcc
    v_accvgpr_write_b32 a200, v21
    v_mfma_f32_16x16x32_bf16 v[124:127], a[24:27], a[64:67], 0
    v_cndmask_b32 v23, v23, 0, vcc
    v_or_b32 v28, v28, v23
    v_mfma_f32_16x16x32_bf16 v[136:139], a[24:27], a[68:71], 0
    v_subrev_u32 v23, 1, v26
    v_mov_b32 v24, 0xffff0000
    v_mfma_f32_16x16x32_bf16 v[148:151], a[24:27], a[72:75], 0
    v_cmp_gt_u32 s[64:65], 8, v23
    v_cmp_ge_i32 s[20:21], -9, v23
    v_mfma_f32_16x16x32_bf16 v[160:163], a[24:27], a[76:79], 0
    v_cmp_gt_i32 vcc, 0, v23
    s_nop 1
    v_cndmask_b32 v23, v22, 0, s[64:65]
    v_mfma_f32_16x16x32_bf16 v[172:175], a[24:27], a[80:83], 0
    s_waitcnt lgkmcnt(0)
    v_mfma_f32_16x16x32_bf16 v[184:187], a[24:27], a[84:87], 0
    s_barrier
    v_mfma_f32_16x16x32_bf16 v[32:35], a[28:31], a[92:95], v[32:35]
    s_add_u32 s46, s46, 128
    s_sub_u32 s67, s46, 768
    s_min_u32 s46, s46, s67
    v_mfma_f32_16x16x32_bf16 v[40:43], a[28:31], a[96:99], v[40:43]
    s_add_u32 m0, s60, 0
    v_accvgpr_write_b32 a189, v23
    v_cndmask_b32 v25, v22, 0, s[20:21]
    v_mfma_f32_16x16x32_bf16 v[48:51], a[28:31], a[100:103], v[48:51]
    buffer_load_dwordx4 v8, s[4:7], s46 offen lds
    v_mfma_f32_16x16x32_bf16 v[56:59], a[28:31], a[104:107], v[56:59]
    v_accvgpr_write_b32 a193, v25
    v_cndmask_b32 v21, v22, v30, s[20:21]
    v_mfma_f32_16x16x32_bf16 v[64:67], a[28:31], a[108:111], v[64:67]
    v_accvgpr_write_b32 a197, v21
    v_cndmask_b32 v23, v22, v31, vcc
    v_mfma_f32_16x16x32_bf16 v[72:75], a[28:31], a[112:115], v[72:75]
    s_addk_i32 m0, 1024
    v_accvgpr_write_b32 a201, v23
    v_cndmask_b32 v24, v24, 0, vcc
    v_mfma_f32_16x16x32_bf16 v[80:83], a[28:31], a[116:119], v[80:83]
    buffer_load_dwordx4 v9, s[4:7], s46 offen lds
    v_mfma_f32_16x16x32_bf16 v[88:91], a[28:31], a[120:123], v[88:91]
    v_or_b32 v28, v28, v24
    v_accvgpr_write_b32 a204, v28
    v_mfma_f32_16x16x32_bf16 v[92:95], a[32:35], a[120:123], v[92:95]
    v_subrev_u32 v24, 2, v26
    v_mov_b32 v25, 0xffff
    v_mfma_f32_16x16x32_bf16 v[84:87], a[32:35], a[116:119], v[84:87]
    v_cmp_gt_u32 s[64:65], 8, v24
    v_cmp_ge_i32 s[20:21], -9, v24
    v_mfma_f32_16x16x32_bf16 v[76:79], a[32:35], a[112:115], v[76:79]
    s_addk_i32 m0, 1024
    v_cmp_gt_i32 vcc, 0, v24
    s_nop 1
    v_cndmask_b32 v24, v22, 0, s[64:65]
    v_mfma_f32_16x16x32_bf16 v[68:71], a[32:35], a[108:111], v[68:71]
    buffer_load_dwordx4 v10, s[4:7], s46 offen lds
    v_mfma_f32_16x16x32_bf16 v[60:63], a[32:35], a[104:107], v[60:63]
    v_accvgpr_write_b32 a190, v24
    v_cndmask_b32 v21, v22, 0, s[20:21]
    v_mfma_f32_16x16x32_bf16 v[52:55], a[32:35], a[100:103], v[52:55]
    v_accvgpr_write_b32 a194, v21
    v_cndmask_b32 v23, v22, v30, s[20:21]
    v_mfma_f32_16x16x32_bf16 v[44:47], a[32:35], a[96:99], v[44:47]
    v_accvgpr_write_b32 a198, v23
    v_cndmask_b32 v28, v22, v31, vcc
    v_mfma_f32_16x16x32_bf16 v[36:39], a[32:35], a[92:95], v[36:39]
    s_addk_i32 m0, 1024
    v_accvgpr_write_b32 a202, v28
    v_cndmask_b32 v25, v25, 0, vcc
    v_mfma_f32_16x16x32_bf16 a[128:131], a[36:39], a[124:127], a[128:131]
    buffer_load_dwordx4 v11, s[4:7], s46 offen lds
    v_mfma_f32_16x16x32_bf16 v[96:99], a[36:39], a[92:95], v[96:99]
    v_or_b32 v29, v29, v25
    v_subrev_u32 v26, 3, v26
    v_mfma_f32_16x16x32_bf16 v[108:111], a[36:39], a[96:99], v[108:111]
    v_mov_b32 v25, 0xffff0000
    v_cmp_gt_u32 s[64:65], 8, v26
    v_mfma_f32_16x16x32_bf16 v[120:123], a[36:39], a[100:103], v[120:123]
    v_cmp_ge_i32 s[20:21], -9, v26
    v_cmp_gt_i32 vcc, 0, v26
    v_mfma_f32_16x16x32_bf16 v[132:135], a[36:39], a[104:107], v[132:135]
    s_add_u32 m0, s61, 0
    v_cndmask_b32 v26, v22, 0, s[64:65]
    v_accvgpr_write_b32 a191, v26
    v_mfma_f32_16x16x32_bf16 v[144:147], a[36:39], a[108:111], v[144:147]
    buffer_load_dwordx4 v12, s[4:7], s46 offen lds
    v_mfma_f32_16x16x32_bf16 v[156:159], a[36:39], a[112:115], v[156:159]
    v_cndmask_b32 v24, v22, 0, s[20:21]
    v_accvgpr_write_b32 a195, v24
    v_mfma_f32_16x16x32_bf16 v[168:171], a[36:39], a[116:119], v[168:171]
    s_waitcnt vmcnt(7)
    v_cndmask_b32 v30, v22, v30, s[20:21]
    v_accvgpr_write_b32 a199, v30
    v_mfma_f32_16x16x32_bf16 v[180:183], a[36:39], a[120:123], v[180:183]
    s_barrier
    ds_read_b128 a[56:59], v19 offset:18432
    v_cndmask_b32 v31, v22, v31, vcc
    v_mfma_f32_16x16x32_bf16 v[188:191], a[40:43], a[120:123], v[188:191]
    s_add_u32 m0, s58, 85760
    ds_read_b128 a[60:63], v19 offset:20480
    v_accvgpr_write_b32 a203, v31
    v_mfma_f32_16x16x32_bf16 v[176:179], a[40:43], a[116:119], v[176:179]
    buffer_load_dwordx4 v3, s[8:11], s47 offen lds
    v_mfma_f32_16x16x32_bf16 v[164:167], a[40:43], a[112:115], v[164:167]
    ds_read_b128 a[64:67], v19 offset:22528
    v_cndmask_b32 v25, v25, 0, vcc
    v_mfma_f32_16x16x32_bf16 v[152:155], a[40:43], a[108:111], v[152:155]
    ds_read_b128 a[68:71], v19 offset:24576
    v_or_b32 v29, v29, v25
    v_mfma_f32_16x16x32_bf16 v[140:143], a[40:43], a[104:107], v[140:143]
    ds_read_b128 a[72:75], v19 offset:26624
    v_accvgpr_write_b32 a205, v29
    v_mfma_f32_16x16x32_bf16 v[128:131], a[40:43], a[100:103], v[128:131]
    s_lshl2_add_u32 s55, s50, s51
    ds_read_b128 a[76:79], v19 offset:28672
    v_mfma_f32_16x16x32_bf16 v[116:119], a[40:43], a[96:99], v[116:119]
    s_addk_i32 m0, 1024
    ds_read_b128 a[80:83], v19 offset:30720
    s_and_b32 s56, s49, 1
    v_mfma_f32_16x16x32_bf16 v[104:107], a[40:43], a[92:95], v[104:107]
    buffer_load_dwordx4 v4, s[8:11], s47 offen lds
    v_mfma_f32_16x16x32_bf16 a[136:139], a[40:43], a[124:127], a[136:139]
    s_lshl1_add_u32 s55, s55, s56
    ds_read_b128 a[84:87], v19 offset:32768
    v_mfma_f32_16x16x32_bf16 a[140:143], a[124:127], a[44:47], a[140:143]
    s_lshr_b32 s56, s49, 1
    ds_read_b128 a[88:91], v19 offset:34816
    v_mfma_f32_16x16x32_bf16 v[192:195], a[92:95], a[44:47], v[192:195]
    s_lshl4_add_u32 s55, s55, s56
    ds_read_b64_tr_b16 a[0:1], v14 offset:0
    v_mfma_f32_16x16x32_bf16 v[208:211], a[96:99], a[44:47], v[208:211]
    s_addk_i32 m0, 1024
    ds_read_b64_tr_b16 a[2:3], v14 offset:13824
    v_and_b32 v25, 7, v0
    v_mfma_f32_16x16x32_bf16 v[196:199], a[100:103], a[44:47], v[196:199]
    buffer_load_dwordx4 v5, s[8:11], s47 offen lds
    v_mfma_f32_16x16x32_bf16 v[212:215], a[104:107], a[44:47], v[212:215]
    ds_read_b64_tr_b16 a[4:5], v14 offset:40
    v_lshlrev_b32 v22, 2, v25
    v_mfma_f32_16x16x32_bf16 v[200:203], a[108:111], a[44:47], v[200:203]
    ds_read_b64_tr_b16 a[6:7], v14 offset:13864
    v_lshl_add_u32 v25, v25, 1, s55
    v_mfma_f32_16x16x32_bf16 v[216:219], a[112:115], a[44:47], v[216:219]
    ds_read_b64_tr_b16 a[8:9], v14 offset:288
    v_mul_u32_u24 v25, 1152, v25
    v_mfma_f32_16x16x32_bf16 v[204:207], a[116:119], a[44:47], v[204:207]
    s_addk_i32 m0, 1024
    ds_read_b64_tr_b16 a[10:11], v14 offset:14112
    v_accvgpr_write_b32 a218, v25
    v_mfma_f32_16x16x32_bf16 v[220:223], a[120:123], a[44:47], v[220:223]
    buffer_load_dwordx4 v6, s[8:11], s47 offen lds
    v_mfma_f32_16x16x32_bf16 v[252:255], a[120:123], a[48:51], v[252:255]
    ds_read_b64_tr_b16 a[12:13], v14 offset:328
    v_lshrrev_b32 v21, 5, v0
    v_mfma_f32_16x16x32_bf16 v[236:239], a[116:119], a[48:51], v[236:239]
    ds_read_b64_tr_b16 a[14:15], v14 offset:14152
    v_lshlrev_b32 v21, 7, v21
    v_mfma_f32_16x16x32_bf16 v[248:251], a[112:115], a[48:51], v[248:251]
    ds_read_b64_tr_b16 a[16:17], v14 offset:576
    v_bfe_u32 v23, v0, 3, 1
    v_mfma_f32_16x16x32_bf16 v[232:235], a[108:111], a[48:51], v[232:235]
    s_addk_i32 m0, 1024
    ds_read_b64_tr_b16 a[18:19], v14 offset:14400
    v_lshl_add_u32 v21, v23, 6, v21
    v_mfma_f32_16x16x32_bf16 v[244:247], a[104:107], a[48:51], v[244:247]
    buffer_load_dwordx4 v7, s[8:11], s47 offen lds
    v_mfma_f32_16x16x32_bf16 v[228:231], a[100:103], a[48:51], v[228:231]
    ds_read_b64_tr_b16 a[20:21], v14 offset:616
    v_bfe_u32 v23, v0, 4, 1
    v_mfma_f32_16x16x32_bf16 v[240:243], a[96:99], a[48:51], v[240:243]
    ds_read_b64_tr_b16 a[22:23], v14 offset:14440
    v_lshl_add_u32 v21, v23, 5, v21
    v_mfma_f32_16x16x32_bf16 v[224:227], a[92:95], a[48:51], v[224:227]
    s_add_u32 s47, s47, s69
    s_sub_u32 s67, s47, 1327104
    s_min_u32 s47, s47, s67
    v_mfma_f32_16x16x32_bf16 a[144:147], a[124:127], a[48:51], a[144:147]
    s_add_u32 m0, s58, 0
    ds_read_b64_tr_b16 a[24:25], v17 offset:0
    s_lshl_b32 s56, s48, 3
    v_mfma_f32_16x16x32_bf16 a[132:135], a[52:55], a[124:127], a[132:135]
    buffer_load_dwordx4 v1, s[8:11], s47 offen lds
    v_mfma_f32_16x16x32_bf16 v[100:103], a[52:55], a[92:95], v[100:103]
    s_add_u32 s56, s56, s3
    ds_read_b64_tr_b16 a[26:27], v18 offset:0
    v_mfma_f32_16x16x32_bf16 v[112:115], a[52:55], a[96:99], v[112:115]
    v_add_u32 v21, s56, v21
    v_subrev_u32 v23, 1152, v21
    v_mfma_f32_16x16x32_bf16 v[124:127], a[52:55], a[100:103], v[124:127]
    v_min_u32 v23, v21, v23
    v_add_u32 v21, 256, v23
    v_mfma_f32_16x16x32_bf16 v[136:139], a[52:55], a[104:107], v[136:139]
    v_subrev_u32 v28, 1152, v21
    v_min_u32 v28, v21, v28
    v_mfma_f32_16x16x32_bf16 v[148:151], a[52:55], a[108:111], v[148:151]
    v_add_u32 v21, 256, v28
    v_subrev_u32 v26, 1152, v21
    v_mfma_f32_16x16x32_bf16 v[160:163], a[52:55], a[112:115], v[160:163]
    v_min_u32 v26, v21, v26
    v_add_u32 v21, 256, v26
    v_mfma_f32_16x16x32_bf16 v[172:175], a[52:55], a[116:119], v[172:175]
    s_waitcnt lgkmcnt(0)
    v_mfma_f32_16x16x32_bf16 v[184:187], a[52:55], a[120:123], v[184:187]
    s_barrier
    v_mfma_f32_16x16x32_bf16 v[32:35], a[0:3], a[56:59], v[32:35]
    s_addk_i32 m0, 1024
    v_subrev_u32 v24, 1152, v21
    v_min_u32 v24, v21, v24
    v_mfma_f32_16x16x32_bf16 v[40:43], a[0:3], a[60:63], v[40:43]
    buffer_load_dwordx4 v2, s[8:11], s47 offen lds
    v_mfma_f32_16x16x32_bf16 v[48:51], a[0:3], a[64:67], v[48:51]
    v_add_u32 v21, 256, v24
    v_subrev_u32 v30, 1152, v21
    v_mfma_f32_16x16x32_bf16 v[56:59], a[0:3], a[68:71], v[56:59]
    v_min_u32 v30, v21, v30
    v_mfma_f32_16x16x32_bf16 v[64:67], a[0:3], a[72:75], v[64:67]
    s_lshl2_add_u32 s55, s48, s55
    v_mfma_f32_16x16x32_bf16 v[72:75], a[0:3], a[76:79], v[72:75]
    s_addk_i32 m0, 1024
    v_lshrrev_b32 v21, 5, v0
    v_lshl_add_u32 v21, v21, 1, s55
    v_mfma_f32_16x16x32_bf16 v[80:83], a[0:3], a[80:83], v[80:83]
    buffer_load_dwordx4 v3, s[8:11], s47 offen lds
    v_mfma_f32_16x16x32_bf16 v[88:91], a[0:3], a[84:87], v[88:91]
    v_mul_u32_u24 v21, 1152, v21
    v_and_b32 v31, 31, v0
    v_mfma_f32_16x16x32_bf16 v[92:95], a[4:7], a[84:87], v[92:95]
    v_mul_u32_u24 v31, 12, v31
    v_add_u32 v21, v21, v31
    v_mfma_f32_16x16x32_bf16 v[84:87], a[4:7], a[80:83], v[84:87]
    buffer_load_dwordx3 a[148:150], v21, s[4:7], 0 offen offset:0
    v_mfma_f32_16x16x32_bf16 v[76:79], a[4:7], a[76:79], v[76:79]
    s_addk_i32 m0, 1024
    v_mfma_f32_16x16x32_bf16 v[68:71], a[4:7], a[72:75], v[68:71]
    buffer_load_dwordx4 v4, s[8:11], s47 offen lds
    v_mfma_f32_16x16x32_bf16 v[60:63], a[4:7], a[68:71], v[60:63]
    buffer_load_dwordx3 a[152:154], v21, s[4:7], 0 offen offset:384
    v_mfma_f32_16x16x32_bf16 v[52:55], a[4:7], a[64:67], v[52:55]
    buffer_load_dwordx3 a[156:158], v21, s[4:7], 0 offen offset:768
    v_mfma_f32_16x16x32_bf16 v[44:47], a[4:7], a[60:63], v[44:47]
    buffer_load_dwordx3 a[160:162], v31, s[36:39], 0 offen offset:0
    v_mfma_f32_16x16x32_bf16 v[36:39], a[4:7], a[56:59], v[36:39]
    s_addk_i32 m0, 1024
    v_mfma_f32_16x16x32_bf16 a[128:131], a[8:11], a[88:91], a[128:131]
    buffer_load_dwordx4 v5, s[8:11], s47 offen lds
    v_mfma_f32_16x16x32_bf16 v[96:99], a[8:11], a[56:59], v[96:99]
    buffer_load_dwordx3 a[164:166], v31, s[36:39], 0 offen offset:384
    v_mfma_f32_16x16x32_bf16 v[108:111], a[8:11], a[60:63], v[108:111]
    buffer_load_dwordx3 a[168:170], v31, s[36:39], 0 offen offset:768
    v_mfma_f32_16x16x32_bf16 v[120:123], a[8:11], a[64:67], v[120:123]
    buffer_load_dwordx2 a[238:239], v23, s[24:27], 0 offen
    v_mfma_f32_16x16x32_bf16 v[132:135], a[8:11], a[68:71], v[132:135]
    s_addk_i32 m0, 1024
    v_mfma_f32_16x16x32_bf16 v[144:147], a[8:11], a[72:75], v[144:147]
    buffer_load_dwordx4 v6, s[8:11], s47 offen lds
    v_mfma_f32_16x16x32_bf16 v[156:159], a[8:11], a[76:79], v[156:159]
    buffer_load_dwordx2 a[240:241], v28, s[24:27], 0 offen
    v_mfma_f32_16x16x32_bf16 v[168:171], a[8:11], a[80:83], v[168:171]
    s_waitcnt vmcnt(14)
    v_mfma_f32_16x16x32_bf16 v[180:183], a[8:11], a[84:87], v[180:183]
    s_barrier
    ds_read_b128 a[92:95], v20 offset:18432
    v_mfma_f32_16x16x32_bf16 v[188:191], a[12:15], a[84:87], v[188:191]
    s_addk_i32 m0, 1024
    ds_read_b128 a[96:99], v20 offset:20480
    v_mfma_f32_16x16x32_bf16 v[176:179], a[12:15], a[80:83], v[176:179]
    buffer_load_dwordx4 v7, s[8:11], s47 offen lds
    v_mfma_f32_16x16x32_bf16 v[164:167], a[12:15], a[76:79], v[164:167]
    ds_read_b128 a[100:103], v20 offset:22528
    v_mfma_f32_16x16x32_bf16 v[152:155], a[12:15], a[72:75], v[152:155]
    ds_read_b128 a[104:107], v20 offset:24576
    v_mfma_f32_16x16x32_bf16 v[140:143], a[12:15], a[68:71], v[140:143]
    ds_read_b128 a[108:111], v20 offset:26624
    v_mfma_f32_16x16x32_bf16 v[128:131], a[12:15], a[64:67], v[128:131]
    s_add_u32 s47, s47, s68
    ds_read_b128 a[112:115], v20 offset:28672
    v_mfma_f32_16x16x32_bf16 v[116:119], a[12:15], a[60:63], v[116:119]
    s_addk_i32 m0, 21760
    ds_read_b128 a[116:119], v20 offset:30720
    v_mfma_f32_16x16x32_bf16 v[104:107], a[12:15], a[56:59], v[104:107]
    buffer_load_dwordx4 v1, s[8:11], s47 offen lds
    v_mfma_f32_16x16x32_bf16 a[136:139], a[12:15], a[88:91], a[136:139]
    ds_read_b128 a[120:123], v20 offset:32768
    v_mfma_f32_16x16x32_bf16 a[140:143], a[88:91], a[16:19], a[140:143]
    ds_read_b128 a[124:127], v20 offset:34816
    v_mfma_f32_16x16x32_bf16 v[192:195], a[56:59], a[16:19], v[192:195]
    ds_read_b64_tr_b16 a[28:29], v14 offset:27904
    v_mfma_f32_16x16x32_bf16 v[208:211], a[60:63], a[16:19], v[208:211]
    s_addk_i32 m0, 1024
    ds_read_b64_tr_b16 a[30:31], v14 offset:41728
    v_mfma_f32_16x16x32_bf16 v[196:199], a[64:67], a[16:19], v[196:199]
    buffer_load_dwordx4 v2, s[8:11], s47 offen lds
    v_mfma_f32_16x16x32_bf16 v[212:215], a[68:71], a[16:19], v[212:215]
    ds_read_b64_tr_b16 a[32:33], v14 offset:27944
    v_mfma_f32_16x16x32_bf16 v[200:203], a[72:75], a[16:19], v[200:203]
    ds_read_b64_tr_b16 a[34:35], v14 offset:41768
    v_mfma_f32_16x16x32_bf16 v[216:219], a[76:79], a[16:19], v[216:219]
    ds_read_b64_tr_b16 a[36:37], v14 offset:28192
    v_mfma_f32_16x16x32_bf16 v[204:207], a[80:83], a[16:19], v[204:207]
    s_addk_i32 m0, 1024
    ds_read_b64_tr_b16 a[38:39], v14 offset:42016
    v_mfma_f32_16x16x32_bf16 v[220:223], a[84:87], a[16:19], v[220:223]
    buffer_load_dwordx4 v3, s[8:11], s47 offen lds
    v_mfma_f32_16x16x32_bf16 v[252:255], a[84:87], a[20:23], v[252:255]
    ds_read_b64_tr_b16 a[40:41], v14 offset:28232
    v_mfma_f32_16x16x32_bf16 v[236:239], a[80:83], a[20:23], v[236:239]
    ds_read_b64_tr_b16 a[42:43], v14 offset:42056
    v_mfma_f32_16x16x32_bf16 v[248:251], a[76:79], a[20:23], v[248:251]
    ds_read_b64_tr_b16 a[44:45], v14 offset:28480
    v_mfma_f32_16x16x32_bf16 v[232:235], a[72:75], a[20:23], v[232:235]
    s_addk_i32 m0, 1024
    ds_read_b64_tr_b16 a[46:47], v14 offset:42304
    v_mfma_f32_16x16x32_bf16 v[244:247], a[68:71], a[20:23], v[244:247]
    buffer_load_dwordx4 v4, s[8:11], s47 offen lds
    v_mfma_f32_16x16x32_bf16 v[228:231], a[64:67], a[20:23], v[228:231]
    ds_read_b64_tr_b16 a[48:49], v14 offset:28520
    v_mfma_f32_16x16x32_bf16 v[240:243], a[60:63], a[20:23], v[240:243]
    ds_read_b64_tr_b16 a[50:51], v14 offset:42344
    v_mfma_f32_16x16x32_bf16 v[224:227], a[56:59], a[20:23], v[224:227]
    ds_read_b64_tr_b16 a[52:53], v17 offset:27904
    v_mfma_f32_16x16x32_bf16 a[144:147], a[88:91], a[20:23], a[144:147]
L_stubA2:
    s_cbranch_execz L_jrAs
    s_nop 0
    s_addk_i32 m0, 1024
    ds_read_b64_tr_b16 a[54:55], v18 offset:27904
    v_mfma_f32_16x16x32_bf16 a[132:135], a[24:27], a[88:91], a[132:135]
    buffer_load_dwordx4 v5, s[8:11], s47 offen lds
    v_mfma_f32_16x16x32_bf16 v[100:103], a[24:27], a[56:59], v[100:103]
    buffer_load_dwordx2 a[242:243], v26, s[24:27], 0 offen
    v_mfma_f32_16x16x32_bf16 v[112:115], a[24:27], a[60:63], v[112:115]
    buffer_load_dwordx2 a[244:245], v24, s[24:27], 0 offen
    v_mfma_f32_16x16x32_bf16 v[124:127], a[24:27], a[64:67], v[124:127]
    buffer_load_dwordx2 a[246:247], v30, s[24:27], 0 offen
    v_mfma_f32_16x16x32_bf16 v[136:139], a[24:27], a[68:71], v[136:139]
    s_lshl_b32 s55, s54, 1
    v_mfma_f32_16x16x32_bf16 v[148:151], a[24:27], a[72:75], v[148:151]
    v_bfe_u32 v30, v0, 3, 2
    v_xor_b32 v30, s55, v30
    v_mfma_f32_16x16x32_bf16 v[160:163], a[24:27], a[76:79], v[160:163]
    v_lshlrev_b32 v30, 5, v30
    v_and_b32 v24, 3, v0
    v_mfma_f32_16x16x32_bf16 v[172:175], a[24:27], a[80:83], v[172:175]
    s_waitcnt lgkmcnt(0)
    v_mfma_f32_16x16x32_bf16 v[184:187], a[24:27], a[84:87], v[184:187]
    s_barrier
    v_mfma_f32_16x16x32_bf16 v[32:35], a[28:31], a[92:95], v[32:35]
    s_add_u32 s46, s46, 128
    s_sub_u32 s67, s46, 768
    s_min_u32 s46, s46, s67
    v_mfma_f32_16x16x32_bf16 v[40:43], a[28:31], a[96:99], v[40:43]
    s_add_u32 m0, s60, 18432
    v_lshl_add_u32 v30, v24, 3, v30
    v_lshrrev_b32 v24, 2, v0
    v_mfma_f32_16x16x32_bf16 v[48:51], a[28:31], a[100:103], v[48:51]
    buffer_load_dwordx4 v8, s[4:7], s46 offen lds
    v_mfma_f32_16x16x32_bf16 v[56:59], a[28:31], a[104:107], v[56:59]
    v_lshl_add_u32 v24, v24, 7, v30
    v_xor_b32 v30, 32, v24
    v_mfma_f32_16x16x32_bf16 v[64:67], a[28:31], a[108:111], v[64:67]
    v_accvgpr_write_b32 a210, v24
    v_accvgpr_write_b32 a211, v30
    v_mfma_f32_16x16x32_bf16 v[72:75], a[28:31], a[112:115], v[72:75]
    s_addk_i32 m0, 1024
    v_bfe_u32 v26, v0, 3, 1
    v_mul_u32_u24 v26, 32768, v26
    v_mfma_f32_16x16x32_bf16 v[80:83], a[28:31], a[116:119], v[80:83]
    buffer_load_dwordx4 v9, s[4:7], s46 offen lds
    v_mfma_f32_16x16x32_bf16 v[88:91], a[28:31], a[120:123], v[88:91]
    v_lshrrev_b32 v28, 5, v0
    v_lshl_add_u32 v26, v28, 14, v26
    v_mfma_f32_16x16x32_bf16 v[92:95], a[32:35], a[120:123], v[92:95]
    v_bfe_u32 v28, v0, 4, 1
    v_lshl_add_u32 v26, v28, 12, v26
    v_mfma_f32_16x16x32_bf16 v[84:87], a[32:35], a[116:119], v[84:87]
    v_lshrrev_b32 v28, 4, v0
    v_xor_b32 v28, s52, v28
    v_mfma_f32_16x16x32_bf16 v[76:79], a[32:35], a[112:115], v[76:79]
    s_addk_i32 m0, 1024
    v_lshl_add_u32 v26, v28, 8, v26
    v_and_b32 v28, 7, v0
    v_mfma_f32_16x16x32_bf16 v[68:71], a[32:35], a[108:111], v[68:71]
    buffer_load_dwordx4 v10, s[4:7], s46 offen lds
    v_mfma_f32_16x16x32_bf16 v[60:63], a[32:35], a[104:107], v[60:63]
    v_lshl_add_u32 v26, v28, 4, v26
    v_mfma_f32_16x16x32_bf16 v[52:55], a[32:35], a[100:103], v[52:55]
    s_mul_i32 s55, s53, 262144
    v_mfma_f32_16x16x32_bf16 v[44:47], a[32:35], a[96:99], v[44:47]
    s_lshl_b32 s56, s54, 7
    v_mfma_f32_16x16x32_bf16 v[36:39], a[32:35], a[92:95], v[36:39]
    s_addk_i32 m0, 1024
    s_add_u32 s55, s55, s56
    v_mfma_f32_16x16x32_bf16 a[128:131], a[36:39], a[124:127], a[128:131]
    buffer_load_dwordx4 v11, s[4:7], s46 offen lds
    v_mfma_f32_16x16x32_bf16 v[96:99], a[36:39], a[92:95], v[96:99]
    v_add_u32 v26, s55, v26
    v_add_u32 v28, 65536, v26
    v_mfma_f32_16x16x32_bf16 v[108:111], a[36:39], a[96:99], v[108:111]
    v_accvgpr_write_b32 a213, v28
    v_add_u32 v23, 131072, v26
    v_mfma_f32_16x16x32_bf16 v[120:123], a[36:39], a[100:103], v[120:123]
    v_accvgpr_write_b32 a214, v23
    v_add_u32 v31, 196608, v26
    v_mfma_f32_16x16x32_bf16 v[132:135], a[36:39], a[104:107], v[132:135]
    s_add_u32 m0, s61, 18432
    v_accvgpr_write_b32 a212, v26
    v_accvgpr_write_b32 a215, v31
    v_mfma_f32_16x16x32_bf16 v[144:147], a[36:39], a[108:111], v[144:147]
    buffer_load_dwordx4 v12, s[4:7], s46 offen lds
    v_mfma_f32_16x16x32_bf16 v[156:159], a[36:39], a[112:115], v[156:159]
    s_lshr_b32 s55, s50, 3
    v_mfma_f32_16x16x32_bf16 v[168:171], a[36:39], a[116:119], v[168:171]
    s_waitcnt vmcnt(13)
    s_lshl_b32 s56, s55, 16
    v_mfma_f32_16x16x32_bf16 v[180:183], a[36:39], a[120:123], v[180:183]
    s_barrier
    ds_read_b128 a[56:59], v19 offset:0
    s_add_u32 s56, s56, s43
    v_mfma_f32_16x16x32_bf16 v[188:191], a[40:43], a[120:123], v[188:191]
    s_add_u32 m0, s58, 33024
    ds_read_b128 a[60:63], v19 offset:2048
    s_add_u32 s42, s56, 8929280
    v_mfma_f32_16x16x32_bf16 v[176:179], a[40:43], a[116:119], v[176:179]
    buffer_load_dwordx4 v6, s[8:11], s47 offen lds
    v_mfma_f32_16x16x32_bf16 v[164:167], a[40:43], a[112:115], v[164:167]
    s_and_b32 s56, s50, 6
    ds_read_b128 a[64:67], v19 offset:4096
    v_mfma_f32_16x16x32_bf16 v[152:155], a[40:43], a[108:111], v[152:155]
    s_add_u32 s55, s55, s56
    ds_read_b128 a[68:71], v19 offset:6144
    v_mfma_f32_16x16x32_bf16 v[140:143], a[40:43], a[104:107], v[140:143]
    s_and_b32 s56, s50, 1
    ds_read_b128 a[72:75], v19 offset:8192
    v_mfma_f32_16x16x32_bf16 v[128:131], a[40:43], a[100:103], v[128:131]
    s_lshl1_add_u32 s55, s55, s56
    ds_read_b128 a[76:79], v19 offset:10240
    v_mfma_f32_16x16x32_bf16 v[116:119], a[40:43], a[96:99], v[116:119]
    s_addk_i32 m0, 1024
    ds_read_b128 a[80:83], v19 offset:12288
    s_lshl_b32 s44, s55, 2
    v_mfma_f32_16x16x32_bf16 v[104:107], a[40:43], a[92:95], v[104:107]
    buffer_load_dwordx4 v7, s[8:11], s47 offen lds
    v_mfma_f32_16x16x32_bf16 a[136:139], a[40:43], a[124:127], a[136:139]
    s_lshl_b32 s55, s53, 12
    ds_read_b128 a[84:87], v19 offset:14336
    v_mfma_f32_16x16x32_bf16 a[140:143], a[124:127], a[44:47], a[140:143]
    s_add_u32 s55, s55, 111616
    ds_read_b128 a[88:91], v19 offset:16384
    v_mfma_f32_16x16x32_bf16 v[192:195], a[92:95], a[44:47], v[192:195]
    s_add_u32 s47, s47, s69
    s_sub_u32 s67, s47, 1327104
    s_min_u32 s47, s47, s67
    v_mfma_f32_16x16x32_bf16 v[208:211], a[96:99], a[44:47], v[208:211]
    s_addk_i32 m0, 21760
    ds_read_b64_tr_b16 a[0:1], v13 offset:0
    v_lshl_add_u32 v21, v0, 4, s55
    v_mfma_f32_16x16x32_bf16 v[196:199], a[100:103], a[44:47], v[196:199]
    buffer_load_dwordx4 v1, s[8:11], s47 offen lds
    v_mfma_f32_16x16x32_bf16 v[212:215], a[104:107], a[44:47], v[212:215]
    ds_read_b64_tr_b16 a[2:3], v13 offset:13824
    v_accvgpr_write_b32 a216, v21
    v_mfma_f32_16x16x32_bf16 v[200:203], a[108:111], a[44:47], v[200:203]
    s_lshl_b32 s55, s53, 11
    ds_read_b64_tr_b16 a[4:5], v13 offset:40
    v_mfma_f32_16x16x32_bf16 v[216:219], a[112:115], a[44:47], v[216:219]
    s_add_u32 s55, s55, 144384
    ds_read_b64_tr_b16 a[6:7], v13 offset:13864
    v_mfma_f32_16x16x32_bf16 v[204:207], a[116:119], a[44:47], v[204:207]
    s_addk_i32 m0, 1024
    ds_read_b64_tr_b16 a[8:9], v13 offset:288
    v_lshl_add_u32 v29, v0, 4, s55
    v_mfma_f32_16x16x32_bf16 v[220:223], a[120:123], a[44:47], v[220:223]
    buffer_load_dwordx4 v2, s[8:11], s47 offen lds
    v_mfma_f32_16x16x32_bf16 v[252:255], a[120:123], a[48:51], v[252:255]
    ds_read_b64_tr_b16 a[10:11], v13 offset:14112
    v_accvgpr_write_b32 a217, v29
    v_mfma_f32_16x16x32_bf16 v[236:239], a[116:119], a[48:51], v[236:239]
    s_lshl_b32 s55, s52, 7
    ds_read_b64_tr_b16 a[12:13], v13 offset:328
    v_mfma_f32_16x16x32_bf16 v[248:251], a[112:115], a[48:51], v[248:251]
    s_cmp_eq_u32 s48, 0
    s_cselect_b32 s55, s55, 0x40000000
    ds_read_b64_tr_b16 a[14:15], v13 offset:14152
    v_mfma_f32_16x16x32_bf16 v[232:235], a[108:111], a[48:51], v[232:235]
    s_addk_i32 m0, 1024
    ds_read_b64_tr_b16 a[16:17], v13 offset:576
    v_lshl_add_u32 v25, v0, 2, s55
    v_mfma_f32_16x16x32_bf16 v[244:247], a[104:107], a[48:51], v[244:247]
    buffer_load_dwordx4 v3, s[8:11], s47 offen lds
    v_mfma_f32_16x16x32_bf16 v[228:231], a[100:103], a[48:51], v[228:231]
    ds_read_b64_tr_b16 a[18:19], v13 offset:14400
    v_mov_b32 v24, 0x40000000
    v_mfma_f32_16x16x32_bf16 v[240:243], a[96:99], a[48:51], v[240:243]
    ds_read_b64_tr_b16 a[20:21], v13 offset:616
    v_cmp_gt_u32 vcc, 32, v0
    v_mfma_f32_16x16x32_bf16 v[224:227], a[92:95], a[48:51], v[224:227]
    s_mul_i32 s55, s52, 32768
    ds_read_b64_tr_b16 a[22:23], v13 offset:14440
    v_mfma_f32_16x16x32_bf16 a[144:147], a[124:127], a[48:51], a[144:147]
    s_addk_i32 m0, 1024
    ds_read_b64_tr_b16 a[24:25], v15 offset:0
    s_add_u32 s40, s43, s55
    v_mfma_f32_16x16x32_bf16 a[132:135], a[52:55], a[124:127], a[132:135]
    buffer_load_dwordx4 v4, s[8:11], s47 offen lds
    v_mfma_f32_16x16x32_bf16 v[100:103], a[52:55], a[92:95], v[100:103]
    ds_read_b64_tr_b16 a[26:27], v16 offset:0
    v_cndmask_b32 v24, v24, v25, vcc
    v_mfma_f32_16x16x32_bf16 v[112:115], a[52:55], a[96:99], v[112:115]
    v_accvgpr_write_b32 a219, v24
    v_mfma_f32_16x16x32_bf16 v[124:127], a[52:55], a[100:103], v[124:127]
    s_lshl_b32 s55, s54, 14
    v_mfma_f32_16x16x32_bf16 v[136:139], a[52:55], a[104:107], v[136:139]
    s_add_u32 s40, s40, s55
    v_mfma_f32_16x16x32_bf16 v[148:151], a[52:55], a[108:111], v[148:151]
    s_lshl_b32 s55, s53, 12
    v_mfma_f32_16x16x32_bf16 v[160:163], a[52:55], a[112:115], v[160:163]
    s_add_u32 s40, s40, s55
    v_mfma_f32_16x16x32_bf16 v[172:175], a[52:55], a[116:119], v[172:175]
    s_waitcnt vmcnt(4) lgkmcnt(0)
    v_mfma_f32_16x16x32_bf16 v[184:187], a[52:55], a[120:123], v[184:187]
    s_barrier
    v_mfma_f32_16x16x32_bf16 v[32:35], a[0:3], a[56:59], v[32:35]
    s_addk_i32 m0, 1024
    ds_read_b128 a[92:95], v20 offset:0
    v_bfe_u32 v25, v0, 1, 3
    v_mfma_f32_16x16x32_bf16 v[40:43], a[0:3], a[60:63], v[40:43]
    buffer_load_dwordx4 v5, s[8:11], s47 offen lds
    v_mfma_f32_16x16x32_bf16 v[48:51], a[0:3], a[64:67], v[48:51]
    ds_read_b128 a[96:99], v20 offset:2048
    v_and_b32 v30, 1, v0
    v_mfma_f32_16x16x32_bf16 v[56:59], a[0:3], a[68:71], v[56:59]
    ds_read_b128 a[100:103], v20 offset:4096
    v_lshlrev_b32 v30, 4, v30
    v_mfma_f32_16x16x32_bf16 v[64:67], a[0:3], a[72:75], v[64:67]
    ds_read_b128 a[104:107], v20 offset:6144
    v_mov_b32 v28, 0x3f80
    v_mfma_f32_16x16x32_bf16 v[72:75], a[0:3], a[76:79], v[72:75]
    s_addk_i32 m0, 1024
    ds_read_b128 a[108:111], v20 offset:8192
    v_lshlrev_b32 v30, v30, v28
    v_mfma_f32_16x16x32_bf16 v[80:83], a[0:3], a[80:83], v[80:83]
    buffer_load_dwordx4 v6, s[8:11], s47 offen lds
    v_mfma_f32_16x16x32_bf16 v[88:91], a[0:3], a[84:87], v[88:91]
    ds_read_b128 a[112:115], v20 offset:10240
    v_cmp_eq_u32 vcc, 0, v25
    v_mfma_f32_16x16x32_bf16 v[92:95], a[4:7], a[84:87], v[92:95]
    ds_read_b128 a[116:119], v20 offset:12288
    v_cmp_eq_u32 s[56:57], 1, v25
    v_mfma_f32_16x16x32_bf16 v[84:87], a[4:7], a[80:83], v[84:87]
    ds_read_b128 a[120:123], v20 offset:14336
    v_cndmask_b32 v28, 0, v30, vcc
    v_mfma_f32_16x16x32_bf16 v[76:79], a[4:7], a[76:79], v[76:79]
    s_addk_i32 m0, 1024
    ds_read_b128 a[124:127], v20 offset:16384
    v_accvgpr_write_b32 a221, v28
    v_mfma_f32_16x16x32_bf16 v[68:71], a[4:7], a[72:75], v[68:71]
    buffer_load_dwordx4 v7, s[8:11], s47 offen lds
    v_mfma_f32_16x16x32_bf16 v[60:63], a[4:7], a[68:71], v[60:63]
    ds_read_b64_tr_b16 a[28:29], v13 offset:27904
    v_cndmask_b32 v23, 0, v30, s[56:57]
    v_mfma_f32_16x16x32_bf16 v[52:55], a[4:7], a[64:67], v[52:55]
    ds_read_b64_tr_b16 a[30:31], v13 offset:41728
    v_accvgpr_write_b32 a222, v23
    v_mfma_f32_16x16x32_bf16 v[44:47], a[4:7], a[60:63], v[44:47]
    s_add_u32 s47, s47, s68
    ds_read_b64_tr_b16 a[32:33], v13 offset:27944
    v_cmp_eq_u32 vcc, 2, v25
    v_mfma_f32_16x16x32_bf16 v[36:39], a[4:7], a[56:59], v[36:39]
    s_addk_i32 m0, 21760
    ds_read_b64_tr_b16 a[34:35], v13 offset:41768
    v_cmp_eq_u32 s[56:57], 3, v25
    v_mfma_f32_16x16x32_bf16 a[128:131], a[8:11], a[88:91], a[128:131]
    buffer_load_dwordx4 v1, s[8:11], s47 offen lds
    v_mfma_f32_16x16x32_bf16 v[96:99], a[8:11], a[56:59], v[96:99]
    ds_read_b64_tr_b16 a[36:37], v13 offset:28192
    v_cndmask_b32 v26, 0, v30, vcc
    v_mfma_f32_16x16x32_bf16 v[108:111], a[8:11], a[60:63], v[108:111]
    ds_read_b64_tr_b16 a[38:39], v13 offset:42016
    v_accvgpr_write_b32 a223, v26
    v_mfma_f32_16x16x32_bf16 v[120:123], a[8:11], a[64:67], v[120:123]
    ds_read_b64_tr_b16 a[40:41], v13 offset:28232
    v_cndmask_b32 v31, 0, v30, s[56:57]
    v_mfma_f32_16x16x32_bf16 v[132:135], a[8:11], a[68:71], v[132:135]
    s_addk_i32 m0, 1024
    ds_read_b64_tr_b16 a[42:43], v13 offset:42056
    v_accvgpr_write_b32 a224, v31
    v_mfma_f32_16x16x32_bf16 v[144:147], a[8:11], a[72:75], v[144:147]
    buffer_load_dwordx4 v2, s[8:11], s47 offen lds
    v_mfma_f32_16x16x32_bf16 v[156:159], a[8:11], a[76:79], v[156:159]
    ds_read_b64_tr_b16 a[44:45], v13 offset:28480
    v_cmp_eq_u32 vcc, 4, v25
    v_mfma_f32_16x16x32_bf16 v[168:171], a[8:11], a[80:83], v[168:171]
    ds_read_b64_tr_b16 a[46:47], v13 offset:42304
    v_cmp_eq_u32 s[56:57], 5, v25
    v_mfma_f32_16x16x32_bf16 v[180:183], a[8:11], a[84:87], v[180:183]
    ds_read_b64_tr_b16 a[48:49], v13 offset:28520
    v_cndmask_b32 v21, 0, v30, vcc
    v_mfma_f32_16x16x32_bf16 v[188:191], a[12:15], a[84:87], v[188:191]
    s_addk_i32 m0, 1024
    ds_read_b64_tr_b16 a[50:51], v13 offset:42344
    v_accvgpr_write_b32 a225, v21
    v_mfma_f32_16x16x32_bf16 v[176:179], a[12:15], a[80:83], v[176:179]
    buffer_load_dwordx4 v3, s[8:11], s47 offen lds
    v_mfma_f32_16x16x32_bf16 v[164:167], a[12:15], a[76:79], v[164:167]
    ds_read_b64_tr_b16 a[52:53], v15 offset:27904
    v_cndmask_b32 v29, 0, v30, s[56:57]
    v_mfma_f32_16x16x32_bf16 v[152:155], a[12:15], a[72:75], v[152:155]
    ds_read_b64_tr_b16 a[54:55], v16 offset:27904
    v_accvgpr_write_b32 a226, v29
    v_mfma_f32_16x16x32_bf16 v[140:143], a[12:15], a[68:71], v[140:143]
    v_cmp_eq_u32 vcc, 6, v25
    v_cmp_eq_u32 s[56:57], 7, v25
    v_mfma_f32_16x16x32_bf16 v[128:131], a[12:15], a[64:67], v[128:131]
    v_cndmask_b32 v25, 0, v30, vcc
    v_accvgpr_write_b32 a227, v25
    v_mfma_f32_16x16x32_bf16 v[116:119], a[12:15], a[60:63], v[116:119]
    s_addk_i32 m0, 1024
    v_cndmask_b32 v30, 0, v30, s[56:57]
    v_accvgpr_write_b32 a228, v30
    v_mfma_f32_16x16x32_bf16 v[104:107], a[12:15], a[56:59], v[104:107]
    buffer_load_dwordx4 v4, s[8:11], s47 offen lds
    v_mfma_f32_16x16x32_bf16 a[136:139], a[12:15], a[88:91], a[136:139]
    v_mfma_f32_16x16x32_bf16 a[140:143], a[88:91], a[16:19], a[140:143]
    v_mfma_f32_16x16x32_bf16 v[192:195], a[56:59], a[16:19], v[192:195]
    v_mfma_f32_16x16x32_bf16 v[208:211], a[60:63], a[16:19], v[208:211]
    s_addk_i32 m0, 1024
    v_mfma_f32_16x16x32_bf16 v[196:199], a[64:67], a[16:19], v[196:199]
    buffer_load_dwordx4 v5, s[8:11], s47 offen lds
    v_mfma_f32_16x16x32_bf16 v[212:215], a[68:71], a[16:19], v[212:215]
    v_mfma_f32_16x16x32_bf16 v[200:203], a[72:75], a[16:19], v[200:203]
    v_mfma_f32_16x16x32_bf16 v[216:219], a[76:79], a[16:19], v[216:219]
    v_mfma_f32_16x16x32_bf16 v[204:207], a[80:83], a[16:19], v[204:207]
    s_addk_i32 m0, 1024
    v_mfma_f32_16x16x32_bf16 v[220:223], a[84:87], a[16:19], v[220:223]
    buffer_load_dwordx4 v6, s[8:11], s47 offen lds
    v_mfma_f32_16x16x32_bf16 v[252:255], a[84:87], a[20:23], v[252:255]
    v_mfma_f32_16x16x32_bf16 v[236:239], a[80:83], a[20:23], v[236:239]
    v_mfma_f32_16x16x32_bf16 v[248:251], a[76:79], a[20:23], v[248:251]
    v_mfma_f32_16x16x32_bf16 v[232:235], a[72:75], a[20:23], v[232:235]
    s_addk_i32 m0, 1024
    v_mfma_f32_16x16x32_bf16 v[244:247], a[68:71], a[20:23], v[244:247]
    buffer_load_dwordx4 v7, s[8:11], s47 offen lds
    v_mfma_f32_16x16x32_bf16 v[228:231], a[64:67], a[20:23], v[228:231]
    v_mfma_f32_16x16x32_bf16 v[240:243], a[60:63], a[20:23], v[240:243]
    v_mfma_f32_16x16x32_bf16 v[224:227], a[56:59], a[20:23], v[224:227]
    s_add_u32 s47, s47, s69
    s_sub_u32 s67, s47, 1327104
    s_min_u32 s47, s47, s67
    v_mfma_f32_16x16x32_bf16 a[144:147], a[88:91], a[20:23], a[144:147]
    s_add_u32 m0, s58, 0
    v_mfma_f32_16x16x32_bf16 a[132:135], a[24:27], a[88:91], a[132:135]
    buffer_load_dwordx4 v1, s[8:11], s47 offen lds
    v_mfma_f32_16x16x32_bf16 v[100:103], a[24:27], a[56:59], v[100:103]
    v_mfma_f32_16x16x32_bf16 v[112:115], a[24:27], a[60:63], v[112:115]
    v_mfma_f32_16x16x32_bf16 v[124:127], a[24:27], a[64:67], v[124:127]
    v_mfma_f32_16x16x32_bf16 v[136:139], a[24:27], a[68:71], v[136:139]
    v_mfma_f32_16x16x32_bf16 v[148:151], a[24:27], a[72:75], v[148:151]
    v_mfma_f32_16x16x32_bf16 v[160:163], a[24:27], a[76:79], v[160:163]
    v_mfma_f32_16x16x32_bf16 v[172:175], a[24:27], a[80:83], v[172:175]
    s_waitcnt vmcnt(8) lgkmcnt(0)
    v_mfma_f32_16x16x32_bf16 v[184:187], a[24:27], a[84:87], v[184:187]
    s_barrier
    v_mfma_f32_16x16x32_bf16 v[32:35], a[28:31], a[92:95], v[32:35]
    s_add_u32 s46, s46, 128
    s_sub_u32 s67, s46, 768
    s_min_u32 s46, s46, s67
    v_mfma_f32_16x16x32_bf16 v[40:43], a[28:31], a[96:99], v[40:43]
    s_add_u32 m0, s60, 0
    ds_read_b128 a[56:59], v19 offset:18432
    v_mov_b32 v24, 0
    v_mfma_f32_16x16x32_bf16 v[48:51], a[28:31], a[100:103], v[48:51]
    buffer_load_dwordx4 v8, s[4:7], s46 offen lds
    v_mfma_f32_16x16x32_bf16 v[56:59], a[28:31], a[104:107], v[56:59]
    ds_read_b128 a[60:63], v19 offset:20480
    v_accvgpr_read_b32 v28, a148
    v_mfma_f32_16x16x32_bf16 v[64:67], a[28:31], a[108:111], v[64:67]
    ds_read_b128 a[64:67], v19 offset:22528
    v_accvgpr_read_b32 v23, a160
    v_mfma_f32_16x16x32_bf16 v[72:75], a[28:31], a[112:115], v[72:75]
    s_addk_i32 m0, 1024
    ds_read_b128 a[68:71], v19 offset:24576
    v_lshlrev_b32 v26, 16, v28
    v_mfma_f32_16x16x32_bf16 v[80:83], a[28:31], a[116:119], v[80:83]
    buffer_load_dwordx4 v9, s[4:7], s46 offen lds
    v_mfma_f32_16x16x32_bf16 v[88:91], a[28:31], a[120:123], v[88:91]
    ds_read_b128 a[72:75], v19 offset:26624
    v_lshlrev_b32 v31, 16, v23
    v_mfma_f32_16x16x32_bf16 v[92:95], a[32:35], a[120:123], v[92:95]
    ds_read_b128 a[76:79], v19 offset:28672
    v_and_b32 v28, s83, v28
    v_mfma_f32_16x16x32_bf16 v[84:87], a[32:35], a[116:119], v[84:87]
    ds_read_b128 a[80:83], v19 offset:30720
    v_and_b32 v23, s83, v23
    v_mfma_f32_16x16x32_bf16 v[76:79], a[32:35], a[112:115], v[76:79]
    s_addk_i32 m0, 1024
    ds_read_b128 a[84:87], v19 offset:32768
    v_fmac_f32 v24, v26, v31
    v_mfma_f32_16x16x32_bf16 v[68:71], a[32:35], a[108:111], v[68:71]
    buffer_load_dwordx4 v10, s[4:7], s46 offen lds
    v_mfma_f32_16x16x32_bf16 v[60:63], a[32:35], a[104:107], v[60:63]
    ds_read_b128 a[88:91], v19 offset:34816
    v_fmac_f32 v24, v28, v23
    v_mfma_f32_16x16x32_bf16 v[52:55], a[32:35], a[100:103], v[52:55]
    ds_read_b64_tr_b16 a[0:1], v14 offset:0
    v_accvgpr_read_b32 v23, a149
    v_mfma_f32_16x16x32_bf16 v[44:47], a[32:35], a[96:99], v[44:47]
    ds_read_b64_tr_b16 a[2:3], v14 offset:13824
    v_accvgpr_read_b32 v28, a161
    v_mfma_f32_16x16x32_bf16 v[36:39], a[32:35], a[92:95], v[36:39]
    s_addk_i32 m0, 1024
    ds_read_b64_tr_b16 a[4:5], v14 offset:40
    v_lshlrev_b32 v31, 16, v23
    v_mfma_f32_16x16x32_bf16 a[128:131], a[36:39], a[124:127], a[128:131]
    buffer_load_dwordx4 v11, s[4:7], s46 offen lds
    v_mfma_f32_16x16x32_bf16 v[96:99], a[36:39], a[92:95], v[96:99]
    ds_read_b64_tr_b16 a[6:7], v14 offset:13864
    v_lshlrev_b32 v26, 16, v28
    v_mfma_f32_16x16x32_bf16 v[108:111], a[36:39], a[96:99], v[108:111]
    ds_read_b64_tr_b16 a[8:9], v14 offset:288
    v_and_b32 v23, s83, v23
    v_mfma_f32_16x16x32_bf16 v[120:123], a[36:39], a[100:103], v[120:123]
    ds_read_b64_tr_b16 a[10:11], v14 offset:14112
    v_and_b32 v28, s83, v28
    v_mfma_f32_16x16x32_bf16 v[132:135], a[36:39], a[104:107], v[132:135]
    s_add_u32 m0, s61, 0
    ds_read_b64_tr_b16 a[12:13], v14 offset:328
    v_fmac_f32 v24, v31, v26
    v_mfma_f32_16x16x32_bf16 v[144:147], a[36:39], a[108:111], v[144:147]
    buffer_load_dwordx4 v12, s[4:7], s46 offen lds
    v_mfma_f32_16x16x32_bf16 v[156:159], a[36:39], a[112:115], v[156:159]
    ds_read_b64_tr_b16 a[14:15], v14 offset:14152
    v_fmac_f32 v24, v23, v28
    v_mfma_f32_16x16x32_bf16 v[168:171], a[36:39], a[116:119], v[168:171]
    ds_read_b64_tr_b16 a[16:17], v14 offset:576
    v_accvgpr_read_b32 v28, a150
    v_mfma_f32_16x16x32_bf16 v[180:183], a[36:39], a[120:123], v[180:183]
    ds_read_b64_tr_b16 a[18:19], v14 offset:14400
    v_accvgpr_read_b32 v23, a162
    v_mfma_f32_16x16x32_bf16 v[188:191], a[40:43], a[120:123], v[188:191]
    s_add_u32 m0, s58, 1024
    ds_read_b64_tr_b16 a[20:21], v14 offset:616
    v_lshlrev_b32 v26, 16, v28
    v_mfma_f32_16x16x32_bf16 v[176:179], a[40:43], a[116:119], v[176:179]
    buffer_load_dwordx4 v2, s[8:11], s47 offen lds
    v_mfma_f32_16x16x32_bf16 v[164:167], a[40:43], a[112:115], v[164:167]
    ds_read_b64_tr_b16 a[22:23], v14 offset:14440
    v_lshlrev_b32 v31, 16, v23
    v_mfma_f32_16x16x32_bf16 v[152:155], a[40:43], a[108:111], v[152:155]
    ds_read_b64_tr_b16 a[24:25], v17 offset:0
    v_and_b32 v28, s83, v28
    v_mfma_f32_16x16x32_bf16 v[140:143], a[40:43], a[104:107], v[140:143]
    ds_read_b64_tr_b16 a[26:27], v18 offset:0
    v_and_b32 v23, s83, v23
    v_mfma_f32_16x16x32_bf16 v[128:131], a[40:43], a[100:103], v[128:131]
    v_fmac_f32 v24, v26, v31
    v_fmac_f32 v24, v28, v23
    v_mfma_f32_16x16x32_bf16 v[116:119], a[40:43], a[96:99], v[116:119]
    s_addk_i32 m0, 1024
    v_accvgpr_read_b32 v23, a152
    v_accvgpr_read_b32 v28, a164
    v_mfma_f32_16x16x32_bf16 v[104:107], a[40:43], a[92:95], v[104:107]
    buffer_load_dwordx4 v3, s[8:11], s47 offen lds
    v_mfma_f32_16x16x32_bf16 a[136:139], a[40:43], a[124:127], a[136:139]
    v_lshlrev_b32 v31, 16, v23
    v_lshlrev_b32 v26, 16, v28
    v_mfma_f32_16x16x32_bf16 a[140:143], a[124:127], a[44:47], a[140:143]
    v_and_b32 v23, s83, v23
    v_and_b32 v28, s83, v28
    v_mfma_f32_16x16x32_bf16 v[192:195], a[92:95], a[44:47], v[192:195]
    v_fmac_f32 v24, v31, v26
    v_fmac_f32 v24, v23, v28
    v_mfma_f32_16x16x32_bf16 v[208:211], a[96:99], a[44:47], v[208:211]
    s_addk_i32 m0, 1024
    v_accvgpr_read_b32 v28, a153
    v_accvgpr_read_b32 v23, a165
    v_mfma_f32_16x16x32_bf16 v[196:199], a[100:103], a[44:47], v[196:199]
    buffer_load_dwordx4 v4, s[8:11], s47 offen lds
    v_mfma_f32_16x16x32_bf16 v[212:215], a[104:107], a[44:47], v[212:215]
    v_lshlrev_b32 v26, 16, v28
    v_lshlrev_b32 v31, 16, v23
    v_mfma_f32_16x16x32_bf16 v[200:203], a[108:111], a[44:47], v[200:203]
    v_and_b32 v28, s83, v28
    v_and_b32 v23, s83, v23
    v_mfma_f32_16x16x32_bf16 v[216:219], a[112:115], a[44:47], v[216:219]
    v_fmac_f32 v24, v26, v31
    v_fmac_f32 v24, v28, v23
    v_mfma_f32_16x16x32_bf16 v[204:207], a[116:119], a[44:47], v[204:207]
    s_addk_i32 m0, 1024
    v_accvgpr_read_b32 v23, a154
    v_accvgpr_read_b32 v28, a166
    v_mfma_f32_16x16x32_bf16 v[220:223], a[120:123], a[44:47], v[220:223]
    buffer_load_dwordx4 v5, s[8:11], s47 offen lds
    v_mfma_f32_16x16x32_bf16 v[252:255], a[120:123], a[48:51], v[252:255]
    v_lshlrev_b32 v31, 16, v23
    v_lshlrev_b32 v26, 16, v28
    v_mfma_f32_16x16x32_bf16 v[236:239], a[116:119], a[48:51], v[236:239]
    v_and_b32 v23, s83, v23
    v_and_b32 v28, s83, v28
    v_mfma_f32_16x16x32_bf16 v[248:251], a[112:115], a[48:51], v[248:251]
    v_fmac_f32 v24, v31, v26
    v_fmac_f32 v24, v23, v28
    v_mfma_f32_16x16x32_bf16 v[232:235], a[108:111], a[48:51], v[232:235]
    s_addk_i32 m0, 1024
    v_accvgpr_read_b32 v28, a156
    v_accvgpr_read_b32 v23, a168
    v_mfma_f32_16x16x32_bf16 v[244:247], a[104:107], a[48:51], v[244:247]
    buffer_load_dwordx4 v6, s[8:11], s47 offen lds
    v_mfma_f32_16x16x32_bf16 v[228:231], a[100:103], a[48:51], v[228:231]
    v_lshlrev_b32 v26, 16, v28
    v_lshlrev_b32 v31, 16, v23
    v_mfma_f32_16x16x32_bf16 v[240:243], a[96:99], a[48:51], v[240:243]
    v_and_b32 v28, s83, v28
    v_and_b32 v23, s83, v23
    v_mfma_f32_16x16x32_bf16 v[224:227], a[92:95], a[48:51], v[224:227]
    v_fmac_f32 v24, v26, v31
    v_fmac_f32 v24, v28, v23
    v_mfma_f32_16x16x32_bf16 a[144:147], a[124:127], a[48:51], a[144:147]
    s_addk_i32 m0, 1024
    v_accvgpr_read_b32 v23, a157
    v_accvgpr_read_b32 v28, a169
    v_mfma_f32_16x16x32_bf16 a[132:135], a[52:55], a[124:127], a[132:135]
    buffer_load_dwordx4 v7, s[8:11], s47 offen lds
    v_mfma_f32_16x16x32_bf16 v[100:103], a[52:55], a[92:95], v[100:103]
    v_lshlrev_b32 v31, 16, v23
    v_lshlrev_b32 v26, 16, v28
    v_mfma_f32_16x16x32_bf16 v[112:115], a[52:55], a[96:99], v[112:115]
    v_and_b32 v23, s83, v23
    v_and_b32 v28, s83, v28
    v_mfma_f32_16x16x32_bf16 v[124:127], a[52:55], a[100:103], v[124:127]
    v_fmac_f32 v24, v31, v26
    v_fmac_f32 v24, v23, v28
    v_mfma_f32_16x16x32_bf16 v[136:139], a[52:55], a[104:107], v[136:139]
    v_accvgpr_read_b32 v28, a158
    v_accvgpr_read_b32 v23, a170
    v_mfma_f32_16x16x32_bf16 v[148:151], a[52:55], a[108:111], v[148:151]
    v_mfma_f32_16x16x32_bf16 v[160:163], a[52:55], a[112:115], v[160:163]
    v_mfma_f32_16x16x32_bf16 v[172:175], a[52:55], a[116:119], v[172:175]
    s_waitcnt vmcnt(12) lgkmcnt(0)
    v_mfma_f32_16x16x32_bf16 v[184:187], a[52:55], a[120:123], v[184:187]
    s_barrier
    v_mfma_f32_16x16x32_bf16 v[32:35], a[0:3], a[56:59], v[32:35]
    s_add_u32 s47, s47, s68
    ds_read_b128 a[92:95], v20 offset:18432
    s_addk_i32 m0, 21760
    v_mfma_f32_16x16x32_bf16 v[40:43], a[0:3], a[60:63], v[40:43]
    buffer_load_dwordx4 v1, s[8:11], s47 offen lds
    v_mfma_f32_16x16x32_bf16 v[48:51], a[0:3], a[64:67], v[48:51]
    ds_read_b128 a[96:99], v20 offset:20480
    v_lshlrev_b32 v26, 16, v28
    v_mfma_f32_16x16x32_bf16 v[56:59], a[0:3], a[68:71], v[56:59]
    ds_read_b128 a[100:103], v20 offset:22528
    v_lshlrev_b32 v31, 16, v23
    v_mfma_f32_16x16x32_bf16 v[64:67], a[0:3], a[72:75], v[64:67]
    ds_read_b128 a[104:107], v20 offset:24576
    v_and_b32 v28, s83, v28
    v_mfma_f32_16x16x32_bf16 v[72:75], a[0:3], a[76:79], v[72:75]
    s_addk_i32 m0, 1024
    ds_read_b128 a[108:111], v20 offset:26624
    v_and_b32 v23, s83, v23
    v_mfma_f32_16x16x32_bf16 v[80:83], a[0:3], a[80:83], v[80:83]
    buffer_load_dwordx4 v2, s[8:11], s47 offen lds
    v_mfma_f32_16x16x32_bf16 v[88:91], a[0:3], a[84:87], v[88:91]
    ds_read_b128 a[112:115], v20 offset:28672
    v_fmac_f32 v24, v26, v31
    v_mfma_f32_16x16x32_bf16 v[92:95], a[4:7], a[84:87], v[92:95]
    ds_read_b128 a[116:119], v20 offset:30720
    v_fmac_f32 v24, v28, v23
    v_mfma_f32_16x16x32_bf16 v[84:87], a[4:7], a[80:83], v[84:87]
    ds_read_b128 a[120:123], v20 offset:32768
    v_add_f32_dpp v24, v24, v24 quad_perm:[1,0,3,2] row_mask:0xf bank_mask:0xf
    v_mfma_f32_16x16x32_bf16 v[76:79], a[4:7], a[76:79], v[76:79]
    s_addk_i32 m0, 1024
    ds_read_b128 a[124:127], v20 offset:34816
    v_add_f32_dpp v24, v24, v24 quad_perm:[2,3,0,1] row_mask:0xf bank_mask:0xf
    v_mfma_f32_16x16x32_bf16 v[68:71], a[4:7], a[72:75], v[68:71]
    buffer_load_dwordx4 v3, s[8:11], s47 offen lds
    v_mfma_f32_16x16x32_bf16 v[60:63], a[4:7], a[68:71], v[60:63]
    ds_read_b64_tr_b16 a[28:29], v14 offset:27904
    v_add_f32_dpp v24, v24, v24 row_half_mirror row_mask:0xf bank_mask:0xf
    v_mfma_f32_16x16x32_bf16 v[52:55], a[4:7], a[64:67], v[52:55]
    ds_read_b64_tr_b16 a[30:31], v14 offset:41728
    v_add_f32_dpp v24, v24, v24 row_mirror row_mask:0xf bank_mask:0xf
    v_mfma_f32_16x16x32_bf16 v[44:47], a[4:7], a[60:63], v[44:47]
    ds_read_b64_tr_b16 a[32:33], v14 offset:27944
    v_mov_b32 v23, v24
    v_mfma_f32_16x16x32_bf16 v[36:39], a[4:7], a[56:59], v[36:39]
    s_addk_i32 m0, 1024
    ds_read_b64_tr_b16 a[34:35], v14 offset:41768
    v_mfma_f32_16x16x32_bf16 a[128:131], a[8:11], a[88:91], a[128:131]
    buffer_load_dwordx4 v4, s[8:11], s47 offen lds
    v_mfma_f32_16x16x32_bf16 v[96:99], a[8:11], a[56:59], v[96:99]
    ds_read_b64_tr_b16 a[36:37], v14 offset:28192
    v_mfma_f32_16x16x32_bf16 v[108:111], a[8:11], a[60:63], v[108:111]
    ds_read_b64_tr_b16 a[38:39], v14 offset:42016
    v_mfma_f32_16x16x32_bf16 v[120:123], a[8:11], a[64:67], v[120:123]
    ds_read_b64_tr_b16 a[40:41], v14 offset:28232
    v_mfma_f32_16x16x32_bf16 v[132:135], a[8:11], a[68:71], v[132:135]
    s_addk_i32 m0, 1024
    ds_read_b64_tr_b16 a[42:43], v14 offset:42056
    v_mfma_f32_16x16x32_bf16 v[144:147], a[8:11], a[72:75], v[144:147]
    buffer_load_dwordx4 v5, s[8:11], s47 offen lds
    v_mfma_f32_16x16x32_bf16 v[156:159], a[8:11], a[76:79], v[156:159]
    ds_read_b64_tr_b16 a[44:45], v14 offset:28480
    v_mfma_f32_16x16x32_bf16 v[168:171], a[8:11], a[80:83], v[168:171]
    ds_read_b64_tr_b16 a[46:47], v14 offset:42304
    v_mfma_f32_16x16x32_bf16 v[180:183], a[8:11], a[84:87], v[180:183]
    ds_read_b64_tr_b16 a[48:49], v14 offset:28520
    v_mfma_f32_16x16x32_bf16 v[188:191], a[12:15], a[84:87], v[188:191]
    s_addk_i32 m0, 1024
    ds_read_b64_tr_b16 a[50:51], v14 offset:42344
    v_mfma_f32_16x16x32_bf16 v[176:179], a[12:15], a[80:83], v[176:179]
    buffer_load_dwordx4 v6, s[8:11], s47 offen lds
    v_mfma_f32_16x16x32_bf16 v[164:167], a[12:15], a[76:79], v[164:167]
L_stubA3:
    s_cbranch_execz L_jrA0
    s_nop 0
    ds_read_b64_tr_b16 a[52:53], v17 offset:27904
    v_mfma_f32_16x16x32_bf16 v[152:155], a[12:15], a[72:75], v[152:155]
    ds_read_b64_tr_b16 a[54:55], v18 offset:27904
    v_mfma_f32_16x16x32_bf16 v[140:143], a[12:15], a[68:71], v[140:143]
    v_permlane16_swap_b32 v24, v23
    v_mfma_f32_16x16x32_bf16 v[128:131], a[12:15], a[64:67], v[128:131]
    v_add_f32 v24, v24, v23
    v_mul_f32 v24, 0xbfb8aa3b, v24
    v_mfma_f32_16x16x32_bf16 v[116:119], a[12:15], a[60:63], v[116:119]
    s_addk_i32 m0, 1024
    v_exp_f32 v24, v24
    v_mfma_f32_16x16x32_bf16 v[104:107], a[12:15], a[56:59], v[104:107]
    buffer_load_dwordx4 v7, s[8:11], s47 offen lds
    v_mfma_f32_16x16x32_bf16 a[136:139], a[12:15], a[88:91], a[136:139]
    s_lshl_b32 s57, s48, 3
    v_mfma_f32_16x16x32_bf16 a[140:143], a[88:91], a[16:19], a[140:143]
    v_lshrrev_b32 v23, 5, v0
    v_add_f32 v24, 1.0, v24
    v_mfma_f32_16x16x32_bf16 v[192:195], a[56:59], a[16:19], v[192:195]
    s_add_u32 s47, s47, s69
    s_sub_u32 s67, s47, 1327104
    s_min_u32 s47, s47, s67
    v_mfma_f32_16x16x32_bf16 v[208:211], a[60:63], a[16:19], v[208:211]
    s_addk_i32 m0, 21760
    v_rcp_f32 v24, v24
    v_mfma_f32_16x16x32_bf16 v[196:199], a[64:67], a[16:19], v[196:199]
    buffer_load_dwordx4 v1, s[8:11], s47 offen lds
    v_mfma_f32_16x16x32_bf16 v[212:215], a[68:71], a[16:19], v[212:215]
    v_lshl_add_u32 v23, v23, 2, s57
    v_add_u32 v23, 163776, v23
    v_mfma_f32_16x16x32_bf16 v[200:203], a[72:75], a[16:19], v[200:203]
    v_add_u32 v22, 163776, v22
    v_accvgpr_write_b32 a220, v22
    v_mfma_f32_16x16x32_bf16 v[216:219], a[76:79], a[16:19], v[216:219]
    ds_write_b32 v23, v24
    v_mfma_f32_16x16x32_bf16 v[204:207], a[80:83], a[16:19], v[204:207]
    s_addk_i32 m0, 1024
    v_bfe_u32 v26, v0, 1, 2
    v_bfe_u32 v28, v0, 4, 2
    v_mfma_f32_16x16x32_bf16 v[220:223], a[84:87], a[16:19], v[220:223]
    buffer_load_dwordx4 v2, s[8:11], s47 offen lds
    v_mfma_f32_16x16x32_bf16 v[252:255], a[84:87], a[20:23], v[252:255]
    v_xor_b32 v26, v26, v28
    v_and_b32 v28, 1, v0
    v_mfma_f32_16x16x32_bf16 v[236:239], a[80:83], a[20:23], v[236:239]
    v_lshlrev_b32 v28, 4, v28
    v_lshl_add_u32 v28, v26, 5, v28
    v_mfma_f32_16x16x32_bf16 v[248:251], a[76:79], a[20:23], v[248:251]
    s_and_b32 s77, s49, 1
    v_mfma_f32_16x16x32_bf16 v[232:235], a[72:75], a[20:23], v[232:235]
    s_addk_i32 m0, 1024
    s_mul_i32 s75, s77, 165888
    v_mfma_f32_16x16x32_bf16 v[244:247], a[68:71], a[20:23], v[244:247]
    buffer_load_dwordx4 v3, s[8:11], s47 offen lds
    v_mfma_f32_16x16x32_bf16 v[228:231], a[64:67], a[20:23], v[228:231]
    s_sub_u32 s76, 165888, s75
    v_mfma_f32_16x16x32_bf16 v[240:243], a[60:63], a[20:23], v[240:243]
    s_lshl_b32 s55, s77, 7
    v_mfma_f32_16x16x32_bf16 v[224:227], a[56:59], a[20:23], v[224:227]
    s_add_u32 s70, s3, s55
    v_mfma_f32_16x16x32_bf16 a[144:147], a[88:91], a[20:23], a[144:147]
    s_addk_i32 m0, 1024
    s_sub_u32 s55, s70, 1152
    v_mfma_f32_16x16x32_bf16 a[132:135], a[24:27], a[88:91], a[132:135]
    buffer_load_dwordx4 v4, s[8:11], s47 offen lds
    v_mfma_f32_16x16x32_bf16 v[100:103], a[24:27], a[56:59], v[100:103]
    s_min_u32 s70, s70, s55
    v_mfma_f32_16x16x32_bf16 v[112:115], a[24:27], a[60:63], v[112:115]
    s_add_u32 s71, s70, 256
    v_mfma_f32_16x16x32_bf16 v[124:127], a[24:27], a[64:67], v[124:127]
    s_sub_u32 s55, s71, 1152
    v_mfma_f32_16x16x32_bf16 v[136:139], a[24:27], a[68:71], v[136:139]
    s_min_u32 s71, s71, s55
    v_mfma_f32_16x16x32_bf16 v[148:151], a[24:27], a[72:75], v[148:151]
    v_mfma_f32_16x16x32_bf16 v[160:163], a[24:27], a[76:79], v[160:163]
    v_mfma_f32_16x16x32_bf16 v[172:175], a[24:27], a[80:83], v[172:175]
    s_waitcnt vmcnt(11) lgkmcnt(0)
    v_mfma_f32_16x16x32_bf16 v[184:187], a[24:27], a[84:87], v[184:187]
    s_barrier
    v_mfma_f32_16x16x32_bf16 v[32:35], a[28:31], a[92:95], v[32:35]
    s_add_u32 s46, s46, 128
    s_sub_u32 s67, s46, 768
    s_min_u32 s46, s46, s67
    v_mfma_f32_16x16x32_bf16 v[40:43], a[28:31], a[96:99], v[40:43]
    s_add_u32 m0, s60, 18432
    ds_read_b128 a[56:59], v19 offset:0
    s_add_u32 s72, s71, 256
    v_mfma_f32_16x16x32_bf16 v[48:51], a[28:31], a[100:103], v[48:51]
    buffer_load_dwordx4 v8, s[4:7], s46 offen lds
    v_mfma_f32_16x16x32_bf16 v[56:59], a[28:31], a[104:107], v[56:59]
    s_sub_u32 s55, s72, 1152
    ds_read_b128 a[60:63], v19 offset:2048
    v_mfma_f32_16x16x32_bf16 v[64:67], a[28:31], a[108:111], v[64:67]
    s_min_u32 s72, s72, s55
    ds_read_b128 a[64:67], v19 offset:4096
    v_mfma_f32_16x16x32_bf16 v[72:75], a[28:31], a[112:115], v[72:75]
    s_addk_i32 m0, 1024
    ds_read_b128 a[68:71], v19 offset:6144
    s_add_u32 s73, s72, 256
    v_mfma_f32_16x16x32_bf16 v[80:83], a[28:31], a[116:119], v[80:83]
    buffer_load_dwordx4 v9, s[4:7], s46 offen lds
    v_mfma_f32_16x16x32_bf16 v[88:91], a[28:31], a[120:123], v[88:91]
    s_sub_u32 s55, s73, 1152
    ds_read_b128 a[72:75], v19 offset:8192
    v_mfma_f32_16x16x32_bf16 v[92:95], a[32:35], a[120:123], v[92:95]
    s_min_u32 s73, s73, s55
    ds_read_b128 a[76:79], v19 offset:10240
    v_mfma_f32_16x16x32_bf16 v[84:87], a[32:35], a[116:119], v[84:87]
    s_add_u32 s3, s3, 1024
    ds_read_b128 a[80:83], v19 offset:12288
    v_mfma_f32_16x16x32_bf16 v[76:79], a[32:35], a[112:115], v[76:79]
    s_addk_i32 m0, 1024
    ds_read_b128 a[84:87], v19 offset:14336
    s_sub_u32 s55, s3, 1152
    v_mfma_f32_16x16x32_bf16 v[68:71], a[32:35], a[108:111], v[68:71]
    buffer_load_dwordx4 v10, s[4:7], s46 offen lds
    v_mfma_f32_16x16x32_bf16 v[60:63], a[32:35], a[104:107], v[60:63]
    s_min_u32 s3, s3, s55
    ds_read_b128 a[88:91], v19 offset:16384
    v_mfma_f32_16x16x32_bf16 v[52:55], a[32:35], a[100:103], v[52:55]
    s_mov_b32 s74, s3
    ds_read_b64_tr_b16 a[0:1], v13 offset:0
    v_mfma_f32_16x16x32_bf16 v[44:47], a[32:35], a[96:99], v[44:47]
    s_and_b32 s55, s49, 2
    ds_read_b64_tr_b16 a[2:3], v13 offset:13824
    v_mfma_f32_16x16x32_bf16 v[36:39], a[32:35], a[92:95], v[36:39]
    s_addk_i32 m0, 1024
    ds_read_b64_tr_b16 a[4:5], v13 offset:40
    s_mul_i32 s55, s55, 144
    v_mfma_f32_16x16x32_bf16 a[128:131], a[36:39], a[124:127], a[128:131]
    buffer_load_dwordx4 v11, s[4:7], s46 offen lds
    v_mfma_f32_16x16x32_bf16 v[96:99], a[36:39], a[92:95], v[96:99]
    s_mul_i32 s56, s48, 36
    ds_read_b64_tr_b16 a[6:7], v13 offset:13864
    v_mfma_f32_16x16x32_bf16 v[108:111], a[36:39], a[96:99], v[108:111]
    s_add_u32 s56, s55, s56
    ds_read_b64_tr_b16 a[8:9], v13 offset:288
    v_mfma_f32_16x16x32_bf16 v[120:123], a[36:39], a[100:103], v[120:123]
    ds_read_b64_tr_b16 a[10:11], v13 offset:14112
    v_lshrrev_b32 v26, 3, v0
    v_mfma_f32_16x16x32_bf16 v[132:135], a[36:39], a[104:107], v[132:135]
    s_add_u32 m0, s61, 18432
    ds_read_b64_tr_b16 a[12:13], v13 offset:328
    v_add_u32 v29, s56, v26
    v_mfma_f32_16x16x32_bf16 v[144:147], a[36:39], a[108:111], v[144:147]
    buffer_load_dwordx4 v12, s[4:7], s46 offen lds
    v_mfma_f32_16x16x32_bf16 v[156:159], a[36:39], a[112:115], v[156:159]
    ds_read_b64_tr_b16 a[14:15], v13 offset:14152
    v_mul_u32_u24 v29, 1152, v29
    v_mfma_f32_16x16x32_bf16 v[168:171], a[36:39], a[116:119], v[168:171]
    ds_read_b64_tr_b16 a[16:17], v13 offset:576
    v_add_u32 v21, v29, v28
    v_mfma_f32_16x16x32_bf16 v[180:183], a[36:39], a[120:123], v[180:183]
    ds_read_b64_tr_b16 a[18:19], v13 offset:14400
    v_add_u32 v22, 9216, v21
    v_mfma_f32_16x16x32_bf16 v[188:191], a[40:43], a[120:123], v[188:191]
    s_add_u32 m0, s58, 59904
    ds_read_b64_tr_b16 a[20:21], v13 offset:616
    v_add_u32 v23, 23040, v21
    v_mfma_f32_16x16x32_bf16 v[176:179], a[40:43], a[116:119], v[176:179]
    buffer_load_dwordx4 v5, s[8:11], s47 offen lds
    v_mfma_f32_16x16x32_bf16 v[164:167], a[40:43], a[112:115], v[164:167]
    ds_read_b64_tr_b16 a[22:23], v13 offset:14440
    v_add_u32 v24, 32256, v21
    v_mfma_f32_16x16x32_bf16 v[152:155], a[40:43], a[108:111], v[152:155]
    s_xor_b32 s56, s54, s77
    ds_read_b64_tr_b16 a[24:25], v15 offset:0
    v_mfma_f32_16x16x32_bf16 v[140:143], a[40:43], a[104:107], v[140:143]
    s_lshl1_add_u32 s56, s56, s53
    ds_read_b64_tr_b16 a[26:27], v16 offset:0
    v_mfma_f32_16x16x32_bf16 v[128:131], a[40:43], a[100:103], v[128:131]
    s_mul_i32 s56, s56, 72
    v_mfma_f32_16x16x32_bf16 v[116:119], a[40:43], a[96:99], v[116:119]
    s_addk_i32 m0, 1024
    s_add_u32 s56, s56, s55
    v_mfma_f32_16x16x32_bf16 v[104:107], a[40:43], a[92:95], v[104:107]
    buffer_load_dwordx4 v6, s[8:11], s47 offen lds
    v_mfma_f32_16x16x32_bf16 a[136:139], a[40:43], a[124:127], a[136:139]
    s_add_u32 s56, s56, 16
    v_mfma_f32_16x16x32_bf16 a[140:143], a[124:127], a[44:47], a[140:143]
    s_lshl_b32 s77, s77, 5
    v_mfma_f32_16x16x32_bf16 v[192:195], a[92:95], a[44:47], v[192:195]
    v_lshrrev_b32 v29, 5, v0
    v_mul_u32_u24 v29, 36, v29
    v_mfma_f32_16x16x32_bf16 v[208:211], a[96:99], a[44:47], v[208:211]
    s_addk_i32 m0, 1024
    v_and_b32 v26, 3, v26
    v_add3_u32 v29, v29, v26, s56
    v_mfma_f32_16x16x32_bf16 v[196:199], a[100:103], a[44:47], v[196:199]
    buffer_load_dwordx4 v7, s[8:11], s47 offen lds
    v_mfma_f32_16x16x32_bf16 v[212:215], a[104:107], a[44:47], v[212:215]
    v_mul_u32_u24 v29, 1152, v29
    v_add_u32 v25, v29, v28
    v_mfma_f32_16x16x32_bf16 v[200:203], a[108:111], a[44:47], v[200:203]
    s_lshl_b32 s62, s48, 12
    v_mfma_f32_16x16x32_bf16 v[216:219], a[112:115], a[44:47], v[216:219]
    s_add_u32 s47, s47, s68
    s_lshl_b32 s63, s48, 10
    v_mfma_f32_16x16x32_bf16 v[204:207], a[116:119], a[44:47], v[204:207]
    s_addk_i32 m0, 21760
    s_add_u32 s63, s63, 16384
    v_mfma_f32_16x16x32_bf16 v[220:223], a[120:123], a[44:47], v[220:223]
    buffer_load_dwordx4 v1, s[8:11], s47 offen lds
    v_mfma_f32_16x16x32_bf16 v[252:255], a[120:123], a[48:51], v[252:255]
    v_and_b32 v26, 3, v0
    v_lshlrev_b32 v26, 2, v26
    v_mfma_f32_16x16x32_bf16 v[236:239], a[116:119], a[48:51], v[236:239]
    s_mov_b32 s64, 0x3eae1a93
    v_mfma_f32_16x16x32_bf16 v[248:251], a[112:115], a[48:51], v[248:251]
    s_mov_b32 s65, 0xbeae1a93
    v_mfma_f32_16x16x32_bf16 v[232:235], a[108:111], a[48:51], v[232:235]
    s_addk_i32 m0, 1024
    v_mfma_f32_16x16x32_bf16 v[244:247], a[104:107], a[48:51], v[244:247]
    buffer_load_dwordx4 v2, s[8:11], s47 offen lds
    v_mfma_f32_16x16x32_bf16 v[228:231], a[100:103], a[48:51], v[228:231]
    v_mfma_f32_16x16x32_bf16 v[240:243], a[96:99], a[48:51], v[240:243]
    v_mfma_f32_16x16x32_bf16 v[224:227], a[92:95], a[48:51], v[224:227]
    v_mfma_f32_16x16x32_bf16 a[144:147], a[124:127], a[48:51], a[144:147]
    s_addk_i32 m0, 1024
    v_mfma_f32_16x16x32_bf16 a[132:135], a[52:55], a[124:127], a[132:135]
    buffer_load_dwordx4 v3, s[8:11], s47 offen lds
    v_mfma_f32_16x16x32_bf16 v[100:103], a[52:55], a[92:95], v[100:103]
    v_mfma_f32_16x16x32_bf16 v[112:115], a[52:55], a[96:99], v[112:115]
    v_mfma_f32_16x16x32_bf16 v[124:127], a[52:55], a[100:103], v[124:127]
    v_mfma_f32_16x16x32_bf16 v[136:139], a[52:55], a[104:107], v[136:139]
    v_mfma_f32_16x16x32_bf16 v[148:151], a[52:55], a[108:111], v[148:151]
    v_mfma_f32_16x16x32_bf16 v[160:163], a[52:55], a[112:115], v[160:163]
    v_mfma_f32_16x16x32_bf16 v[172:175], a[52:55], a[116:119], v[172:175]
    s_waitcnt vmcnt(15) lgkmcnt(0)
    v_mfma_f32_16x16x32_bf16 v[184:187], a[52:55], a[120:123], v[184:187]
    s_barrier
    v_mfma_f32_16x16x32_bf16 v[32:35], a[0:3], a[56:59], v[32:35]
    s_addk_i32 m0, 1024
    ds_read_b128 a[92:95], v20 offset:0
    v_mfma_f32_16x16x32_bf16 v[40:43], a[0:3], a[60:63], v[40:43]
    buffer_load_dwordx4 v4, s[8:11], s47 offen lds
    v_mfma_f32_16x16x32_bf16 v[48:51], a[0:3], a[64:67], v[48:51]
    ds_read_b128 a[96:99], v20 offset:2048
    v_mfma_f32_16x16x32_bf16 v[56:59], a[0:3], a[68:71], v[56:59]
    ds_read_b128 a[100:103], v20 offset:4096
    v_mfma_f32_16x16x32_bf16 v[64:67], a[0:3], a[72:75], v[64:67]
    ds_read_b128 a[104:107], v20 offset:6144
    v_mfma_f32_16x16x32_bf16 v[72:75], a[0:3], a[76:79], v[72:75]
    s_addk_i32 m0, 1024
    ds_read_b128 a[108:111], v20 offset:8192
    v_mfma_f32_16x16x32_bf16 v[80:83], a[0:3], a[80:83], v[80:83]
    buffer_load_dwordx4 v5, s[8:11], s47 offen lds
    v_mfma_f32_16x16x32_bf16 v[88:91], a[0:3], a[84:87], v[88:91]
    ds_read_b128 a[112:115], v20 offset:10240
    v_mfma_f32_16x16x32_bf16 v[92:95], a[4:7], a[84:87], v[92:95]
    ds_read_b128 a[116:119], v20 offset:12288
    v_mfma_f32_16x16x32_bf16 v[84:87], a[4:7], a[80:83], v[84:87]
    ds_read_b128 a[120:123], v20 offset:14336
    v_mfma_f32_16x16x32_bf16 v[76:79], a[4:7], a[76:79], v[76:79]
    ds_read_b128 a[124:127], v20 offset:16384
    v_mfma_f32_16x16x32_bf16 v[68:71], a[4:7], a[72:75], v[68:71]
    s_addk_i32 m0, 1024
    ds_read_b64_tr_b16 a[28:29], v13 offset:27904
    v_mfma_f32_16x16x32_bf16 v[60:63], a[4:7], a[68:71], v[60:63]
    buffer_load_dwordx4 v6, s[8:11], s47 offen lds
    v_mfma_f32_16x16x32_bf16 v[52:55], a[4:7], a[64:67], v[52:55]
    ds_read_b64_tr_b16 a[30:31], v13 offset:41728
    v_mfma_f32_16x16x32_bf16 v[44:47], a[4:7], a[60:63], v[44:47]
    ds_read_b64_tr_b16 a[32:33], v13 offset:27944
    v_mfma_f32_16x16x32_bf16 v[36:39], a[4:7], a[56:59], v[36:39]
    ds_read_b64_tr_b16 a[34:35], v13 offset:41768
    v_mfma_f32_16x16x32_bf16 a[128:131], a[8:11], a[88:91], a[128:131]
    ds_read_b64_tr_b16 a[36:37], v13 offset:28192
    v_mfma_f32_16x16x32_bf16 v[96:99], a[8:11], a[56:59], v[96:99]
    s_addk_i32 m0, 1024
    ds_read_b64_tr_b16 a[38:39], v13 offset:42016
    v_mfma_f32_16x16x32_bf16 v[108:111], a[8:11], a[60:63], v[108:111]
    buffer_load_dwordx4 v7, s[8:11], s47 offen lds
    v_mfma_f32_16x16x32_bf16 v[120:123], a[8:11], a[64:67], v[120:123]
    ds_read_b64_tr_b16 a[40:41], v13 offset:28232
    v_mfma_f32_16x16x32_bf16 v[132:135], a[8:11], a[68:71], v[132:135]
    ds_read_b64_tr_b16 a[42:43], v13 offset:42056
    v_mfma_f32_16x16x32_bf16 v[144:147], a[8:11], a[72:75], v[144:147]
    s_mul_i32 s47, s23, 110592
    ds_read_b64_tr_b16 a[44:45], v13 offset:28480
    v_mfma_f32_16x16x32_bf16 v[156:159], a[8:11], a[76:79], v[156:159]
    s_add_u32 m0, s58, 0
    ds_read_b64_tr_b16 a[46:47], v13 offset:42304
    v_mfma_f32_16x16x32_bf16 v[168:171], a[8:11], a[80:83], v[168:171]
    buffer_load_dwordx4 v1, s[8:11], s47 offen lds
    v_mfma_f32_16x16x32_bf16 v[180:183], a[8:11], a[84:87], v[180:183]
    ds_read_b64_tr_b16 a[48:49], v13 offset:28520
    v_mfma_f32_16x16x32_bf16 v[188:191], a[12:15], a[84:87], v[188:191]
    ds_read_b64_tr_b16 a[50:51], v13 offset:42344
    v_mfma_f32_16x16x32_bf16 v[176:179], a[12:15], a[80:83], v[176:179]
    ds_read_b64_tr_b16 a[52:53], v15 offset:27904
    v_mfma_f32_16x16x32_bf16 v[164:167], a[12:15], a[76:79], v[164:167]
    ds_read_b64_tr_b16 a[54:55], v16 offset:27904
    v_mfma_f32_16x16x32_bf16 v[152:155], a[12:15], a[72:75], v[152:155]
    s_addk_i32 m0, 1024
    v_mfma_f32_16x16x32_bf16 v[140:143], a[12:15], a[68:71], v[140:143]
    buffer_load_dwordx4 v2, s[8:11], s47 offen lds
    v_mfma_f32_16x16x32_bf16 v[128:131], a[12:15], a[64:67], v[128:131]
    v_mfma_f32_16x16x32_bf16 v[116:119], a[12:15], a[60:63], v[116:119]
    v_mfma_f32_16x16x32_bf16 v[104:107], a[12:15], a[56:59], v[104:107]
    v_mfma_f32_16x16x32_bf16 a[136:139], a[12:15], a[88:91], a[136:139]
    v_mfma_f32_16x16x32_bf16 a[140:143], a[88:91], a[16:19], a[140:143]
    s_addk_i32 m0, 1024
    v_mfma_f32_16x16x32_bf16 v[192:195], a[56:59], a[16:19], v[192:195]
    buffer_load_dwordx4 v3, s[8:11], s47 offen lds
    v_mfma_f32_16x16x32_bf16 v[208:211], a[60:63], a[16:19], v[208:211]
    v_mfma_f32_16x16x32_bf16 v[196:199], a[64:67], a[16:19], v[196:199]
    v_mfma_f32_16x16x32_bf16 v[212:215], a[68:71], a[16:19], v[212:215]
    v_mfma_f32_16x16x32_bf16 v[200:203], a[72:75], a[16:19], v[200:203]
    s_addk_i32 m0, 1024
    v_mfma_f32_16x16x32_bf16 v[216:219], a[76:79], a[16:19], v[216:219]
    buffer_load_dwordx4 v4, s[8:11], s47 offen lds
    v_mfma_f32_16x16x32_bf16 v[204:207], a[80:83], a[16:19], v[204:207]
    v_mfma_f32_16x16x32_bf16 v[220:223], a[84:87], a[16:19], v[220:223]
    v_mfma_f32_16x16x32_bf16 v[252:255], a[84:87], a[20:23], v[252:255]
    v_mfma_f32_16x16x32_bf16 v[236:239], a[80:83], a[20:23], v[236:239]
    v_mfma_f32_16x16x32_bf16 v[248:251], a[76:79], a[20:23], v[248:251]
    s_addk_i32 m0, 1024
    v_mfma_f32_16x16x32_bf16 v[232:235], a[72:75], a[20:23], v[232:235]
    buffer_load_dwordx4 v5, s[8:11], s47 offen lds
    v_mfma_f32_16x16x32_bf16 v[244:247], a[68:71], a[20:23], v[244:247]
    v_mfma_f32_16x16x32_bf16 v[228:231], a[64:67], a[20:23], v[228:231]
    v_mfma_f32_16x16x32_bf16 v[240:243], a[60:63], a[20:23], v[240:243]
    v_mfma_f32_16x16x32_bf16 v[224:227], a[56:59], a[20:23], v[224:227]
    v_mfma_f32_16x16x32_bf16 a[144:147], a[88:91], a[20:23], a[144:147]
    s_addk_i32 m0, 1024
    v_mfma_f32_16x16x32_bf16 a[132:135], a[24:27], a[88:91], a[132:135]
    buffer_load_dwordx4 v6, s[8:11], s47 offen lds
    v_mfma_f32_16x16x32_bf16 v[100:103], a[24:27], a[56:59], v[100:103]
    v_mfma_f32_16x16x32_bf16 v[112:115], a[24:27], a[60:63], v[112:115]
    v_mfma_f32_16x16x32_bf16 v[124:127], a[24:27], a[64:67], v[124:127]
    v_mfma_f32_16x16x32_bf16 v[136:139], a[24:27], a[68:71], v[136:139]
    v_mfma_f32_16x16x32_bf16 v[148:151], a[24:27], a[72:75], v[148:151]
    v_mfma_f32_16x16x32_bf16 v[160:163], a[24:27], a[76:79], v[160:163]
    v_mfma_f32_16x16x32_bf16 v[172:175], a[24:27], a[80:83], v[172:175]
    s_waitcnt vmcnt(13) lgkmcnt(0)
    v_mfma_f32_16x16x32_bf16 v[184:187], a[24:27], a[84:87], v[184:187]
    s_barrier
    v_mfma_f32_16x16x32_bf16 v[32:35], a[28:31], a[92:95], v[32:35]
    s_lshr_b32 s46, s23, 1
    s_lshl_b32 s46, s46, 7
    ds_read_b128 a[56:59], v19 offset:18432
    s_add_u32 m0, s60, 0
    v_mfma_f32_16x16x32_bf16 v[40:43], a[28:31], a[96:99], v[40:43]
    buffer_load_dwordx4 v8, s[4:7], s46 offen lds
    v_mfma_f32_16x16x32_bf16 v[48:51], a[28:31], a[100:103], v[48:51]
    ds_read_b128 a[60:63], v19 offset:20480
    v_mfma_f32_16x16x32_bf16 v[56:59], a[28:31], a[104:107], v[56:59]
    ds_read_b128 a[64:67], v19 offset:22528
    v_mfma_f32_16x16x32_bf16 v[64:67], a[28:31], a[108:111], v[64:67]
    ds_read_b128 a[68:71], v19 offset:24576
    v_mfma_f32_16x16x32_bf16 v[72:75], a[28:31], a[112:115], v[72:75]
    s_addk_i32 m0, 1024
    ds_read_b128 a[72:75], v19 offset:26624
    v_mfma_f32_16x16x32_bf16 v[80:83], a[28:31], a[116:119], v[80:83]
    buffer_load_dwordx4 v9, s[4:7], s46 offen lds
    v_mfma_f32_16x16x32_bf16 v[88:91], a[28:31], a[120:123], v[88:91]
    ds_read_b128 a[76:79], v19 offset:28672
    v_mfma_f32_16x16x32_bf16 v[92:95], a[32:35], a[120:123], v[92:95]
    ds_read_b128 a[80:83], v19 offset:30720
    v_mfma_f32_16x16x32_bf16 v[84:87], a[32:35], a[116:119], v[84:87]
    ds_read_b128 a[84:87], v19 offset:32768
    v_mfma_f32_16x16x32_bf16 v[76:79], a[32:35], a[112:115], v[76:79]
    ds_read_b128 a[88:91], v19 offset:34816
    v_mfma_f32_16x16x32_bf16 v[68:71], a[32:35], a[108:111], v[68:71]
    s_addk_i32 m0, 1024
    ds_read_b64_tr_b16 a[0:1], v14 offset:0
    v_mfma_f32_16x16x32_bf16 v[60:63], a[32:35], a[104:107], v[60:63]
    buffer_load_dwordx4 v10, s[4:7], s46 offen lds
    v_mfma_f32_16x16x32_bf16 v[52:55], a[32:35], a[100:103], v[52:55]
    ds_read_b64_tr_b16 a[2:3], v14 offset:13824
    v_mfma_f32_16x16x32_bf16 v[44:47], a[32:35], a[96:99], v[44:47]
    ds_read_b64_tr_b16 a[4:5], v14 offset:40
    v_mfma_f32_16x16x32_bf16 v[36:39], a[32:35], a[92:95], v[36:39]
    ds_read_b64_tr_b16 a[6:7], v14 offset:13864
    v_mfma_f32_16x16x32_bf16 a[128:131], a[36:39], a[124:127], a[128:131]
    ds_read_b64_tr_b16 a[8:9], v14 offset:288
    v_mfma_f32_16x16x32_bf16 v[96:99], a[36:39], a[92:95], v[96:99]
    s_addk_i32 m0, 1024
    ds_read_b64_tr_b16 a[10:11], v14 offset:14112
    v_mfma_f32_16x16x32_bf16 v[108:111], a[36:39], a[96:99], v[108:111]
    buffer_load_dwordx4 v11, s[4:7], s46 offen lds
    v_mfma_f32_16x16x32_bf16 v[120:123], a[36:39], a[100:103], v[120:123]
    ds_read_b64_tr_b16 a[12:13], v14 offset:328
    v_mfma_f32_16x16x32_bf16 v[132:135], a[36:39], a[104:107], v[132:135]
    ds_read_b64_tr_b16 a[14:15], v14 offset:14152
    v_mfma_f32_16x16x32_bf16 v[144:147], a[36:39], a[108:111], v[144:147]
    ds_read_b64_tr_b16 a[16:17], v14 offset:576
    v_mfma_f32_16x16x32_bf16 v[156:159], a[36:39], a[112:115], v[156:159]
    s_add_u32 m0, s61, 0
    ds_read_b64_tr_b16 a[18:19], v14 offset:14400
    v_mfma_f32_16x16x32_bf16 v[168:171], a[36:39], a[116:119], v[168:171]
    buffer_load_dwordx4 v12, s[4:7], s46 offen lds
    v_mfma_f32_16x16x32_bf16 v[180:183], a[36:39], a[120:123], v[180:183]
    ds_read_b64_tr_b16 a[20:21], v14 offset:616
    v_mfma_f32_16x16x32_bf16 v[188:191], a[40:43], a[120:123], v[188:191]
    ds_read_b64_tr_b16 a[22:23], v14 offset:14440
    v_mfma_f32_16x16x32_bf16 v[176:179], a[40:43], a[116:119], v[176:179]
    ds_read_b64_tr_b16 a[24:25], v17 offset:0
    v_mfma_f32_16x16x32_bf16 v[164:167], a[40:43], a[112:115], v[164:167]
    ds_read_b64_tr_b16 a[26:27], v18 offset:0
    v_mfma_f32_16x16x32_bf16 v[152:155], a[40:43], a[108:111], v[152:155]
    s_add_u32 m0, s58, 6144
    v_mfma_f32_16x16x32_bf16 v[140:143], a[40:43], a[104:107], v[140:143]
    buffer_load_dwordx4 v7, s[8:11], s47 offen lds
    v_mfma_f32_16x16x32_bf16 v[128:131], a[40:43], a[100:103], v[128:131]
    v_mfma_f32_16x16x32_bf16 v[116:119], a[40:43], a[96:99], v[116:119]
    v_mfma_f32_16x16x32_bf16 v[104:107], a[40:43], a[92:95], v[104:107]
    v_mfma_f32_16x16x32_bf16 a[136:139], a[40:43], a[124:127], a[136:139]
    s_add_u32 s47, s47, s68
    v_mfma_f32_16x16x32_bf16 a[140:143], a[124:127], a[44:47], a[140:143]
    s_addk_i32 m0, 21760
    v_mfma_f32_16x16x32_bf16 v[192:195], a[92:95], a[44:47], v[192:195]
    buffer_load_dwordx4 v1, s[8:11], s47 offen lds
    v_mfma_f32_16x16x32_bf16 v[208:211], a[96:99], a[44:47], v[208:211]
    v_mfma_f32_16x16x32_bf16 v[196:199], a[100:103], a[44:47], v[196:199]
    v_mfma_f32_16x16x32_bf16 v[212:215], a[104:107], a[44:47], v[212:215]
    v_mfma_f32_16x16x32_bf16 v[200:203], a[108:111], a[44:47], v[200:203]
    s_addk_i32 m0, 1024
    v_mfma_f32_16x16x32_bf16 v[216:219], a[112:115], a[44:47], v[216:219]
    buffer_load_dwordx4 v2, s[8:11], s47 offen lds
    v_mfma_f32_16x16x32_bf16 v[204:207], a[116:119], a[44:47], v[204:207]
    v_mfma_f32_16x16x32_bf16 v[220:223], a[120:123], a[44:47], v[220:223]
    v_mfma_f32_16x16x32_bf16 v[252:255], a[120:123], a[48:51], v[252:255]
    v_mfma_f32_16x16x32_bf16 v[236:239], a[116:119], a[48:51], v[236:239]
    v_mfma_f32_16x16x32_bf16 v[248:251], a[112:115], a[48:51], v[248:251]
    s_addk_i32 m0, 1024
    v_mfma_f32_16x16x32_bf16 v[232:235], a[108:111], a[48:51], v[232:235]
    buffer_load_dwordx4 v3, s[8:11], s47 offen lds
    v_mfma_f32_16x16x32_bf16 v[244:247], a[104:107], a[48:51], v[244:247]
    v_mfma_f32_16x16x32_bf16 v[228:231], a[100:103], a[48:51], v[228:231]
    v_mfma_f32_16x16x32_bf16 v[240:243], a[96:99], a[48:51], v[240:243]
    v_mfma_f32_16x16x32_bf16 v[224:227], a[92:95], a[48:51], v[224:227]
    v_mfma_f32_16x16x32_bf16 a[144:147], a[124:127], a[48:51], a[144:147]
    s_addk_i32 m0, 1024
    v_mfma_f32_16x16x32_bf16 a[132:135], a[52:55], a[124:127], a[132:135]
    buffer_load_dwordx4 v4, s[8:11], s47 offen lds
    v_mfma_f32_16x16x32_bf16 v[100:103], a[52:55], a[92:95], v[100:103]
    v_mfma_f32_16x16x32_bf16 v[112:115], a[52:55], a[96:99], v[112:115]
    v_mfma_f32_16x16x32_bf16 v[124:127], a[52:55], a[100:103], v[124:127]
    v_mfma_f32_16x16x32_bf16 v[136:139], a[52:55], a[104:107], v[136:139]
    v_mfma_f32_16x16x32_bf16 v[148:151], a[52:55], a[108:111], v[148:151]
    v_mfma_f32_16x16x32_bf16 v[160:163], a[52:55], a[112:115], v[160:163]
    v_mfma_f32_16x16x32_bf16 v[172:175], a[52:55], a[116:119], v[172:175]
    s_mov_b64 exec, 0
    s_cmp_eq_u32 s48, 0
    s_cbranch_scc1 L_stubA5
    s_cmp_eq_u32 s48, 1
    s_cbranch_scc1 L_stubA6
    s_cmp_eq_u32 s48, 2
    s_cbranch_scc1 L_stubA7
    s_cmp_eq_u32 s48, 3
    s_cbranch_scc1 L_stubA8
L_jrA2:
    s_mov_b64 exec, -1
    s_waitcnt vmcnt(16) lgkmcnt(0)
    v_mfma_f32_16x16x32_bf16 v[184:187], a[52:55], a[120:123], v[184:187]
    s_barrier
    v_mfma_f32_16x16x32_bf16 v[32:35], a[0:3], a[56:59], v[32:35]
    s_addk_i32 m0, 1024
    ds_read_b128 a[92:95], v20 offset:18432
    v_mfma_f32_16x16x32_bf16 v[40:43], a[0:3], a[60:63], v[40:43]
    buffer_load_dwordx4 v5, s[8:11], s47 offen lds
    v_mfma_f32_16x16x32_bf16 v[48:51], a[0:3], a[64:67], v[48:51]
    ds_read_b128 a[96:99], v20 offset:20480
    v_mfma_f32_16x16x32_bf16 v[56:59], a[0:3], a[68:71], v[56:59]
    ds_read_b128 a[100:103], v20 offset:22528
    v_mfma_f32_16x16x32_bf16 v[64:67], a[0:3], a[72:75], v[64:67]
    ds_read_b128 a[104:107], v20 offset:24576
    v_mfma_f32_16x16x32_bf16 v[72:75], a[0:3], a[76:79], v[72:75]
    s_addk_i32 m0, 1024
    ds_read_b128 a[108:111], v20 offset:26624
    v_mfma_f32_16x16x32_bf16 v[80:83], a[0:3], a[80:83], v[80:83]
    buffer_load_dwordx4 v6, s[8:11], s47 offen lds
    v_mfma_f32_16x16x32_bf16 v[88:91], a[0:3], a[84:87], v[88:91]
    ds_read_b128 a[112:115], v20 offset:28672
    v_mfma_f32_16x16x32_bf16 v[92:95], a[4:7], a[84:87], v[92:95]
    ds_read_b128 a[116:119], v20 offset:30720
    v_mfma_f32_16x16x32_bf16 v[84:87], a[4:7], a[80:83], v[84:87]
    ds_read_b128 a[120:123], v20 offset:32768
    v_mfma_f32_16x16x32_bf16 v[76:79], a[4:7], a[76:79], v[76:79]
    ds_read_b128 a[124:127], v20 offset:34816
    v_mfma_f32_16x16x32_bf16 v[68:71], a[4:7], a[72:75], v[68:71]
    s_addk_i32 m0, 1024
    ds_read_b64_tr_b16 a[28:29], v14 offset:27904
    v_mfma_f32_16x16x32_bf16 v[60:63], a[4:7], a[68:71], v[60:63]
    buffer_load_dwordx4 v7, s[8:11], s47 offen lds
    v_mfma_f32_16x16x32_bf16 v[52:55], a[4:7], a[64:67], v[52:55]
    ds_read_b64_tr_b16 a[30:31], v14 offset:41728
    v_mfma_f32_16x16x32_bf16 v[44:47], a[4:7], a[60:63], v[44:47]
    ds_read_b64_tr_b16 a[32:33], v14 offset:27944
    v_mfma_f32_16x16x32_bf16 v[36:39], a[4:7], a[56:59], v[36:39]
    ds_read_b64_tr_b16 a[34:35], v14 offset:41768
    v_mfma_f32_16x16x32_bf16 a[128:131], a[8:11], a[88:91], a[128:131]
    s_add_u32 s47, s47, s69
    s_sub_u32 s67, s47, 663552
    s_cmp_ge_u32 s47, 1990656
    s_cselect_b32 s47, s67, s47
    v_mfma_f32_16x16x32_bf16 v[96:99], a[8:11], a[56:59], v[96:99]
    s_addk_i32 m0, 21760
    ds_read_b64_tr_b16 a[36:37], v14 offset:28192
    v_mfma_f32_16x16x32_bf16 v[108:111], a[8:11], a[60:63], v[108:111]
    buffer_load_dwordx4 v1, s[8:11], s47 offen lds
    v_mfma_f32_16x16x32_bf16 v[120:123], a[8:11], a[64:67], v[120:123]
    ds_read_b64_tr_b16 a[38:39], v14 offset:42016
    v_mfma_f32_16x16x32_bf16 v[132:135], a[8:11], a[68:71], v[132:135]
    ds_read_b64_tr_b16 a[40:41], v14 offset:28232
    v_mfma_f32_16x16x32_bf16 v[144:147], a[8:11], a[72:75], v[144:147]
    ds_read_b64_tr_b16 a[42:43], v14 offset:42056
    v_mfma_f32_16x16x32_bf16 v[156:159], a[8:11], a[76:79], v[156:159]
    s_addk_i32 m0, 1024
    ds_read_b64_tr_b16 a[44:45], v14 offset:28480
    v_mfma_f32_16x16x32_bf16 v[168:171], a[8:11], a[80:83], v[168:171]
    buffer_load_dwordx4 v2, s[8:11], s47 offen lds
    v_mfma_f32_16x16x32_bf16 v[180:183], a[8:11], a[84:87], v[180:183]
    ds_read_b64_tr_b16 a[46:47], v14 offset:42304
    v_mfma_f32_16x16x32_bf16 v[188:191], a[12:15], a[84:87], v[188:191]
    ds_read_b64_tr_b16 a[48:49], v14 offset:28520
    v_mfma_f32_16x16x32_bf16 v[176:179], a[12:15], a[80:83], v[176:179]
    ds_read_b64_tr_b16 a[50:51], v14 offset:42344
    v_mfma_f32_16x16x32_bf16 v[164:167], a[12:15], a[76:79], v[164:167]
    ds_read_b64_tr_b16 a[52:53], v17 offset:27904
    v_mfma_f32_16x16x32_bf16 v[152:155], a[12:15], a[72:75], v[152:155]
    s_addk_i32 m0, 1024
    ds_read_b64_tr_b16 a[54:55], v18 offset:27904
    v_mfma_f32_16x16x32_bf16 v[140:143], a[12:15], a[68:71], v[140:143]
    buffer_load_dwordx4 v3, s[8:11], s47 offen lds
    v_mfma_f32_16x16x32_bf16 v[128:131], a[12:15], a[64:67], v[128:131]
    v_mfma_f32_16x16x32_bf16 v[116:119], a[12:15], a[60:63], v[116:119]
    v_mfma_f32_16x16x32_bf16 v[104:107], a[12:15], a[56:59], v[104:107]
    v_mfma_f32_16x16x32_bf16 a[136:139], a[12:15], a[88:91], a[136:139]
    v_mfma_f32_16x16x32_bf16 a[140:143], a[88:91], a[16:19], a[140:143]
    s_addk_i32 m0, 1024
    v_mfma_f32_16x16x32_bf16 v[192:195], a[56:59], a[16:19], v[192:195]
    buffer_load_dwordx4 v4, s[8:11], s47 offen lds
    v_mfma_f32_16x16x32_bf16 v[208:211], a[60:63], a[16:19], v[208:211]
    v_mfma_f32_16x16x32_bf16 v[196:199], a[64:67], a[16:19], v[196:199]
    v_mfma_f32_16x16x32_bf16 v[212:215], a[68:71], a[16:19], v[212:215]
    v_mfma_f32_16x16x32_bf16 v[200:203], a[72:75], a[16:19], v[200:203]
    s_addk_i32 m0, 1024
    v_mfma_f32_16x16x32_bf16 v[216:219], a[76:79], a[16:19], v[216:219]
    buffer_load_dwordx4 v5, s[8:11], s47 offen lds
    v_mfma_f32_16x16x32_bf16 v[204:207], a[80:83], a[16:19], v[204:207]
    v_mfma_f32_16x16x32_bf16 v[220:223], a[84:87], a[16:19], v[220:223]
    v_mfma_f32_16x16x32_bf16 v[252:255], a[84:87], a[20:23], v[252:255]
    v_mfma_f32_16x16x32_bf16 v[236:239], a[80:83], a[20:23], v[236:239]
    v_mfma_f32_16x16x32_bf16 v[248:251], a[76:79], a[20:23], v[248:251]
    s_addk_i32 m0, 1024
    v_mfma_f32_16x16x32_bf16 v[232:235], a[72:75], a[20:23], v[232:235]
    buffer_load_dwordx4 v6, s[8:11], s47 offen lds
    v_mfma_f32_16x16x32_bf16 v[244:247], a[68:71], a[20:23], v[244:247]
    v_mfma_f32_16x16x32_bf16 v[228:231], a[64:67], a[20:23], v[228:231]
    v_mfma_f32_16x16x32_bf16 v[240:243], a[60:63], a[20:23], v[240:243]
    v_mfma_f32_16x16x32_bf16 v[224:227], a[56:59], a[20:23], v[224:227]
    v_mfma_f32_16x16x32_bf16 a[144:147], a[88:91], a[20:23], a[144:147]
    s_addk_i32 m0, 1024
    v_mfma_f32_16x16x32_bf16 a[132:135], a[24:27], a[88:91], a[132:135]
    buffer_load_dwordx4 v7, s[8:11], s47 offen lds
    v_mfma_f32_16x16x32_bf16 v[100:103], a[24:27], a[56:59], v[100:103]
    v_mfma_f32_16x16x32_bf16 v[112:115], a[24:27], a[60:63], v[112:115]
    v_mfma_f32_16x16x32_bf16 v[124:127], a[24:27], a[64:67], v[124:127]
    v_mfma_f32_16x16x32_bf16 v[136:139], a[24:27], a[68:71], v[136:139]
    v_mfma_f32_16x16x32_bf16 v[148:151], a[24:27], a[72:75], v[148:151]
    v_mfma_f32_16x16x32_bf16 v[160:163], a[24:27], a[76:79], v[160:163]
    v_mfma_f32_16x16x32_bf16 v[172:175], a[24:27], a[80:83], v[172:175]
L_stubA4:
    s_cbranch_execz L_jrA0
    s_nop 0
    s_waitcnt vmcnt(14) lgkmcnt(0)
    v_mfma_f32_16x16x32_bf16 v[184:187], a[24:27], a[84:87], v[184:187]
    s_barrier
    v_mfma_f32_16x16x32_bf16 v[32:35], a[28:31], a[92:95], v[32:35]
    s_add_u32 s46, s46, 128
    s_cmpk_eq_u32 s46, 1152
    s_cselect_b32 s46, 768, s46
    ds_read_b128 a[56:59], v19 offset:0
    s_add_u32 m0, s60, 18432
    v_mfma_f32_16x16x32_bf16 v[40:43], a[28:31], a[96:99], v[40:43]
    buffer_load_dwordx4 v8, s[4:7], s46 offen lds
    v_mfma_f32_16x16x32_bf16 v[48:51], a[28:31], a[100:103], v[48:51]
    ds_read_b128 a[60:63], v19 offset:2048
    v_mfma_f32_16x16x32_bf16 v[56:59], a[28:31], a[104:107], v[56:59]
    ds_read_b128 a[64:67], v19 offset:4096
    v_mfma_f32_16x16x32_bf16 v[64:67], a[28:31], a[108:111], v[64:67]
    ds_read_b128 a[68:71], v19 offset:6144
    v_mfma_f32_16x16x32_bf16 v[72:75], a[28:31], a[112:115], v[72:75]
    s_addk_i32 m0, 1024
    ds_read_b128 a[72:75], v19 offset:8192
    v_mfma_f32_16x16x32_bf16 v[80:83], a[28:31], a[116:119], v[80:83]
    buffer_load_dwordx4 v9, s[4:7], s46 offen lds
    v_mfma_f32_16x16x32_bf16 v[88:91], a[28:31], a[120:123], v[88:91]
    ds_read_b128 a[76:79], v19 offset:10240
    v_mfma_f32_16x16x32_bf16 v[92:95], a[32:35], a[120:123], v[92:95]
    ds_read_b128 a[80:83], v19 offset:12288
    v_mfma_f32_16x16x32_bf16 v[84:87], a[32:35], a[116:119], v[84:87]
    ds_read_b128 a[84:87], v19 offset:14336
    v_mfma_f32_16x16x32_bf16 v[76:79], a[32:35], a[112:115], v[76:79]
    ds_read_b128 a[88:91], v19 offset:16384
    v_mfma_f32_16x16x32_bf16 v[68:71], a[32:35], a[108:111], v[68:71]
    s_addk_i32 m0, 1024
    ds_read_b64_tr_b16 a[0:1], v13 offset:0
    v_mfma_f32_16x16x32_bf16 v[60:63], a[32:35], a[104:107], v[60:63]
    buffer_load_dwordx4 v10, s[4:7], s46 offen lds
    v_mfma_f32_16x16x32_bf16 v[52:55], a[32:35], a[100:103], v[52:55]
    ds_read_b64_tr_b16 a[2:3], v13 offset:13824
    v_mfma_f32_16x16x32_bf16 v[44:47], a[32:35], a[96:99], v[44:47]
    ds_read_b64_tr_b16 a[4:5], v13 offset:40
    v_mfma_f32_16x16x32_bf16 v[36:39], a[32:35], a[92:95], v[36:39]
    ds_read_b64_tr_b16 a[6:7], v13 offset:13864
    v_mfma_f32_16x16x32_bf16 a[128:131], a[36:39], a[124:127], a[128:131]
    ds_read_b64_tr_b16 a[8:9], v13 offset:288
    v_mfma_f32_16x16x32_bf16 v[96:99], a[36:39], a[92:95], v[96:99]
    s_addk_i32 m0, 1024
    ds_read_b64_tr_b16 a[10:11], v13 offset:14112
    v_mfma_f32_16x16x32_bf16 v[108:111], a[36:39], a[96:99], v[108:111]
    buffer_load_dwordx4 v11, s[4:7], s46 offen lds
    v_mfma_f32_16x16x32_bf16 v[120:123], a[36:39], a[100:103], v[120:123]
    ds_read_b64_tr_b16 a[12:13], v13 offset:328
    v_mfma_f32_16x16x32_bf16 v[132:135], a[36:39], a[104:107], v[132:135]
    ds_read_b64_tr_b16 a[14:15], v13 offset:14152
    v_mfma_f32_16x16x32_bf16 v[144:147], a[36:39], a[108:111], v[144:147]
    ds_read_b64_tr_b16 a[16:17], v13 offset:576
    v_mfma_f32_16x16x32_bf16 v[156:159], a[36:39], a[112:115], v[156:159]
    s_add_u32 m0, s61, 18432
    ds_read_b64_tr_b16 a[18:19], v13 offset:14400
    v_mfma_f32_16x16x32_bf16 v[168:171], a[36:39], a[116:119], v[168:171]
    buffer_load_dwordx4 v12, s[4:7], s46 offen lds
    v_mfma_f32_16x16x32_bf16 v[180:183], a[36:39], a[120:123], v[180:183]
    ds_read_b64_tr_b16 a[20:21], v13 offset:616
    v_mfma_f32_16x16x32_bf16 v[188:191], a[40:43], a[120:123], v[188:191]
    ds_read_b64_tr_b16 a[22:23], v13 offset:14440
    v_mfma_f32_16x16x32_bf16 v[176:179], a[40:43], a[116:119], v[176:179]
    ds_read_b64_tr_b16 a[24:25], v15 offset:0
    v_mfma_f32_16x16x32_bf16 v[164:167], a[40:43], a[112:115], v[164:167]
    s_add_u32 s47, s47, s68
    ds_read_b64_tr_b16 a[26:27], v16 offset:0
    v_mfma_f32_16x16x32_bf16 v[152:155], a[40:43], a[108:111], v[152:155]
    s_add_u32 m0, s58, 83712
    v_mfma_f32_16x16x32_bf16 v[140:143], a[40:43], a[104:107], v[140:143]
    buffer_load_dwordx4 v1, s[8:11], s47 offen lds
    v_mfma_f32_16x16x32_bf16 v[128:131], a[40:43], a[100:103], v[128:131]
    v_mfma_f32_16x16x32_bf16 v[116:119], a[40:43], a[96:99], v[116:119]
    v_mfma_f32_16x16x32_bf16 v[104:107], a[40:43], a[92:95], v[104:107]
    v_mfma_f32_16x16x32_bf16 a[136:139], a[40:43], a[124:127], a[136:139]
    v_mfma_f32_16x16x32_bf16 a[140:143], a[124:127], a[44:47], a[140:143]
    s_addk_i32 m0, 1024
    v_mfma_f32_16x16x32_bf16 v[192:195], a[92:95], a[44:47], v[192:195]
    buffer_load_dwordx4 v2, s[8:11], s47 offen lds
    v_mfma_f32_16x16x32_bf16 v[208:211], a[96:99], a[44:47], v[208:211]
    v_mfma_f32_16x16x32_bf16 v[196:199], a[100:103], a[44:47], v[196:199]
    v_mfma_f32_16x16x32_bf16 v[212:215], a[104:107], a[44:47], v[212:215]
    v_mfma_f32_16x16x32_bf16 v[200:203], a[108:111], a[44:47], v[200:203]
    s_addk_i32 m0, 1024
    v_mfma_f32_16x16x32_bf16 v[216:219], a[112:115], a[44:47], v[216:219]
    buffer_load_dwordx4 v3, s[8:11], s47 offen lds
    v_mfma_f32_16x16x32_bf16 v[204:207], a[116:119], a[44:47], v[204:207]
    v_mfma_f32_16x16x32_bf16 v[220:223], a[120:123], a[44:47], v[220:223]
    v_mfma_f32_16x16x32_bf16 v[252:255], a[120:123], a[48:51], v[252:255]
    v_mfma_f32_16x16x32_bf16 v[236:239], a[116:119], a[48:51], v[236:239]
    v_mfma_f32_16x16x32_bf16 v[248:251], a[112:115], a[48:51], v[248:251]
    s_addk_i32 m0, 1024
    v_mfma_f32_16x16x32_bf16 v[232:235], a[108:111], a[48:51], v[232:235]
    buffer_load_dwordx4 v4, s[8:11], s47 offen lds
    v_mfma_f32_16x16x32_bf16 v[244:247], a[104:107], a[48:51], v[244:247]
    v_mfma_f32_16x16x32_bf16 v[228:231], a[100:103], a[48:51], v[228:231]
    v_mfma_f32_16x16x32_bf16 v[240:243], a[96:99], a[48:51], v[240:243]
    v_mfma_f32_16x16x32_bf16 v[224:227], a[92:95], a[48:51], v[224:227]
    v_mfma_f32_16x16x32_bf16 a[144:147], a[124:127], a[48:51], a[144:147]
    s_addk_i32 m0, 1024
    v_mfma_f32_16x16x32_bf16 a[132:135], a[52:55], a[124:127], a[132:135]
    buffer_load_dwordx4 v5, s[8:11], s47 offen lds
    v_mfma_f32_16x16x32_bf16 v[100:103], a[52:55], a[92:95], v[100:103]
    v_mfma_f32_16x16x32_bf16 v[112:115], a[52:55], a[96:99], v[112:115]
    v_mfma_f32_16x16x32_bf16 v[124:127], a[52:55], a[100:103], v[124:127]
    v_mfma_f32_16x16x32_bf16 v[136:139], a[52:55], a[104:107], v[136:139]
    v_mfma_f32_16x16x32_bf16 v[148:151], a[52:55], a[108:111], v[148:151]
    v_mfma_f32_16x16x32_bf16 v[160:163], a[52:55], a[112:115], v[160:163]
    v_mfma_f32_16x16x32_bf16 v[172:175], a[52:55], a[116:119], v[172:175]
    s_waitcnt vmcnt(17) lgkmcnt(0)
    v_mfma_f32_16x16x32_bf16 v[184:187], a[52:55], a[120:123], v[184:187]
    s_barrier
    v_mfma_f32_16x16x32_bf16 v[32:35], a[0:3], a[56:59], v[32:35]
    s_addk_i32 m0, 1024
    ds_read_b128 a[92:95], v20 offset:0
    v_mfma_f32_16x16x32_bf16 v[40:43], a[0:3], a[60:63], v[40:43]
    buffer_load_dwordx4 v6, s[8:11], s47 offen lds
    v_mfma_f32_16x16x32_bf16 v[48:51], a[0:3], a[64:67], v[48:51]
    ds_read_b128 a[96:99], v20 offset:2048
    v_mfma_f32_16x16x32_bf16 v[56:59], a[0:3], a[68:71], v[56:59]
    ds_read_b128 a[100:103], v20 offset:4096
    v_mfma_f32_16x16x32_bf16 v[64:67], a[0:3], a[72:75], v[64:67]
    ds_read_b128 a[104:107], v20 offset:6144
    v_mfma_f32_16x16x32_bf16 v[72:75], a[0:3], a[76:79], v[72:75]
    ds_read_b128 a[108:111], v20 offset:8192
    v_mfma_f32_16x16x32_bf16 v[80:83], a[0:3], a[80:83], v[80:83]
    s_addk_i32 m0, 1024
    ds_read_b128 a[112:115], v20 offset:10240
    v_mfma_f32_16x16x32_bf16 v[88:91], a[0:3], a[84:87], v[88:91]
    buffer_load_dwordx4 v7, s[8:11], s47 offen lds
    v_mfma_f32_16x16x32_bf16 v[92:95], a[4:7], a[84:87], v[92:95]
    ds_read_b128 a[116:119], v20 offset:12288
    v_mfma_f32_16x16x32_bf16 v[84:87], a[4:7], a[80:83], v[84:87]
    ds_read_b128 a[120:123], v20 offset:14336
    v_mfma_f32_16x16x32_bf16 v[76:79], a[4:7], a[76:79], v[76:79]
    ds_read_b128 a[124:127], v20 offset:16384
    v_mfma_f32_16x16x32_bf16 v[68:71], a[4:7], a[72:75], v[68:71]
    s_add_u32 s47, s47, s69
    s_sub_u32 s67, s47, 663552
    s_cmp_ge_u32 s47, 1990656
    s_cselect_b32 s47, s67, s47
    v_mfma_f32_16x16x32_bf16 v[60:63], a[4:7], a[68:71], v[60:63]
    s_add_u32 m0, s58, 0
    ds_read_b64_tr_b16 a[28:29], v13 offset:27904
    v_mfma_f32_16x16x32_bf16 v[52:55], a[4:7], a[64:67], v[52:55]
    buffer_load_dwordx4 v1, s[8:11], s47 offen lds
    v_mfma_f32_16x16x32_bf16 v[44:47], a[4:7], a[60:63], v[44:47]
    ds_read_b64_tr_b16 a[30:31], v13 offset:41728
    v_mfma_f32_16x16x32_bf16 v[36:39], a[4:7], a[56:59], v[36:39]
    ds_read_b64_tr_b16 a[32:33], v13 offset:27944
    v_mfma_f32_16x16x32_bf16 a[128:131], a[8:11], a[88:91], a[128:131]
    ds_read_b64_tr_b16 a[34:35], v13 offset:41768
    v_mfma_f32_16x16x32_bf16 v[96:99], a[8:11], a[56:59], v[96:99]
    ds_read_b64_tr_b16 a[36:37], v13 offset:28192
    v_mfma_f32_16x16x32_bf16 v[108:111], a[8:11], a[60:63], v[108:111]
    ds_read_b64_tr_b16 a[38:39], v13 offset:42016
    v_mfma_f32_16x16x32_bf16 v[120:123], a[8:11], a[64:67], v[120:123]
    s_addk_i32 m0, 1024
    ds_read_b64_tr_b16 a[40:41], v13 offset:28232
    v_mfma_f32_16x16x32_bf16 v[132:135], a[8:11], a[68:71], v[132:135]
    buffer_load_dwordx4 v2, s[8:11], s47 offen lds
    v_mfma_f32_16x16x32_bf16 v[144:147], a[8:11], a[72:75], v[144:147]
    ds_read_b64_tr_b16 a[42:43], v13 offset:42056
    v_mfma_f32_16x16x32_bf16 v[156:159], a[8:11], a[76:79], v[156:159]
    ds_read_b64_tr_b16 a[44:45], v13 offset:28480
    v_mfma_f32_16x16x32_bf16 v[168:171], a[8:11], a[80:83], v[168:171]
    ds_read_b64_tr_b16 a[46:47], v13 offset:42304
    v_mfma_f32_16x16x32_bf16 v[180:183], a[8:11], a[84:87], v[180:183]
    ds_read_b64_tr_b16 a[48:49], v13 offset:28520
    v_mfma_f32_16x16x32_bf16 v[188:191], a[12:15], a[84:87], v[188:191]
    s_addk_i32 m0, 1024
    ds_read_b64_tr_b16 a[50:51], v13 offset:42344
    v_mfma_f32_16x16x32_bf16 v[176:179], a[12:15], a[80:83], v[176:179]
    buffer_load_dwordx4 v3, s[8:11], s47 offen lds
    v_mfma_f32_16x16x32_bf16 v[164:167], a[12:15], a[76:79], v[164:167]
    ds_read_b64_tr_b16 a[52:53], v15 offset:27904
    v_mfma_f32_16x16x32_bf16 v[152:155], a[12:15], a[72:75], v[152:155]
    ds_read_b64_tr_b16 a[54:55], v16 offset:27904
    v_mfma_f32_16x16x32_bf16 v[140:143], a[12:15], a[68:71], v[140:143]
    v_mfma_f32_16x16x32_bf16 v[128:131], a[12:15], a[64:67], v[128:131]
    v_mfma_f32_16x16x32_bf16 v[116:119], a[12:15], a[60:63], v[116:119]
    s_addk_i32 m0, 1024
    v_mfma_f32_16x16x32_bf16 v[104:107], a[12:15], a[56:59], v[104:107]
    buffer_load_dwordx4 v4, s[8:11], s47 offen lds
    v_mfma_f32_16x16x32_bf16 a[136:139], a[12:15], a[88:91], a[136:139]
    v_mfma_f32_16x16x32_bf16 a[140:143], a[88:91], a[16:19], a[140:143]
    v_mfma_f32_16x16x32_bf16 v[192:195], a[56:59], a[16:19], v[192:195]
    v_mfma_f32_16x16x32_bf16 v[208:211], a[60:63], a[16:19], v[208:211]
    v_mfma_f32_16x16x32_bf16 v[196:199], a[64:67], a[16:19], v[196:199]
    v_mfma_f32_16x16x32_bf16 v[212:215], a[68:71], a[16:19], v[212:215]
    s_addk_i32 m0, 1024
    v_mfma_f32_16x16x32_bf16 v[200:203], a[72:75], a[16:19], v[200:203]
    buffer_load_dwordx4 v5, s[8:11], s47 offen lds
    v_mfma_f32_16x16x32_bf16 v[216:219], a[76:79], a[16:19], v[216:219]
    v_mfma_f32_16x16x32_bf16 v[204:207], a[80:83], a[16:19], v[204:207]
    v_mfma_f32_16x16x32_bf16 v[220:223], a[84:87], a[16:19], v[220:223]
    v_mfma_f32_16x16x32_bf16 v[252:255], a[84:87], a[20:23], v[252:255]
    v_mfma_f32_16x16x32_bf16 v[236:239], a[80:83], a[20:23], v[236:239]
    s_addk_i32 m0, 1024
    v_mfma_f32_16x16x32_bf16 v[248:251], a[76:79], a[20:23], v[248:251]
    buffer_load_dwordx4 v6, s[8:11], s47 offen lds
    v_mfma_f32_16x16x32_bf16 v[232:235], a[72:75], a[20:23], v[232:235]
    v_mfma_f32_16x16x32_bf16 v[244:247], a[68:71], a[20:23], v[244:247]
    v_mfma_f32_16x16x32_bf16 v[228:231], a[64:67], a[20:23], v[228:231]
    v_mfma_f32_16x16x32_bf16 v[240:243], a[60:63], a[20:23], v[240:243]
    v_mfma_f32_16x16x32_bf16 v[224:227], a[56:59], a[20:23], v[224:227]
    s_addk_i32 m0, 1024
    v_mfma_f32_16x16x32_bf16 a[144:147], a[88:91], a[20:23], a[144:147]
    buffer_load_dwordx4 v7, s[8:11], s47 offen lds
    v_mfma_f32_16x16x32_bf16 a[132:135], a[24:27], a[88:91], a[132:135]
    v_mfma_f32_16x16x32_bf16 v[100:103], a[24:27], a[56:59], v[100:103]
    v_mfma_f32_16x16x32_bf16 v[112:115], a[24:27], a[60:63], v[112:115]
    v_mfma_f32_16x16x32_bf16 v[124:127], a[24:27], a[64:67], v[124:127]
    v_mfma_f32_16x16x32_bf16 v[136:139], a[24:27], a[68:71], v[136:139]
    v_mfma_f32_16x16x32_bf16 v[148:151], a[24:27], a[72:75], v[148:151]
    v_mfma_f32_16x16x32_bf16 v[160:163], a[24:27], a[76:79], v[160:163]
    v_mfma_f32_16x16x32_bf16 v[172:175], a[24:27], a[80:83], v[172:175]
    s_waitcnt vmcnt(14) lgkmcnt(0)
    v_mfma_f32_16x16x32_bf16 v[184:187], a[24:27], a[84:87], v[184:187]
    s_barrier
    v_mfma_f32_16x16x32_bf16 v[32:35], a[28:31], a[92:95], v[32:35]
    s_add_u32 s46, s46, 128
    s_cmpk_eq_u32 s46, 1152
    s_cselect_b32 s46, 768, s46
    ds_read_b128 a[56:59], v19 offset:18432
    s_add_u32 m0, s60, 0
    v_mfma_f32_16x16x32_bf16 v[40:43], a[28:31], a[96:99], v[40:43]
    buffer_load_dwordx4 v8, s[4:7], s46 offen lds
    v_mfma_f32_16x16x32_bf16 v[48:51], a[28:31], a[100:103], v[48:51]
    ds_read_b128 a[60:63], v19 offset:20480
    v_mfma_f32_16x16x32_bf16 v[56:59], a[28:31], a[104:107], v[56:59]
    ds_read_b128 a[64:67], v19 offset:22528
    v_mfma_f32_16x16x32_bf16 v[64:67], a[28:31], a[108:111], v[64:67]
    ds_read_b128 a[68:71], v19 offset:24576
    v_mfma_f32_16x16x32_bf16 v[72:75], a[28:31], a[112:115], v[72:75]
    s_addk_i32 m0, 1024
    ds_read_b128 a[72:75], v19 offset:26624
    v_mfma_f32_16x16x32_bf16 v[80:83], a[28:31], a[116:119], v[80:83]
    buffer_load_dwordx4 v9, s[4:7], s46 offen lds
    v_mfma_f32_16x16x32_bf16 v[88:91], a[28:31], a[120:123], v[88:91]
    ds_read_b128 a[76:79], v19 offset:28672
    v_mfma_f32_16x16x32_bf16 v[92:95], a[32:35], a[120:123], v[92:95]
    ds_read_b128 a[80:83], v19 offset:30720
    v_mfma_f32_16x16x32_bf16 v[84:87], a[32:35], a[116:119], v[84:87]
    ds_read_b128 a[84:87], v19 offset:32768
    v_mfma_f32_16x16x32_bf16 v[76:79], a[32:35], a[112:115], v[76:79]
    ds_read_b128 a[88:91], v19 offset:34816
    v_mfma_f32_16x16x32_bf16 v[68:71], a[32:35], a[108:111], v[68:71]
    s_addk_i32 m0, 1024
    ds_read_b64_tr_b16 a[0:1], v14 offset:0
    v_mfma_f32_16x16x32_bf16 v[60:63], a[32:35], a[104:107], v[60:63]
    buffer_load_dwordx4 v10, s[4:7], s46 offen lds
    v_mfma_f32_16x16x32_bf16 v[52:55], a[32:35], a[100:103], v[52:55]
    ds_read_b64_tr_b16 a[2:3], v14 offset:13824
    v_mfma_f32_16x16x32_bf16 v[44:47], a[32:35], a[96:99], v[44:47]
    ds_read_b64_tr_b16 a[4:5], v14 offset:40
    v_mfma_f32_16x16x32_bf16 v[36:39], a[32:35], a[92:95], v[36:39]
    ds_read_b64_tr_b16 a[6:7], v14 offset:13864
    v_mfma_f32_16x16x32_bf16 a[128:131], a[36:39], a[124:127], a[128:131]
    ds_read_b64_tr_b16 a[8:9], v14 offset:288
    v_mfma_f32_16x16x32_bf16 v[96:99], a[36:39], a[92:95], v[96:99]
    s_addk_i32 m0, 1024
    ds_read_b64_tr_b16 a[10:11], v14 offset:14112
    v_mfma_f32_16x16x32_bf16 v[108:111], a[36:39], a[96:99], v[108:111]
    buffer_load_dwordx4 v11, s[4:7], s46 offen lds
    v_mfma_f32_16x16x32_bf16 v[120:123], a[36:39], a[100:103], v[120:123]
    ds_read_b64_tr_b16 a[12:13], v14 offset:328
    v_mfma_f32_16x16x32_bf16 v[132:135], a[36:39], a[104:107], v[132:135]
    ds_read_b64_tr_b16 a[14:15], v14 offset:14152
    v_mfma_f32_16x16x32_bf16 v[144:147], a[36:39], a[108:111], v[144:147]
    ds_read_b64_tr_b16 a[16:17], v14 offset:576
    v_mfma_f32_16x16x32_bf16 v[156:159], a[36:39], a[112:115], v[156:159]
    s_add_u32 m0, s61, 0
    ds_read_b64_tr_b16 a[18:19], v14 offset:14400
    v_mfma_f32_16x16x32_bf16 v[168:171], a[36:39], a[116:119], v[168:171]
    buffer_load_dwordx4 v12, s[4:7], s46 offen lds
    v_mfma_f32_16x16x32_bf16 v[180:183], a[36:39], a[120:123], v[180:183]
    ds_read_b64_tr_b16 a[20:21], v14 offset:616
    v_mfma_f32_16x16x32_bf16 v[188:191], a[40:43], a[120:123], v[188:191]
    ds_read_b64_tr_b16 a[22:23], v14 offset:14440
    v_mfma_f32_16x16x32_bf16 v[176:179], a[40:43], a[116:119], v[176:179]
    ds_read_b64_tr_b16 a[24:25], v17 offset:0
    v_mfma_f32_16x16x32_bf16 v[164:167], a[40:43], a[112:115], v[164:167]
    s_add_u32 s47, s47, s68
    ds_read_b64_tr_b16 a[26:27], v18 offset:0
    v_mfma_f32_16x16x32_bf16 v[152:155], a[40:43], a[108:111], v[152:155]
    s_add_u32 m0, s58, 27904
    v_mfma_f32_16x16x32_bf16 v[140:143], a[40:43], a[104:107], v[140:143]
    buffer_load_dwordx4 v1, s[8:11], s47 offen lds
    v_mfma_f32_16x16x32_bf16 v[128:131], a[40:43], a[100:103], v[128:131]
    v_mfma_f32_16x16x32_bf16 v[116:119], a[40:43], a[96:99], v[116:119]
    v_mfma_f32_16x16x32_bf16 v[104:107], a[40:43], a[92:95], v[104:107]
    v_mfma_f32_16x16x32_bf16 a[136:139], a[40:43], a[124:127], a[136:139]
    v_mfma_f32_16x16x32_bf16 a[140:143], a[124:127], a[44:47], a[140:143]
    s_addk_i32 m0, 1024
    v_mfma_f32_16x16x32_bf16 v[192:195], a[92:95], a[44:47], v[192:195]
    buffer_load_dwordx4 v2, s[8:11], s47 offen lds
    v_mfma_f32_16x16x32_bf16 v[208:211], a[96:99], a[44:47], v[208:211]
    v_mfma_f32_16x16x32_bf16 v[196:199], a[100:103], a[44:47], v[196:199]
    v_mfma_f32_16x16x32_bf16 v[212:215], a[104:107], a[44:47], v[212:215]
    v_mfma_f32_16x16x32_bf16 v[200:203], a[108:111], a[44:47], v[200:203]
    s_addk_i32 m0, 1024
    v_mfma_f32_16x16x32_bf16 v[216:219], a[112:115], a[44:47], v[216:219]
    buffer_load_dwordx4 v3, s[8:11], s47 offen lds
    v_mfma_f32_16x16x32_bf16 v[204:207], a[116:119], a[44:47], v[204:207]
    v_mfma_f32_16x16x32_bf16 v[220:223], a[120:123], a[44:47], v[220:223]
    v_mfma_f32_16x16x32_bf16 v[252:255], a[120:123], a[48:51], v[252:255]
    v_mfma_f32_16x16x32_bf16 v[236:239], a[116:119], a[48:51], v[236:239]
    v_mfma_f32_16x16x32_bf16 v[248:251], a[112:115], a[48:51], v[248:251]
    s_addk_i32 m0, 1024
    v_mfma_f32_16x16x32_bf16 v[232:235], a[108:111], a[48:51], v[232:235]
    buffer_load_dwordx4 v4, s[8:11], s47 offen lds
    v_mfma_f32_16x16x32_bf16 v[244:247], a[104:107], a[48:51], v[244:247]
    v_mfma_f32_16x16x32_bf16 v[228:231], a[100:103], a[48:51], v[228:231]
    v_mfma_f32_16x16x32_bf16 v[240:243], a[96:99], a[48:51], v[240:243]
    v_mfma_f32_16x16x32_bf16 v[224:227], a[92:95], a[48:51], v[224:227]
    v_mfma_f32_16x16x32_bf16 a[144:147], a[124:127], a[48:51], a[144:147]
    s_addk_i32 m0, 1024
    v_mfma_f32_16x16x32_bf16 a[132:135], a[52:55], a[124:127], a[132:135]
    buffer_load_dwordx4 v5, s[8:11], s47 offen lds
    v_mfma_f32_16x16x32_bf16 v[100:103], a[52:55], a[92:95], v[100:103]
    v_mfma_f32_16x16x32_bf16 v[112:115], a[52:55], a[96:99], v[112:115]
    v_mfma_f32_16x16x32_bf16 v[124:127], a[52:55], a[100:103], v[124:127]
    v_mfma_f32_16x16x32_bf16 v[136:139], a[52:55], a[104:107], v[136:139]
    v_mfma_f32_16x16x32_bf16 v[148:151], a[52:55], a[108:111], v[148:151]
    v_mfma_f32_16x16x32_bf16 v[160:163], a[52:55], a[112:115], v[160:163]
    v_mfma_f32_16x16x32_bf16 v[172:175], a[52:55], a[116:119], v[172:175]
    s_waitcnt vmcnt(17) lgkmcnt(0)
    v_mfma_f32_16x16x32_bf16 v[184:187], a[52:55], a[120:123], v[184:187]
    s_barrier
    v_mfma_f32_16x16x32_bf16 v[32:35], a[0:3], a[56:59], v[32:35]
    s_and_b32 s44, s44, 48
    ds_read_b128 a[92:95], v20 offset:18432
    v_mfma_f32_16x16x32_bf16 v[40:43], a[0:3], a[60:63], v[40:43]
    buffer_load_dword v27, v26, s[28:31], s44 offen sc1
    v_mfma_f32_16x16x32_bf16 v[48:51], a[0:3], a[64:67], v[48:51]
    ds_read_b128 a[96:99], v20 offset:20480
    v_mfma_f32_16x16x32_bf16 v[56:59], a[0:3], a[68:71], v[56:59]
    ds_read_b128 a[100:103], v20 offset:22528
    v_mfma_f32_16x16x32_bf16 v[64:67], a[0:3], a[72:75], v[64:67]
    ds_read_b128 a[104:107], v20 offset:24576
    v_mfma_f32_16x16x32_bf16 v[72:75], a[0:3], a[76:79], v[72:75]
    ds_read_b128 a[108:111], v20 offset:26624
    v_mfma_f32_16x16x32_bf16 v[80:83], a[0:3], a[80:83], v[80:83]
    ds_read_b128 a[112:115], v20 offset:28672
    v_mfma_f32_16x16x32_bf16 v[88:91], a[0:3], a[84:87], v[88:91]
    ds_read_b128 a[116:119], v20 offset:30720
    v_mfma_f32_16x16x32_bf16 v[92:95], a[4:7], a[84:87], v[92:95]
    s_addk_i32 m0, 1024
    ds_read_b128 a[120:123], v20 offset:32768
    v_mfma_f32_16x16x32_bf16 v[84:87], a[4:7], a[80:83], v[84:87]
    buffer_load_dwordx4 v6, s[8:11], s47 offen lds
    v_mfma_f32_16x16x32_bf16 v[76:79], a[4:7], a[76:79], v[76:79]
    ds_read_b128 a[124:127], v20 offset:34816
    v_mfma_f32_16x16x32_bf16 v[68:71], a[4:7], a[72:75], v[68:71]
    ds_read_b64_tr_b16 a[28:29], v14 offset:27904
    v_mfma_f32_16x16x32_bf16 v[60:63], a[4:7], a[68:71], v[60:63]
    ds_read_b64_tr_b16 a[30:31], v14 offset:41728
    v_mfma_f32_16x16x32_bf16 v[52:55], a[4:7], a[64:67], v[52:55]
    ds_read_b64_tr_b16 a[32:33], v14 offset:27944
    v_mfma_f32_16x16x32_bf16 v[44:47], a[4:7], a[60:63], v[44:47]
    ds_read_b64_tr_b16 a[34:35], v14 offset:41768
    v_mfma_f32_16x16x32_bf16 v[36:39], a[4:7], a[56:59], v[36:39]
    ds_read_b64_tr_b16 a[36:37], v14 offset:28192
    v_mfma_f32_16x16x32_bf16 a[128:131], a[8:11], a[88:91], a[128:131]
    s_addk_i32 m0, 1024
    ds_read_b64_tr_b16 a[38:39], v14 offset:42016
    v_mfma_f32_16x16x32_bf16 v[96:99], a[8:11], a[56:59], v[96:99]
    buffer_load_dwordx4 v7, s[8:11], s47 offen lds
    v_mfma_f32_16x16x32_bf16 v[108:111], a[8:11], a[60:63], v[108:111]
    ds_read_b64_tr_b16 a[40:41], v14 offset:28232
    v_mfma_f32_16x16x32_bf16 v[120:123], a[8:11], a[64:67], v[120:123]
    ds_read_b64_tr_b16 a[42:43], v14 offset:42056
    v_mfma_f32_16x16x32_bf16 v[132:135], a[8:11], a[68:71], v[132:135]
    ds_read_b64_tr_b16 a[44:45], v14 offset:28480
    v_mfma_f32_16x16x32_bf16 v[144:147], a[8:11], a[72:75], v[144:147]
    ds_read_b64_tr_b16 a[46:47], v14 offset:42304
    v_mfma_f32_16x16x32_bf16 v[156:159], a[8:11], a[76:79], v[156:159]
    ds_read_b64_tr_b16 a[48:49], v14 offset:28520
    v_mfma_f32_16x16x32_bf16 v[168:171], a[8:11], a[80:83], v[168:171]
    s_add_u32 s57, s70, s75
    ds_read_b64_tr_b16 a[50:51], v14 offset:42344
    v_mfma_f32_16x16x32_bf16 v[180:183], a[8:11], a[84:87], v[180:183]
    s_add_u32 m0, s62, 55808
    ds_read_b64_tr_b16 a[52:53], v17 offset:27904
    v_mfma_f32_16x16x32_bf16 v[188:191], a[12:15], a[84:87], v[188:191]
    buffer_load_dwordx4 v21, s[12:15], s57 offen lds
    v_mfma_f32_16x16x32_bf16 v[176:179], a[12:15], a[80:83], v[176:179]
    ds_read_b64_tr_b16 a[54:55], v18 offset:27904
    v_mfma_f32_16x16x32_bf16 v[164:167], a[12:15], a[76:79], v[164:167]
    v_mfma_f32_16x16x32_bf16 v[152:155], a[12:15], a[72:75], v[152:155]
    v_mfma_f32_16x16x32_bf16 v[140:143], a[12:15], a[68:71], v[140:143]
    v_mfma_f32_16x16x32_bf16 v[128:131], a[12:15], a[64:67], v[128:131]
    v_mfma_f32_16x16x32_bf16 v[116:119], a[12:15], a[60:63], v[116:119]
    v_mfma_f32_16x16x32_bf16 v[104:107], a[12:15], a[56:59], v[104:107]
    s_addk_i32 m0, 1024
    v_mfma_f32_16x16x32_bf16 a[136:139], a[12:15], a[88:91], a[136:139]
    buffer_load_dwordx4 v22, s[12:15], s57 offen lds
    v_mfma_f32_16x16x32_bf16 a[140:143], a[88:91], a[16:19], a[140:143]
    v_mfma_f32_16x16x32_bf16 v[192:195], a[56:59], a[16:19], v[192:195]
    v_mfma_f32_16x16x32_bf16 v[208:211], a[60:63], a[16:19], v[208:211]
    v_mfma_f32_16x16x32_bf16 v[196:199], a[64:67], a[16:19], v[196:199]
    v_mfma_f32_16x16x32_bf16 v[212:215], a[68:71], a[16:19], v[212:215]
    v_mfma_f32_16x16x32_bf16 v[200:203], a[72:75], a[16:19], v[200:203]
    v_mfma_f32_16x16x32_bf16 v[216:219], a[76:79], a[16:19], v[216:219]
    s_addk_i32 m0, 1024
    v_mfma_f32_16x16x32_bf16 v[204:207], a[80:83], a[16:19], v[204:207]
    buffer_load_dwordx4 v23, s[12:15], s57 offen lds
    v_mfma_f32_16x16x32_bf16 v[220:223], a[84:87], a[16:19], v[220:223]
    v_mfma_f32_16x16x32_bf16 v[252:255], a[84:87], a[20:23], v[252:255]
    v_mfma_f32_16x16x32_bf16 v[236:239], a[80:83], a[20:23], v[236:239]
    v_mfma_f32_16x16x32_bf16 v[248:251], a[76:79], a[20:23], v[248:251]
    v_mfma_f32_16x16x32_bf16 v[232:235], a[72:75], a[20:23], v[232:235]
    v_mfma_f32_16x16x32_bf16 v[244:247], a[68:71], a[20:23], v[244:247]
    v_mfma_f32_16x16x32_bf16 v[228:231], a[64:67], a[20:23], v[228:231]
    s_addk_i32 m0, 1024
    v_mfma_f32_16x16x32_bf16 v[240:243], a[60:63], a[20:23], v[240:243]
    buffer_load_dwordx4 v24, s[12:15], s57 offen lds
    v_mfma_f32_16x16x32_bf16 v[224:227], a[56:59], a[20:23], v[224:227]
    v_mfma_f32_16x16x32_bf16 a[144:147], a[88:91], a[20:23], a[144:147]
    v_mfma_f32_16x16x32_bf16 a[132:135], a[24:27], a[88:91], a[132:135]
    v_mfma_f32_16x16x32_bf16 v[100:103], a[24:27], a[56:59], v[100:103]
    v_mfma_f32_16x16x32_bf16 v[112:115], a[24:27], a[60:63], v[112:115]
    v_mfma_f32_16x16x32_bf16 v[124:127], a[24:27], a[64:67], v[124:127]
    v_mfma_f32_16x16x32_bf16 v[136:139], a[24:27], a[68:71], v[136:139]
    v_mfma_f32_16x16x32_bf16 v[148:151], a[24:27], a[72:75], v[148:151]
    v_mfma_f32_16x16x32_bf16 v[160:163], a[24:27], a[76:79], v[160:163]
    v_mfma_f32_16x16x32_bf16 v[172:175], a[24:27], a[80:83], v[172:175]
    s_waitcnt vmcnt(12) lgkmcnt(0)
    v_mfma_f32_16x16x32_bf16 v[184:187], a[24:27], a[84:87], v[184:187]
    s_barrier
    v_mfma_f32_16x16x32_bf16 v[32:35], a[28:31], a[92:95], v[32:35]
    s_add_u32 s57, s71, s75
    ds_read_b128 a[56:59], v19 offset:0
    s_addk_i32 m0, 13312
    v_mfma_f32_16x16x32_bf16 v[40:43], a[28:31], a[96:99], v[40:43]
    buffer_load_dwordx4 v21, s[12:15], s57 offen lds
    v_mfma_f32_16x16x32_bf16 v[48:51], a[28:31], a[100:103], v[48:51]
    ds_read_b128 a[60:63], v19 offset:2048
    v_mfma_f32_16x16x32_bf16 v[56:59], a[28:31], a[104:107], v[56:59]
    ds_read_b128 a[64:67], v19 offset:4096
    v_mfma_f32_16x16x32_bf16 v[64:67], a[28:31], a[108:111], v[64:67]
    ds_read_b128 a[68:71], v19 offset:6144
    v_mfma_f32_16x16x32_bf16 v[72:75], a[28:31], a[112:115], v[72:75]
    ds_read_b128 a[72:75], v19 offset:8192
    v_mfma_f32_16x16x32_bf16 v[80:83], a[28:31], a[116:119], v[80:83]
    ds_read_b128 a[76:79], v19 offset:10240
    v_mfma_f32_16x16x32_bf16 v[88:91], a[28:31], a[120:123], v[88:91]
    s_addk_i32 m0, 1024
    ds_read_b128 a[80:83], v19 offset:12288
    v_mfma_f32_16x16x32_bf16 v[92:95], a[32:35], a[120:123], v[92:95]
    buffer_load_dwordx4 v22, s[12:15], s57 offen lds
    v_mfma_f32_16x16x32_bf16 v[84:87], a[32:35], a[116:119], v[84:87]
    ds_read_b128 a[84:87], v19 offset:14336
    v_mfma_f32_16x16x32_bf16 v[76:79], a[32:35], a[112:115], v[76:79]
    ds_read_b128 a[88:91], v19 offset:16384
    v_mfma_f32_16x16x32_bf16 v[68:71], a[32:35], a[108:111], v[68:71]
    ds_read_b64_tr_b16 a[0:1], v13 offset:0
    v_mfma_f32_16x16x32_bf16 v[60:63], a[32:35], a[104:107], v[60:63]
    ds_read_b64_tr_b16 a[2:3], v13 offset:13824
    v_mfma_f32_16x16x32_bf16 v[52:55], a[32:35], a[100:103], v[52:55]
    ds_read_b64_tr_b16 a[4:5], v13 offset:40
    v_mfma_f32_16x16x32_bf16 v[44:47], a[32:35], a[96:99], v[44:47]
    s_addk_i32 m0, 1024
    ds_read_b64_tr_b16 a[6:7], v13 offset:13864
    v_mfma_f32_16x16x32_bf16 v[36:39], a[32:35], a[92:95], v[36:39]
    buffer_load_dwordx4 v23, s[12:15], s57 offen lds
    v_mfma_f32_16x16x32_bf16 a[128:131], a[36:39], a[124:127], a[128:131]
    ds_read_b64_tr_b16 a[8:9], v13 offset:288
    v_mfma_f32_16x16x32_bf16 v[96:99], a[36:39], a[92:95], v[96:99]
    ds_read_b64_tr_b16 a[10:11], v13 offset:14112
    v_mfma_f32_16x16x32_bf16 v[108:111], a[36:39], a[96:99], v[108:111]
    ds_read_b64_tr_b16 a[12:13], v13 offset:328
    v_mfma_f32_16x16x32_bf16 v[120:123], a[36:39], a[100:103], v[120:123]
    ds_read_b64_tr_b16 a[14:15], v13 offset:14152
    v_mfma_f32_16x16x32_bf16 v[132:135], a[36:39], a[104:107], v[132:135]
    ds_read_b64_tr_b16 a[16:17], v13 offset:576
    v_mfma_f32_16x16x32_bf16 v[144:147], a[36:39], a[108:111], v[144:147]
    s_addk_i32 m0, 1024
    ds_read_b64_tr_b16 a[18:19], v13 offset:14400
    v_mfma_f32_16x16x32_bf16 v[156:159], a[36:39], a[112:115], v[156:159]
    buffer_load_dwordx4 v24, s[12:15], s57 offen lds
    v_mfma_f32_16x16x32_bf16 v[168:171], a[36:39], a[116:119], v[168:171]
    ds_read_b64_tr_b16 a[20:21], v13 offset:616
    v_mfma_f32_16x16x32_bf16 v[180:183], a[36:39], a[120:123], v[180:183]
    ds_read_b64_tr_b16 a[22:23], v13 offset:14440
    v_mfma_f32_16x16x32_bf16 v[188:191], a[40:43], a[120:123], v[188:191]
    ds_read_b64_tr_b16 a[24:25], v15 offset:0
    v_mfma_f32_16x16x32_bf16 v[176:179], a[40:43], a[116:119], v[176:179]
    ds_read_b64_tr_b16 a[26:27], v16 offset:0
    v_mfma_f32_16x16x32_bf16 v[164:167], a[40:43], a[112:115], v[164:167]
    s_add_u32 s57, s72, s75
    v_mfma_f32_16x16x32_bf16 v[152:155], a[40:43], a[108:111], v[152:155]
    s_addk_i32 m0, 13312
    v_mfma_f32_16x16x32_bf16 v[140:143], a[40:43], a[104:107], v[140:143]
    buffer_load_dwordx4 v21, s[12:15], s57 offen lds
    v_mfma_f32_16x16x32_bf16 v[128:131], a[40:43], a[100:103], v[128:131]
    v_mfma_f32_16x16x32_bf16 v[116:119], a[40:43], a[96:99], v[116:119]
    v_mfma_f32_16x16x32_bf16 v[104:107], a[40:43], a[92:95], v[104:107]
    v_mfma_f32_16x16x32_bf16 a[136:139], a[40:43], a[124:127], a[136:139]
    v_mfma_f32_16x16x32_bf16 a[140:143], a[124:127], a[44:47], a[140:143]
    v_mfma_f32_16x16x32_bf16 v[192:195], a[92:95], a[44:47], v[192:195]
    s_addk_i32 m0, 1024
    v_mfma_f32_16x16x32_bf16 v[208:211], a[96:99], a[44:47], v[208:211]
    buffer_load_dwordx4 v22, s[12:15], s57 offen lds
    v_mfma_f32_16x16x32_bf16 v[196:199], a[100:103], a[44:47], v[196:199]
    v_mfma_f32_16x16x32_bf16 v[212:215], a[104:107], a[44:47], v[212:215]
    v_mfma_f32_16x16x32_bf16 v[200:203], a[108:111], a[44:47], v[200:203]
    v_mfma_f32_16x16x32_bf16 v[216:219], a[112:115], a[44:47], v[216:219]
    v_mfma_f32_16x16x32_bf16 v[204:207], a[116:119], a[44:47], v[204:207]
    v_mfma_f32_16x16x32_bf16 v[220:223], a[120:123], a[44:47], v[220:223]
    s_addk_i32 m0, 1024
    v_mfma_f32_16x16x32_bf16 v[252:255], a[120:123], a[48:51], v[252:255]
    buffer_load_dwordx4 v23, s[12:15], s57 offen lds
    v_mfma_f32_16x16x32_bf16 v[236:239], a[116:119], a[48:51], v[236:239]
    v_mfma_f32_16x16x32_bf16 v[248:251], a[112:115], a[48:51], v[248:251]
    v_mfma_f32_16x16x32_bf16 v[232:235], a[108:111], a[48:51], v[232:235]
    v_mfma_f32_16x16x32_bf16 v[244:247], a[104:107], a[48:51], v[244:247]
    v_mfma_f32_16x16x32_bf16 v[228:231], a[100:103], a[48:51], v[228:231]
    v_mfma_f32_16x16x32_bf16 v[240:243], a[96:99], a[48:51], v[240:243]
    s_addk_i32 m0, 1024
    v_mfma_f32_16x16x32_bf16 v[224:227], a[92:95], a[48:51], v[224:227]
    buffer_load_dwordx4 v24, s[12:15], s57 offen lds
    v_mfma_f32_16x16x32_bf16 a[144:147], a[124:127], a[48:51], a[144:147]
    v_mfma_f32_16x16x32_bf16 a[132:135], a[52:55], a[124:127], a[132:135]
    v_mfma_f32_16x16x32_bf16 v[100:103], a[52:55], a[92:95], v[100:103]
    v_mfma_f32_16x16x32_bf16 v[112:115], a[52:55], a[96:99], v[112:115]
    v_mfma_f32_16x16x32_bf16 v[124:127], a[52:55], a[100:103], v[124:127]
    v_mfma_f32_16x16x32_bf16 v[136:139], a[52:55], a[104:107], v[136:139]
    v_mfma_f32_16x16x32_bf16 v[148:151], a[52:55], a[108:111], v[148:151]
    v_mfma_f32_16x16x32_bf16 v[160:163], a[52:55], a[112:115], v[160:163]
    v_mfma_f32_16x16x32_bf16 v[172:175], a[52:55], a[116:119], v[172:175]
    s_waitcnt vmcnt(12) lgkmcnt(0)
    v_mfma_f32_16x16x32_bf16 v[184:187], a[52:55], a[120:123], v[184:187]
    s_barrier
    v_mfma_f32_16x16x32_bf16 v[32:35], a[0:3], a[56:59], v[32:35]
    ds_read_b128 a[92:95], v20 offset:0
    v_cmp_gt_u32 vcc, 1, v27
    v_mfma_f32_16x16x32_bf16 v[40:43], a[0:3], a[60:63], v[40:43]
    ds_read_b128 a[96:99], v20 offset:2048
    v_mfma_f32_16x16x32_bf16 v[48:51], a[0:3], a[64:67], v[48:51]
L_stubA5:
    s_cbranch_execz L_jrA2
    s_nop 0
    s_and_b32 s55, vcc_lo, 0xffff
    ds_read_b128 a[100:103], v20 offset:4096
    s_cbranch_scc0 L_spA1r
    s_mov_b32 s41, 0
L_spA1b:
    buffer_load_dword v27, v26, s[28:31], s44 offen sc1
    s_add_u32 s41, s41, 1
    s_cmp_gt_u32 s41, 200000
    s_cbranch_scc1 L_spA1r
    s_waitcnt vmcnt(0)
    v_cmp_gt_u32 vcc, 1, v27
    s_nop 1
    s_and_b32 s55, vcc_lo, 0xffff
    s_cbranch_scc1 L_spA1b
L_spA1r:
    v_mfma_f32_16x16x32_bf16 v[56:59], a[0:3], a[68:71], v[56:59]
    s_add_u32 s57, s73, s75
    ds_read_b128 a[104:107], v20 offset:6144
    s_add_u32 m0, s62, 0
    v_mfma_f32_16x16x32_bf16 v[64:67], a[0:3], a[72:75], v[64:67]
    buffer_load_dwordx4 v21, s[12:15], s57 offen lds
    v_mfma_f32_16x16x32_bf16 v[72:75], a[0:3], a[76:79], v[72:75]
    ds_read_b128 a[108:111], v20 offset:8192
    v_add_u32_dpp v27, v27, v27 quad_perm:[1,0,3,2] row_mask:0xf bank_mask:0xf
    v_mfma_f32_16x16x32_bf16 v[80:83], a[0:3], a[80:83], v[80:83]
    ds_read_b128 a[112:115], v20 offset:10240
    v_add_u32_dpp v27, v27, v27 quad_perm:[2,3,0,1] row_mask:0xf bank_mask:0xf
    v_mfma_f32_16x16x32_bf16 v[88:91], a[0:3], a[84:87], v[88:91]
    ds_read_b128 a[116:119], v20 offset:12288
    v_readfirstlane_b32 s56, v27
    v_mfma_f32_16x16x32_bf16 v[92:95], a[4:7], a[84:87], v[92:95]
    s_nop 0
    s_add_u32 s55, s56, 0x20000
    ds_read_b128 a[120:123], v20 offset:14336
    v_mfma_f32_16x16x32_bf16 v[84:87], a[4:7], a[80:83], v[84:87]
    s_lshr_b32 s56, s56, 31
    ds_read_b128 a[124:127], v20 offset:16384
    v_mfma_f32_16x16x32_bf16 v[76:79], a[4:7], a[76:79], v[76:79]
    s_xor_b32 s56, s56, s50
    ds_read_b64_tr_b16 a[28:29], v13 offset:27904
    v_mfma_f32_16x16x32_bf16 v[68:71], a[4:7], a[72:75], v[68:71]
    s_cmp_lt_u32 s55, 0x50000
    s_cselect_b32 s56, 0, s56
    ds_read_b64_tr_b16 a[30:31], v13 offset:41728
    v_mfma_f32_16x16x32_bf16 v[60:63], a[4:7], a[68:71], v[60:63]
    s_lshr_b32 s55, s50, 3
    ds_read_b64_tr_b16 a[32:33], v13 offset:27944
    v_mfma_f32_16x16x32_bf16 v[52:55], a[4:7], a[64:67], v[52:55]
    s_xor_b32 s56, s56, s55
    ds_read_b64_tr_b16 a[34:35], v13 offset:41768
    v_mfma_f32_16x16x32_bf16 v[44:47], a[4:7], a[60:63], v[44:47]
    s_and_b32 s56, s56, 1
    ds_read_b64_tr_b16 a[36:37], v13 offset:28192
    v_mfma_f32_16x16x32_bf16 v[36:39], a[4:7], a[56:59], v[36:39]
    s_lshl_b32 s56, s56, 13
    ds_read_b64_tr_b16 a[38:39], v13 offset:42016
    v_mfma_f32_16x16x32_bf16 a[128:131], a[8:11], a[88:91], a[128:131]
    s_addk_i32 m0, 1024
    ds_read_b64_tr_b16 a[40:41], v13 offset:28232
    s_add_u32 s43, s43, s56
    v_mfma_f32_16x16x32_bf16 v[96:99], a[8:11], a[56:59], v[96:99]
    buffer_load_dwordx4 v22, s[12:15], s57 offen lds
    v_mfma_f32_16x16x32_bf16 v[108:111], a[8:11], a[60:63], v[108:111]
    s_add_u32 s40, s40, s56
    ds_read_b64_tr_b16 a[42:43], v13 offset:42056
    v_mfma_f32_16x16x32_bf16 v[120:123], a[8:11], a[64:67], v[120:123]
    s_add_u32 s42, s42, s56
    ds_read_b64_tr_b16 a[44:45], v13 offset:28480
    v_mfma_f32_16x16x32_bf16 v[132:135], a[8:11], a[68:71], v[132:135]
    ds_read_b64_tr_b16 a[46:47], v13 offset:42304
    v_and_b32 v26, 15, v0
    v_mfma_f32_16x16x32_bf16 v[144:147], a[8:11], a[72:75], v[144:147]
    ds_read_b64_tr_b16 a[48:49], v13 offset:28520
    v_lshlrev_b32 v26, 7, v26
    v_mfma_f32_16x16x32_bf16 v[156:159], a[8:11], a[76:79], v[156:159]
    s_mul_i32 s55, s49, 81920
    ds_read_b64_tr_b16 a[50:51], v13 offset:42344
    v_mfma_f32_16x16x32_bf16 v[168:171], a[8:11], a[80:83], v[168:171]
    s_add_u32 s56, s43, 9437184
    ds_read_b64_tr_b16 a[52:53], v15 offset:27904
    v_mfma_f32_16x16x32_bf16 v[180:183], a[8:11], a[84:87], v[180:183]
    s_add_u32 s55, s55, s56
    ds_read_b64_tr_b16 a[54:55], v16 offset:27904
    v_mfma_f32_16x16x32_bf16 v[188:191], a[12:15], a[84:87], v[188:191]
    s_lshl_b32 s78, s48, 14
    v_accvgpr_read_b32 v2, a188
    v_accvgpr_read_b32 v3, a189
    v_mfma_f32_16x16x32_bf16 v[176:179], a[12:15], a[80:83], v[176:179]
    s_add_u32 s78, s78, s55
    v_accvgpr_read_b32 v4, a190
    v_accvgpr_read_b32 v5, a191
    v_mfma_f32_16x16x32_bf16 v[164:167], a[12:15], a[76:79], v[164:167]
    s_add_u32 s79, s78, 4096
    v_accvgpr_read_b32 v6, a192
    v_accvgpr_read_b32 v7, a193
    v_mfma_f32_16x16x32_bf16 v[152:155], a[12:15], a[72:75], v[152:155]
    s_lshl_b32 s80, s48, 8
    v_accvgpr_read_b32 v8, a194
    v_accvgpr_read_b32 v9, a195
    v_mfma_f32_16x16x32_bf16 v[140:143], a[12:15], a[68:71], v[140:143]
    s_add_u32 s80, s80, s55
    v_accvgpr_read_b32 v10, a196
    v_accvgpr_read_b32 v11, a197
    v_mfma_f32_16x16x32_bf16 v[128:131], a[12:15], a[64:67], v[128:131]
    s_addk_i32 m0, 1024
    v_accvgpr_read_b32 v12, a198
    s_add_u32 s80, s80, 65536
    v_mfma_f32_16x16x32_bf16 v[116:119], a[12:15], a[60:63], v[116:119]
    buffer_load_dwordx4 v23, s[12:15], s57 offen lds
    v_mfma_f32_16x16x32_bf16 v[104:107], a[12:15], a[56:59], v[104:107]
    s_xor_b32 s55, s49, 1
    v_accvgpr_read_b32 v1, a206
    v_accvgpr_read_b32 v28, a208
    v_mfma_f32_16x16x32_bf16 a[136:139], a[12:15], a[88:91], a[136:139]
    s_mul_i32 s55, s55, 81920
    v_accvgpr_read_b32 v29, a209
    v_mfma_f32_16x16x32_bf16 a[140:143], a[88:91], a[16:19], a[140:143]
    s_add_u32 s55, s55, s56
    v_mfma_f32_16x16x32_bf16 v[192:195], a[56:59], a[16:19], v[192:195]
    s_lshl_b32 s82, s53, 11
    v_mfma_f32_16x16x32_bf16 v[208:211], a[60:63], a[16:19], v[208:211]
    s_lshl1_add_u32 s81, s82, s55
    v_mfma_f32_16x16x32_bf16 v[196:199], a[64:67], a[16:19], v[196:199]
    s_add_u32 s82, s82, s55
    v_mfma_f32_16x16x32_bf16 v[212:215], a[68:71], a[16:19], v[212:215]
    s_add_u32 s82, s82, 65536
    v_mfma_f32_16x16x32_bf16 v[200:203], a[72:75], a[16:19], v[200:203]
    v_mfma_f32_16x16x32_bf16 v[216:219], a[76:79], a[16:19], v[216:219]
    v_mfma_f32_16x16x32_bf16 v[204:207], a[80:83], a[16:19], v[204:207]
    v_mfma_f32_16x16x32_bf16 v[220:223], a[84:87], a[16:19], v[220:223]
    v_mfma_f32_16x16x32_bf16 v[252:255], a[84:87], a[20:23], v[252:255]
    s_addk_i32 m0, 1024
    v_mfma_f32_16x16x32_bf16 v[236:239], a[80:83], a[20:23], v[236:239]
    buffer_load_dwordx4 v24, s[12:15], s57 offen lds
    v_mfma_f32_16x16x32_bf16 v[248:251], a[76:79], a[20:23], v[248:251]
    v_mfma_f32_16x16x32_bf16 v[232:235], a[72:75], a[20:23], v[232:235]
    v_mfma_f32_16x16x32_bf16 v[244:247], a[68:71], a[20:23], v[244:247]
    v_mfma_f32_16x16x32_bf16 v[228:231], a[64:67], a[20:23], v[228:231]
    v_mfma_f32_16x16x32_bf16 v[240:243], a[60:63], a[20:23], v[240:243]
    v_mfma_f32_16x16x32_bf16 v[224:227], a[56:59], a[20:23], v[224:227]
    v_mfma_f32_16x16x32_bf16 a[144:147], a[88:91], a[20:23], a[144:147]
    v_mfma_f32_16x16x32_bf16 a[132:135], a[24:27], a[88:91], a[132:135]
    v_mfma_f32_16x16x32_bf16 v[100:103], a[24:27], a[56:59], v[100:103]
    v_mfma_f32_16x16x32_bf16 v[112:115], a[24:27], a[60:63], v[112:115]
    v_mfma_f32_16x16x32_bf16 v[124:127], a[24:27], a[64:67], v[124:127]
    v_mfma_f32_16x16x32_bf16 v[136:139], a[24:27], a[68:71], v[136:139]
    v_mfma_f32_16x16x32_bf16 v[148:151], a[24:27], a[72:75], v[148:151]
    v_mfma_f32_16x16x32_bf16 v[160:163], a[24:27], a[76:79], v[160:163]
    v_mfma_f32_16x16x32_bf16 v[172:175], a[24:27], a[80:83], v[172:175]
    s_waitcnt lgkmcnt(0)
    v_mfma_f32_16x16x32_bf16 v[184:187], a[24:27], a[84:87], v[184:187]
    s_barrier
    v_mfma_f32_16x16x32_bf16 v[96:99], a[36:39], a[92:95], v[96:99]
    s_add_u32 s57, s74, s75
    v_accvgpr_read_b32 v20, a207
    v_accvgpr_read_b32 v13, a199
    v_mfma_f32_16x16x32_bf16 v[100:103], a[52:55], a[92:95], v[100:103]
    s_addk_i32 m0, 13312
    v_accvgpr_read_b32 v14, a200
    v_accvgpr_read_b32 v15, a201
    v_mfma_f32_16x16x32_bf16 v[108:111], a[36:39], a[96:99], v[108:111]
    buffer_load_dwordx4 v21, s[12:15], s57 offen lds
    v_mfma_f32_16x16x32_bf16 v[112:115], a[52:55], a[96:99], v[112:115]
    s_addk_i32 m0, 1024
    v_cvt_pk_bf16_f32 v96, v96, v97
    v_cvt_pk_bf16_f32 v97, v98, v99
    v_mfma_f32_16x16x32_bf16 v[120:123], a[36:39], a[100:103], v[120:123]
    v_cvt_pk_bf16_f32 v98, v100, v101
    v_cvt_pk_bf16_f32 v99, v102, v103
    v_mfma_f32_16x16x32_bf16 v[124:127], a[52:55], a[100:103], v[124:127]
    ds_write2_b32 v1, v98, v99 offset0:0 offset1:2
    v_mfma_f32_16x16x32_bf16 v[132:135], a[36:39], a[104:107], v[132:135]
    v_cvt_pk_bf16_f32 v108, v108, v109
    v_cvt_pk_bf16_f32 v109, v110, v111
    v_mfma_f32_16x16x32_bf16 v[136:139], a[52:55], a[104:107], v[136:139]
    buffer_load_dwordx4 v22, s[12:15], s57 offen lds
    v_mfma_f32_16x16x32_bf16 v[144:147], a[36:39], a[108:111], v[144:147]
    s_addk_i32 m0, 1024
    v_cvt_pk_bf16_f32 v110, v112, v113
    v_cvt_pk_bf16_f32 v111, v114, v115
    v_mfma_f32_16x16x32_bf16 v[148:151], a[52:55], a[108:111], v[148:151]
    ds_write2_b32 v1, v110, v111 offset0:64 offset1:66
    v_mfma_f32_16x16x32_bf16 v[156:159], a[36:39], a[112:115], v[156:159]
    v_cvt_pk_bf16_f32 v120, v120, v121
    v_cvt_pk_bf16_f32 v121, v122, v123
    v_mfma_f32_16x16x32_bf16 v[160:163], a[52:55], a[112:115], v[160:163]
    v_cvt_pk_bf16_f32 v122, v124, v125
    v_cvt_pk_bf16_f32 v123, v126, v127
    v_mfma_f32_16x16x32_bf16 v[168:171], a[36:39], a[116:119], v[168:171]
    buffer_load_dwordx4 v23, s[12:15], s57 offen lds
    v_mfma_f32_16x16x32_bf16 v[172:175], a[52:55], a[116:119], v[172:175]
    s_addk_i32 m0, 1024
    ds_write2_b32 v1, v122, v123 offset0:128 offset1:130
    v_mfma_f32_16x16x32_bf16 a[128:131], a[36:39], a[124:127], a[128:131]
    v_cvt_pk_bf16_f32 v132, v132, v133
    v_cvt_pk_bf16_f32 v133, v134, v135
    v_mfma_f32_16x16x32_bf16 v[180:183], a[36:39], a[120:123], v[180:183]
    v_cvt_pk_bf16_f32 v134, v136, v137
    v_cvt_pk_bf16_f32 v135, v138, v139
    v_mfma_f32_16x16x32_bf16 v[184:187], a[52:55], a[120:123], v[184:187]
    ds_write2_b32 v1, v134, v135 offset0:192 offset1:194
    v_mfma_f32_16x16x32_bf16 v[104:107], a[40:43], a[92:95], v[104:107]
    buffer_load_dwordx4 v24, s[12:15], s57 offen lds
    v_mfma_f32_16x16x32_bf16 a[132:135], a[52:55], a[124:127], a[132:135]
    s_add_u32 s57, s70, s76
    v_accvgpr_read_b32 v30, a128
    v_accvgpr_read_b32 v31, a129
    v_mfma_f32_16x16x32_bf16 v[32:35], a[28:31], a[92:95], v[32:35]
    s_addk_i32 m0, 13312
    v_cvt_pk_bf16_f32 v102, v30, v31
    v_accvgpr_read_b32 v30, a130
    v_mfma_f32_16x16x32_bf16 v[36:39], a[32:35], a[92:95], v[36:39]
    v_accvgpr_read_b32 v31, a131
    v_cvt_pk_bf16_f32 v103, v30, v31
    v_mfma_f32_16x16x32_bf16 a[136:139], a[40:43], a[124:127], a[136:139]
    v_cvt_pk_bf16_f32 v100, v104, v105
    v_accvgpr_read_b32 v30, a132
    v_mfma_f32_16x16x32_bf16 v[116:119], a[40:43], a[96:99], v[116:119]
    buffer_load_dwordx4 v21, s[12:15], s57 offen lds
    v_mfma_f32_16x16x32_bf16 v[128:131], a[40:43], a[100:103], v[128:131]
    s_addk_i32 m0, 1024
    v_accvgpr_read_b32 v31, a133
    v_cvt_pk_bf16_f32 v104, v30, v31
    v_mfma_f32_16x16x32_bf16 v[140:143], a[40:43], a[104:107], v[140:143]
    v_accvgpr_read_b32 v30, a134
    v_accvgpr_read_b32 v31, a135
    v_mfma_f32_16x16x32_bf16 v[152:155], a[40:43], a[108:111], v[152:155]
    v_cvt_pk_bf16_f32 v105, v30, v31
    v_cvt_pk_bf16_f32 v32, v32, v33
    v_mfma_f32_16x16x32_bf16 v[40:43], a[28:31], a[96:99], v[40:43]
    v_cvt_pk_bf16_f32 v39, v38, v39
    v_cvt_pk_bf16_f32 v101, v106, v107
    v_mfma_f32_16x16x32_bf16 v[44:47], a[32:35], a[96:99], v[44:47]
    buffer_load_dwordx4 v22, s[12:15], s57 offen lds
    v_mfma_f32_16x16x32_bf16 v[196:199], a[100:103], a[44:47], v[196:199]
    s_addk_i32 m0, 1024
    v_cvt_pk_bf16_f32 v33, v34, v35
    v_cvt_pk_bf16_f32 v38, v36, v37
    v_mfma_f32_16x16x32_bf16 v[200:203], a[108:111], a[44:47], v[200:203]
    v_accvgpr_read_b32 v30, a136
    v_accvgpr_read_b32 v31, a137
    v_mfma_f32_16x16x32_bf16 v[164:167], a[40:43], a[112:115], v[164:167]
    v_mov_b32 v34, 0
    v_mov_b32 v37, 0
    v_mfma_f32_16x16x32_bf16 v[176:179], a[40:43], a[116:119], v[176:179]
    v_cvt_pk_bf16_f32 v106, v30, v31
    v_permlane32_swap_b32 v98, v34
    v_mfma_f32_16x16x32_bf16 v[204:207], a[116:119], a[44:47], v[204:207]
    buffer_load_dwordx4 v23, s[12:15], s57 offen lds
    v_mfma_f32_16x16x32_bf16 v[188:191], a[40:43], a[120:123], v[188:191]
    s_addk_i32 m0, 1024
    v_permlane32_swap_b32 v99, v37
    v_mfma_f32_16x16x32_bf16 v[192:195], a[92:95], a[44:47], v[192:195]
    v_accvgpr_read_b32 v30, a138
    v_accvgpr_read_b32 v31, a139
    v_mfma_f32_16x16x32_bf16 v[208:211], a[96:99], a[44:47], v[208:211]
    v_mov_b32 v35, 0
    v_mov_b32 v36, 0
    v_mfma_f32_16x16x32_bf16 a[140:143], a[124:127], a[44:47], a[140:143]
    v_cvt_pk_bf16_f32 v107, v30, v31
    v_cvt_pk_bf16_f32 v112, v116, v117
    v_mfma_f32_16x16x32_bf16 v[224:227], a[92:95], a[48:51], v[224:227]
    buffer_load_dwordx4 v24, s[12:15], s57 offen lds
    v_mfma_f32_16x16x32_bf16 v[240:243], a[96:99], a[48:51], v[240:243]
    s_add_u32 m0, s63, 32768
    v_cvt_pk_bf16_f32 v124, v128, v129
    v_cvt_pk_bf16_f32 v136, v140, v141
    v_mfma_f32_16x16x32_bf16 a[144:147], a[124:127], a[48:51], a[144:147]
    v_cvt_pk_bf16_f32 v40, v40, v41
    v_cvt_pk_bf16_f32 v47, v46, v47
    v_mfma_f32_16x16x32_bf16 v[48:51], a[28:31], a[100:103], v[48:51]
    v_cvt_pk_bf16_f32 v41, v42, v43
    v_cvt_pk_bf16_f32 v46, v44, v45
    v_mfma_f32_16x16x32_bf16 v[52:55], a[32:35], a[100:103], v[52:55]
    v_cvt_pk_bf16_f32 v196, v196, v197
    v_mov_b32 v42, 0
    v_mfma_f32_16x16x32_bf16 v[212:215], a[104:107], a[44:47], v[212:215]
    buffer_load_dwordx4 v25, s[12:15], s70 offen lds
    v_mfma_f32_16x16x32_bf16 v[216:219], a[112:115], a[44:47], v[216:219]
    v_mov_b32 v45, 0
    v_cvt_pk_bf16_f32 v197, v198, v199
    v_mfma_f32_16x16x32_bf16 v[220:223], a[120:123], a[44:47], v[220:223]
    v_permlane32_swap_b32 v110, v42
    v_mfma_f32_16x16x32_bf16 v[228:231], a[100:103], a[48:51], v[228:231]
    v_permlane32_swap_b32 v111, v45
    v_mfma_f32_16x16x32_bf16 v[56:59], a[28:31], a[104:107], v[56:59]
    v_accvgpr_read_b32 v16, a202
    v_accvgpr_read_b32 v17, a203
    v_mfma_f32_16x16x32_bf16 v[60:63], a[32:35], a[104:107], v[60:63]
    v_cvt_pk_bf16_f32 v113, v118, v119
    v_mov_b32 v43, 0
    v_mfma_f32_16x16x32_bf16 v[232:235], a[108:111], a[48:51], v[232:235]
    v_mov_b32 v44, 0
    v_cvt_pk_bf16_f32 v137, v142, v143
    v_mfma_f32_16x16x32_bf16 v[236:239], a[116:119], a[48:51], v[236:239]
    v_cvt_pk_bf16_f32 v195, v194, v195
    v_cvt_pk_bf16_f32 v211, v210, v211
    v_mfma_f32_16x16x32_bf16 v[244:247], a[104:107], a[48:51], v[244:247]
    v_cvt_pk_bf16_f32 v194, v192, v193
    v_cvt_pk_bf16_f32 v210, v208, v209
    v_mfma_f32_16x16x32_bf16 v[64:67], a[28:31], a[108:111], v[64:67]
    v_accvgpr_read_b32 v30, a140
    v_accvgpr_read_b32 v31, a141
    v_mfma_f32_16x16x32_bf16 v[68:71], a[32:35], a[108:111], v[68:71]
    v_cvt_pk_bf16_f32 v192, v30, v31
    v_cvt_pk_bf16_f32 v208, v30, v31
    v_mfma_f32_16x16x32_bf16 v[72:75], a[28:31], a[112:115], v[72:75]
    v_accvgpr_read_b32 v30, a142
    v_accvgpr_read_b32 v31, a143
    v_mfma_f32_16x16x32_bf16 v[76:79], a[32:35], a[112:115], v[76:79]
    v_accvgpr_read_b32 v18, a204
    v_accvgpr_read_b32 v19, a205
    v_mfma_f32_16x16x32_bf16 v[248:251], a[112:115], a[48:51], v[248:251]
    v_cvt_pk_bf16_f32 v144, v144, v145
    v_cvt_pk_bf16_f32 v145, v146, v147
    v_mfma_f32_16x16x32_bf16 v[252:255], a[120:123], a[48:51], v[252:255]
    v_cvt_pk_bf16_f32 v146, v148, v149
    v_cvt_pk_bf16_f32 v147, v150, v151
    v_mfma_f32_16x16x32_bf16 v[80:83], a[28:31], a[116:119], v[80:83]
    v_add_u32 v1, 1024, v1
    v_cvt_pk_bf16_f32 v156, v156, v157
    v_mfma_f32_16x16x32_bf16 v[84:87], a[32:35], a[116:119], v[84:87]
    ds_write2_b32 v1, v146, v147 offset0:0 offset1:2
    v_mfma_f32_16x16x32_bf16 v[88:91], a[28:31], a[120:123], v[88:91]
    v_cvt_pk_bf16_f32 v157, v158, v159
    v_cvt_pk_bf16_f32 v158, v160, v161
    v_mfma_f32_16x16x32_bf16 v[92:95], a[32:35], a[120:123], v[92:95]
    v_cvt_pk_bf16_f32 v159, v162, v163
    v_cvt_pk_bf16_f32 v168, v168, v169
    v_cvt_pk_bf16_f32 v169, v170, v171
    v_cvt_pk_bf16_f32 v170, v172, v173
    v_cvt_pk_bf16_f32 v171, v174, v175
    v_cvt_pk_bf16_f32 v180, v180, v181
    v_cvt_pk_bf16_f32 v181, v182, v183
    v_cvt_pk_bf16_f32 v182, v184, v185
    v_cvt_pk_bf16_f32 v183, v186, v187
    v_cvt_pk_bf16_f32 v148, v152, v153
    v_cvt_pk_bf16_f32 v198, v200, v201
    v_cvt_pk_bf16_f32 v199, v202, v203
    v_cvt_pk_bf16_f32 v160, v164, v165
    v_cvt_pk_bf16_f32 v172, v176, v177
    v_cvt_pk_bf16_f32 v200, v204, v205
    v_cvt_pk_bf16_f32 v184, v188, v189
    v_cvt_pk_bf16_f32 v161, v166, v167
    v_cvt_pk_bf16_f32 v185, v190, v191
    v_cvt_pk_bf16_f32 v227, v226, v227
    v_cvt_pk_bf16_f32 v243, v242, v243
    v_cvt_pk_bf16_f32 v193, v30, v31
    v_cvt_pk_bf16_f32 v209, v30, v31
    v_cvt_pk_bf16_f32 v226, v224, v225
    v_mfma_f32_16x16x32_bf16 v[114:117], v[96:99], v[32:35], v[2:5]
    ds_write2_b32 v1, v158, v159 offset0:64 offset1:66
    v_mfma_f32_16x16x32_bf16 v[138:141], v[98:101], v[36:39], v[2:5]
    ds_write2_b32 v1, v170, v171 offset0:128 offset1:130
    v_mfma_f32_16x16x32_bf16 v[126:129], v[102:105], v[32:35], v[10:13]
    ds_write2_b32 v1, v182, v183 offset0:192 offset1:194
    v_mfma_f32_16x16x32_bf16 v[150:153], v[104:107], v[36:39], v[10:13]
    v_add_u32 v1, 1024, v1
    v_cvt_pk_bf16_f32 v242, v240, v241
    v_accvgpr_read_b32 v30, a144
    v_accvgpr_read_b32 v31, a145
    v_cvt_pk_bf16_f32 v224, v30, v31
    v_cvt_pk_bf16_f32 v240, v30, v31
    v_max_f32 v114, v114, v126
    v_max_f32 v115, v115, v127
    v_max_f32 v138, v138, v150
    v_max_f32 v139, v139, v151
    v_max_f32 v116, v116, v128
    v_max_f32 v140, v140, v152
    v_max_f32 v117, v117, v129
    v_max_f32 v141, v141, v153
    v_max3_f32 v118, v114, v115, v116
    v_max3_f32 v142, v138, v139, v140
    v_max_f32 v118, v118, v117
    v_max_f32 v142, v142, v141
    v_accvgpr_read_b32 v30, a146
    v_accvgpr_read_b32 v31, a147
    v_permlane32_swap_b32 v118, v142
    v_max_f32 v119, v118, v142
    v_max_f32 v118, v118, v142
    v_cvt_pk_bf16_f32 v225, v30, v31
    v_cvt_pk_bf16_f32 v241, v30, v31
    v_permlane16_swap_b32 v118, v119
    v_max_f32 v119, v118, v119
    v_mul_f32 v118, s65, v119
    v_mul_f32 v142, s65, v119
    v_cvt_pk_bf16_f32 v48, v48, v49
    v_cvt_pk_bf16_f32 v55, v54, v55
    v_permlane32_swap_b32 v118, v142
    v_fma_f32 v114, v114, s64, v118
    v_fma_f32 v138, v138, s64, v142
    v_fma_f32 v115, v115, s64, v118
    v_fma_f32 v139, v139, s64, v142
    v_fma_f32 v116, v116, s64, v118
    v_fma_f32 v140, v140, s64, v142
    v_fma_f32 v117, v117, s64, v118
    v_fma_f32 v141, v141, s64, v142
    v_exp_f32 v114, v114
    v_exp_f32 v138, v138
    v_exp_f32 v115, v115
    v_exp_f32 v139, v139
    v_exp_f32 v116, v116
    v_exp_f32 v140, v140
    v_exp_f32 v117, v117
    v_exp_f32 v141, v141
    v_cvt_pk_bf16_f32 v126, v114, v115
    v_cvt_pk_bf16_f32 v150, v138, v139
    v_cvt_pk_bf16_f32 v127, v116, v117
    v_cvt_pk_bf16_f32 v151, v140, v141
    v_and_b32 v128, v126, v18
    v_and_b32 v152, v150, v18
    v_and_b32 v129, v127, v19
    v_and_b32 v153, v151, v19
    v_xor_b32 v126, v126, v128
    v_xor_b32 v150, v150, v152
    v_xor_b32 v127, v127, v129
    v_xor_b32 v151, v151, v153
    v_cvt_pk_bf16_f32 v212, v212, v213
    v_cvt_pk_bf16_f32 v49, v50, v51
    v_cvt_pk_bf16_f32 v54, v52, v53
    v_cvt_pk_bf16_f32 v213, v214, v215
    v_mov_b32 v50, 0
    v_mov_b32 v53, 0
    v_cvt_pk_bf16_f32 v214, v216, v217
    v_permlane32_swap_b32 v122, v50
    v_permlane32_swap_b32 v123, v53
    v_cvt_pk_bf16_f32 v215, v218, v219
    v_cvt_pk_bf16_f32 v216, v220, v221
    v_cvt_pk_bf16_f32 v125, v130, v131
    v_mfma_f32_16x16x32_bf16 v[114:117], v[192:195], v[126:129], 0
    ds_write2_b32 v1, v104, v105 offset0:0 offset1:2
    v_mfma_f32_16x16x32_bf16 v[138:141], v[224:227], v[150:153], 0
    ds_read_b64_tr_b16 a[148:149], v20 offset:2048
    ds_read_b64_tr_b16 a[158:159], v20 offset:2048
    ds_read_b64_tr_b16 a[168:169], v20 offset:2056
    ds_read_b64_tr_b16 a[178:179], v20 offset:2056
    ds_read_b64_tr_b16 a[150:151], v20 offset:0
    ds_read_b64_tr_b16 a[160:161], v20 offset:256
    ds_read_b64_tr_b16 a[170:171], v20 offset:8
    ds_read_b64_tr_b16 a[180:181], v20 offset:264
    ds_read_b64_tr_b16 a[152:153], v20 offset:512
    ds_read_b64_tr_b16 a[162:163], v20 offset:768
    ds_read_b64_tr_b16 a[172:173], v20 offset:520
    ds_read_b64_tr_b16 a[182:183], v20 offset:776
    ds_read_b64_tr_b16 a[154:155], v20 offset:1024
    ds_read_b64_tr_b16 a[164:165], v20 offset:1280
    ds_read_b64_tr_b16 a[174:175], v20 offset:1032
    ds_read_b64_tr_b16 a[184:185], v20 offset:1288
    ds_read_b64_tr_b16 a[156:157], v20 offset:1536
    ds_read_b64_tr_b16 a[166:167], v20 offset:1792
    ds_read_b64_tr_b16 a[176:177], v20 offset:1544
    ds_read_b64_tr_b16 a[186:187], v20 offset:1800
    v_mov_b32 v51, 0
    v_mov_b32 v52, 0
    v_cvt_pk_bf16_f32 v228, v228, v229
    v_cvt_pk_bf16_f32 v56, v56, v57
    v_cvt_pk_bf16_f32 v63, v62, v63
    v_cvt_pk_bf16_f32 v229, v230, v231
    v_cvt_pk_bf16_f32 v57, v58, v59
    v_cvt_pk_bf16_f32 v62, v60, v61
    v_mfma_f32_16x16x32_bf16 v[162:165], v[108:111], v[40:43], v[2:5]
    v_mov_b32 v58, 0
    v_mov_b32 v61, 0
    v_mfma_f32_16x16x32_bf16 v[186:189], v[110:113], v[44:47], v[2:5]
    v_cvt_pk_bf16_f32 v230, v232, v233
    v_permlane32_swap_b32 v134, v58
    v_permlane32_swap_b32 v135, v61
    v_cvt_pk_bf16_f32 v231, v234, v235
    v_cvt_pk_bf16_f32 v232, v236, v237
    v_mov_b32 v59, 0
    v_mfma_f32_16x16x32_bf16 v[174:177], v[102:105], v[40:43], v[14:17]
    v_mov_b32 v60, 0
    v_lshlrev_b32 v1, 4, v0
    v_mfma_f32_16x16x32_bf16 v[202:205], v[104:107], v[44:47], v[14:17]
    v_cvt_pk_bf16_f32 v244, v244, v245
    s_waitcnt lgkmcnt(0)
    v_mfma_f32_16x16x32_bf16 v[32:35], a[148:151], v[126:129], 0
    v_cvt_pk_bf16_f32 v245, v246, v247
    v_cvt_pk_bf16_f32 v64, v64, v65
    v_mfma_f32_16x16x32_bf16 v[36:39], a[168:171], v[150:153], 0
    v_max_f32 v162, v162, v174
    v_max_f32 v163, v163, v175
    v_max_f32 v186, v186, v202
    v_max_f32 v187, v187, v203
    v_max_f32 v164, v164, v176
    v_max_f32 v188, v188, v204
    v_max_f32 v165, v165, v177
    v_max_f32 v189, v189, v205
    v_max3_f32 v166, v162, v163, v164
    v_max3_f32 v190, v186, v187, v188
    v_max_f32 v166, v166, v165
    v_max_f32 v190, v190, v189
    v_rcp_f32 v118, v34
    v_rcp_f32 v142, v38
    v_mul_f32 v114, v114, v118
    v_mul_f32 v138, v138, v142
    v_mul_f32 v115, v115, v118
    v_mul_f32 v139, v139, v142
    v_mul_f32 v116, v116, v118
    v_mul_f32 v140, v140, v142
    v_mul_f32 v117, v117, v118
    v_mul_f32 v141, v141, v142
    v_cvt_pk_bf16_f32 v218, v114, v115
    v_cvt_pk_bf16_f32 v219, v116, v117
    v_cvt_pk_bf16_f32 v220, v138, v139
    v_cvt_pk_bf16_f32 v221, v140, v141
    v_mul_f32 v32, v32, v118
    v_mul_f32 v36, v36, v142
    v_mul_f32 v33, v33, v118
    v_mul_f32 v37, v37, v142
    v_cvt_pk_bf16_f32 v71, v70, v71
    v_cvt_pk_bf16_f32 v65, v66, v67
    v_cvt_pk_bf16_f32 v70, v68, v69
    v_mov_b32 v66, 0
    v_mov_b32 v69, 0
    v_cvt_pk_bf16_f32 v149, v154, v155
    v_permlane32_swap_b32 v166, v190
    v_max_f32 v167, v166, v190
    v_max_f32 v166, v166, v190
    v_permlane32_swap_b32 v146, v66
    v_permlane32_swap_b32 v147, v69
    v_permlane16_swap_b32 v166, v167
    v_max_f32 v167, v166, v167
    v_mul_f32 v166, s65, v167
    v_mul_f32 v190, s65, v167
    v_mov_b32 v67, 0
    v_mov_b32 v68, 0
    v_permlane32_swap_b32 v166, v190
    v_fma_f32 v162, v162, s64, v166
    v_fma_f32 v186, v186, s64, v190
    v_fma_f32 v163, v163, s64, v166
    v_fma_f32 v187, v187, s64, v190
    v_fma_f32 v164, v164, s64, v166
    v_fma_f32 v188, v188, s64, v190
    v_fma_f32 v165, v165, s64, v166
    v_fma_f32 v189, v189, s64, v190
    v_exp_f32 v162, v162
    v_exp_f32 v186, v186
    v_exp_f32 v163, v163
    v_exp_f32 v187, v187
    v_exp_f32 v164, v164
    v_exp_f32 v188, v188
    v_exp_f32 v165, v165
    v_exp_f32 v189, v189
    v_cvt_pk_bf16_f32 v72, v72, v73
    v_cvt_pk_bf16_f32 v174, v162, v163
    v_cvt_pk_bf16_f32 v79, v78, v79
    v_cvt_pk_bf16_f32 v73, v74, v75
    v_cvt_pk_bf16_f32 v202, v186, v187
    v_cvt_pk_bf16_f32 v175, v164, v165
    v_cvt_pk_bf16_f32 v78, v76, v77
    v_cvt_pk_bf16_f32 v203, v188, v189
    v_mov_b32 v74, 0
    v_and_b32 v176, v174, v18
    v_mov_b32 v77, 0
    v_permlane32_swap_b32 v158, v74
    v_mov_b32 v75, 0
    v_and_b32 v204, v202, v18
    v_permlane32_swap_b32 v159, v77
    v_mov_b32 v76, 0
    v_and_b32 v177, v175, v19
    v_and_b32 v205, v203, v19
    v_xor_b32 v174, v174, v176
    v_xor_b32 v202, v202, v204
    v_xor_b32 v175, v175, v177
    v_xor_b32 v203, v203, v205
    v_cvt_pk_bf16_f32 v246, v248, v249
    v_mfma_f32_16x16x32_bf16 v[40:43], a[158:161], v[174:177], 0
    buffer_store_dwordx4 v[218:221], v1, s[16:19], s78 offen offset:0 sc1
    ds_write_b128 v28, v[218:221] offset:0
    v_cvt_pk_bf16_f32 v247, v250, v251
    v_mfma_f32_16x16x32_bf16 v[44:47], a[178:181], v[202:205], 0
    v_cvt_pk_bf16_f32 v248, v252, v253
    v_lshrrev_b32 v20, 4, v0
    v_mfma_f32_16x16x32_bf16 v[162:165], v[208:211], v[174:177], 0
    s_nop 0
    v_rcp_f32 v166, v42
    v_mfma_f32_16x16x32_bf16 v[186:189], v[240:243], v[202:205], 0
    v_mul_f32 v40, v40, v166
    v_lshl_add_u32 v20, v20, 28, v1
    v_cvt_pk_bf16_f32 v250, v32, v33
    v_rcp_f32 v190, v46
    v_cvt_pk_bf16_f32 v251, v36, v37
    v_cvt_pk_bf16_f32 v80, v80, v81
    v_cvt_pk_bf16_f32 v87, v86, v87
    v_cvt_pk_bf16_f32 v81, v82, v83
    v_cvt_pk_bf16_f32 v86, v84, v85
    v_mov_b32 v82, 0
    v_mov_b32 v85, 0
    v_cvt_pk_bf16_f32 v173, v178, v179
    v_mul_f32 v162, v162, v166
    v_mul_f32 v186, v186, v190
    v_mul_f32 v163, v163, v166
    v_mul_f32 v187, v187, v190
    v_mul_f32 v44, v44, v190
    v_mul_f32 v41, v41, v166
    v_mul_f32 v45, v45, v190
    v_permlane32_swap_b32 v170, v82
    v_permlane32_swap_b32 v171, v85
    v_mov_b32 v83, 0
    v_mul_f32 v164, v164, v166
    v_mov_b32 v84, 0
    v_mul_f32 v188, v188, v190
    v_mul_f32 v165, v165, v166
    v_mul_f32 v189, v189, v190
    v_cvt_pk_bf16_f32 v234, v162, v163
    v_cvt_pk_bf16_f32 v235, v164, v165
    v_cvt_pk_bf16_f32 v88, v88, v89
L_stubA6:
    s_cbranch_execz L_jrA2
    s_nop 0
    v_cvt_pk_bf16_f32 v95, v94, v95
    v_cvt_pk_bf16_f32 v89, v90, v91
    v_cvt_pk_bf16_f32 v94, v92, v93
    v_mov_b32 v90, 0
    v_mov_b32 v93, 0
    v_mov_b32 v91, 0
    v_permlane32_swap_b32 v182, v90
    v_permlane32_swap_b32 v183, v93
    v_mov_b32 v92, 0
    v_cvt_pk_bf16_f32 v201, v206, v207
    v_cvt_pk_bf16_f32 v236, v186, v187
    v_cvt_pk_bf16_f32 v237, v188, v189
    v_cvt_pk_bf16_f32 v233, v238, v239
    v_mfma_f32_16x16x32_bf16 v[114:117], v[120:123], v[48:51], v[2:5]
    buffer_store_dwordx4 v[234:237], v1, s[16:19], s78 offen offset:1024 sc1
    v_mfma_f32_16x16x32_bf16 v[138:141], v[122:125], v[52:55], v[2:5]
    ds_write_b128 v28, v[234:237] offset:1024
    v_mfma_f32_16x16x32_bf16 v[126:129], v[96:99], v[48:51], v[6:9]
    v_cvt_pk_bf16_f32 v252, v40, v41
    v_cvt_pk_bf16_f32 v253, v44, v45
    v_mfma_f32_16x16x32_bf16 v[150:153], v[98:101], v[52:55], v[6:9]
    buffer_store_dwordx4 v[250:253], v20, s[16:19], s80 offen offset:0 sc1
    ds_write_b128 v29, v[250:253] offset:0
    v_cvt_pk_bf16_f32 v217, v222, v223
    v_cvt_pk_bf16_f32 v249, v254, v255
    v_mfma_f32_16x16x32_bf16 v[162:165], v[132:135], v[56:59], v[2:5]
    v_max_f32 v114, v114, v126
    v_max_f32 v115, v115, v127
    v_mfma_f32_16x16x32_bf16 v[186:189], v[134:137], v[60:63], v[2:5]
    v_max_f32 v138, v138, v150
    v_max_f32 v139, v139, v151
    v_mfma_f32_16x16x32_bf16 v[174:177], v[108:111], v[56:59], v[6:9]
    v_max_f32 v116, v116, v128
    v_max_f32 v140, v140, v152
    v_mfma_f32_16x16x32_bf16 v[202:205], v[110:113], v[60:63], v[6:9]
    v_max_f32 v117, v117, v129
    v_max_f32 v141, v141, v153
    v_max3_f32 v118, v114, v115, v116
    v_max3_f32 v142, v138, v139, v140
    v_max_f32 v118, v118, v117
    v_max_f32 v142, v142, v141
    v_max_f32 v162, v162, v174
    v_max_f32 v163, v163, v175
    v_permlane32_swap_b32 v118, v142
    v_max_f32 v119, v118, v142
    v_max_f32 v118, v118, v142
    v_max_f32 v186, v186, v202
    v_max_f32 v187, v187, v203
    v_permlane16_swap_b32 v118, v119
    v_max_f32 v164, v164, v176
    v_max_f32 v188, v188, v204
    v_max_f32 v119, v118, v119
    v_max_f32 v165, v165, v177
    v_max_f32 v189, v189, v205
    v_max3_f32 v166, v162, v163, v164
    v_max3_f32 v190, v186, v187, v188
    v_mul_f32 v118, s65, v119
    v_mul_f32 v142, s65, v119
    v_max_f32 v166, v166, v165
    v_max_f32 v190, v190, v189
    v_permlane32_swap_b32 v118, v142
    v_fma_f32 v114, v114, s64, v118
    v_permlane32_swap_b32 v166, v190
    v_fma_f32 v138, v138, s64, v142
    v_fma_f32 v115, v115, s64, v118
    v_fma_f32 v139, v139, s64, v142
    v_fma_f32 v116, v116, s64, v118
    v_fma_f32 v140, v140, s64, v142
    v_fma_f32 v117, v117, s64, v118
    v_fma_f32 v141, v141, s64, v142
    v_max_f32 v167, v166, v190
    v_exp_f32 v114, v114
    v_exp_f32 v138, v138
    v_exp_f32 v115, v115
    v_exp_f32 v139, v139
    v_exp_f32 v116, v116
    v_exp_f32 v140, v140
    v_exp_f32 v117, v117
    v_exp_f32 v141, v141
    v_max_f32 v166, v166, v190
    v_cvt_pk_bf16_f32 v126, v114, v115
    v_cvt_pk_bf16_f32 v150, v138, v139
    v_permlane16_swap_b32 v166, v167
    v_cvt_pk_bf16_f32 v127, v116, v117
    v_cvt_pk_bf16_f32 v151, v140, v141
    v_and_b32 v128, v126, v18
    v_and_b32 v152, v150, v18
    v_and_b32 v129, v127, v19
    v_and_b32 v153, v151, v19
    v_max_f32 v167, v166, v167
    v_xor_b32 v126, v126, v128
    v_xor_b32 v150, v150, v152
    v_xor_b32 v127, v127, v129
    v_xor_b32 v151, v151, v153
    v_mul_f32 v166, s65, v167
    v_mfma_f32_16x16x32_bf16 v[48:51], a[150:153], v[126:129], 0
    v_mul_f32 v190, s65, v167
    v_mfma_f32_16x16x32_bf16 v[52:55], a[170:173], v[150:153], 0
    s_nop 0
    v_permlane32_swap_b32 v166, v190
    v_mfma_f32_16x16x32_bf16 v[114:117], v[194:197], v[126:129], 0
    v_fma_f32 v162, v162, s64, v166
    v_fma_f32 v186, v186, s64, v190
    v_mfma_f32_16x16x32_bf16 v[138:141], v[226:229], v[150:153], 0
    v_fma_f32 v163, v163, s64, v166
    v_fma_f32 v187, v187, s64, v190
    v_mfma_f32_16x16x32_bf16 v[126:129], v[120:123], v[64:67], v[6:9]
    v_fma_f32 v164, v164, s64, v166
    v_fma_f32 v188, v188, s64, v190
    v_mfma_f32_16x16x32_bf16 v[150:153], v[122:125], v[68:71], v[6:9]
    v_fma_f32 v165, v165, s64, v166
    v_fma_f32 v189, v189, s64, v190
    v_exp_f32 v162, v162
    v_exp_f32 v186, v186
    v_exp_f32 v163, v163
    v_exp_f32 v187, v187
    v_exp_f32 v164, v164
    v_exp_f32 v188, v188
    v_exp_f32 v165, v165
    v_exp_f32 v189, v189
    v_cvt_pk_bf16_f32 v174, v162, v163
    v_cvt_pk_bf16_f32 v202, v186, v187
    v_cvt_pk_bf16_f32 v175, v164, v165
    v_cvt_pk_bf16_f32 v203, v188, v189
    v_and_b32 v176, v174, v18
    v_and_b32 v204, v202, v18
    v_and_b32 v177, v175, v19
    v_and_b32 v205, v203, v19
    v_xor_b32 v174, v174, v176
    v_xor_b32 v202, v202, v204
    v_xor_b32 v175, v175, v177
    v_xor_b32 v203, v203, v205
    v_rcp_f32 v118, v50
    v_mfma_f32_16x16x32_bf16 v[56:59], a[160:163], v[174:177], 0
    v_rcp_f32 v142, v54
    v_mfma_f32_16x16x32_bf16 v[60:63], a[180:183], v[202:205], 0
    v_mul_f32 v114, v114, v118
    v_mul_f32 v138, v138, v142
    v_mfma_f32_16x16x32_bf16 v[162:165], v[210:213], v[174:177], 0
    v_mul_f32 v115, v115, v118
    v_mul_f32 v139, v139, v142
    v_mfma_f32_16x16x32_bf16 v[186:189], v[242:245], v[202:205], 0
    v_mul_f32 v116, v116, v118
    v_mul_f32 v140, v140, v142
    v_mfma_f32_16x16x32_bf16 v[174:177], v[132:135], v[72:75], v[6:9]
    v_mul_f32 v117, v117, v118
    v_mul_f32 v141, v141, v142
    v_mfma_f32_16x16x32_bf16 v[202:205], v[134:137], v[76:79], v[6:9]
    v_cvt_pk_bf16_f32 v218, v114, v115
    v_cvt_pk_bf16_f32 v219, v116, v117
    v_mfma_f32_16x16x32_bf16 v[114:117], v[144:147], v[64:67], v[2:5]
    v_cvt_pk_bf16_f32 v220, v138, v139
    v_cvt_pk_bf16_f32 v221, v140, v141
    v_mfma_f32_16x16x32_bf16 v[138:141], v[146:149], v[68:71], v[2:5]
    buffer_store_dwordx4 v[218:221], v1, s[16:19], s78 offen offset:2048 sc1
    v_rcp_f32 v166, v58
    v_rcp_f32 v190, v62
    v_mul_f32 v162, v162, v166
    v_mul_f32 v186, v186, v190
    v_mul_f32 v163, v163, v166
    v_mul_f32 v187, v187, v190
    v_mul_f32 v164, v164, v166
    v_mul_f32 v188, v188, v190
    v_mul_f32 v165, v165, v166
    v_mul_f32 v189, v189, v190
    v_cvt_pk_bf16_f32 v234, v162, v163
    v_cvt_pk_bf16_f32 v235, v164, v165
    v_mfma_f32_16x16x32_bf16 v[162:165], v[156:159], v[72:75], v[2:5]
    v_cvt_pk_bf16_f32 v236, v186, v187
    v_cvt_pk_bf16_f32 v237, v188, v189
    v_mfma_f32_16x16x32_bf16 v[186:189], v[158:161], v[76:79], v[2:5]
    buffer_store_dwordx4 v[234:237], v1, s[16:19], s78 offen offset:3072 sc1
    v_mul_f32 v48, v48, v118
    v_mul_f32 v52, v52, v142
    v_mul_f32 v49, v49, v118
    v_mul_f32 v53, v53, v142
    v_max_f32 v114, v114, v126
    v_max_f32 v138, v138, v150
    v_max_f32 v115, v115, v127
    v_max_f32 v139, v139, v151
    v_max_f32 v116, v116, v128
    v_max_f32 v140, v140, v152
    v_max_f32 v117, v117, v129
    v_max_f32 v141, v141, v153
    v_max3_f32 v118, v114, v115, v116
    v_max3_f32 v142, v138, v139, v140
    v_max_f32 v118, v118, v117
    v_max_f32 v142, v142, v141
    v_mul_f32 v56, v56, v166
    v_mul_f32 v60, v60, v190
    v_permlane32_swap_b32 v118, v142
    v_max_f32 v119, v118, v142
    v_max_f32 v118, v118, v142
    v_mul_f32 v57, v57, v166
    v_mul_f32 v61, v61, v190
    v_permlane16_swap_b32 v118, v119
    v_max_f32 v162, v162, v174
    v_max_f32 v186, v186, v202
    v_max_f32 v163, v163, v175
    v_max_f32 v187, v187, v203
    v_max_f32 v164, v164, v176
    v_max_f32 v188, v188, v204
    v_max_f32 v119, v118, v119
    v_max_f32 v165, v165, v177
    v_max_f32 v189, v189, v205
    v_max3_f32 v166, v162, v163, v164
    v_max3_f32 v190, v186, v187, v188
    v_mul_f32 v118, s65, v119
    v_mul_f32 v142, s65, v119
    v_max_f32 v166, v166, v165
    v_max_f32 v190, v190, v189
    v_permlane32_swap_b32 v118, v142
    v_fma_f32 v114, v114, s64, v118
    v_permlane32_swap_b32 v166, v190
    v_fma_f32 v138, v138, s64, v142
    v_fma_f32 v115, v115, s64, v118
    v_fma_f32 v139, v139, s64, v142
    v_fma_f32 v116, v116, s64, v118
    v_fma_f32 v140, v140, s64, v142
    v_fma_f32 v117, v117, s64, v118
    v_fma_f32 v141, v141, s64, v142
    v_max_f32 v167, v166, v190
    v_exp_f32 v114, v114
    v_exp_f32 v138, v138
    v_exp_f32 v115, v115
    v_exp_f32 v139, v139
    v_exp_f32 v116, v116
    v_exp_f32 v140, v140
    v_exp_f32 v117, v117
    v_exp_f32 v141, v141
    v_max_f32 v166, v166, v190
    v_cvt_pk_bf16_f32 v126, v114, v115
    v_cvt_pk_bf16_f32 v150, v138, v139
    v_permlane16_swap_b32 v166, v167
    v_cvt_pk_bf16_f32 v127, v116, v117
    v_cvt_pk_bf16_f32 v151, v140, v141
    v_and_b32 v128, v126, v18
    v_and_b32 v152, v150, v18
    v_and_b32 v129, v127, v19
    v_and_b32 v153, v151, v19
    v_max_f32 v167, v166, v167
    v_xor_b32 v126, v126, v128
    v_xor_b32 v150, v150, v152
    v_xor_b32 v127, v127, v129
    v_xor_b32 v151, v151, v153
    v_mul_f32 v166, s65, v167
    v_mfma_f32_16x16x32_bf16 v[64:67], a[152:155], v[126:129], 0
    v_mul_f32 v190, s65, v167
    v_cvt_pk_bf16_f32 v250, v48, v49
    v_mfma_f32_16x16x32_bf16 v[68:71], a[172:175], v[150:153], 0
    v_permlane32_swap_b32 v166, v190
    v_mfma_f32_16x16x32_bf16 v[114:117], v[196:199], v[126:129], 0
    v_fma_f32 v162, v162, s64, v166
    v_fma_f32 v186, v186, s64, v190
    v_mfma_f32_16x16x32_bf16 v[138:141], v[228:231], v[150:153], 0
    v_fma_f32 v163, v163, s64, v166
    v_fma_f32 v187, v187, s64, v190
    v_fma_f32 v164, v164, s64, v166
    v_fma_f32 v188, v188, s64, v190
    v_fma_f32 v165, v165, s64, v166
    v_fma_f32 v189, v189, s64, v190
    v_exp_f32 v162, v162
    v_exp_f32 v186, v186
    v_exp_f32 v163, v163
    v_exp_f32 v187, v187
    v_exp_f32 v164, v164
    v_exp_f32 v188, v188
    v_exp_f32 v165, v165
    v_rcp_f32 v118, v66
    v_rcp_f32 v142, v70
    v_mul_f32 v114, v114, v118
    v_mul_f32 v138, v138, v142
    v_mul_f32 v115, v115, v118
    v_mul_f32 v139, v139, v142
    v_mul_f32 v116, v116, v118
    v_mul_f32 v140, v140, v142
    v_mul_f32 v117, v117, v118
    v_mul_f32 v141, v141, v142
    v_cvt_pk_bf16_f32 v251, v52, v53
    v_exp_f32 v189, v189
    v_cvt_pk_bf16_f32 v174, v162, v163
    v_cvt_pk_bf16_f32 v252, v56, v57
    v_cvt_pk_bf16_f32 v253, v60, v61
    v_mul_f32 v64, v64, v118
    v_mul_f32 v68, v68, v142
    v_mul_f32 v65, v65, v118
    v_mul_f32 v69, v69, v142
    ds_write_b128 v28, v[218:221] offset:2048
    v_mfma_f32_16x16x32_bf16 v[126:129], v[144:147], v[80:83], v[6:9]
    buffer_store_dwordx4 v[250:253], v20, s[16:19], s80 offen offset:1024 sc1
    v_mfma_f32_16x16x32_bf16 v[150:153], v[146:149], v[84:87], v[6:9]
    v_cvt_pk_bf16_f32 v202, v186, v187
    v_cvt_pk_bf16_f32 v175, v164, v165
    v_cvt_pk_bf16_f32 v203, v188, v189
    v_and_b32 v176, v174, v18
    v_and_b32 v204, v202, v18
    v_and_b32 v177, v175, v19
    v_and_b32 v205, v203, v19
    v_xor_b32 v174, v174, v176
    v_xor_b32 v202, v202, v204
    v_xor_b32 v175, v175, v177
    v_xor_b32 v203, v203, v205
    v_cvt_pk_bf16_f32 v218, v114, v115
    v_mfma_f32_16x16x32_bf16 v[72:75], a[162:165], v[174:177], 0
    v_cvt_pk_bf16_f32 v219, v116, v117
    v_cvt_pk_bf16_f32 v220, v138, v139
    v_mfma_f32_16x16x32_bf16 v[76:79], a[182:185], v[202:205], 0
    v_cvt_pk_bf16_f32 v221, v140, v141
    v_mfma_f32_16x16x32_bf16 v[162:165], v[212:215], v[174:177], 0
    buffer_store_dwordx4 v[218:221], v1, s[16:19], s79 offen offset:0 sc1
    v_mfma_f32_16x16x32_bf16 v[186:189], v[244:247], v[202:205], 0
    ds_write_b128 v28, v[234:237] offset:3072
    v_mfma_f32_16x16x32_bf16 v[114:117], v[168:171], v[80:83], v[2:5]
    v_rcp_f32 v166, v74
    v_mfma_f32_16x16x32_bf16 v[138:141], v[170:173], v[84:87], v[2:5]
    v_rcp_f32 v190, v78
    v_mul_f32 v72, v72, v166
    v_mul_f32 v162, v162, v166
    v_mul_f32 v163, v163, v166
    v_mul_f32 v186, v186, v190
    v_mul_f32 v187, v187, v190
    v_mul_f32 v164, v164, v166
    v_mul_f32 v188, v188, v190
    v_mul_f32 v165, v165, v166
    v_mul_f32 v189, v189, v190
    v_cvt_pk_bf16_f32 v234, v162, v163
    v_cvt_pk_bf16_f32 v235, v164, v165
    v_cvt_pk_bf16_f32 v236, v186, v187
    v_cvt_pk_bf16_f32 v237, v188, v189
    v_max_f32 v114, v114, v126
    v_max_f32 v138, v138, v150
    v_max_f32 v115, v115, v127
    v_max_f32 v139, v139, v151
    v_max_f32 v116, v116, v128
    v_max_f32 v140, v140, v152
    v_max_f32 v117, v117, v129
    v_max_f32 v141, v141, v153
    v_max3_f32 v118, v114, v115, v116
    v_max3_f32 v142, v138, v139, v140
    v_max_f32 v118, v118, v117
    v_max_f32 v142, v142, v141
    v_mul_f32 v76, v76, v190
    v_mul_f32 v73, v73, v166
    v_permlane32_swap_b32 v118, v142
    v_max_f32 v119, v118, v142
    v_max_f32 v118, v118, v142
    v_mul_f32 v77, v77, v190
    s_nop 0
    v_permlane16_swap_b32 v118, v119
    v_max_f32 v119, v118, v119
    v_mul_f32 v118, s65, v119
    v_mul_f32 v142, s65, v119
    ds_write_b128 v29, v[250:253] offset:1024
    v_mfma_f32_16x16x32_bf16 v[162:165], v[180:183], v[88:91], v[2:5]
    buffer_store_dwordx4 v[234:237], v1, s[16:19], s79 offen offset:1024 sc1
    v_mfma_f32_16x16x32_bf16 v[186:189], v[182:185], v[92:95], v[2:5]
    v_permlane32_swap_b32 v118, v142
    v_mfma_f32_16x16x32_bf16 v[174:177], v[156:159], v[88:91], v[6:9]
    v_fma_f32 v114, v114, s64, v118
    v_fma_f32 v138, v138, s64, v142
    v_mfma_f32_16x16x32_bf16 v[202:205], v[158:161], v[92:95], v[6:9]
    v_fma_f32 v115, v115, s64, v118
    v_fma_f32 v139, v139, s64, v142
    v_fma_f32 v116, v116, s64, v118
    v_fma_f32 v140, v140, s64, v142
    v_fma_f32 v117, v117, s64, v118
    v_max_f32 v162, v162, v174
    v_max_f32 v163, v163, v175
    v_max_f32 v164, v164, v176
    v_max_f32 v186, v186, v202
    v_max_f32 v187, v187, v203
    v_max_f32 v188, v188, v204
    v_max_f32 v165, v165, v177
    v_max_f32 v189, v189, v205
    v_max3_f32 v166, v162, v163, v164
    v_max3_f32 v190, v186, v187, v188
    v_max_f32 v166, v166, v165
    v_max_f32 v190, v190, v189
    v_fma_f32 v141, v141, s64, v142
    v_exp_f32 v114, v114
    v_permlane32_swap_b32 v166, v190
    v_max_f32 v167, v166, v190
    v_exp_f32 v138, v138
    v_exp_f32 v115, v115
    v_exp_f32 v139, v139
    v_exp_f32 v116, v116
    v_exp_f32 v140, v140
    v_exp_f32 v117, v117
    v_exp_f32 v141, v141
    v_max_f32 v166, v166, v190
    v_cvt_pk_bf16_f32 v126, v114, v115
    v_cvt_pk_bf16_f32 v150, v138, v139
    v_permlane16_swap_b32 v166, v167
    v_cvt_pk_bf16_f32 v127, v116, v117
    v_cvt_pk_bf16_f32 v151, v140, v141
    v_and_b32 v128, v126, v18
    v_and_b32 v152, v150, v18
    v_and_b32 v129, v127, v19
    v_and_b32 v153, v151, v19
    v_max_f32 v167, v166, v167
    v_xor_b32 v126, v126, v128
    v_xor_b32 v150, v150, v152
    v_xor_b32 v127, v127, v129
    v_xor_b32 v151, v151, v153
    v_mul_f32 v166, s65, v167
    v_mfma_f32_16x16x32_bf16 v[80:83], a[154:157], v[126:129], 0
    ds_write_b128 v28, v[218:221] offset:4096
    v_mfma_f32_16x16x32_bf16 v[84:87], a[174:177], v[150:153], 0
    v_mul_f32 v190, s65, v167
    v_cvt_pk_bf16_f32 v250, v64, v65
    v_mfma_f32_16x16x32_bf16 v[114:117], v[198:201], v[126:129], 0
    v_permlane32_swap_b32 v166, v190
    v_mfma_f32_16x16x32_bf16 v[138:141], v[230:233], v[150:153], 0
    v_fma_f32 v162, v162, s64, v166
    v_fma_f32 v186, v186, s64, v190
    v_fma_f32 v163, v163, s64, v166
    v_fma_f32 v187, v187, s64, v190
    v_fma_f32 v164, v164, s64, v166
    v_fma_f32 v188, v188, s64, v190
    v_fma_f32 v165, v165, s64, v166
    v_fma_f32 v189, v189, s64, v190
    v_exp_f32 v162, v162
    v_exp_f32 v186, v186
    v_exp_f32 v163, v163
    v_exp_f32 v187, v187
    v_exp_f32 v164, v164
    v_exp_f32 v188, v188
    v_exp_f32 v165, v165
    v_cvt_pk_bf16_f32 v251, v68, v69
    v_exp_f32 v189, v189
    v_cvt_pk_bf16_f32 v252, v72, v73
    v_cvt_pk_bf16_f32 v253, v76, v77
    v_cvt_pk_bf16_f32 v174, v162, v163
    v_cvt_pk_bf16_f32 v202, v186, v187
    v_cvt_pk_bf16_f32 v175, v164, v165
    v_cvt_pk_bf16_f32 v203, v188, v189
    v_and_b32 v176, v174, v18
    v_and_b32 v204, v202, v18
    v_and_b32 v177, v175, v19
    v_and_b32 v205, v203, v19
    v_xor_b32 v174, v174, v176
    v_xor_b32 v202, v202, v204
    v_xor_b32 v175, v175, v177
    v_xor_b32 v203, v203, v205
    v_rcp_f32 v118, v82
    v_mfma_f32_16x16x32_bf16 v[88:91], a[164:167], v[174:177], 0
    buffer_store_dwordx4 v[250:253], v20, s[16:19], s80 offen offset:2048 sc1
    v_mfma_f32_16x16x32_bf16 v[92:95], a[184:187], v[202:205], 0
    ds_write_b128 v28, v[234:237] offset:5120
    v_mfma_f32_16x16x32_bf16 v[162:165], v[214:217], v[174:177], 0
    ds_write_b128 v29, v[250:253] offset:2048
    v_mfma_f32_16x16x32_bf16 v[186:189], v[246:249], v[202:205], 0
    v_rcp_f32 v142, v86
    v_mul_f32 v114, v114, v118
    v_mul_f32 v138, v138, v142
    v_mul_f32 v115, v115, v118
    v_mul_f32 v139, v139, v142
    v_mul_f32 v116, v116, v118
    v_mul_f32 v140, v140, v142
    v_mul_f32 v117, v117, v118
    v_mul_f32 v141, v141, v142
    v_cvt_pk_bf16_f32 v218, v114, v115
    v_cvt_pk_bf16_f32 v219, v116, v117
    v_cvt_pk_bf16_f32 v220, v138, v139
    v_cvt_pk_bf16_f32 v221, v140, v141
    v_rcp_f32 v166, v90
    v_rcp_f32 v190, v94
    v_mul_f32 v162, v162, v166
    v_mul_f32 v186, v186, v190
    v_mul_f32 v163, v163, v166
    v_mul_f32 v187, v187, v190
    v_mul_f32 v164, v164, v166
    v_mul_f32 v188, v188, v190
    v_mul_f32 v165, v165, v166
    v_mul_f32 v189, v189, v190
    v_cvt_pk_bf16_f32 v234, v162, v163
    v_cvt_pk_bf16_f32 v235, v164, v165
    v_cvt_pk_bf16_f32 v236, v186, v187
    v_cvt_pk_bf16_f32 v237, v188, v189
    v_mul_f32 v80, v80, v118
    v_mul_f32 v84, v84, v142
    v_mul_f32 v81, v81, v118
    v_mul_f32 v85, v85, v142
    v_mul_f32 v88, v88, v166
    v_mul_f32 v92, v92, v190
    v_mul_f32 v89, v89, v166
    v_mul_f32 v93, v93, v190
    v_cvt_pk_bf16_f32 v250, v80, v81
    v_cvt_pk_bf16_f32 v251, v84, v85
    v_cvt_pk_bf16_f32 v252, v88, v89
    v_cvt_pk_bf16_f32 v253, v92, v93
    v_accvgpr_read_b32 v2, a210
    v_accvgpr_read_b32 v3, a211
    v_accvgpr_read_b32 v8, a216
    v_accvgpr_read_b32 v9, a217
    v_add_u32 v10, 55808, v2
    v_add_u32 v11, 55808, v3
    buffer_store_dwordx4 v[218:221], v1, s[16:19], s79 offen offset:2048 sc1
    ds_write_b128 v28, v[218:221] offset:6144
    ds_write_b128 v28, v[234:237] offset:7168
    buffer_store_dwordx4 v[234:237], v1, s[16:19], s79 offen offset:3072 sc1
    ds_write_b128 v29, v[250:253] offset:3072
    buffer_store_dwordx4 v[250:253], v20, s[16:19], s80 offen offset:3072 sc1
    s_waitcnt vmcnt(12) lgkmcnt(0)
    s_barrier
    ds_read_b64_tr_b16 a[0:1], v10 offset:0
    ds_read_b64_tr_b16 a[2:3], v10 offset:2048
    ds_read_b128 a[56:59], v8 offset:0
    ds_read_b128 a[60:63], v8 offset:1024
    ds_read_b128 a[64:67], v8 offset:2048
    ds_read_b128 a[68:71], v8 offset:3072
    ds_read_b64_tr_b16 a[4:5], v10 offset:4096
    ds_read_b64_tr_b16 a[6:7], v10 offset:6144
    ds_read_b128 a[72:75], v8 offset:8192
    ds_read_b128 a[76:79], v8 offset:9216
    ds_read_b128 a[80:83], v8 offset:10240
    ds_read_b128 a[84:87], v8 offset:11264
    v_mov_b32 v54, 1
    v_accvgpr_read_b32 v49, a218
    v_accvgpr_read_b32 v51, a219
    v_accvgpr_read_b32 v59, a220
    v_accvgpr_read_b32 v60, a221
    v_accvgpr_read_b32 v61, a222
    v_accvgpr_read_b32 v62, a223
    v_accvgpr_read_b32 v63, a224
    s_waitcnt lgkmcnt(6)
    v_mfma_f32_16x16x32_bf16 v[96:99], a[0:3], a[56:59], 0
    ds_read_b64_tr_b16 a[8:9], v10 offset:8192
    ds_read_b64_tr_b16 a[10:11], v10 offset:10240
    v_mfma_f32_16x16x32_bf16 v[100:103], a[0:3], a[60:63], 0
    ds_read_b128 a[88:91], v8 offset:16384
    ds_read_b128 a[92:95], v8 offset:17408
    v_mfma_f32_16x16x32_bf16 v[104:107], a[0:3], a[64:67], 0
    ds_read_b128 a[96:99], v8 offset:18432
    ds_read_b128 a[100:103], v8 offset:19456
    v_mfma_f32_16x16x32_bf16 v[108:111], a[0:3], a[68:71], 0
    v_accvgpr_read_b32 v64, a225
    v_accvgpr_read_b32 v65, a226
    s_waitcnt lgkmcnt(6)
    v_mfma_f32_16x16x32_bf16 v[96:99], a[4:7], a[72:75], v[96:99]
    ds_read_b64_tr_b16 a[12:13], v10 offset:12288
    ds_read_b64_tr_b16 a[14:15], v10 offset:14336
    v_mfma_f32_16x16x32_bf16 v[100:103], a[4:7], a[76:79], v[100:103]
    ds_read_b128 a[104:107], v8 offset:24576
    ds_read_b128 a[108:111], v8 offset:25600
    v_mfma_f32_16x16x32_bf16 v[104:107], a[4:7], a[80:83], v[104:107]
    ds_read_b128 a[112:115], v8 offset:26624
    ds_read_b128 a[116:119], v8 offset:27648
    v_mfma_f32_16x16x32_bf16 v[108:111], a[4:7], a[84:87], v[108:111]
    v_accvgpr_read_b32 v66, a227
    v_accvgpr_read_b32 v67, a228
    s_waitcnt lgkmcnt(6)
    v_mfma_f32_16x16x32_bf16 v[96:99], a[8:11], a[88:91], v[96:99]
    ds_read_b64_tr_b16 a[20:21], v11 offset:0
    ds_read_b64_tr_b16 a[22:23], v11 offset:2048
    v_mfma_f32_16x16x32_bf16 v[100:103], a[8:11], a[92:95], v[100:103]
    ds_read_b64_tr_b16 a[24:25], v11 offset:4096
    ds_read_b64_tr_b16 a[26:27], v11 offset:6144
    v_mfma_f32_16x16x32_bf16 v[104:107], a[8:11], a[96:99], v[104:107]
    ds_read_b64_tr_b16 a[28:29], v11 offset:8192
    ds_read_b64_tr_b16 a[30:31], v11 offset:10240
    v_mfma_f32_16x16x32_bf16 v[108:111], a[8:11], a[100:103], v[108:111]
    v_accvgpr_read_b32 v4, a212
    v_accvgpr_read_b32 v5, a213
    s_waitcnt lgkmcnt(6)
    v_mfma_f32_16x16x32_bf16 v[96:99], a[12:15], a[104:107], v[96:99]
    ds_read_b64_tr_b16 a[32:33], v11 offset:12288
    ds_read_b64_tr_b16 a[34:35], v11 offset:14336
    v_mfma_f32_16x16x32_bf16 v[100:103], a[12:15], a[108:111], v[100:103]
    ds_read_b64 a[120:121], v9 offset:0
    ds_read_b64 a[124:125], v9 offset:8
    v_mfma_f32_16x16x32_bf16 v[104:107], a[12:15], a[112:115], v[104:107]
    ds_read_b64 a[128:129], v9 offset:1024
    ds_read_b64 a[132:133], v9 offset:1032
    v_mfma_f32_16x16x32_bf16 v[108:111], a[12:15], a[116:119], v[108:111]
    v_accvgpr_read_b32 v6, a214
    v_accvgpr_read_b32 v7, a215
    s_waitcnt vmcnt(0) lgkmcnt(0)
    s_barrier
    v_mfma_f32_16x16x32_bf16 v[112:115], a[20:23], a[56:59], 0
    s_add_u32 s59, s42, 6144
    ds_read_b64_tr_b16 a[0:1], v10 offset:16384
    v_add_u32 v16, 111616, v2
    v_mfma_f32_16x16x32_bf16 v[112:115], a[24:27], a[72:75], v[112:115]
    buffer_store_dword v54, v51, s[16:19], s59 offen sc1
    v_mfma_f32_16x16x32_bf16 v[112:115], a[28:31], a[88:91], v[112:115]
    s_add_u32 s57, s71, s76
    ds_read_b64_tr_b16 a[2:3], v10 offset:18432
    s_add_u32 m0, s62, 111616
    v_mfma_f32_16x16x32_bf16 v[112:115], a[32:35], a[104:107], v[112:115]
    buffer_load_dwordx4 v21, s[12:15], s57 offen lds
    v_mfma_f32_16x16x32_bf16 v[116:119], a[32:35], a[108:111], 0
    s_addk_i32 m0, 1024
    ds_read_b64_tr_b16 a[4:5], v10 offset:20480
    v_add_u32 v17, 111616, v3
    v_mfma_f32_16x16x32_bf16 v[116:119], a[28:31], a[92:95], v[116:119]
    buffer_load_dwordx4 v22, s[12:15], s57 offen lds
    v_mfma_f32_16x16x32_bf16 v[116:119], a[24:27], a[76:79], v[116:119]
    s_addk_i32 m0, 1024
    ds_read_b64_tr_b16 a[6:7], v10 offset:22528
    v_xor_b32 v18, s77, v2
    v_mfma_f32_16x16x32_bf16 v[116:119], a[20:23], a[60:63], v[116:119]
    buffer_load_dwordx4 v23, s[12:15], s57 offen lds
    v_mfma_f32_16x16x32_bf16 v[120:123], a[20:23], a[64:67], 0
    s_addk_i32 m0, 1024
    ds_read_b64_tr_b16 a[8:9], v10 offset:24576
    v_add_u32 v19, 55808, v18
    v_mfma_f32_16x16x32_bf16 v[120:123], a[24:27], a[80:83], v[120:123]
    buffer_load_dwordx4 v24, s[12:15], s57 offen lds
    v_mfma_f32_16x16x32_bf16 v[120:123], a[28:31], a[96:99], v[120:123]
    s_add_u32 m0, s63, 111616
    ds_read_b64_tr_b16 a[10:11], v10 offset:26624
    s_xor_b32 s45, s52, 1
    v_mfma_f32_16x16x32_bf16 v[120:123], a[32:35], a[112:115], v[120:123]
    buffer_load_dwordx4 v25, s[12:15], s71 offen lds
    v_mfma_f32_16x16x32_bf16 v[124:127], a[32:35], a[116:119], 0
    s_lshl_b32 s45, s45, 7
    ds_read_b64_tr_b16 a[12:13], v10 offset:28672
    v_mfma_f32_16x16x32_bf16 v[124:127], a[28:31], a[100:103], v[124:127]
    s_add_u32 s45, s45, s42
    ds_read_b64_tr_b16 a[14:15], v10 offset:30720
    v_mfma_f32_16x16x32_bf16 v[124:127], a[24:27], a[84:87], v[124:127]
    s_add_u32 s45, s45, 6144
    v_mfma_f32_16x16x32_bf16 v[124:127], a[20:23], a[68:71], v[124:127]
    s_waitcnt lgkmcnt(0)
    v_mfma_f32_16x16x32_bf16 v[128:131], a[0:3], a[56:59], 0
    s_add_u32 s57, s72, s76
    ds_read_b64_tr_b16 a[20:21], v11 offset:16384
    s_add_u32 m0, s62, 132096
    v_mfma_f32_16x16x32_bf16 v[128:131], a[4:7], a[72:75], v[128:131]
    buffer_load_dwordx4 v21, s[12:15], s57 offen lds
    v_mfma_f32_16x16x32_bf16 v[128:131], a[8:11], a[88:91], v[128:131]
    s_addk_i32 m0, 1024
    ds_read_b64_tr_b16 a[22:23], v11 offset:18432
    v_mfma_f32_16x16x32_bf16 v[128:131], a[12:15], a[104:107], v[128:131]
    buffer_load_dwordx4 v22, s[12:15], s57 offen lds
    v_mfma_f32_16x16x32_bf16 v[132:135], a[12:15], a[108:111], 0
    ds_read_b64_tr_b16 a[24:25], v11 offset:20480
    v_mfma_f32_16x16x32_bf16 v[132:135], a[8:11], a[92:95], v[132:135]
    s_addk_i32 m0, 1024
    ds_read_b64_tr_b16 a[26:27], v11 offset:22528
    v_mfma_f32_16x16x32_bf16 v[132:135], a[4:7], a[76:79], v[132:135]
    buffer_load_dwordx4 v23, s[12:15], s57 offen lds
    v_mfma_f32_16x16x32_bf16 v[132:135], a[0:3], a[60:63], v[132:135]
    s_addk_i32 m0, 1024
    ds_read_b64_tr_b16 a[28:29], v11 offset:24576
    v_mfma_f32_16x16x32_bf16 v[136:139], a[0:3], a[64:67], 0
    buffer_load_dwordx4 v24, s[12:15], s57 offen lds
    v_mfma_f32_16x16x32_bf16 v[136:139], a[4:7], a[80:83], v[136:139]
    ds_read_b64_tr_b16 a[30:31], v11 offset:26624
    v_mfma_f32_16x16x32_bf16 v[136:139], a[8:11], a[96:99], v[136:139]
    s_add_u32 m0, s63, 132096
    ds_read_b64_tr_b16 a[32:33], v11 offset:28672
    v_mfma_f32_16x16x32_bf16 v[136:139], a[12:15], a[112:115], v[136:139]
    buffer_load_dwordx4 v25, s[12:15], s72 offen lds
    v_mfma_f32_16x16x32_bf16 v[140:143], a[12:15], a[116:119], 0
    ds_read_b64_tr_b16 a[34:35], v11 offset:30720
    v_mfma_f32_16x16x32_bf16 v[140:143], a[8:11], a[100:103], v[140:143]
    v_mfma_f32_16x16x32_bf16 v[140:143], a[4:7], a[84:87], v[140:143]
    v_mfma_f32_16x16x32_bf16 v[140:143], a[0:3], a[68:71], v[140:143]
    s_waitcnt lgkmcnt(0)
    s_barrier
    v_mfma_f32_16x16x32_bf16 v[144:147], a[20:23], a[56:59], 0
    s_add_u32 s57, s73, s76
    ds_read_b64_tr_b16 a[0:1], v10 offset:32768
    s_add_u32 m0, s62, 55808
    v_mfma_f32_16x16x32_bf16 v[144:147], a[24:27], a[72:75], v[144:147]
    buffer_load_dwordx4 v21, s[12:15], s57 offen lds
    v_mfma_f32_16x16x32_bf16 v[144:147], a[28:31], a[88:91], v[144:147]
    ds_read_b64_tr_b16 a[2:3], v10 offset:34816
    v_mfma_f32_16x16x32_bf16 v[144:147], a[32:35], a[104:107], v[144:147]
    ds_read_b64_tr_b16 a[4:5], v10 offset:36864
    v_mfma_f32_16x16x32_bf16 v[148:151], a[32:35], a[108:111], 0
L_stubA7:
    s_cbranch_execz L_stubA10
    s_nop 0
    s_addk_i32 m0, 1024
    ds_read_b64_tr_b16 a[6:7], v10 offset:38912
    v_mfma_f32_16x16x32_bf16 v[148:151], a[28:31], a[92:95], v[148:151]
    buffer_load_dwordx4 v22, s[12:15], s57 offen lds
    v_mfma_f32_16x16x32_bf16 v[148:151], a[24:27], a[76:79], v[148:151]
    ds_read_b64_tr_b16 a[8:9], v10 offset:40960
    v_mfma_f32_16x16x32_bf16 v[148:151], a[20:23], a[60:63], v[148:151]
    ds_read_b64_tr_b16 a[10:11], v10 offset:43008
    v_mfma_f32_16x16x32_bf16 v[152:155], a[20:23], a[64:67], 0
    s_addk_i32 m0, 1024
    ds_read_b64_tr_b16 a[12:13], v10 offset:45056
    v_mfma_f32_16x16x32_bf16 v[152:155], a[24:27], a[80:83], v[152:155]
    buffer_load_dwordx4 v23, s[12:15], s57 offen lds
    v_mfma_f32_16x16x32_bf16 v[152:155], a[28:31], a[96:99], v[152:155]
    ds_read_b64_tr_b16 a[14:15], v10 offset:47104
    v_mfma_f32_16x16x32_bf16 v[152:155], a[32:35], a[112:115], v[152:155]
    ds_read_b32 v55, v59
    v_mfma_f32_16x16x32_bf16 v[156:159], a[32:35], a[116:119], 0
    v_mfma_f32_16x16x32_bf16 v[156:159], a[28:31], a[100:103], v[156:159]
    v_mfma_f32_16x16x32_bf16 v[156:159], a[24:27], a[84:87], v[156:159]
    v_mfma_f32_16x16x32_bf16 v[156:159], a[20:23], a[68:71], v[156:159]
    s_waitcnt lgkmcnt(0)
    v_mfma_f32_16x16x32_bf16 v[160:163], a[0:3], a[56:59], 0
    ds_read_b64_tr_b16 a[20:21], v11 offset:32768
    v_mfma_f32_16x16x32_bf16 v[160:163], a[4:7], a[72:75], v[160:163]
    buffer_load_dword v27, off, s[16:19], s45 sc1
    v_mfma_f32_16x16x32_bf16 v[160:163], a[8:11], a[88:91], v[160:163]
    ds_read_b64_tr_b16 a[22:23], v11 offset:34816
    v_mfma_f32_16x16x32_bf16 v[160:163], a[12:15], a[104:107], v[160:163]
    ds_read_b64_tr_b16 a[24:25], v11 offset:36864
    v_sub_f32 v56, 1.0, v55
    v_mfma_f32_16x16x32_bf16 v[164:167], a[12:15], a[108:111], 0
    s_addk_i32 m0, 1024
    ds_read_b64_tr_b16 a[26:27], v11 offset:38912
    v_accvgpr_read_b32 v77, a238
    v_mfma_f32_16x16x32_bf16 v[164:167], a[8:11], a[92:95], v[164:167]
    buffer_load_dwordx4 v24, s[12:15], s57 offen lds
    v_mfma_f32_16x16x32_bf16 v[164:167], a[4:7], a[76:79], v[164:167]
    ds_read_b64_tr_b16 a[28:29], v11 offset:40960
    v_accvgpr_read_b32 v79, a239
    v_mfma_f32_16x16x32_bf16 v[164:167], a[0:3], a[60:63], v[164:167]
    ds_read_b64_tr_b16 a[30:31], v11 offset:43008
    v_lshlrev_b32 v76, 16, v77
    v_mfma_f32_16x16x32_bf16 v[168:171], a[0:3], a[64:67], 0
    s_add_u32 m0, s63, 55808
    ds_read_b64_tr_b16 a[32:33], v11 offset:45056
    v_lshlrev_b32 v78, 16, v79
    v_mfma_f32_16x16x32_bf16 v[168:171], a[4:7], a[80:83], v[168:171]
    buffer_load_dwordx4 v25, s[12:15], s73 offen lds
    v_mfma_f32_16x16x32_bf16 v[168:171], a[8:11], a[96:99], v[168:171]
    ds_read_b64_tr_b16 a[34:35], v11 offset:47104
    v_and_b32 v77, s83, v77
    v_mfma_f32_16x16x32_bf16 v[168:171], a[12:15], a[112:115], v[168:171]
    v_and_b32 v79, s83, v79
    v_mul_f32 v76, v76, v56
    v_mfma_f32_16x16x32_bf16 v[172:175], a[12:15], a[116:119], 0
    v_mul_f32 v77, v77, v56
    v_mul_f32 v78, v78, v56
    v_mfma_f32_16x16x32_bf16 v[172:175], a[8:11], a[100:103], v[172:175]
    v_mul_f32 v79, v79, v56
    v_accvgpr_read_b32 v81, a240
    v_mfma_f32_16x16x32_bf16 v[172:175], a[4:7], a[84:87], v[172:175]
    v_accvgpr_read_b32 v83, a241
    v_lshlrev_b32 v80, 16, v81
    v_mfma_f32_16x16x32_bf16 v[172:175], a[0:3], a[68:71], v[172:175]
    s_waitcnt lgkmcnt(0)
    v_lshlrev_b32 v82, 16, v83
    v_and_b32 v81, s83, v81
    s_barrier
    v_mfma_f32_16x16x32_bf16 v[176:179], a[20:23], a[56:59], 0
    s_add_u32 s57, s74, s76
    ds_read_b64_tr_b16 a[0:1], v2 offset:0
    s_add_u32 m0, s62, 76288
    v_mfma_f32_16x16x32_bf16 v[176:179], a[24:27], a[72:75], v[176:179]
    buffer_load_dwordx4 v21, s[12:15], s57 offen lds
    v_mfma_f32_16x16x32_bf16 v[176:179], a[28:31], a[88:91], v[176:179]
    s_addk_i32 m0, 1024
    ds_read_b64_tr_b16 a[2:3], v2 offset:2048
    v_mfma_f32_16x16x32_bf16 v[176:179], a[32:35], a[104:107], v[176:179]
    buffer_load_dwordx4 v22, s[12:15], s57 offen lds
    v_mfma_f32_16x16x32_bf16 v[180:183], a[32:35], a[108:111], 0
    ds_read_b64_tr_b16 a[4:5], v2 offset:4096
    v_and_b32 v83, s83, v83
    v_mfma_f32_16x16x32_bf16 v[180:183], a[28:31], a[92:95], v[180:183]
    s_addk_i32 m0, 1024
    ds_read_b64_tr_b16 a[6:7], v2 offset:6144
    v_mul_f32 v80, v80, v56
    v_mfma_f32_16x16x32_bf16 v[180:183], a[24:27], a[76:79], v[180:183]
    buffer_load_dwordx4 v23, s[12:15], s57 offen lds
    v_mfma_f32_16x16x32_bf16 v[180:183], a[20:23], a[60:63], v[180:183]
    s_addk_i32 m0, 1024
    ds_read_b64_tr_b16 a[8:9], v2 offset:8192
    v_mul_f32 v81, v81, v56
    v_mfma_f32_16x16x32_bf16 v[184:187], a[20:23], a[64:67], 0
    buffer_load_dwordx4 v24, s[12:15], s57 offen lds
    v_mfma_f32_16x16x32_bf16 v[184:187], a[24:27], a[80:83], v[184:187]
    ds_read_b64_tr_b16 a[10:11], v2 offset:10240
    v_mul_f32 v82, v82, v56
    v_mfma_f32_16x16x32_bf16 v[184:187], a[28:31], a[96:99], v[184:187]
    s_add_u32 m0, s63, 76288
    ds_read_b64_tr_b16 a[12:13], v2 offset:12288
    v_mul_f32 v83, v83, v56
    v_mfma_f32_16x16x32_bf16 v[184:187], a[32:35], a[112:115], v[184:187]
    buffer_load_dwordx4 v25, s[12:15], s74 offen lds
    v_mfma_f32_16x16x32_bf16 v[188:191], a[32:35], a[116:119], 0
    ds_read_b64_tr_b16 a[14:15], v2 offset:14336
    v_accvgpr_read_b32 v85, a242
    v_mfma_f32_16x16x32_bf16 v[188:191], a[28:31], a[100:103], v[188:191]
    v_accvgpr_read_b32 v87, a243
    v_lshlrev_b32 v84, 16, v85
    v_mfma_f32_16x16x32_bf16 v[188:191], a[24:27], a[84:87], v[188:191]
    v_lshlrev_b32 v86, 16, v87
    v_and_b32 v85, s83, v85
    v_mfma_f32_16x16x32_bf16 v[188:191], a[20:23], a[68:71], v[188:191]
    s_waitcnt vmcnt(7) lgkmcnt(0)
    v_and_b32 v87, s83, v87
    v_mul_f32 v84, v84, v56
    v_mfma_f32_16x16x32_bf16 v[192:195], a[0:3], a[56:59], 0
    ds_read_b64_tr_b16 a[20:21], v3 offset:0
    v_cmp_gt_u32 vcc, 1, v27
    v_mfma_f32_16x16x32_bf16 v[192:195], a[4:7], a[72:75], v[192:195]
    ds_read_b64_tr_b16 a[22:23], v3 offset:2048
    v_mfma_f32_16x16x32_bf16 v[192:195], a[8:11], a[88:91], v[192:195]
    s_and_b32 s55, vcc_lo, 0xffff
    ds_read_b64_tr_b16 a[24:25], v3 offset:4096
    s_cbranch_scc0 L_spA2r
    s_mov_b32 s41, 0
L_spA2b:
    buffer_load_dword v27, off, s[16:19], s45 sc1
    s_add_u32 s41, s41, 1
    s_cmp_gt_u32 s41, 200000
    s_cbranch_scc1 L_spA2r
    s_waitcnt vmcnt(0)
    v_cmp_gt_u32 vcc, 1, v27
    s_nop 1
    s_and_b32 s55, vcc_lo, 0xffff
    s_cbranch_scc1 L_spA2b
L_spA2r:
    v_mfma_f32_16x16x32_bf16 v[192:195], a[12:15], a[104:107], v[192:195]
    s_add_u32 s59, s81, 0
    ds_read_b64_tr_b16 a[26:27], v3 offset:6144
    v_mul_f32 v85, v85, v56
    v_mfma_f32_16x16x32_bf16 v[196:199], a[12:15], a[108:111], 0
    buffer_load_dwordx4 a[136:139], v1, s[16:19], s59 offen offset:0 sc1
    v_mfma_f32_16x16x32_bf16 v[196:199], a[8:11], a[92:95], v[196:199]
    s_addk_i32 s59, 16384
    ds_read_b64_tr_b16 a[28:29], v3 offset:8192
    v_mul_f32 v86, v86, v56
    v_mfma_f32_16x16x32_bf16 v[196:199], a[4:7], a[76:79], v[196:199]
    buffer_load_dwordx4 a[152:155], v1, s[16:19], s59 offen offset:0 sc1
    v_mfma_f32_16x16x32_bf16 v[196:199], a[0:3], a[60:63], v[196:199]
    ds_read_b64_tr_b16 a[30:31], v3 offset:10240
    v_mul_f32 v87, v87, v56
    v_mfma_f32_16x16x32_bf16 v[200:203], a[0:3], a[64:67], 0
    s_addk_i32 s59, 16384
    ds_read_b64_tr_b16 a[32:33], v3 offset:12288
    v_accvgpr_read_b32 v89, a244
    v_mfma_f32_16x16x32_bf16 v[200:203], a[4:7], a[80:83], v[200:203]
    buffer_load_dwordx4 a[168:171], v1, s[16:19], s59 offen offset:0 sc1
    v_mfma_f32_16x16x32_bf16 v[200:203], a[8:11], a[96:99], v[200:203]
    s_addk_i32 s59, 16384
    ds_read_b64_tr_b16 a[34:35], v3 offset:14336
    v_accvgpr_read_b32 v91, a245
    v_mfma_f32_16x16x32_bf16 v[200:203], a[12:15], a[112:115], v[200:203]
    buffer_load_dwordx4 a[184:187], v1, s[16:19], s59 offen offset:0 sc1
    v_mfma_f32_16x16x32_bf16 v[204:207], a[12:15], a[116:119], 0
    v_lshlrev_b32 v88, 16, v89
    v_lshlrev_b32 v90, 16, v91
    v_mfma_f32_16x16x32_bf16 v[204:207], a[8:11], a[100:103], v[204:207]
    v_and_b32 v89, s83, v89
    v_and_b32 v91, s83, v91
    v_mfma_f32_16x16x32_bf16 v[204:207], a[4:7], a[84:87], v[204:207]
    v_mul_f32 v88, v88, v56
    v_mul_f32 v89, v89, v56
    v_mfma_f32_16x16x32_bf16 v[204:207], a[0:3], a[68:71], v[204:207]
    s_waitcnt lgkmcnt(0)
    v_mul_f32 v90, v90, v56
    v_mul_f32 v91, v91, v56
    v_mfma_f32_16x16x32_bf16 v[208:211], a[20:23], a[56:59], 0
    ds_read_b64_tr_b16 a[0:1], v18 offset:16384
    v_mfma_f32_16x16x32_bf16 v[208:211], a[24:27], a[72:75], v[208:211]
    buffer_load_dwordx2 a[122:123], v1, s[16:19], s82 offen offset:0 sc1
    v_mfma_f32_16x16x32_bf16 v[208:211], a[28:31], a[88:91], v[208:211]
    s_add_u32 s59, s81, 0
    ds_read_b64_tr_b16 a[2:3], v18 offset:18432
    v_mfma_f32_16x16x32_bf16 v[208:211], a[32:35], a[104:107], v[208:211]
    buffer_load_dwordx4 a[140:143], v1, s[16:19], s59 offen offset:1024 sc1
    v_mfma_f32_16x16x32_bf16 v[212:215], a[32:35], a[108:111], 0
    s_addk_i32 s59, 16384
    ds_read_b64_tr_b16 a[4:5], v18 offset:20480
    v_accvgpr_read_b32 v93, a246
    v_mfma_f32_16x16x32_bf16 v[212:215], a[28:31], a[92:95], v[212:215]
    buffer_load_dwordx4 a[156:159], v1, s[16:19], s59 offen offset:1024 sc1
    v_mfma_f32_16x16x32_bf16 v[212:215], a[24:27], a[76:79], v[212:215]
    s_addk_i32 s59, 16384
    ds_read_b64_tr_b16 a[6:7], v18 offset:22528
    v_accvgpr_read_b32 v95, a247
    v_mfma_f32_16x16x32_bf16 v[212:215], a[20:23], a[60:63], v[212:215]
    buffer_load_dwordx4 a[172:175], v1, s[16:19], s59 offen offset:1024 sc1
    v_mfma_f32_16x16x32_bf16 v[216:219], a[20:23], a[64:67], 0
    s_addk_i32 s59, 16384
    ds_read_b64_tr_b16 a[8:9], v18 offset:24576
    v_lshlrev_b32 v92, 16, v93
    v_mfma_f32_16x16x32_bf16 v[216:219], a[24:27], a[80:83], v[216:219]
    buffer_load_dwordx4 a[188:191], v1, s[16:19], s59 offen offset:1024 sc1
    v_mfma_f32_16x16x32_bf16 v[216:219], a[28:31], a[96:99], v[216:219]
    ds_read_b64_tr_b16 a[10:11], v18 offset:26624
    v_lshlrev_b32 v94, 16, v95
    v_mfma_f32_16x16x32_bf16 v[216:219], a[32:35], a[112:115], v[216:219]
    buffer_load_dwordx2 a[126:127], v1, s[16:19], s82 offen offset:8 sc1
    v_mfma_f32_16x16x32_bf16 v[220:223], a[32:35], a[116:119], 0
    ds_read_b64_tr_b16 a[12:13], v18 offset:28672
    v_and_b32 v93, s83, v93
    v_mfma_f32_16x16x32_bf16 v[220:223], a[28:31], a[100:103], v[220:223]
    ds_read_b64_tr_b16 a[14:15], v18 offset:30720
    v_and_b32 v95, s83, v95
    v_mfma_f32_16x16x32_bf16 v[220:223], a[24:27], a[84:87], v[220:223]
    v_mul_f32 v92, v92, v56
    v_mul_f32 v93, v93, v56
    v_mfma_f32_16x16x32_bf16 v[220:223], a[20:23], a[68:71], v[220:223]
    s_waitcnt lgkmcnt(0)
    v_mul_f32 v94, v94, v56
    v_mul_f32 v95, v95, v56
    v_mfma_f32_16x16x32_bf16 v[224:227], a[0:3], a[56:59], 0
    s_add_u32 s59, s81, 0
    ds_read_b64_tr_b16 a[20:21], v2 offset:32768
    v_mfma_f32_16x16x32_bf16 v[224:227], a[4:7], a[72:75], v[224:227]
    buffer_load_dwordx4 a[144:147], v1, s[16:19], s59 offen offset:2048 sc1
    v_mfma_f32_16x16x32_bf16 v[224:227], a[8:11], a[88:91], v[224:227]
    s_addk_i32 s59, 16384
    ds_read_b64_tr_b16 a[22:23], v2 offset:34816
    v_mfma_f32_16x16x32_bf16 v[224:227], a[12:15], a[104:107], v[224:227]
    buffer_load_dwordx4 a[160:163], v1, s[16:19], s59 offen offset:2048 sc1
    v_mfma_f32_16x16x32_bf16 v[228:231], a[12:15], a[108:111], 0
    ds_read_b64_tr_b16 a[24:25], v2 offset:36864
    v_mfma_f32_16x16x32_bf16 v[228:231], a[8:11], a[92:95], v[228:231]
    s_addk_i32 s59, 16384
    ds_read_b64_tr_b16 a[26:27], v2 offset:38912
    v_mfma_f32_16x16x32_bf16 v[228:231], a[4:7], a[76:79], v[228:231]
    buffer_load_dwordx4 a[176:179], v1, s[16:19], s59 offen offset:2048 sc1
    v_mfma_f32_16x16x32_bf16 v[228:231], a[0:3], a[60:63], v[228:231]
    s_addk_i32 s59, 16384
    ds_read_b64_tr_b16 a[28:29], v2 offset:40960
    v_mfma_f32_16x16x32_bf16 v[232:235], a[0:3], a[64:67], 0
    buffer_load_dwordx4 a[192:195], v1, s[16:19], s59 offen offset:2048 sc1
    v_mfma_f32_16x16x32_bf16 v[232:235], a[4:7], a[80:83], v[232:235]
    ds_read_b64_tr_b16 a[30:31], v2 offset:43008
    v_mfma_f32_16x16x32_bf16 v[232:235], a[8:11], a[96:99], v[232:235]
    ds_read_b64_tr_b16 a[32:33], v2 offset:45056
    v_mfma_f32_16x16x32_bf16 v[232:235], a[12:15], a[112:115], v[232:235]
    buffer_load_dwordx2 a[130:131], v1, s[16:19], s82 offen offset:1024 sc1
    v_mfma_f32_16x16x32_bf16 v[236:239], a[12:15], a[116:119], 0
    ds_read_b64_tr_b16 a[34:35], v2 offset:47104
    v_mfma_f32_16x16x32_bf16 v[236:239], a[8:11], a[100:103], v[236:239]
    ds_read_b64_tr_b16 a[36:37], v2 offset:49152
    v_mfma_f32_16x16x32_bf16 v[236:239], a[4:7], a[84:87], v[236:239]
    ds_read_b64_tr_b16 a[38:39], v2 offset:51200
    v_mfma_f32_16x16x32_bf16 v[236:239], a[0:3], a[68:71], v[236:239]
    s_waitcnt lgkmcnt(0)
    s_add_u32 s59, s81, 0
    buffer_load_dwordx4 a[148:151], v1, s[16:19], s59 offen offset:3072 sc1
    s_addk_i32 s59, 16384
    buffer_load_dwordx4 a[164:167], v1, s[16:19], s59 offen offset:3072 sc1
    s_addk_i32 s59, 16384
    buffer_load_dwordx4 a[180:183], v1, s[16:19], s59 offen offset:3072 sc1
    s_addk_i32 s59, 16384
    buffer_load_dwordx4 a[196:199], v1, s[16:19], s59 offen offset:3072 sc1
    buffer_load_dwordx2 a[134:135], v1, s[16:19], s82 offen offset:1032 sc1
    s_waitcnt vmcnt(15)
    v_mfma_f32_16x16x32_bf16 v[96:99], a[20:23], a[136:139], v[96:99]
    s_add_u32 s45, s42, 0
    ds_read_b64_tr_b16 a[0:1], v3 offset:32768
    v_mfma_f32_16x16x32_bf16 v[96:99], a[24:27], a[152:155], v[96:99]
    buffer_load_dword v27, v26, s[16:19], s45 offen sc1
    v_mfma_f32_16x16x32_bf16 v[96:99], a[28:31], a[168:171], v[96:99]
    ds_read_b64_tr_b16 a[2:3], v3 offset:34816
    v_mfma_f32_16x16x32_bf16 v[96:99], a[32:35], a[184:187], v[96:99]
    ds_read_b64_tr_b16 a[4:5], v3 offset:36864
    v_mfma_f32_16x16x32_bf16 v[96:99], a[36:39], a[120:123], v[96:99]
    s_waitcnt vmcnt(11)
    ds_read_b64_tr_b16 a[6:7], v3 offset:38912
    v_mfma_f32_16x16x32_bf16 v[100:103], a[20:23], a[140:143], v[100:103]
    ds_read_b64_tr_b16 a[8:9], v3 offset:40960
    v_mfma_f32_16x16x32_bf16 v[100:103], a[24:27], a[156:159], v[100:103]
    ds_read_b64_tr_b16 a[10:11], v3 offset:43008
    v_mfma_f32_16x16x32_bf16 v[100:103], a[28:31], a[172:175], v[100:103]
    ds_read_b64_tr_b16 a[12:13], v3 offset:45056
    v_mfma_f32_16x16x32_bf16 v[100:103], a[32:35], a[188:191], v[100:103]
    ds_read_b64_tr_b16 a[14:15], v3 offset:47104
    v_cvt_pk_bf16_f32 v32, v96, v97
    v_mfma_f32_16x16x32_bf16 v[100:103], a[36:39], a[124:127], v[100:103]
    s_waitcnt vmcnt(6)
    ds_read_b64_tr_b16 a[16:17], v3 offset:49152
    v_cvt_pk_bf16_f32 v33, v98, v99
    v_mfma_f32_16x16x32_bf16 v[104:107], a[20:23], a[144:147], v[104:107]
    ds_read_b64_tr_b16 a[18:19], v3 offset:51200
    v_mfma_f32_16x16x32_bf16 v[104:107], a[24:27], a[160:163], v[104:107]
    v_mfma_f32_16x16x32_bf16 v[104:107], a[28:31], a[176:179], v[104:107]
    v_mfma_f32_16x16x32_bf16 v[104:107], a[32:35], a[192:195], v[104:107]
    v_cvt_pk_bf16_f32 v36, v100, v101
    v_mfma_f32_16x16x32_bf16 v[104:107], a[36:39], a[128:131], v[104:107]
    s_waitcnt vmcnt(1)
    v_cvt_pk_bf16_f32 v37, v102, v103
    v_mfma_f32_16x16x32_bf16 v[108:111], a[20:23], a[148:151], v[108:111]
    v_mfma_f32_16x16x32_bf16 v[108:111], a[24:27], a[164:167], v[108:111]
    v_mfma_f32_16x16x32_bf16 v[108:111], a[28:31], a[180:183], v[108:111]
    s_nop 0
    v_mfma_f32_16x16x32_bf16 v[108:111], a[32:35], a[196:199], v[108:111]
    s_waitcnt vmcnt(21) lgkmcnt(0)
    v_cvt_pk_bf16_f32 v40, v104, v105
    v_mfma_f32_16x16x32_bf16 v[108:111], a[36:39], a[132:135], v[108:111]
    s_barrier
    v_cvt_pk_bf16_f32 v41, v106, v107
    v_mfma_f32_16x16x32_bf16 v[112:115], a[0:3], a[136:139], v[112:115]
    ds_read_b64_tr_b16 a[20:21], v16 offset:0
    v_mfma_f32_16x16x32_bf16 v[112:115], a[4:7], a[152:155], v[112:115]
    ds_read_b64_tr_b16 a[22:23], v16 offset:2048
    v_mfma_f32_16x16x32_bf16 v[112:115], a[8:11], a[168:171], v[112:115]
    ds_read_b64_tr_b16 a[24:25], v16 offset:4096
    v_mfma_f32_16x16x32_bf16 v[112:115], a[12:15], a[184:187], v[112:115]
    ds_read_b64_tr_b16 a[26:27], v16 offset:6144
    v_cvt_pk_bf16_f32 v44, v108, v109
    v_mfma_f32_16x16x32_bf16 v[112:115], a[16:19], a[120:123], v[112:115]
    ds_read_b64_tr_b16 a[28:29], v16 offset:8192
    v_cvt_pk_bf16_f32 v45, v110, v111
    v_mfma_f32_16x16x32_bf16 v[116:119], a[16:19], a[124:127], v[116:119]
    ds_read_b64_tr_b16 a[30:31], v16 offset:10240
    v_mfma_f32_16x16x32_bf16 v[116:119], a[12:15], a[188:191], v[116:119]
    ds_read_b64_tr_b16 a[32:33], v16 offset:12288
    v_mfma_f32_16x16x32_bf16 v[116:119], a[8:11], a[172:175], v[116:119]
    ds_read_b64_tr_b16 a[34:35], v16 offset:14336
    v_mfma_f32_16x16x32_bf16 v[116:119], a[4:7], a[156:159], v[116:119]
    ds_read_b64_tr_b16 a[36:37], v16 offset:16384
    v_cvt_pk_bf16_f32 v34, v112, v113
    v_mfma_f32_16x16x32_bf16 v[116:119], a[0:3], a[140:143], v[116:119]
    ds_read_b64_tr_b16 a[38:39], v16 offset:18432
    v_cvt_pk_bf16_f32 v35, v114, v115
    v_mfma_f32_16x16x32_bf16 v[120:123], a[0:3], a[144:147], v[120:123]
    buffer_store_dwordx4 v[32:35], v4, s[16:19], s43 offen sc1
    v_mfma_f32_16x16x32_bf16 v[120:123], a[4:7], a[160:163], v[120:123]
    v_mfma_f32_16x16x32_bf16 v[120:123], a[8:11], a[176:179], v[120:123]
    v_mfma_f32_16x16x32_bf16 v[120:123], a[12:15], a[192:195], v[120:123]
    s_nop 0
    v_cvt_pk_bf16_f32 v38, v116, v117
    v_mfma_f32_16x16x32_bf16 v[120:123], a[16:19], a[128:131], v[120:123]
    v_cvt_pk_bf16_f32 v39, v118, v119
    v_mfma_f32_16x16x32_bf16 v[124:127], a[16:19], a[132:135], v[124:127]
    buffer_store_dwordx4 v[36:39], v5, s[16:19], s43 offen sc1
    v_mfma_f32_16x16x32_bf16 v[124:127], a[12:15], a[196:199], v[124:127]
    v_mfma_f32_16x16x32_bf16 v[124:127], a[8:11], a[180:183], v[124:127]
    s_nop 0
    v_mfma_f32_16x16x32_bf16 v[124:127], a[4:7], a[164:167], v[124:127]
    s_nop 0
    v_cvt_pk_bf16_f32 v42, v120, v121
    v_mfma_f32_16x16x32_bf16 v[124:127], a[0:3], a[148:151], v[124:127]
    s_waitcnt vmcnt(2) lgkmcnt(0)
    v_cvt_pk_bf16_f32 v43, v122, v123
    v_mfma_f32_16x16x32_bf16 v[128:131], a[20:23], a[136:139], v[128:131]
    ds_read_b64_tr_b16 a[0:1], v17 offset:0
    v_cmp_gt_u32 vcc, 1, v27
    v_mfma_f32_16x16x32_bf16 v[128:131], a[24:27], a[152:155], v[128:131]
    ds_read_b64_tr_b16 a[2:3], v17 offset:2048
    v_mfma_f32_16x16x32_bf16 v[128:131], a[28:31], a[168:171], v[128:131]
    s_and_b32 s55, vcc_lo, 0xfff
    ds_read_b64_tr_b16 a[4:5], v17 offset:4096
    s_cbranch_scc0 L_spA3r
    s_mov_b32 s41, 0
L_spA3b:
    buffer_load_dword v27, v26, s[16:19], s45 offen sc1
    s_add_u32 s41, s41, 1
    s_cmp_gt_u32 s41, 200000
    s_cbranch_scc1 L_spA3r
    s_waitcnt vmcnt(0)
    v_cmp_gt_u32 vcc, 1, v27
    s_nop 1
    s_and_b32 s55, vcc_lo, 0xfff
    s_cbranch_scc1 L_spA3b
L_spA3r:
    v_mfma_f32_16x16x32_bf16 v[128:131], a[32:35], a[184:187], v[128:131]
    ds_read_b64_tr_b16 a[6:7], v17 offset:6144
    v_cvt_pk_bf16_f32 v46, v124, v125
    v_mfma_f32_16x16x32_bf16 v[128:131], a[36:39], a[120:123], v[128:131]
    buffer_store_dwordx4 v[40:43], v6, s[16:19], s43 offen sc1
    v_mfma_f32_16x16x32_bf16 v[132:135], a[36:39], a[124:127], v[132:135]
    ds_read_b64_tr_b16 a[8:9], v17 offset:8192
    v_cvt_pk_bf16_f32 v47, v126, v127
    v_mfma_f32_16x16x32_bf16 v[132:135], a[32:35], a[188:191], v[132:135]
    buffer_store_dwordx4 v[44:47], v7, s[16:19], s43 offen sc1
    v_mfma_f32_16x16x32_bf16 v[132:135], a[28:31], a[172:175], v[132:135]
    s_add_u32 s43, s43, 1048576
    ds_read_b64_tr_b16 a[10:11], v17 offset:10240
    v_mfma_f32_16x16x32_bf16 v[132:135], a[24:27], a[156:159], v[132:135]
    ds_read_b64_tr_b16 a[12:13], v17 offset:12288
    v_cvt_pk_bf16_f32 v32, v128, v129
    v_mfma_f32_16x16x32_bf16 v[132:135], a[20:23], a[140:143], v[132:135]
    s_add_u32 s59, s40, 0
    ds_read_b64_tr_b16 a[14:15], v17 offset:14336
    v_cvt_pk_bf16_f32 v33, v130, v131
    v_mfma_f32_16x16x32_bf16 v[136:139], a[20:23], a[144:147], v[136:139]
    buffer_load_dwordx4 a[56:59], v1, s[16:19], s59 offen offset:0 sc1
    v_mfma_f32_16x16x32_bf16 v[136:139], a[24:27], a[160:163], v[136:139]
    s_add_u32 s59, s40, 0
    ds_read_b64_tr_b16 a[16:17], v17 offset:16384
    v_mfma_f32_16x16x32_bf16 v[136:139], a[28:31], a[176:179], v[136:139]
    buffer_load_dwordx4 a[60:63], v1, s[16:19], s59 offen offset:1024 sc1
    v_mfma_f32_16x16x32_bf16 v[136:139], a[32:35], a[192:195], v[136:139]
    ds_read_b64_tr_b16 a[18:19], v17 offset:18432
    v_cvt_pk_bf16_f32 v36, v132, v133
    v_mfma_f32_16x16x32_bf16 v[136:139], a[36:39], a[128:131], v[136:139]
    v_cvt_pk_bf16_f32 v37, v134, v135
    v_mfma_f32_16x16x32_bf16 v[140:143], a[36:39], a[132:135], v[140:143]
    v_mfma_f32_16x16x32_bf16 v[140:143], a[32:35], a[196:199], v[140:143]
    s_nop 0
    v_mfma_f32_16x16x32_bf16 v[140:143], a[28:31], a[180:183], v[140:143]
    s_nop 0
    v_mfma_f32_16x16x32_bf16 v[140:143], a[24:27], a[164:167], v[140:143]
    s_nop 0
    v_cvt_pk_bf16_f32 v40, v136, v137
    v_mfma_f32_16x16x32_bf16 v[140:143], a[20:23], a[148:151], v[140:143]
    s_waitcnt lgkmcnt(0)
    v_cvt_pk_bf16_f32 v41, v138, v139
    v_mfma_f32_16x16x32_bf16 v[144:147], a[0:3], a[136:139], v[144:147]
    s_add_u32 s59, s40, 0
    ds_read_b64_tr_b16 a[20:21], v16 offset:20480
    v_mfma_f32_16x16x32_bf16 v[144:147], a[4:7], a[152:155], v[144:147]
    buffer_load_dwordx4 a[64:67], v1, s[16:19], s59 offen offset:2048 sc1
    v_mfma_f32_16x16x32_bf16 v[144:147], a[8:11], a[168:171], v[144:147]
    ds_read_b64_tr_b16 a[22:23], v16 offset:22528
    v_mfma_f32_16x16x32_bf16 v[144:147], a[12:15], a[184:187], v[144:147]
    ds_read_b64_tr_b16 a[24:25], v16 offset:24576
    v_cvt_pk_bf16_f32 v44, v140, v141
    v_mfma_f32_16x16x32_bf16 v[144:147], a[16:19], a[120:123], v[144:147]
    ds_read_b64_tr_b16 a[26:27], v16 offset:26624
    v_cvt_pk_bf16_f32 v45, v142, v143
    v_mfma_f32_16x16x32_bf16 v[148:151], a[16:19], a[124:127], v[148:151]
    ds_read_b64_tr_b16 a[28:29], v16 offset:28672
    v_mfma_f32_16x16x32_bf16 v[148:151], a[12:15], a[188:191], v[148:151]
    ds_read_b64_tr_b16 a[30:31], v16 offset:30720
    v_mfma_f32_16x16x32_bf16 v[148:151], a[8:11], a[172:175], v[148:151]
    ds_read_b64_tr_b16 a[32:33], v16 offset:32768
    v_mfma_f32_16x16x32_bf16 v[148:151], a[4:7], a[156:159], v[148:151]
    ds_read_b64_tr_b16 a[34:35], v16 offset:34816
    v_cvt_pk_bf16_f32 v34, v144, v145
    v_mfma_f32_16x16x32_bf16 v[148:151], a[0:3], a[140:143], v[148:151]
    ds_read_b64_tr_b16 a[36:37], v16 offset:36864
    v_cvt_pk_bf16_f32 v35, v146, v147
    v_mfma_f32_16x16x32_bf16 v[152:155], a[0:3], a[144:147], v[152:155]
    buffer_store_dwordx4 v[32:35], v4, s[16:19], s43 offen sc1
    v_mfma_f32_16x16x32_bf16 v[152:155], a[4:7], a[160:163], v[152:155]
    s_add_u32 s59, s40, 524288
    ds_read_b64_tr_b16 a[38:39], v16 offset:38912
    v_mfma_f32_16x16x32_bf16 v[152:155], a[8:11], a[176:179], v[152:155]
    buffer_load_dwordx4 a[68:71], v1, s[16:19], s59 offen offset:0 sc1
    v_mfma_f32_16x16x32_bf16 v[152:155], a[12:15], a[192:195], v[152:155]
    v_cvt_pk_bf16_f32 v38, v148, v149
    v_mfma_f32_16x16x32_bf16 v[152:155], a[16:19], a[128:131], v[152:155]
    v_cvt_pk_bf16_f32 v39, v150, v151
    v_mfma_f32_16x16x32_bf16 v[156:159], a[16:19], a[132:135], v[156:159]
    buffer_store_dwordx4 v[36:39], v5, s[16:19], s43 offen sc1
    v_mfma_f32_16x16x32_bf16 v[156:159], a[12:15], a[196:199], v[156:159]
    v_mfma_f32_16x16x32_bf16 v[156:159], a[8:11], a[180:183], v[156:159]
    s_nop 0
    v_mfma_f32_16x16x32_bf16 v[156:159], a[4:7], a[164:167], v[156:159]
    s_nop 0
    v_cvt_pk_bf16_f32 v42, v152, v153
    v_mfma_f32_16x16x32_bf16 v[156:159], a[0:3], a[148:151], v[156:159]
    s_waitcnt lgkmcnt(0)
    v_cvt_pk_bf16_f32 v43, v154, v155
    v_mfma_f32_16x16x32_bf16 v[160:163], a[20:23], a[136:139], v[160:163]
    ds_read_b64_tr_b16 a[0:1], v17 offset:20480
    v_mfma_f32_16x16x32_bf16 v[160:163], a[24:27], a[152:155], v[160:163]
    buffer_store_dwordx4 v[40:43], v6, s[16:19], s43 offen sc1
    v_mfma_f32_16x16x32_bf16 v[160:163], a[28:31], a[168:171], v[160:163]
    ds_read_b64_tr_b16 a[2:3], v17 offset:22528
    v_mfma_f32_16x16x32_bf16 v[160:163], a[32:35], a[184:187], v[160:163]
    ds_read_b64_tr_b16 a[4:5], v17 offset:24576
    v_cvt_pk_bf16_f32 v46, v156, v157
    v_mfma_f32_16x16x32_bf16 v[160:163], a[36:39], a[120:123], v[160:163]
    ds_read_b64_tr_b16 a[6:7], v17 offset:26624
    v_cvt_pk_bf16_f32 v47, v158, v159
    v_mfma_f32_16x16x32_bf16 v[164:167], a[36:39], a[124:127], v[164:167]
    buffer_store_dwordx4 v[44:47], v7, s[16:19], s43 offen sc1
    v_mfma_f32_16x16x32_bf16 v[164:167], a[32:35], a[188:191], v[164:167]
    s_add_u32 s43, s43, 3145728
    ds_read_b64_tr_b16 a[8:9], v17 offset:28672
    s_addk_i32 s59, 0
    v_mfma_f32_16x16x32_bf16 v[164:167], a[28:31], a[172:175], v[164:167]
    buffer_load_dwordx4 a[72:75], v1, s[16:19], s59 offen offset:1024 sc1
    v_mfma_f32_16x16x32_bf16 v[164:167], a[24:27], a[156:159], v[164:167]
    ds_read_b64_tr_b16 a[10:11], v17 offset:30720
    v_cvt_pk_bf16_f32 v32, v160, v161
    v_mfma_f32_16x16x32_bf16 v[164:167], a[20:23], a[140:143], v[164:167]
    s_addk_i32 s59, 0
    ds_read_b64_tr_b16 a[12:13], v17 offset:32768
    v_cvt_pk_bf16_f32 v33, v162, v163
    v_mfma_f32_16x16x32_bf16 v[168:171], a[20:23], a[144:147], v[168:171]
    buffer_load_dwordx4 a[76:79], v1, s[16:19], s59 offen offset:2048 sc1
    v_mfma_f32_16x16x32_bf16 v[168:171], a[24:27], a[160:163], v[168:171]
    ds_read_b64_tr_b16 a[14:15], v17 offset:34816
    v_mfma_f32_16x16x32_bf16 v[168:171], a[28:31], a[176:179], v[168:171]
    ds_read_b64_tr_b16 a[16:17], v17 offset:36864
    v_mfma_f32_16x16x32_bf16 v[168:171], a[32:35], a[192:195], v[168:171]
    ds_read_b64_tr_b16 a[18:19], v17 offset:38912
    v_cvt_pk_bf16_f32 v36, v164, v165
    v_mfma_f32_16x16x32_bf16 v[168:171], a[36:39], a[128:131], v[168:171]
    v_cvt_pk_bf16_f32 v37, v166, v167
    v_mfma_f32_16x16x32_bf16 v[172:175], a[36:39], a[132:135], v[172:175]
    v_mfma_f32_16x16x32_bf16 v[172:175], a[32:35], a[196:199], v[172:175]
    s_nop 0
    v_mfma_f32_16x16x32_bf16 v[172:175], a[28:31], a[180:183], v[172:175]
    s_nop 0
    v_mfma_f32_16x16x32_bf16 v[172:175], a[24:27], a[164:167], v[172:175]
    s_nop 0
    v_cvt_pk_bf16_f32 v40, v168, v169
    v_mfma_f32_16x16x32_bf16 v[172:175], a[20:23], a[148:151], v[172:175]
    s_waitcnt lgkmcnt(0)
    v_cvt_pk_bf16_f32 v41, v170, v171
    v_mfma_f32_16x16x32_bf16 v[176:179], a[0:3], a[136:139], v[176:179]
    s_add_u32 s59, s40, 1048576
    ds_read_b64_tr_b16 a[20:21], v10 offset:0
    v_mfma_f32_16x16x32_bf16 v[176:179], a[4:7], a[152:155], v[176:179]
    buffer_load_dwordx4 a[80:83], v1, s[16:19], s59 offen offset:0 sc1
    v_mfma_f32_16x16x32_bf16 v[176:179], a[8:11], a[168:171], v[176:179]
    ds_read_b64_tr_b16 a[22:23], v10 offset:2048
    v_mfma_f32_16x16x32_bf16 v[176:179], a[12:15], a[184:187], v[176:179]
    ds_read_b64_tr_b16 a[24:25], v10 offset:4096
    v_cvt_pk_bf16_f32 v44, v172, v173
    v_mfma_f32_16x16x32_bf16 v[176:179], a[16:19], a[120:123], v[176:179]
    ds_read_b64_tr_b16 a[26:27], v10 offset:6144
    v_cvt_pk_bf16_f32 v45, v174, v175
    v_mfma_f32_16x16x32_bf16 v[180:183], a[16:19], a[124:127], v[180:183]
    ds_read_b64_tr_b16 a[28:29], v10 offset:8192
    v_mfma_f32_16x16x32_bf16 v[180:183], a[12:15], a[188:191], v[180:183]
    ds_read_b64_tr_b16 a[30:31], v10 offset:10240
    v_mfma_f32_16x16x32_bf16 v[180:183], a[8:11], a[172:175], v[180:183]
    ds_read_b64_tr_b16 a[32:33], v10 offset:12288
    v_mfma_f32_16x16x32_bf16 v[180:183], a[4:7], a[156:159], v[180:183]
    ds_read_b64_tr_b16 a[34:35], v10 offset:14336
    v_cvt_pk_bf16_f32 v34, v176, v177
    v_mfma_f32_16x16x32_bf16 v[180:183], a[0:3], a[140:143], v[180:183]
    ds_read_b64_tr_b16 a[36:37], v10 offset:16384
    v_cvt_pk_bf16_f32 v35, v178, v179
    v_mfma_f32_16x16x32_bf16 v[184:187], a[0:3], a[144:147], v[184:187]
    buffer_store_dwordx4 v[32:35], v4, s[16:19], s43 offen sc1
    v_mfma_f32_16x16x32_bf16 v[184:187], a[4:7], a[160:163], v[184:187]
    s_addk_i32 s59, 0
    ds_read_b64_tr_b16 a[38:39], v10 offset:18432
    v_mfma_f32_16x16x32_bf16 v[184:187], a[8:11], a[176:179], v[184:187]
    buffer_load_dwordx4 a[84:87], v1, s[16:19], s59 offen offset:1024 sc1
    v_mfma_f32_16x16x32_bf16 v[184:187], a[12:15], a[192:195], v[184:187]
    v_cvt_pk_bf16_f32 v38, v180, v181
    v_mfma_f32_16x16x32_bf16 v[184:187], a[16:19], a[128:131], v[184:187]
    v_cvt_pk_bf16_f32 v39, v182, v183
    v_mfma_f32_16x16x32_bf16 v[188:191], a[16:19], a[132:135], v[188:191]
    buffer_store_dwordx4 v[36:39], v5, s[16:19], s43 offen sc1
    v_mfma_f32_16x16x32_bf16 v[188:191], a[12:15], a[196:199], v[188:191]
    v_mfma_f32_16x16x32_bf16 v[188:191], a[8:11], a[180:183], v[188:191]
    s_nop 0
    v_mfma_f32_16x16x32_bf16 v[188:191], a[4:7], a[164:167], v[188:191]
    s_nop 0
    v_cvt_pk_bf16_f32 v42, v184, v185
    v_mfma_f32_16x16x32_bf16 v[188:191], a[0:3], a[148:151], v[188:191]
    s_waitcnt lgkmcnt(0)
    v_cvt_pk_bf16_f32 v43, v186, v187
    v_mfma_f32_16x16x32_bf16 v[192:195], a[20:23], a[136:139], v[192:195]
    ds_read_b64_tr_b16 a[0:1], v11 offset:0
    v_mfma_f32_16x16x32_bf16 v[192:195], a[24:27], a[152:155], v[192:195]
    buffer_store_dwordx4 v[40:43], v6, s[16:19], s43 offen sc1
    v_mfma_f32_16x16x32_bf16 v[192:195], a[28:31], a[168:171], v[192:195]
    ds_read_b64_tr_b16 a[2:3], v11 offset:2048
    v_mfma_f32_16x16x32_bf16 v[192:195], a[32:35], a[184:187], v[192:195]
    ds_read_b64_tr_b16 a[4:5], v11 offset:4096
    v_cvt_pk_bf16_f32 v46, v188, v189
    v_mfma_f32_16x16x32_bf16 v[192:195], a[36:39], a[120:123], v[192:195]
L_stubA8:
    s_cbranch_execz L_stubA11
    s_nop 0
    ds_read_b64_tr_b16 a[6:7], v11 offset:6144
    v_cvt_pk_bf16_f32 v47, v190, v191
    v_mfma_f32_16x16x32_bf16 v[196:199], a[36:39], a[124:127], v[196:199]
    buffer_store_dwordx4 v[44:47], v7, s[16:19], s43 offen sc1
    v_mfma_f32_16x16x32_bf16 v[196:199], a[32:35], a[188:191], v[196:199]
    s_add_u32 s43, s43, 1048576
    ds_read_b64_tr_b16 a[8:9], v11 offset:8192
    s_addk_i32 s59, 0
    v_mfma_f32_16x16x32_bf16 v[196:199], a[28:31], a[172:175], v[196:199]
    buffer_load_dwordx4 a[88:91], v1, s[16:19], s59 offen offset:2048 sc1
    v_mfma_f32_16x16x32_bf16 v[196:199], a[24:27], a[156:159], v[196:199]
    ds_read_b64_tr_b16 a[10:11], v11 offset:10240
    v_cvt_pk_bf16_f32 v32, v192, v193
    v_mfma_f32_16x16x32_bf16 v[196:199], a[20:23], a[140:143], v[196:199]
    ds_read_b64_tr_b16 a[12:13], v11 offset:12288
    v_cvt_pk_bf16_f32 v33, v194, v195
    v_mfma_f32_16x16x32_bf16 v[200:203], a[20:23], a[144:147], v[200:203]
    ds_read_b64_tr_b16 a[14:15], v11 offset:14336
    v_mfma_f32_16x16x32_bf16 v[200:203], a[24:27], a[160:163], v[200:203]
    ds_read_b64_tr_b16 a[16:17], v11 offset:16384
    v_mfma_f32_16x16x32_bf16 v[200:203], a[28:31], a[176:179], v[200:203]
    ds_read_b64_tr_b16 a[18:19], v11 offset:18432
    v_mfma_f32_16x16x32_bf16 v[200:203], a[32:35], a[192:195], v[200:203]
    v_cvt_pk_bf16_f32 v36, v196, v197
    v_mfma_f32_16x16x32_bf16 v[200:203], a[36:39], a[128:131], v[200:203]
    v_cvt_pk_bf16_f32 v37, v198, v199
    v_mfma_f32_16x16x32_bf16 v[204:207], a[36:39], a[132:135], v[204:207]
    v_mfma_f32_16x16x32_bf16 v[204:207], a[32:35], a[196:199], v[204:207]
    s_nop 0
    v_mfma_f32_16x16x32_bf16 v[204:207], a[28:31], a[180:183], v[204:207]
    s_nop 0
    v_mfma_f32_16x16x32_bf16 v[204:207], a[24:27], a[164:167], v[204:207]
    s_nop 0
    v_cvt_pk_bf16_f32 v40, v200, v201
    v_mfma_f32_16x16x32_bf16 v[204:207], a[20:23], a[148:151], v[204:207]
    s_waitcnt lgkmcnt(0)
    v_cvt_pk_bf16_f32 v41, v202, v203
    v_mfma_f32_16x16x32_bf16 v[208:211], a[0:3], a[136:139], v[208:211]
    ds_read_b64_tr_b16 a[20:21], v19 offset:20480
    v_mfma_f32_16x16x32_bf16 v[208:211], a[4:7], a[152:155], v[208:211]
    ds_read_b64_tr_b16 a[22:23], v19 offset:22528
    v_mfma_f32_16x16x32_bf16 v[208:211], a[8:11], a[168:171], v[208:211]
    ds_read_b64_tr_b16 a[24:25], v19 offset:24576
    v_mfma_f32_16x16x32_bf16 v[208:211], a[12:15], a[184:187], v[208:211]
    ds_read_b64_tr_b16 a[26:27], v19 offset:26624
    v_cvt_pk_bf16_f32 v44, v204, v205
    v_mfma_f32_16x16x32_bf16 v[208:211], a[16:19], a[120:123], v[208:211]
    ds_read_b64_tr_b16 a[28:29], v19 offset:28672
    v_cvt_pk_bf16_f32 v45, v206, v207
    v_mfma_f32_16x16x32_bf16 v[212:215], a[16:19], a[124:127], v[212:215]
    ds_read_b64_tr_b16 a[30:31], v19 offset:30720
    v_mfma_f32_16x16x32_bf16 v[212:215], a[12:15], a[188:191], v[212:215]
    ds_read_b64_tr_b16 a[32:33], v19 offset:32768
    v_mfma_f32_16x16x32_bf16 v[212:215], a[8:11], a[172:175], v[212:215]
    ds_read_b64_tr_b16 a[34:35], v19 offset:34816
    v_mfma_f32_16x16x32_bf16 v[212:215], a[4:7], a[156:159], v[212:215]
    ds_read_b64_tr_b16 a[36:37], v19 offset:36864
    v_cvt_pk_bf16_f32 v34, v208, v209
    v_mfma_f32_16x16x32_bf16 v[212:215], a[0:3], a[140:143], v[212:215]
    ds_read_b64_tr_b16 a[38:39], v19 offset:38912
    v_cvt_pk_bf16_f32 v35, v210, v211
    v_mfma_f32_16x16x32_bf16 v[216:219], a[0:3], a[144:147], v[216:219]
    buffer_store_dwordx4 v[32:35], v4, s[16:19], s43 offen sc1
    v_mfma_f32_16x16x32_bf16 v[216:219], a[4:7], a[160:163], v[216:219]
    v_mfma_f32_16x16x32_bf16 v[216:219], a[8:11], a[176:179], v[216:219]
    v_mfma_f32_16x16x32_bf16 v[216:219], a[12:15], a[192:195], v[216:219]
    s_nop 0
    v_cvt_pk_bf16_f32 v38, v212, v213
    v_mfma_f32_16x16x32_bf16 v[216:219], a[16:19], a[128:131], v[216:219]
    v_cvt_pk_bf16_f32 v39, v214, v215
    v_mfma_f32_16x16x32_bf16 v[220:223], a[16:19], a[132:135], v[220:223]
    buffer_store_dwordx4 v[36:39], v5, s[16:19], s43 offen sc1
    v_mfma_f32_16x16x32_bf16 v[220:223], a[12:15], a[196:199], v[220:223]
    v_mfma_f32_16x16x32_bf16 v[220:223], a[8:11], a[180:183], v[220:223]
    s_nop 0
    v_mfma_f32_16x16x32_bf16 v[220:223], a[4:7], a[164:167], v[220:223]
    s_nop 0
    v_cvt_pk_bf16_f32 v42, v216, v217
    v_mfma_f32_16x16x32_bf16 v[220:223], a[0:3], a[148:151], v[220:223]
    s_waitcnt lgkmcnt(0)
    v_cvt_pk_bf16_f32 v43, v218, v219
    v_mfma_f32_16x16x32_bf16 v[224:227], a[20:23], a[136:139], v[224:227]
    s_nop 0
    v_mfma_f32_16x16x32_bf16 v[224:227], a[24:27], a[152:155], v[224:227]
    buffer_store_dwordx4 v[40:43], v6, s[16:19], s43 offen sc1
    v_mfma_f32_16x16x32_bf16 v[224:227], a[28:31], a[168:171], v[224:227]
    s_nop 0
    v_mfma_f32_16x16x32_bf16 v[224:227], a[32:35], a[184:187], v[224:227]
    s_nop 0
    v_cvt_pk_bf16_f32 v46, v220, v221
    v_mfma_f32_16x16x32_bf16 v[224:227], a[36:39], a[120:123], v[224:227]
    v_cvt_pk_bf16_f32 v47, v222, v223
    v_mfma_f32_16x16x32_bf16 v[228:231], a[36:39], a[124:127], v[228:231]
    buffer_store_dwordx4 v[44:47], v7, s[16:19], s43 offen sc1
    v_mfma_f32_16x16x32_bf16 v[228:231], a[32:35], a[188:191], v[228:231]
    s_add_u32 s43, s43, 3145728
    v_mfma_f32_16x16x32_bf16 v[228:231], a[28:31], a[172:175], v[228:231]
    v_mfma_f32_16x16x32_bf16 v[228:231], a[24:27], a[156:159], v[228:231]
    s_nop 0
    v_cvt_pk_bf16_f32 v34, v224, v225
    v_mfma_f32_16x16x32_bf16 v[228:231], a[20:23], a[140:143], v[228:231]
    v_cvt_pk_bf16_f32 v35, v226, v227
    v_mfma_f32_16x16x32_bf16 v[232:235], a[20:23], a[144:147], v[232:235]
    buffer_store_dwordx4 v[32:35], v4, s[16:19], s43 offen sc1
    v_mfma_f32_16x16x32_bf16 v[232:235], a[24:27], a[160:163], v[232:235]
    v_mfma_f32_16x16x32_bf16 v[232:235], a[28:31], a[176:179], v[232:235]
    s_nop 0
    v_mfma_f32_16x16x32_bf16 v[232:235], a[32:35], a[192:195], v[232:235]
    s_nop 0
    v_cvt_pk_bf16_f32 v38, v228, v229
    v_mfma_f32_16x16x32_bf16 v[232:235], a[36:39], a[128:131], v[232:235]
    v_cvt_pk_bf16_f32 v39, v230, v231
    v_mfma_f32_16x16x32_bf16 v[236:239], a[36:39], a[132:135], v[236:239]
    buffer_store_dwordx4 v[36:39], v5, s[16:19], s43 offen sc1
    v_mfma_f32_16x16x32_bf16 v[236:239], a[32:35], a[196:199], v[236:239]
    v_mfma_f32_16x16x32_bf16 v[236:239], a[28:31], a[180:183], v[236:239]
    s_nop 0
    v_mfma_f32_16x16x32_bf16 v[236:239], a[24:27], a[164:167], v[236:239]
    s_nop 0
    v_cvt_pk_bf16_f32 v42, v232, v233
    v_mfma_f32_16x16x32_bf16 v[236:239], a[20:23], a[148:151], v[236:239]
    v_cvt_pk_bf16_f32 v43, v234, v235
    buffer_store_dwordx4 v[40:43], v6, s[16:19], s43 offen sc1
    s_nop 5
    v_cvt_pk_bf16_f32 v46, v236, v237
    v_cvt_pk_bf16_f32 v47, v238, v239
    buffer_store_dwordx4 v[44:47], v7, s[16:19], s43 offen sc1
    s_add_u32 s45, s42, 2048
    buffer_load_dword v27, v26, s[16:19], s45 offen sc1
L_stubA10:
    s_cbranch_execz L_jrA2
    s_nop 0
    v_lshrrev_b32 v72, 4, v0
    v_xor_b32 v72, s48, v72
    v_and_b32 v72, 1, v72
    v_cmp_eq_u32 vcc, 1, v72
    v_mov_b32 v72, 0
    v_mov_b32 v73, 0
    v_cndmask_b32 v74, v60, v62, vcc
    v_cndmask_b32 v75, v61, v63, vcc
    v_cndmask_b32 v68, v60, v64, vcc
    v_cndmask_b32 v69, v61, v65, vcc
    v_cndmask_b32 v70, v62, v66, vcc
    v_cndmask_b32 v71, v63, v67, vcc
    v_and_b32 v140, 7, v0
    v_mul_u32_u24 v140, 144, v140
    v_bfe_u32 v141, v0, 3, 1
    v_lshl_add_u32 v140, v141, 6, v140
    v_bfe_u32 v141, v0, 4, 1
    v_lshl_add_u32 v140, v141, 5, v140
    v_lshrrev_b32 v141, 5, v0
    v_mul_u32_u24 v141, 1152, v141
    s_lshl_b32 s55, s48, 3
    v_add3_u32 v57, v140, v141, s55
    v_lshrrev_b32 v140, 3, v0
    v_lshlrev_b32 v141, 4, v140
    s_mul_i32 s55, s48, 1152
    v_add3_u32 v58, v141, v1, s55
    v_readfirstlane_b32 s56, v49
    v_mul_u32_u24 v140, 2176, v140
    s_lshl_b32 s55, s48, 7
    s_add_u32 s55, s55, s3
    v_add3_u32 v59, v140, v1, s56
    s_add_u32 s70, s55, 128
    s_sub_u32 s67, s70, 1152
    s_min_u32 s70, s70, s67
    s_add_u32 s71, s55, 640
    s_sub_u32 s67, s71, 1152
    s_min_u32 s71, s71, s67
    s_cmp_lt_u32 s48, 2
    s_cselect_b32 s71, s71, 0x40000000
    s_add_u32 s72, s55, 896
    s_sub_u32 s67, s72, 1152
    s_min_u32 s72, s72, s67
    s_cmp_lt_u32 s48, 3
    s_cselect_b32 s72, s72, 0x40000000
    s_waitcnt vmcnt(1) lgkmcnt(0)
    s_barrier
    s_add_u32 s59, s42, 4096
    buffer_store_dword v54, v51, s[16:19], s59 offen sc1
    s_waitcnt vmcnt(1)
    s_mov_b32 s41, 0
    s_branch L_siA4c
L_siA4b:
    buffer_load_dword v27, v26, s[16:19], s45 offen sc1
    s_add_u32 s41, s41, 1
    s_cmp_gt_u32 s41, 200000
    s_cbranch_scc1 L_siA4r
    s_waitcnt vmcnt(0)
L_siA4c:
    v_cmp_gt_u32 vcc, 1, v27
    s_nop 1
    s_and_b32 s55, vcc_lo, 0xfff
    s_cbranch_scc1 L_siA4b
L_siA4r:
    s_add_u32 s59, s40, 1572864
    buffer_load_dwordx4 v[192:195], v1, s[16:19], s59 offen offset:0 sc1
    s_addk_i32 s59, 0
    buffer_load_dwordx4 v[196:199], v1, s[16:19], s59 offen offset:1024 sc1
    s_addk_i32 s59, 0
    buffer_load_dwordx4 v[200:203], v1, s[16:19], s59 offen offset:2048 sc1
    s_add_u32 s59, s40, 4194304
    buffer_load_dwordx4 v[204:207], v1, s[16:19], s59 offen offset:0 sc1
    s_addk_i32 s59, 0
    buffer_load_dwordx4 v[208:211], v1, s[16:19], s59 offen offset:1024 sc1
    s_addk_i32 s59, 0
    buffer_load_dwordx4 v[212:215], v1, s[16:19], s59 offen offset:2048 sc1
    s_add_u32 s45, s42, 4096
    buffer_load_dword v27, v26, s[16:19], s45 offen sc1
    v_mfma_f32_16x16x32_bf16 v[100:103], v[60:63], a[56:59], 0
    v_mfma_f32_16x16x32_bf16 v[100:103], v[60:63], a[60:63], v[100:103]
    v_mfma_f32_16x16x32_bf16 v[100:103], v[60:63], a[64:67], v[100:103]
    v_mfma_f32_16x16x32_bf16 v[100:103], v[64:67], a[68:71], v[100:103]
    v_mfma_f32_16x16x32_bf16 v[100:103], v[64:67], a[72:75], v[100:103]
    v_mfma_f32_16x16x32_bf16 v[100:103], v[64:67], a[76:79], v[100:103]
    v_mfma_f32_16x16x32_bf16 v[104:107], v[60:63], a[80:83], 0
    v_mfma_f32_16x16x32_bf16 v[104:107], v[60:63], a[84:87], v[104:107]
    v_mfma_f32_16x16x32_bf16 v[104:107], v[60:63], a[88:91], v[104:107]
    s_waitcnt vmcnt(0)
    s_mov_b32 s41, 0
    s_branch L_siA5c
L_siA5b:
    buffer_load_dword v27, v26, s[16:19], s45 offen sc1
    s_add_u32 s41, s41, 1
    s_cmp_gt_u32 s41, 200000
    s_cbranch_scc1 L_siA5r
    s_waitcnt vmcnt(0)
L_siA5c:
    v_cmp_gt_u32 vcc, 1, v27
    s_nop 1
    s_and_b32 s55, vcc_lo, 0xfff
    s_cbranch_scc1 L_siA5b
L_siA5r:
    s_add_u32 s59, s40, 4718592
    buffer_load_dwordx4 v[216:219], v1, s[16:19], s59 offen offset:0 sc1
    s_addk_i32 s59, 0
    buffer_load_dwordx4 v[220:223], v1, s[16:19], s59 offen offset:1024 sc1
    s_addk_i32 s59, 0
    buffer_load_dwordx4 a[0:3], v1, s[16:19], s59 offen offset:2048 sc1
    s_add_u32 s59, s40, 5242880
    buffer_load_dwordx4 a[4:7], v1, s[16:19], s59 offen offset:0 sc1
    s_addk_i32 s59, 0
    buffer_load_dwordx4 a[8:11], v1, s[16:19], s59 offen offset:1024 sc1
    s_addk_i32 s59, 0
    buffer_load_dwordx4 a[12:15], v1, s[16:19], s59 offen offset:2048 sc1
    s_mov_b32 s41, 0
    s_branch L_siA6c
L_siA6b:
    buffer_load_dword v27, v26, s[16:19], s45 offen sc1
    s_add_u32 s41, s41, 1
    s_cmp_gt_u32 s41, 200000
    s_cbranch_scc1 L_siA6r
    s_waitcnt vmcnt(0)
L_siA6c:
    v_cmp_gt_u32 vcc, 1, v27
    s_nop 1
    s_and_b32 s55, vcc_lo, 0xf000
    s_cbranch_scc1 L_siA6b
L_siA6r:
    s_add_u32 s59, s40, 0
    buffer_load_dwordx4 a[16:19], v1, s[16:19], s59 offen offset:3072 sc1
    s_add_u32 s59, s40, 1048576
    buffer_load_dwordx4 a[20:23], v1, s[16:19], s59 offen offset:3072 sc1
    s_add_u32 s59, s40, 4194304
    buffer_load_dwordx4 a[24:27], v1, s[16:19], s59 offen offset:3072 sc1
    s_add_u32 s59, s40, 5242880
    buffer_load_dwordx4 a[28:31], v1, s[16:19], s59 offen offset:3072 sc1
    s_add_u32 s59, s40, 8388608
    buffer_load_dwordx4 a[32:35], v1, s[16:19], s59 offen offset:3072 sc1
    s_add_u32 s45, s42, 6144
    buffer_load_dword v27, v26, s[16:19], s45 offen sc1
    s_waitcnt vmcnt(18)
    v_mfma_f32_16x16x32_bf16 v[104:107], v[64:67], v[192:195], v[104:107]
    s_waitcnt vmcnt(17)
    v_mfma_f32_16x16x32_bf16 v[104:107], v[64:67], v[196:199], v[104:107]
    s_waitcnt vmcnt(16)
    v_mfma_f32_16x16x32_bf16 v[104:107], v[64:67], v[200:203], v[104:107]
    s_waitcnt vmcnt(15)
    v_mfma_f32_16x16x32_bf16 v[108:111], v[60:63], v[204:207], 0
    s_waitcnt vmcnt(14)
    v_mfma_f32_16x16x32_bf16 v[108:111], v[60:63], v[208:211], v[108:111]
    s_waitcnt vmcnt(13)
    v_mfma_f32_16x16x32_bf16 v[108:111], v[60:63], v[212:215], v[108:111]
    s_waitcnt vmcnt(11)
    v_mfma_f32_16x16x32_bf16 v[108:111], v[64:67], v[216:219], v[108:111]
    s_waitcnt vmcnt(10)
    v_mfma_f32_16x16x32_bf16 v[108:111], v[64:67], v[220:223], v[108:111]
    s_waitcnt vmcnt(9)
    v_mfma_f32_16x16x32_bf16 v[108:111], v[64:67], a[0:3], v[108:111]
    s_waitcnt vmcnt(8)
    v_mfma_f32_16x16x32_bf16 v[112:115], v[60:63], a[4:7], 0
    s_waitcnt vmcnt(7)
    v_mfma_f32_16x16x32_bf16 v[112:115], v[60:63], a[8:11], v[112:115]
    s_waitcnt vmcnt(6)
    v_mfma_f32_16x16x32_bf16 v[112:115], v[60:63], a[12:15], v[112:115]
    s_waitcnt vmcnt(5)
    v_mfma_f32_16x16x32_bf16 v[120:123], v[68:71], a[16:19], 0
    s_waitcnt vmcnt(4)
    v_mfma_f32_16x16x32_bf16 v[124:127], v[68:71], a[20:23], 0
L_stubA11:
    s_cbranch_execz L_jrA2
    s_nop 0
    s_waitcnt vmcnt(0)
    s_mov_b32 s41, 0
    s_branch L_siA7c
L_siA7b:
    buffer_load_dword v27, v26, s[16:19], s45 offen sc1
    s_add_u32 s41, s41, 1
    s_cmp_gt_u32 s41, 200000
    s_cbranch_scc1 L_siA7r
    s_waitcnt vmcnt(0)
L_siA7c:
    v_cmp_gt_u32 vcc, 1, v27
    s_nop 1
    s_and_b32 s55, vcc_lo, 0xfff
    s_cbranch_scc1 L_siA7b
L_siA7r:
    s_add_u32 s59, s40, 5767168
    buffer_load_dwordx4 a[36:39], v1, s[16:19], s59 offen offset:0 sc1
    s_addk_i32 s59, 0
    buffer_load_dwordx4 a[92:95], v1, s[16:19], s59 offen offset:1024 sc1
    s_addk_i32 s59, 0
    buffer_load_dwordx4 a[96:99], v1, s[16:19], s59 offen offset:2048 sc1
    s_add_u32 s59, s40, 8388608
    buffer_load_dwordx4 a[100:103], v1, s[16:19], s59 offen offset:0 sc1
    s_addk_i32 s59, 0
    buffer_load_dwordx4 a[104:107], v1, s[16:19], s59 offen offset:1024 sc1
    s_addk_i32 s59, 0
    buffer_load_dwordx4 a[108:111], v1, s[16:19], s59 offen offset:2048 sc1
    v_mfma_f32_16x16x32_bf16 v[128:131], v[68:71], a[24:27], 0
    v_mfma_f32_16x16x32_bf16 v[132:135], v[68:71], a[28:31], 0
    v_mfma_f32_16x16x32_bf16 v[136:139], v[72:75], a[32:35], 0
    v_fmac_f32 v76, v100, v56
    v_fmac_f32 v77, v101, v56
    v_fmac_f32 v78, v102, v56
    v_fmac_f32 v79, v103, v56
    v_fmac_f32 v76, v120, v55
    v_fmac_f32 v77, v121, v55
    v_fmac_f32 v78, v122, v55
    v_fmac_f32 v79, v123, v55
    v_cvt_pk_bf16_f32 v76, v76, v77
    v_cvt_pk_bf16_f32 v77, v78, v79
    ds_write_b64 v57, v[76:77] offset:0
    v_fmac_f32 v80, v104, v56
    v_fmac_f32 v81, v105, v56
    v_fmac_f32 v82, v106, v56
    v_fmac_f32 v83, v107, v56
    v_fmac_f32 v80, v124, v55
    v_fmac_f32 v81, v125, v55
    v_fmac_f32 v82, v126, v55
    v_fmac_f32 v83, v127, v55
    v_cvt_pk_bf16_f32 v80, v80, v81
    v_cvt_pk_bf16_f32 v81, v82, v83
    ds_write_b64 v57, v[80:81] offset:2304
    v_fmac_f32 v84, v108, v56
    v_fmac_f32 v85, v109, v56
    v_fmac_f32 v86, v110, v56
    v_fmac_f32 v87, v111, v56
    v_fmac_f32 v84, v128, v55
    v_fmac_f32 v85, v129, v55
    v_fmac_f32 v86, v130, v55
    v_fmac_f32 v87, v131, v55
    v_cvt_pk_bf16_f32 v84, v84, v85
    v_cvt_pk_bf16_f32 v85, v86, v87
    ds_write_b64 v57, v[84:85] offset:4608
    s_waitcnt lgkmcnt(0)
    s_barrier
    ds_read_b128 v[140:143], v58 offset:0
    ds_read_b128 v[144:147], v58 offset:4608
    s_waitcnt lgkmcnt(1)
    buffer_store_dwordx4 v[140:143], v59, s[32:35], s70 offen sc1
    s_waitcnt lgkmcnt(0)
    buffer_store_dwordx4 v[144:147], v59, s[32:35], s71 offen sc1
    s_waitcnt vmcnt(5)
    v_mfma_f32_16x16x32_bf16 v[112:115], v[64:67], a[36:39], v[112:115]
    v_mfma_f32_16x16x32_bf16 v[112:115], v[64:67], a[92:95], v[112:115]
    v_mfma_f32_16x16x32_bf16 v[112:115], v[64:67], a[96:99], v[112:115]
    s_waitcnt vmcnt(2)
    v_mfma_f32_16x16x32_bf16 v[116:119], v[60:63], a[100:103], 0
    v_mfma_f32_16x16x32_bf16 v[116:119], v[60:63], a[104:107], v[116:119]
    v_mfma_f32_16x16x32_bf16 v[116:119], v[60:63], a[108:111], v[116:119]
    s_nop 3
    v_fmac_f32 v88, v112, v56
    v_fmac_f32 v89, v113, v56
    v_fmac_f32 v90, v114, v56
    v_fmac_f32 v91, v115, v56
    v_fmac_f32 v88, v132, v55
    v_fmac_f32 v89, v133, v55
    v_fmac_f32 v90, v134, v55
    v_fmac_f32 v91, v135, v55
    v_cvt_pk_bf16_f32 v88, v88, v89
    v_cvt_pk_bf16_f32 v89, v90, v91
    ds_write_b64 v57, v[88:89] offset:6912
    v_fmac_f32 v92, v116, v56
    v_fmac_f32 v93, v117, v56
    v_fmac_f32 v94, v118, v56
    v_fmac_f32 v95, v119, v56
    v_fmac_f32 v92, v136, v55
    v_fmac_f32 v93, v137, v55
    v_fmac_f32 v94, v138, v55
    v_fmac_f32 v95, v139, v55
    v_cvt_pk_bf16_f32 v92, v92, v93
    v_cvt_pk_bf16_f32 v93, v94, v95
    ds_write_b64 v57, v[92:93] offset:9216
    s_waitcnt lgkmcnt(0)
    s_barrier
    ds_read_b128 v[150:153], v58 offset:6912
    s_waitcnt lgkmcnt(0)
    buffer_store_dwordx4 v[150:153], v59, s[32:35], s72 offen sc1
    s_endpgm
L_exit:
    s_endpgm
L_code_end:
.section .rodata,"a"
.p2align 6
.amdhsa_kernel gated_mix__sliding_local_dilated__dense_activation_squared_relu__prompt_kernel
  .amdhsa_next_free_vgpr 512
  .amdhsa_next_free_sgpr 102
  .amdhsa_accum_offset 256
  .amdhsa_group_segment_fixed_size 0
  .amdhsa_kernarg_size 96
  .amdhsa_user_sgpr_count 2
  .amdhsa_user_sgpr_kernarg_segment_ptr 1
  .amdhsa_system_sgpr_workgroup_id_x 1
.end_amdhsa_kernel
```
